```python
import torch

def _softmax(x, axis=-1):
    return torch.softmax(x, dim=axis)

def _gelu(x):
    return torch.nn.functional.gelu(x, approximate='tanh')

def _silu(x):
    return torch.nn.functional.silu(x)

def _sigmoid(x):
    return torch.sigmoid(x)

def _layernorm(x, axis=-1, eps=1e-05):
    m = x.mean(dim=axis, keepdim=True)
    v = x.var(dim=axis, keepdim=True, unbiased=False)
    return (x - m) / torch.sqrt(v + eps)

def _scatter_add(tgt, idx, src, axis=0):
    return tgt.clone().index_add_(axis, idx, src)

def _segment_sum(src, seg, n):
    out = torch.zeros((n,) + src.shape[1:], dtype=src.dtype)
    return out.index_add_(0, seg, src)

def _pad(x, pw):
    flat = tuple((v for pair in reversed(pw) for v in pair))
    return torch.nn.functional.pad(x, flat)
kernel_name = 'adaLN_cond__memory_aug_recurrent_mem_tr__mixer_channel_mlp__prompt'

def setup_inputs():

    _w = lambda a: (lambda t: t.to(torch.bfloat16) if t.is_floating_point() else t)(torch.as_tensor(a))

    def _A_setup():
        B, S, Dm = (1, 2048, 512)
        H, Dh = (32, 128)
        M, seg = (8, 32)
        seg = min(seg, S)
        S = S // seg * seg
        return {'x': _w((lambda *s: torch.randn(*s, dtype=torch.bfloat16) * 0.05)(B, S, Dm)), 'mem0': _w((lambda *s: torch.randn(*s, dtype=torch.bfloat16) * 0.4)(B, M, Dm)), 'Wq': _w((lambda *s: torch.randn(*s, dtype=torch.bfloat16) * 3.2)(Dm, H, Dh) * Dm ** (-0.5)), 'Wk': _w((lambda *s: torch.randn(*s, dtype=torch.bfloat16) * 3.2)(Dm, H, Dh) * Dm ** (-0.5)), 'Wv': _w((lambda *s: torch.randn(*s, dtype=torch.bfloat16) * 0.4)(Dm, H, Dh) * Dm ** (-0.5)), 'Wo': _w((lambda *s: torch.randn(*s, dtype=torch.bfloat16) * 0.4)(H, Dh, Dm) * (H * Dh) ** (-0.5)), 'seg_len': seg}
    _A_in = _A_setup()

    def _B_setup():
        B, S, D, F = (1, 2048, 512, 1792)
        return {'x': _w((lambda *s: torch.randn(*s, dtype=torch.bfloat16) * 0.05)(B, S, D)), 'w1': _w((lambda *s: torch.randn(*s, dtype=torch.bfloat16) * 3.2)(D, F) * D ** (-0.5)), 'b1': _w((lambda *s: torch.randn(*s, dtype=torch.bfloat16) * 0.1)(F)), 'w2': _w((lambda *s: torch.randn(*s, dtype=torch.bfloat16) * 0.1)(F, D) * F ** (-0.5)), 'b2': _w((lambda *s: torch.randn(*s, dtype=torch.bfloat16) * 0.1)(D))}
    _B_in = _B_setup()
    return {'A_x': _A_in['x'], 'A_mem0': _A_in['mem0'], 'A_Wq': _A_in['Wq'], 'A_Wk': _A_in['Wk'], 'A_Wv': _A_in['Wv'], 'A_Wo': _A_in['Wo'], 'A_seg_len': _A_in['seg_len'], 'B_x': _B_in['x'], 'B_w1': _B_in['w1'], 'B_b1': _B_in['b1'], 'B_w2': _B_in['w2'], 'B_b2': _B_in['b2'], 'c': _w((lambda *s: torch.randn(*s, dtype=torch.bfloat16) * 0.05)(1, 512) * 8.0), 'w_mod': _w((lambda *s: torch.randn(*s, dtype=torch.bfloat16) * 0.05)(512, 6 * 512) * 512 ** (-0.5) * 8.0)}

def reference(A_x, A_mem0, A_Wq, A_Wk, A_Wv, A_Wo, A_seg_len, B_x, B_w1, B_b1, B_w2, B_b2, c, w_mod):

    def _A_ref(x, mem0, Wq, Wk, Wv, Wo, seg_len):
        B, S, Dm = x.shape
        H, Dh = (Wq.shape[1], Wq.shape[2])
        M = mem0.shape[1]
        scale = Dh ** (-0.5)
        n_seg = S // seg_len
        L = M + seg_len
        idx = torch.arange(L)
        mask = (idx[:, None] < M) | (idx[:, None] >= idx[None, :])
        mem = mem0
        outs = []
        for s in range(n_seg):
            xs = x[:, s * seg_len:(s + 1) * seg_len, :].clone()
            h = torch.concatenate([mem, xs], axis=1)
            q = torch.einsum('btd,dhe->bhte', h, Wq)
            k = torch.einsum('btd,dhe->bhte', h, Wk)
            v = torch.einsum('btd,dhe->bhte', h, Wv)
            scores = torch.einsum('bhqe,bhke->bhqk', q, k) * scale
            scores = torch.where(mask[None, None], scores, -1000000000.0)
            p = _softmax(scores, axis=-1)
            o = torch.einsum('bhqk,bhke->bhqe', p, v)
            o = torch.einsum('bhte,hed->btd', o, Wo)
            mem = o[:, :M, :].clone()
            outs.append(o[:, M:, :])
        return torch.concatenate(outs, axis=1)

    def _B_ref(x, w1, b1, w2, b2):
        y = _layernorm(x, axis=-1)
        h = _gelu(torch.einsum('bsd,df->bsf', y, w1) + b1)
        return torch.einsum('bsf,fd->bsd', h, w2) + b2
    x = A_x
    mod = (_silu(c) @ w_mod).reshape(c.shape[0], 6, 1, -1)
    sa, ca, ga, sb, cb, gb = (mod[:, 0].clone(), mod[:, 1].clone(), mod[:, 2].clone(), mod[:, 3].clone(), mod[:, 4].clone(), mod[:, 5].clone())
    h = _layernorm(x, axis=-1) * (1 + ca) + sa
    x = x + ga * _A_ref(h, A_mem0, A_Wq, A_Wk, A_Wv, A_Wo, A_seg_len)
    h = _layernorm(x, axis=-1) * (1 + cb) + sb
    x = x + gb * _B_ref(h, B_w1, B_b1, B_w2, B_b2)
    return x
```

```asm
; @launch kernel=main_kernel grid=(256,1,1) block=(256,1,1) lds=160768
.amdgcn_target "amdgcn-amd-amdhsa--gfx950"
.text
.globl main_kernel
.p2align 8
.type main_kernel,@function
main_kernel:
    s_cmp_ge_u32 s2, 0x100
    s_cbranch_scc1 main_kernel_exit
    s_load_dwordx2 s[6:7], s[0:1], 0x80
    s_load_dwordx2 s[96:97], s[0:1], 0x78
    v_lshrrev_b32 v1, 6, v0
    s_nop 0
    v_readfirstlane_b32 s3, v1
    v_and_b32 v0, 63, v0
    s_getreg_b32 s4, hwreg(HW_REG_XCC_ID)
    s_and_b32 s4, s4, 15
    s_waitcnt lgkmcnt(0)
    s_and_b32 s97, s97, 0xffff
    s_mov_b32 s98, 0x100
    s_mov_b32 s99, 0x20000
    s_cmp_lg_u32 s3, 0
    s_cbranch_scc1 main_kernel_eldone
    s_mov_b64 exec, 1
    s_mov_b32 s12, -1
    s_mov_b32 s13, 0
    s_lshl_b32 s14, s4, 2
    v_mov_b32 v2, s14
    v_mov_b32 v3, 1
    buffer_atomic_add v3, v2, s[96:99], 0 offen sc0
    s_waitcnt vmcnt(0)
    v_readfirstlane_b32 s15, v3
    s_cmp_ge_u32 s15, 32
    s_cbranch_scc1 main_kernel_elstore
    v_mov_b32 v2, 64
    s_add_u32 s16, s4, 1
    s_cmp_lg_u32 s15, 31
    s_cbranch_scc1 main_kernel_no31
    v_mov_b32 v4, s16
    v_mov_b32 v5, 0
    buffer_atomic_cmpswap v[4:5], v2, s[96:99], 0 offen sc0
    s_waitcnt vmcnt(0)
main_kernel_no31:
    s_memrealtime s[18:19]
    s_waitcnt lgkmcnt(0)
main_kernel_elpoll:
    buffer_load_dword v4, v2, s[96:99], 0 offen sc1
    s_waitcnt vmcnt(0)
    v_readfirstlane_b32 s17, v4
    s_cmp_lg_u32 s17, 0
    s_cbranch_scc1 main_kernel_elgot
    s_memrealtime s[20:21]
    s_waitcnt lgkmcnt(0)
    s_sub_u32 s20, s20, s18
    s_cmp_lt_u32 s20, 0xc350
    s_cbranch_scc1 main_kernel_noto
    v_mov_b32 v4, 0x64
    v_mov_b32 v5, 0
    buffer_atomic_cmpswap v[4:5], v2, s[96:99], 0 offen sc0
    s_waitcnt vmcnt(0)
main_kernel_noto:
    s_sleep 2
    s_branch main_kernel_elpoll
main_kernel_elgot:
    s_cmp_eq_u32 s17, 0x64
    s_cbranch_scc1 main_kernel_elslow
    s_cmp_eq_u32 s17, s16
    s_cselect_b32 s12, s15, -1
    s_branch main_kernel_elstore
main_kernel_elslow:
    v_mov_b32 v2, 0x44
    v_mov_b32 v3, 1
    buffer_atomic_add v3, v2, s[96:99], 0 offen sc0
    s_waitcnt vmcnt(0)
    v_readfirstlane_b32 s15, v3
    s_mov_b32 s13, 1
    s_cmp_lt_u32 s15, 32
    s_cselect_b32 s12, s15, -1
main_kernel_elstore:
    v_mov_b32 v2, 0x7000
    v_mov_b32 v4, s12
    v_mov_b32 v5, s13
    ds_write_b64 v2, v[4:5]
    s_waitcnt lgkmcnt(0)
    s_mov_b64 exec, -1
main_kernel_eldone:
    s_barrier
    v_mov_b32 v2, 0x7000
    ds_read_b64 v[4:5], v2
    s_waitcnt lgkmcnt(0)
    v_readfirstlane_b32 s12, v4
    v_readfirstlane_b32 s13, v5
    s_cmp_ge_u32 s12, 32
    s_cbranch_scc1 w_entry
    s_add_u32 s8, s6, 0x396000
    s_addc_u32 s9, s7, 0
    s_and_b32 s9, s9, 0xffff
    s_mov_b32 s10, 0xc00000
    s_mov_b32 s11, 0x20000
    s_add_u32 s16, s6, 0xf96000
    s_addc_u32 s17, s7, 0
    s_and_b32 s17, s17, 0xffff
    s_mov_b32 s18, 0x400000
    s_mov_b32 s19, 0x20000
    s_add_u32 s20, s6, 0x2716000
    s_addc_u32 s21, s7, 0
    s_and_b32 s21, s21, 0xffff
    s_mov_b32 s22, 0x1000000
    s_mov_b32 s23, 0x20000
    s_add_u32 s24, s6, 0x3716000
    s_addc_u32 s25, s7, 0
    s_and_b32 s25, s25, 0xffff
    s_mov_b32 s26, 0x1000000
    s_mov_b32 s27, 0x20000
    s_add_u32 s28, s6, 0x14000
    s_addc_u32 s29, s7, 0
    s_and_b32 s29, s29, 0xffff
    s_mov_b32 s30, 0x82000
    s_mov_b32 s31, 0x20000
    s_add_u32 s32, s6, 0x96000
    s_addc_u32 s33, s7, 0
    s_and_b32 s33, s33, 0xffff
    s_mov_b32 s34, 0x80000
    s_mov_b32 s35, 0x20000
    s_add_u32 s36, s6, 0x116000
    s_addc_u32 s37, s7, 0
    s_and_b32 s37, s37, 0xffff
    s_mov_b32 s38, 0x80000
    s_mov_b32 s39, 0x20000
    s_add_u32 s40, s6, 0x4b16000
    s_addc_u32 s41, s7, 0
    s_and_b32 s41, s41, 0xffff
    s_mov_b32 s42, 0x400000
    s_mov_b32 s43, 0x20000
    v_lshlrev_b32 v1, 4, v0
    v_and_b32 v16, 15, v0
    v_lshrrev_b32 v17, 4, v0
    v_and_b32 v18, 7, v0
    v_lshrrev_b32 v19, 3, v0
    v_lshrrev_b32 v20, 2, v16
    v_lshlrev_b32 v20, 3, v20
    v_and_b32 v21, 3, v16
    v_add_u32 v20, v20, v21
    v_lshlrev_b32 v3, 13, v20
    v_lshl_add_u32 v3, v17, 4, v3
    v_add_u32 v4, 0x8000, v3
    v_lshlrev_b32 v5, 12, v20
    v_lshl_add_u32 v5, v17, 4, v5
    v_add_u32 v6, 0x4000, v5
    v_mov_b32 v22, 0x7ffffff0
    v_lshrrev_b32 v23, 1, v17
    v_and_b32 v24, 1, v17
    v_lshrrev_b32 v25, 2, v16
    v_lshl_add_u32 v25, v25, 1, v23
    v_lshlrev_b32 v7, 12, v25
    v_lshl_add_u32 v7, v21, 5, v7
    v_lshl_add_u32 v7, v24, 4, v7
    v_and_b32 v25, 10, v0
    v_cmp_eq_u32 vcc, 0, v25
    v_and_b32 v26, 1, v0
    v_lshl_add_u32 v27, v26, 2, v17
    v_bfe_u32 v28, v0, 2, 1
    v_lshlrev_b32 v29, 4, v27
    v_lshl_add_u32 v29, v28, 7, v29
    v_cndmask_b32 v123, v22, v29, vcc
    v_lshlrev_b32 v29, 10, v26
    v_lshl_add_u32 v29, v17, 4, v29
    v_lshl_add_u32 v29, v28, 2, v29
    v_cndmask_b32 v8, v22, v29, vcc
    v_lshrrev_b32 v25, 2, v19
    v_and_b32 v26, 3, v19
    v_lshlrev_b32 v10, 10, v25
    v_lshl_add_u32 v10, v26, 8, v10
    v_lshl_add_u32 v10, v18, 4, v10
    v_add_u32 v10, 0x2400, v10
    v_lshlrev_b32 v11, 8, v25
    v_lshl_add_u32 v11, v18, 4, v11
    v_lshl_add_u32 v11, v26, 2, v11
    v_add_u32 v11, 0x2000, v11
    s_lshl_b32 s44, s3, 10
    s_add_u32 s44, s44, 0x6000
    v_lshlrev_b32 v12, 6, v18
    v_lshl_add_u32 v12, v26, 4, v12
    v_lshl_add_u32 v12, v25, 3, v12
    v_add_u32 v12, s44, v12
    v_lshlrev_b32 v13, 4, v18
    v_lshl_add_u32 v13, v19, 1, v13
    v_add_u32 v13, s44, v13
    v_add_u32 v13, 0x200, v13
    v_lshlrev_b32 v15, 6, v18
    v_lshl_add_u32 v15, v17, 4, v15
    v_add_u32 v15, s44, v15
    v_lshlrev_b32 v120, 4, v18
    v_lshl_add_u32 v120, v24, 3, v120
    v_add_u32 v120, s44, v120
    v_add_u32 v120, 0x200, v120
    s_add_u32 s45, s44, 0x300
    s_lshr_b32 s46, s3, 1
    s_lshl_b32 s46, s46, 10
    s_and_b32 s47, s3, 1
    s_lshl_b32 s47, s47, 9
    s_add_u32 s46, s46, s47
    s_add_u32 s46, s46, 0x5000
    v_lshlrev_b32 v25, 4, v16
    v_lshl_add_u32 v25, v23, 8, v25
    v_lshl_add_u32 v25, v24, 3, v25
    v_add_u32 v25, s46, v25
    v_mov_b32 v26, s45
    v_cmp_gt_u32 vcc, 8, v16
    s_nop 1
    v_cndmask_b32 v122, v26, v25, vcc
    s_mul_i32 s44, s3, 0xc00
    s_add_u32 s44, s44, 0x2000
    v_add_u32 v121, s44, v1
    s_lshl_b32 s44, s3, 15
    s_add_u32 s44, s44, 0x7400
    v_add_u32 v14, s44, v1
    s_lshl_b32 s45, s12, 2
    s_add_u32 s45, s45, s3
    s_lshl_b32 s46, s45, 6
    s_lshl_b32 s47, s45, 17
    s_lshl_b32 s50, s12, 7
    s_lshl_b32 s51, s3, 17
    s_add_u32 s50, s50, s51
    s_lshl_b32 s51, s45, 12
    s_lshl_b32 s52, s12, 8
    s_lshl_b32 s53, s3, 2
    s_add_u32 s52, s52, s53
    s_lshl_b32 s53, s3, 11
    s_lshr_b32 s48, s12, 1
    s_lshl_b32 s48, s48, 11
    s_and_b32 s49, s12, 1
    s_lshl_b32 s49, s49, 9
    s_add_u32 s48, s48, s49
    s_lshr_b32 s49, s3, 1
    s_lshl_b32 s49, s49, 8
    s_add_u32 s48, s48, s49
    s_and_b32 s49, s3, 1
    s_lshl_b32 s49, s49, 3
    s_add_u32 s48, s48, s49
    s_mov_b32 s56, 0
    s_mov_b32 s57, -1
    s_add_u32 s80, s50, 0
    s_add_u32 s81, s50, 0x8000
    s_add_u32 s82, s50, 0x10000
    s_add_u32 s83, s50, 0x18000
    s_load_dwordx4 s[68:71], s[0:1], 16
    s_load_dwordx4 s[72:75], s[0:1], 32
    v_lshrrev_b32 v16, 2, v0
    v_and_b32 v17, 3, v0
    v_lshlrev_b32 v125, 13, v16
    v_lshl_add_u32 v125, v17, 4, v125
    v_mul_u32_u24 v126, 0x50, v16
    v_lshl_add_u32 v126, v17, 4, v126
    v_add_u32 v126, s44, v126
    v_lshrrev_b32 v18, 4, v0
    v_bfe_u32 v19, v0, 2, 2
    v_lshl_add_u32 v19, v18, 3, v19
    v_mul_u32_u24 v127, 0x50, v19
    v_lshl_add_u32 v127, v17, 4, v127
    v_add_u32 v127, s44, v127
    s_waitcnt lgkmcnt(0)
    s_mov_b32 s8, s68
    s_mov_b32 s9, s69
    s_and_b32 s9, s9, 0xffff
    s_mov_b32 s10, 0x400000
    s_mov_b32 s11, 0x20000
    s_add_u32 s60, s3, 0
    s_and_b32 s60, s60, 3
    s_lshl_b32 s60, s60, 20
    s_add_u32 s60, s60, s46
    buffer_load_dwordx4 v[16:19], v125, s[8:11], s60 offen
    s_add_u32 s60, s60, 0x20000
    buffer_load_dwordx4 v[20:23], v125, s[8:11], s60 offen
    s_add_u32 s60, s60, 0x20000
    buffer_load_dwordx4 v[24:27], v125, s[8:11], s60 offen
    s_add_u32 s60, s60, 0x20000
    buffer_load_dwordx4 v[28:31], v125, s[8:11], s60 offen
    s_add_u32 s60, s60, 0x20000
    buffer_load_dwordx4 v[32:35], v125, s[8:11], s60 offen
    s_add_u32 s60, s60, 0x20000
    buffer_load_dwordx4 v[36:39], v125, s[8:11], s60 offen
    s_add_u32 s60, s60, 0x20000
    buffer_load_dwordx4 v[40:43], v125, s[8:11], s60 offen
    s_add_u32 s60, s60, 0x20000
    buffer_load_dwordx4 v[44:47], v125, s[8:11], s60 offen
    s_add_u32 s60, s60, 0x20000
    s_add_u32 s60, s3, 1
    s_and_b32 s60, s60, 3
    s_lshl_b32 s60, s60, 20
    s_add_u32 s60, s60, s46
    buffer_load_dwordx4 v[48:51], v125, s[8:11], s60 offen
    s_add_u32 s60, s60, 0x20000
    buffer_load_dwordx4 v[52:55], v125, s[8:11], s60 offen
    s_add_u32 s60, s60, 0x20000
    buffer_load_dwordx4 v[56:59], v125, s[8:11], s60 offen
    s_add_u32 s60, s60, 0x20000
    buffer_load_dwordx4 v[60:63], v125, s[8:11], s60 offen
    s_add_u32 s60, s60, 0x20000
    buffer_load_dwordx4 v[64:67], v125, s[8:11], s60 offen
    s_add_u32 s60, s60, 0x20000
    buffer_load_dwordx4 v[68:71], v125, s[8:11], s60 offen
    s_add_u32 s60, s60, 0x20000
    buffer_load_dwordx4 v[72:75], v125, s[8:11], s60 offen
    s_add_u32 s60, s60, 0x20000
    buffer_load_dwordx4 v[76:79], v125, s[8:11], s60 offen
    s_add_u32 s60, s60, 0x20000
    s_add_u32 s60, s3, 2
    s_and_b32 s60, s60, 3
    s_lshl_b32 s60, s60, 20
    s_add_u32 s60, s60, s46
    buffer_load_dwordx4 v[80:83], v125, s[8:11], s60 offen
    s_add_u32 s60, s60, 0x20000
    buffer_load_dwordx4 v[84:87], v125, s[8:11], s60 offen
    s_add_u32 s60, s60, 0x20000
    buffer_load_dwordx4 v[88:91], v125, s[8:11], s60 offen
    s_add_u32 s60, s60, 0x20000
    buffer_load_dwordx4 v[92:95], v125, s[8:11], s60 offen
    s_add_u32 s60, s60, 0x20000
    buffer_load_dwordx4 v[96:99], v125, s[8:11], s60 offen
    s_add_u32 s60, s60, 0x20000
    buffer_load_dwordx4 v[100:103], v125, s[8:11], s60 offen
    s_add_u32 s60, s60, 0x20000
    buffer_load_dwordx4 v[104:107], v125, s[8:11], s60 offen
    s_add_u32 s60, s60, 0x20000
    buffer_load_dwordx4 v[108:111], v125, s[8:11], s60 offen
    s_add_u32 s60, s60, 0x20000
    s_waitcnt vmcnt(23)
    ds_write_b128 v126, v[16:19] offset:0
    s_waitcnt vmcnt(22)
    ds_write_b128 v126, v[20:23] offset:1280
    s_waitcnt vmcnt(21)
    ds_write_b128 v126, v[24:27] offset:2560
    s_waitcnt vmcnt(20)
    ds_write_b128 v126, v[28:31] offset:3840
    s_waitcnt vmcnt(19)
    ds_write_b128 v126, v[32:35] offset:5120
    s_waitcnt vmcnt(18)
    ds_write_b128 v126, v[36:39] offset:6400
    s_waitcnt vmcnt(17)
    ds_write_b128 v126, v[40:43] offset:7680
    s_waitcnt vmcnt(16)
    ds_write_b128 v126, v[44:47] offset:8960
    s_waitcnt lgkmcnt(0)
    ds_read_b64_tr_b16 a[0:1], v127 offset:0
    ds_read_b64_tr_b16 a[2:3], v127 offset:320
    ds_read_b64_tr_b16 a[8:9], v127 offset:8
    ds_read_b64_tr_b16 a[10:11], v127 offset:328
    ds_read_b64_tr_b16 a[4:5], v127 offset:2560
    ds_read_b64_tr_b16 a[6:7], v127 offset:2880
    ds_read_b64_tr_b16 a[12:13], v127 offset:2568
    ds_read_b64_tr_b16 a[14:15], v127 offset:2888
    ds_read_b64_tr_b16 a[16:17], v127 offset:5120
    ds_read_b64_tr_b16 a[18:19], v127 offset:5440
    ds_read_b64_tr_b16 a[24:25], v127 offset:5128
    ds_read_b64_tr_b16 a[26:27], v127 offset:5448
    ds_read_b64_tr_b16 a[20:21], v127 offset:7680
    ds_read_b64_tr_b16 a[22:23], v127 offset:8000
    ds_read_b64_tr_b16 a[28:29], v127 offset:7688
    ds_read_b64_tr_b16 a[30:31], v127 offset:8008
    s_waitcnt lgkmcnt(0)
    s_add_u32 s60, s3, 3
    s_and_b32 s60, s60, 3
    s_lshl_b32 s60, s60, 20
    s_add_u32 s60, s60, s46
    buffer_load_dwordx4 v[16:19], v125, s[8:11], s60 offen
    s_add_u32 s60, s60, 0x20000
    buffer_load_dwordx4 v[20:23], v125, s[8:11], s60 offen
    s_add_u32 s60, s60, 0x20000
    buffer_load_dwordx4 v[24:27], v125, s[8:11], s60 offen
    s_add_u32 s60, s60, 0x20000
    buffer_load_dwordx4 v[28:31], v125, s[8:11], s60 offen
    s_add_u32 s60, s60, 0x20000
    buffer_load_dwordx4 v[32:35], v125, s[8:11], s60 offen
    s_add_u32 s60, s60, 0x20000
    buffer_load_dwordx4 v[36:39], v125, s[8:11], s60 offen
    s_add_u32 s60, s60, 0x20000
    buffer_load_dwordx4 v[40:43], v125, s[8:11], s60 offen
    s_add_u32 s60, s60, 0x20000
    buffer_load_dwordx4 v[44:47], v125, s[8:11], s60 offen
    s_add_u32 s60, s60, 0x20000
    s_waitcnt vmcnt(23)
    ds_write_b128 v126, v[48:51] offset:10240
    s_waitcnt vmcnt(22)
    ds_write_b128 v126, v[52:55] offset:11520
    s_waitcnt vmcnt(21)
    ds_write_b128 v126, v[56:59] offset:12800
    s_waitcnt vmcnt(20)
    ds_write_b128 v126, v[60:63] offset:14080
    s_waitcnt vmcnt(19)
    ds_write_b128 v126, v[64:67] offset:15360
    s_waitcnt vmcnt(18)
    ds_write_b128 v126, v[68:71] offset:16640
    s_waitcnt vmcnt(17)
    ds_write_b128 v126, v[72:75] offset:17920
    s_waitcnt vmcnt(16)
    ds_write_b128 v126, v[76:79] offset:19200
    s_waitcnt lgkmcnt(0)
    ds_read_b64_tr_b16 a[32:33], v127 offset:10240
    ds_read_b64_tr_b16 a[34:35], v127 offset:10560
    ds_read_b64_tr_b16 a[40:41], v127 offset:10248
    ds_read_b64_tr_b16 a[42:43], v127 offset:10568
    ds_read_b64_tr_b16 a[36:37], v127 offset:12800
    ds_read_b64_tr_b16 a[38:39], v127 offset:13120
    ds_read_b64_tr_b16 a[44:45], v127 offset:12808
    ds_read_b64_tr_b16 a[46:47], v127 offset:13128
    ds_read_b64_tr_b16 a[48:49], v127 offset:15360
    ds_read_b64_tr_b16 a[50:51], v127 offset:15680
    ds_read_b64_tr_b16 a[56:57], v127 offset:15368
    ds_read_b64_tr_b16 a[58:59], v127 offset:15688
    ds_read_b64_tr_b16 a[52:53], v127 offset:17920
    ds_read_b64_tr_b16 a[54:55], v127 offset:18240
    ds_read_b64_tr_b16 a[60:61], v127 offset:17928
    ds_read_b64_tr_b16 a[62:63], v127 offset:18248
    s_waitcnt lgkmcnt(0)
    s_mov_b32 s8, s70
    s_mov_b32 s9, s71
    s_and_b32 s9, s9, 0xffff
    s_mov_b32 s10, 0x400000
    s_mov_b32 s11, 0x20000
    s_add_u32 s60, s3, 0
    s_and_b32 s60, s60, 3
    s_lshl_b32 s60, s60, 20
    s_add_u32 s60, s60, s46
    buffer_load_dwordx4 v[48:51], v125, s[8:11], s60 offen
    s_add_u32 s60, s60, 0x20000
    buffer_load_dwordx4 v[52:55], v125, s[8:11], s60 offen
    s_add_u32 s60, s60, 0x20000
    buffer_load_dwordx4 v[56:59], v125, s[8:11], s60 offen
    s_add_u32 s60, s60, 0x20000
    buffer_load_dwordx4 v[60:63], v125, s[8:11], s60 offen
    s_add_u32 s60, s60, 0x20000
    buffer_load_dwordx4 v[64:67], v125, s[8:11], s60 offen
    s_add_u32 s60, s60, 0x20000
    buffer_load_dwordx4 v[68:71], v125, s[8:11], s60 offen
    s_add_u32 s60, s60, 0x20000
    buffer_load_dwordx4 v[72:75], v125, s[8:11], s60 offen
    s_add_u32 s60, s60, 0x20000
    buffer_load_dwordx4 v[76:79], v125, s[8:11], s60 offen
    s_add_u32 s60, s60, 0x20000
    s_waitcnt vmcnt(23)
    ds_write_b128 v126, v[80:83] offset:0
    s_waitcnt vmcnt(22)
    ds_write_b128 v126, v[84:87] offset:1280
    s_waitcnt vmcnt(21)
    ds_write_b128 v126, v[88:91] offset:2560
    s_waitcnt vmcnt(20)
    ds_write_b128 v126, v[92:95] offset:3840
    s_waitcnt vmcnt(19)
    ds_write_b128 v126, v[96:99] offset:5120
    s_waitcnt vmcnt(18)
    ds_write_b128 v126, v[100:103] offset:6400
    s_waitcnt vmcnt(17)
    ds_write_b128 v126, v[104:107] offset:7680
    s_waitcnt vmcnt(16)
    ds_write_b128 v126, v[108:111] offset:8960
    s_waitcnt lgkmcnt(0)
    ds_read_b64_tr_b16 a[64:65], v127 offset:0
    ds_read_b64_tr_b16 a[66:67], v127 offset:320
    ds_read_b64_tr_b16 a[72:73], v127 offset:8
    ds_read_b64_tr_b16 a[74:75], v127 offset:328
    ds_read_b64_tr_b16 a[68:69], v127 offset:2560
    ds_read_b64_tr_b16 a[70:71], v127 offset:2880
    ds_read_b64_tr_b16 a[76:77], v127 offset:2568
    ds_read_b64_tr_b16 a[78:79], v127 offset:2888
    ds_read_b64_tr_b16 a[80:81], v127 offset:5120
    ds_read_b64_tr_b16 a[82:83], v127 offset:5440
    ds_read_b64_tr_b16 a[88:89], v127 offset:5128
    ds_read_b64_tr_b16 a[90:91], v127 offset:5448
    ds_read_b64_tr_b16 a[84:85], v127 offset:7680
    ds_read_b64_tr_b16 a[86:87], v127 offset:8000
    ds_read_b64_tr_b16 a[92:93], v127 offset:7688
    ds_read_b64_tr_b16 a[94:95], v127 offset:8008
    s_waitcnt lgkmcnt(0)
    s_add_u32 s60, s3, 1
    s_and_b32 s60, s60, 3
    s_lshl_b32 s60, s60, 20
    s_add_u32 s60, s60, s46
    buffer_load_dwordx4 v[80:83], v125, s[8:11], s60 offen
    s_add_u32 s60, s60, 0x20000
    buffer_load_dwordx4 v[84:87], v125, s[8:11], s60 offen
    s_add_u32 s60, s60, 0x20000
    buffer_load_dwordx4 v[88:91], v125, s[8:11], s60 offen
    s_add_u32 s60, s60, 0x20000
    buffer_load_dwordx4 v[92:95], v125, s[8:11], s60 offen
    s_add_u32 s60, s60, 0x20000
    buffer_load_dwordx4 v[96:99], v125, s[8:11], s60 offen
    s_add_u32 s60, s60, 0x20000
    buffer_load_dwordx4 v[100:103], v125, s[8:11], s60 offen
    s_add_u32 s60, s60, 0x20000
    buffer_load_dwordx4 v[104:107], v125, s[8:11], s60 offen
    s_add_u32 s60, s60, 0x20000
    buffer_load_dwordx4 v[108:111], v125, s[8:11], s60 offen
    s_add_u32 s60, s60, 0x20000
    s_waitcnt vmcnt(23)
    ds_write_b128 v126, v[16:19] offset:10240
    s_waitcnt vmcnt(22)
    ds_write_b128 v126, v[20:23] offset:11520
    s_waitcnt vmcnt(21)
    ds_write_b128 v126, v[24:27] offset:12800
    s_waitcnt vmcnt(20)
    ds_write_b128 v126, v[28:31] offset:14080
    s_waitcnt vmcnt(19)
    ds_write_b128 v126, v[32:35] offset:15360
    s_waitcnt vmcnt(18)
    ds_write_b128 v126, v[36:39] offset:16640
    s_waitcnt vmcnt(17)
    ds_write_b128 v126, v[40:43] offset:17920
    s_waitcnt vmcnt(16)
    ds_write_b128 v126, v[44:47] offset:19200
    s_waitcnt lgkmcnt(0)
    ds_read_b64_tr_b16 a[96:97], v127 offset:10240
    ds_read_b64_tr_b16 a[98:99], v127 offset:10560
    ds_read_b64_tr_b16 a[104:105], v127 offset:10248
    ds_read_b64_tr_b16 a[106:107], v127 offset:10568
    ds_read_b64_tr_b16 a[100:101], v127 offset:12800
    ds_read_b64_tr_b16 a[102:103], v127 offset:13120
    ds_read_b64_tr_b16 a[108:109], v127 offset:12808
    ds_read_b64_tr_b16 a[110:111], v127 offset:13128
    ds_read_b64_tr_b16 a[112:113], v127 offset:15360
    ds_read_b64_tr_b16 a[114:115], v127 offset:15680
    ds_read_b64_tr_b16 a[120:121], v127 offset:15368
    ds_read_b64_tr_b16 a[122:123], v127 offset:15688
    ds_read_b64_tr_b16 a[116:117], v127 offset:17920
    ds_read_b64_tr_b16 a[118:119], v127 offset:18240
    ds_read_b64_tr_b16 a[124:125], v127 offset:17928
    ds_read_b64_tr_b16 a[126:127], v127 offset:18248
    s_waitcnt lgkmcnt(0)
    s_add_u32 s60, s3, 2
    s_and_b32 s60, s60, 3
    s_lshl_b32 s60, s60, 20
    s_add_u32 s60, s60, s46
    buffer_load_dwordx4 v[16:19], v125, s[8:11], s60 offen
    s_add_u32 s60, s60, 0x20000
    buffer_load_dwordx4 v[20:23], v125, s[8:11], s60 offen
    s_add_u32 s60, s60, 0x20000
    buffer_load_dwordx4 v[24:27], v125, s[8:11], s60 offen
    s_add_u32 s60, s60, 0x20000
    buffer_load_dwordx4 v[28:31], v125, s[8:11], s60 offen
    s_add_u32 s60, s60, 0x20000
    buffer_load_dwordx4 v[32:35], v125, s[8:11], s60 offen
    s_add_u32 s60, s60, 0x20000
    buffer_load_dwordx4 v[36:39], v125, s[8:11], s60 offen
    s_add_u32 s60, s60, 0x20000
    buffer_load_dwordx4 v[40:43], v125, s[8:11], s60 offen
    s_add_u32 s60, s60, 0x20000
    buffer_load_dwordx4 v[44:47], v125, s[8:11], s60 offen
    s_add_u32 s60, s60, 0x20000
    s_waitcnt vmcnt(23)
    ds_write_b128 v126, v[48:51] offset:0
    s_waitcnt vmcnt(22)
    ds_write_b128 v126, v[52:55] offset:1280
    s_waitcnt vmcnt(21)
    ds_write_b128 v126, v[56:59] offset:2560
    s_waitcnt vmcnt(20)
    ds_write_b128 v126, v[60:63] offset:3840
    s_waitcnt vmcnt(19)
    ds_write_b128 v126, v[64:67] offset:5120
    s_waitcnt vmcnt(18)
    ds_write_b128 v126, v[68:71] offset:6400
    s_waitcnt vmcnt(17)
    ds_write_b128 v126, v[72:75] offset:7680
    s_waitcnt vmcnt(16)
    ds_write_b128 v126, v[76:79] offset:8960
    s_waitcnt lgkmcnt(0)
    ds_read_b64_tr_b16 a[128:129], v127 offset:0
    ds_read_b64_tr_b16 a[130:131], v127 offset:320
    ds_read_b64_tr_b16 a[136:137], v127 offset:8
    ds_read_b64_tr_b16 a[138:139], v127 offset:328
    ds_read_b64_tr_b16 a[132:133], v127 offset:2560
    ds_read_b64_tr_b16 a[134:135], v127 offset:2880
    ds_read_b64_tr_b16 a[140:141], v127 offset:2568
    ds_read_b64_tr_b16 a[142:143], v127 offset:2888
    ds_read_b64_tr_b16 a[144:145], v127 offset:5120
    ds_read_b64_tr_b16 a[146:147], v127 offset:5440
    ds_read_b64_tr_b16 a[152:153], v127 offset:5128
    ds_read_b64_tr_b16 a[154:155], v127 offset:5448
    ds_read_b64_tr_b16 a[148:149], v127 offset:7680
    ds_read_b64_tr_b16 a[150:151], v127 offset:8000
    ds_read_b64_tr_b16 a[156:157], v127 offset:7688
    ds_read_b64_tr_b16 a[158:159], v127 offset:8008
    s_waitcnt lgkmcnt(0)
    s_add_u32 s60, s3, 3
    s_and_b32 s60, s60, 3
    s_lshl_b32 s60, s60, 20
    s_add_u32 s60, s60, s46
    buffer_load_dwordx4 v[48:51], v125, s[8:11], s60 offen
    s_add_u32 s60, s60, 0x20000
    buffer_load_dwordx4 v[52:55], v125, s[8:11], s60 offen
    s_add_u32 s60, s60, 0x20000
    buffer_load_dwordx4 v[56:59], v125, s[8:11], s60 offen
    s_add_u32 s60, s60, 0x20000
    buffer_load_dwordx4 v[60:63], v125, s[8:11], s60 offen
    s_add_u32 s60, s60, 0x20000
    buffer_load_dwordx4 v[64:67], v125, s[8:11], s60 offen
    s_add_u32 s60, s60, 0x20000
    buffer_load_dwordx4 v[68:71], v125, s[8:11], s60 offen
    s_add_u32 s60, s60, 0x20000
    buffer_load_dwordx4 v[72:75], v125, s[8:11], s60 offen
    s_add_u32 s60, s60, 0x20000
    buffer_load_dwordx4 v[76:79], v125, s[8:11], s60 offen
    s_add_u32 s60, s60, 0x20000
    s_waitcnt vmcnt(23)
    ds_write_b128 v126, v[80:83] offset:10240
    s_waitcnt vmcnt(22)
    ds_write_b128 v126, v[84:87] offset:11520
    s_waitcnt vmcnt(21)
    ds_write_b128 v126, v[88:91] offset:12800
    s_waitcnt vmcnt(20)
    ds_write_b128 v126, v[92:95] offset:14080
    s_waitcnt vmcnt(19)
    ds_write_b128 v126, v[96:99] offset:15360
    s_waitcnt vmcnt(18)
    ds_write_b128 v126, v[100:103] offset:16640
    s_waitcnt vmcnt(17)
    ds_write_b128 v126, v[104:107] offset:17920
    s_waitcnt vmcnt(16)
    ds_write_b128 v126, v[108:111] offset:19200
    s_waitcnt lgkmcnt(0)
    ds_read_b64_tr_b16 a[160:161], v127 offset:10240
    ds_read_b64_tr_b16 a[162:163], v127 offset:10560
    ds_read_b64_tr_b16 a[168:169], v127 offset:10248
    ds_read_b64_tr_b16 a[170:171], v127 offset:10568
    ds_read_b64_tr_b16 a[164:165], v127 offset:12800
    ds_read_b64_tr_b16 a[166:167], v127 offset:13120
    ds_read_b64_tr_b16 a[172:173], v127 offset:12808
    ds_read_b64_tr_b16 a[174:175], v127 offset:13128
    ds_read_b64_tr_b16 a[176:177], v127 offset:15360
    ds_read_b64_tr_b16 a[178:179], v127 offset:15680
    ds_read_b64_tr_b16 a[184:185], v127 offset:15368
    ds_read_b64_tr_b16 a[186:187], v127 offset:15688
    ds_read_b64_tr_b16 a[180:181], v127 offset:17920
    ds_read_b64_tr_b16 a[182:183], v127 offset:18240
    ds_read_b64_tr_b16 a[188:189], v127 offset:17928
    ds_read_b64_tr_b16 a[190:191], v127 offset:18248
    s_waitcnt lgkmcnt(0)
    s_mov_b32 s8, s72
    s_mov_b32 s9, s73
    s_and_b32 s9, s9, 0xffff
    s_mov_b32 s10, 0x400000
    s_mov_b32 s11, 0x20000
    s_add_u32 s60, s3, 0
    s_and_b32 s60, s60, 3
    s_lshl_b32 s60, s60, 20
    s_add_u32 s60, s60, s46
    buffer_load_dwordx4 v[80:83], v125, s[8:11], s60 offen
    s_add_u32 s60, s60, 0x20000
    buffer_load_dwordx4 v[84:87], v125, s[8:11], s60 offen
    s_add_u32 s60, s60, 0x20000
    buffer_load_dwordx4 v[88:91], v125, s[8:11], s60 offen
    s_add_u32 s60, s60, 0x20000
    buffer_load_dwordx4 v[92:95], v125, s[8:11], s60 offen
    s_add_u32 s60, s60, 0x20000
    buffer_load_dwordx4 v[96:99], v125, s[8:11], s60 offen
    s_add_u32 s60, s60, 0x20000
    buffer_load_dwordx4 v[100:103], v125, s[8:11], s60 offen
    s_add_u32 s60, s60, 0x20000
    buffer_load_dwordx4 v[104:107], v125, s[8:11], s60 offen
    s_add_u32 s60, s60, 0x20000
    buffer_load_dwordx4 v[108:111], v125, s[8:11], s60 offen
    s_add_u32 s60, s60, 0x20000
    s_waitcnt vmcnt(23)
    ds_write_b128 v126, v[16:19] offset:0
    s_waitcnt vmcnt(22)
    ds_write_b128 v126, v[20:23] offset:1280
    s_waitcnt vmcnt(21)
    ds_write_b128 v126, v[24:27] offset:2560
    s_waitcnt vmcnt(20)
    ds_write_b128 v126, v[28:31] offset:3840
    s_waitcnt vmcnt(19)
    ds_write_b128 v126, v[32:35] offset:5120
    s_waitcnt vmcnt(18)
    ds_write_b128 v126, v[36:39] offset:6400
    s_waitcnt vmcnt(17)
    ds_write_b128 v126, v[40:43] offset:7680
    s_waitcnt vmcnt(16)
    ds_write_b128 v126, v[44:47] offset:8960
    s_waitcnt lgkmcnt(0)
    ds_read_b64_tr_b16 a[192:193], v127 offset:0
    ds_read_b64_tr_b16 a[194:195], v127 offset:320
    ds_read_b64_tr_b16 a[200:201], v127 offset:8
    ds_read_b64_tr_b16 a[202:203], v127 offset:328
    ds_read_b64_tr_b16 a[196:197], v127 offset:2560
    ds_read_b64_tr_b16 a[198:199], v127 offset:2880
    ds_read_b64_tr_b16 a[204:205], v127 offset:2568
    ds_read_b64_tr_b16 a[206:207], v127 offset:2888
    ds_read_b64_tr_b16 a[208:209], v127 offset:5120
    ds_read_b64_tr_b16 a[210:211], v127 offset:5440
    ds_read_b64_tr_b16 a[216:217], v127 offset:5128
    ds_read_b64_tr_b16 a[218:219], v127 offset:5448
    ds_read_b64_tr_b16 a[212:213], v127 offset:7680
    ds_read_b64_tr_b16 a[214:215], v127 offset:8000
    ds_read_b64_tr_b16 a[220:221], v127 offset:7688
    ds_read_b64_tr_b16 a[222:223], v127 offset:8008
    s_waitcnt lgkmcnt(0)
    s_add_u32 s60, s3, 1
    s_and_b32 s60, s60, 3
    s_lshl_b32 s60, s60, 20
    s_add_u32 s60, s60, s46
    buffer_load_dwordx4 v[16:19], v125, s[8:11], s60 offen
    s_add_u32 s60, s60, 0x20000
    buffer_load_dwordx4 v[20:23], v125, s[8:11], s60 offen
    s_add_u32 s60, s60, 0x20000
    buffer_load_dwordx4 v[24:27], v125, s[8:11], s60 offen
    s_add_u32 s60, s60, 0x20000
    buffer_load_dwordx4 v[28:31], v125, s[8:11], s60 offen
    s_add_u32 s60, s60, 0x20000
    buffer_load_dwordx4 v[32:35], v125, s[8:11], s60 offen
    s_add_u32 s60, s60, 0x20000
    buffer_load_dwordx4 v[36:39], v125, s[8:11], s60 offen
    s_add_u32 s60, s60, 0x20000
    buffer_load_dwordx4 v[40:43], v125, s[8:11], s60 offen
    s_add_u32 s60, s60, 0x20000
    buffer_load_dwordx4 v[44:47], v125, s[8:11], s60 offen
    s_add_u32 s60, s60, 0x20000
    s_waitcnt vmcnt(23)
    ds_write_b128 v126, v[48:51] offset:10240
    s_waitcnt vmcnt(22)
    ds_write_b128 v126, v[52:55] offset:11520
    s_waitcnt vmcnt(21)
    ds_write_b128 v126, v[56:59] offset:12800
    s_waitcnt vmcnt(20)
    ds_write_b128 v126, v[60:63] offset:14080
    s_waitcnt vmcnt(19)
    ds_write_b128 v126, v[64:67] offset:15360
    s_waitcnt vmcnt(18)
    ds_write_b128 v126, v[68:71] offset:16640
    s_waitcnt vmcnt(17)
    ds_write_b128 v126, v[72:75] offset:17920
    s_waitcnt vmcnt(16)
    ds_write_b128 v126, v[76:79] offset:19200
    s_waitcnt lgkmcnt(0)
    ds_read_b64_tr_b16 a[224:225], v127 offset:10240
    ds_read_b64_tr_b16 a[226:227], v127 offset:10560
    ds_read_b64_tr_b16 a[232:233], v127 offset:10248
    ds_read_b64_tr_b16 a[234:235], v127 offset:10568
    ds_read_b64_tr_b16 a[228:229], v127 offset:12800
    ds_read_b64_tr_b16 a[230:231], v127 offset:13120
    ds_read_b64_tr_b16 a[236:237], v127 offset:12808
    ds_read_b64_tr_b16 a[238:239], v127 offset:13128
    ds_read_b64_tr_b16 a[240:241], v127 offset:15360
    ds_read_b64_tr_b16 a[242:243], v127 offset:15680
    ds_read_b64_tr_b16 a[248:249], v127 offset:15368
    ds_read_b64_tr_b16 a[250:251], v127 offset:15688
    ds_read_b64_tr_b16 a[244:245], v127 offset:17920
    ds_read_b64_tr_b16 a[246:247], v127 offset:18240
    ds_read_b64_tr_b16 a[252:253], v127 offset:17928
    ds_read_b64_tr_b16 a[254:255], v127 offset:18248
    s_waitcnt lgkmcnt(0)
    s_add_u32 s60, s3, 2
    s_and_b32 s60, s60, 3
    s_lshl_b32 s60, s60, 20
    s_add_u32 s60, s60, s46
    buffer_load_dwordx4 v[48:51], v125, s[8:11], s60 offen
    s_add_u32 s60, s60, 0x20000
    buffer_load_dwordx4 v[52:55], v125, s[8:11], s60 offen
    s_add_u32 s60, s60, 0x20000
    buffer_load_dwordx4 v[56:59], v125, s[8:11], s60 offen
    s_add_u32 s60, s60, 0x20000
    buffer_load_dwordx4 v[60:63], v125, s[8:11], s60 offen
    s_add_u32 s60, s60, 0x20000
    buffer_load_dwordx4 v[64:67], v125, s[8:11], s60 offen
    s_add_u32 s60, s60, 0x20000
    buffer_load_dwordx4 v[68:71], v125, s[8:11], s60 offen
    s_add_u32 s60, s60, 0x20000
    buffer_load_dwordx4 v[72:75], v125, s[8:11], s60 offen
    s_add_u32 s60, s60, 0x20000
    buffer_load_dwordx4 v[76:79], v125, s[8:11], s60 offen
    s_add_u32 s60, s60, 0x20000
    s_waitcnt vmcnt(23)
    ds_write_b128 v126, v[80:83] offset:0
    s_waitcnt vmcnt(22)
    ds_write_b128 v126, v[84:87] offset:1280
    s_waitcnt vmcnt(21)
    ds_write_b128 v126, v[88:91] offset:2560
    s_waitcnt vmcnt(20)
    ds_write_b128 v126, v[92:95] offset:3840
    s_waitcnt vmcnt(19)
    ds_write_b128 v126, v[96:99] offset:5120
    s_waitcnt vmcnt(18)
    ds_write_b128 v126, v[100:103] offset:6400
    s_waitcnt vmcnt(17)
    ds_write_b128 v126, v[104:107] offset:7680
    s_waitcnt vmcnt(16)
    ds_write_b128 v126, v[108:111] offset:8960
    s_waitcnt lgkmcnt(0)
    ds_read_b64_tr_b16 v[128:129], v127 offset:0
    ds_read_b64_tr_b16 v[130:131], v127 offset:320
    ds_read_b64_tr_b16 v[136:137], v127 offset:8
    ds_read_b64_tr_b16 v[138:139], v127 offset:328
    ds_read_b64_tr_b16 v[132:133], v127 offset:2560
    ds_read_b64_tr_b16 v[134:135], v127 offset:2880
    ds_read_b64_tr_b16 v[140:141], v127 offset:2568
    ds_read_b64_tr_b16 v[142:143], v127 offset:2888
    ds_read_b64_tr_b16 v[144:145], v127 offset:5120
    ds_read_b64_tr_b16 v[146:147], v127 offset:5440
    ds_read_b64_tr_b16 v[152:153], v127 offset:5128
    ds_read_b64_tr_b16 v[154:155], v127 offset:5448
    ds_read_b64_tr_b16 v[148:149], v127 offset:7680
    ds_read_b64_tr_b16 v[150:151], v127 offset:8000
    ds_read_b64_tr_b16 v[156:157], v127 offset:7688
    ds_read_b64_tr_b16 v[158:159], v127 offset:8008
    s_waitcnt lgkmcnt(0)
    s_add_u32 s60, s3, 3
    s_and_b32 s60, s60, 3
    s_lshl_b32 s60, s60, 20
    s_add_u32 s60, s60, s46
    buffer_load_dwordx4 v[80:83], v125, s[8:11], s60 offen
    s_add_u32 s60, s60, 0x20000
    buffer_load_dwordx4 v[84:87], v125, s[8:11], s60 offen
    s_add_u32 s60, s60, 0x20000
    buffer_load_dwordx4 v[88:91], v125, s[8:11], s60 offen
    s_add_u32 s60, s60, 0x20000
    buffer_load_dwordx4 v[92:95], v125, s[8:11], s60 offen
    s_add_u32 s60, s60, 0x20000
    buffer_load_dwordx4 v[96:99], v125, s[8:11], s60 offen
    s_add_u32 s60, s60, 0x20000
    buffer_load_dwordx4 v[100:103], v125, s[8:11], s60 offen
    s_add_u32 s60, s60, 0x20000
    buffer_load_dwordx4 v[104:107], v125, s[8:11], s60 offen
    s_add_u32 s60, s60, 0x20000
    buffer_load_dwordx4 v[108:111], v125, s[8:11], s60 offen
    s_add_u32 s60, s60, 0x20000
    s_waitcnt vmcnt(23)
    ds_write_b128 v126, v[16:19] offset:10240
    s_waitcnt vmcnt(22)
    ds_write_b128 v126, v[20:23] offset:11520
    s_waitcnt vmcnt(21)
    ds_write_b128 v126, v[24:27] offset:12800
    s_waitcnt vmcnt(20)
    ds_write_b128 v126, v[28:31] offset:14080
    s_waitcnt vmcnt(19)
    ds_write_b128 v126, v[32:35] offset:15360
    s_waitcnt vmcnt(18)
    ds_write_b128 v126, v[36:39] offset:16640
    s_waitcnt vmcnt(17)
    ds_write_b128 v126, v[40:43] offset:17920
    s_waitcnt vmcnt(16)
    ds_write_b128 v126, v[44:47] offset:19200
    s_waitcnt lgkmcnt(0)
    ds_read_b64_tr_b16 v[160:161], v127 offset:10240
    ds_read_b64_tr_b16 v[162:163], v127 offset:10560
    ds_read_b64_tr_b16 v[168:169], v127 offset:10248
    ds_read_b64_tr_b16 v[170:171], v127 offset:10568
    ds_read_b64_tr_b16 v[164:165], v127 offset:12800
    ds_read_b64_tr_b16 v[166:167], v127 offset:13120
    ds_read_b64_tr_b16 v[172:173], v127 offset:12808
    ds_read_b64_tr_b16 v[174:175], v127 offset:13128
    ds_read_b64_tr_b16 v[176:177], v127 offset:15360
    ds_read_b64_tr_b16 v[178:179], v127 offset:15680
    ds_read_b64_tr_b16 v[184:185], v127 offset:15368
    ds_read_b64_tr_b16 v[186:187], v127 offset:15688
    ds_read_b64_tr_b16 v[180:181], v127 offset:17920
    ds_read_b64_tr_b16 v[182:183], v127 offset:18240
    ds_read_b64_tr_b16 v[188:189], v127 offset:17928
    ds_read_b64_tr_b16 v[190:191], v127 offset:18248
    s_waitcnt lgkmcnt(0)
    s_waitcnt vmcnt(15)
    ds_write_b128 v126, v[48:51] offset:0
    s_waitcnt vmcnt(14)
    ds_write_b128 v126, v[52:55] offset:1280
    s_waitcnt vmcnt(13)
    ds_write_b128 v126, v[56:59] offset:2560
    s_waitcnt vmcnt(12)
    ds_write_b128 v126, v[60:63] offset:3840
    s_waitcnt vmcnt(11)
    ds_write_b128 v126, v[64:67] offset:5120
    s_waitcnt vmcnt(10)
    ds_write_b128 v126, v[68:71] offset:6400
    s_waitcnt vmcnt(9)
    ds_write_b128 v126, v[72:75] offset:7680
    s_waitcnt vmcnt(8)
    ds_write_b128 v126, v[76:79] offset:8960
    s_waitcnt lgkmcnt(0)
    ds_read_b64_tr_b16 v[192:193], v127 offset:0
    ds_read_b64_tr_b16 v[194:195], v127 offset:320
    ds_read_b64_tr_b16 v[200:201], v127 offset:8
    ds_read_b64_tr_b16 v[202:203], v127 offset:328
    ds_read_b64_tr_b16 v[196:197], v127 offset:2560
    ds_read_b64_tr_b16 v[198:199], v127 offset:2880
    ds_read_b64_tr_b16 v[204:205], v127 offset:2568
    ds_read_b64_tr_b16 v[206:207], v127 offset:2888
    ds_read_b64_tr_b16 v[208:209], v127 offset:5120
    ds_read_b64_tr_b16 v[210:211], v127 offset:5440
    ds_read_b64_tr_b16 v[216:217], v127 offset:5128
    ds_read_b64_tr_b16 v[218:219], v127 offset:5448
    ds_read_b64_tr_b16 v[212:213], v127 offset:7680
    ds_read_b64_tr_b16 v[214:215], v127 offset:8000
    ds_read_b64_tr_b16 v[220:221], v127 offset:7688
    ds_read_b64_tr_b16 v[222:223], v127 offset:8008
    s_waitcnt lgkmcnt(0)
    s_waitcnt vmcnt(7)
    ds_write_b128 v126, v[80:83] offset:10240
    s_waitcnt vmcnt(6)
    ds_write_b128 v126, v[84:87] offset:11520
    s_waitcnt vmcnt(5)
    ds_write_b128 v126, v[88:91] offset:12800
    s_waitcnt vmcnt(4)
    ds_write_b128 v126, v[92:95] offset:14080
    s_waitcnt vmcnt(3)
    ds_write_b128 v126, v[96:99] offset:15360
    s_waitcnt vmcnt(2)
    ds_write_b128 v126, v[100:103] offset:16640
    s_waitcnt vmcnt(1)
    ds_write_b128 v126, v[104:107] offset:17920
    s_waitcnt vmcnt(0)
    ds_write_b128 v126, v[108:111] offset:19200
    s_waitcnt lgkmcnt(0)
    ds_read_b64_tr_b16 v[224:225], v127 offset:10240
    ds_read_b64_tr_b16 v[226:227], v127 offset:10560
    ds_read_b64_tr_b16 v[232:233], v127 offset:10248
    ds_read_b64_tr_b16 v[234:235], v127 offset:10568
    ds_read_b64_tr_b16 v[228:229], v127 offset:12800
    ds_read_b64_tr_b16 v[230:231], v127 offset:13120
    ds_read_b64_tr_b16 v[236:237], v127 offset:12808
    ds_read_b64_tr_b16 v[238:239], v127 offset:13128
    ds_read_b64_tr_b16 v[240:241], v127 offset:15360
    ds_read_b64_tr_b16 v[242:243], v127 offset:15680
    ds_read_b64_tr_b16 v[248:249], v127 offset:15368
    ds_read_b64_tr_b16 v[250:251], v127 offset:15688
    ds_read_b64_tr_b16 v[244:245], v127 offset:17920
    ds_read_b64_tr_b16 v[246:247], v127 offset:18240
    ds_read_b64_tr_b16 v[252:253], v127 offset:17928
    ds_read_b64_tr_b16 v[254:255], v127 offset:18248
    s_waitcnt lgkmcnt(0)
    s_mov_b32 s8, s74
    s_mov_b32 s9, s75
    s_and_b32 s9, s9, 0xffff
    s_mov_b32 s10, 0x400000
    s_mov_b32 s11, 0x20000
    v_and_b32 v16, 15, v0
    v_lshrrev_b32 v18, 4, v0
    v_lshlrev_b32 v125, 13, v18
    v_lshl_add_u32 v125, v16, 3, v125
    v_lshrrev_b32 v17, 3, v16
    v_lshlrev_b32 v126, 13, v17
    v_and_b32 v17, 1, v16
    v_lshl_add_u32 v126, v17, 10, v126
    v_bfe_u32 v17, v16, 1, 2
    v_lshl_add_u32 v126, v17, 6, v126
    v_lshl_add_u32 v126, v18, 8, v126
    v_add_u32 v126, s44, v126
    s_mov_b32 s58, 0x5040100
    s_mov_b32 s59, 0x7060302
    s_lshl_b32 s60, s12, 17
    s_lshl_b32 s61, s3, 8
    s_add_u32 s60, s60, s61
    s_add_u32 s61, s60, 0
    buffer_load_dwordx2 v[16:17], v125, s[8:11], s61 offen
    s_add_u32 s61, s60, 0x400
    buffer_load_dwordx2 v[18:19], v125, s[8:11], s61 offen
    s_add_u32 s61, s60, 0x800
    buffer_load_dwordx2 v[20:21], v125, s[8:11], s61 offen
    s_add_u32 s61, s60, 0xc00
    buffer_load_dwordx2 v[22:23], v125, s[8:11], s61 offen
    s_add_u32 s61, s60, 0x1000
    buffer_load_dwordx2 v[24:25], v125, s[8:11], s61 offen
    s_add_u32 s61, s60, 0x1400
    buffer_load_dwordx2 v[26:27], v125, s[8:11], s61 offen
    s_add_u32 s61, s60, 0x1800
    buffer_load_dwordx2 v[28:29], v125, s[8:11], s61 offen
    s_add_u32 s61, s60, 0x1c00
    buffer_load_dwordx2 v[30:31], v125, s[8:11], s61 offen
    s_add_u32 s61, s60, 0x80
    buffer_load_dwordx2 v[32:33], v125, s[8:11], s61 offen
    s_add_u32 s61, s60, 0x480
    buffer_load_dwordx2 v[34:35], v125, s[8:11], s61 offen
    s_add_u32 s61, s60, 0x880
    buffer_load_dwordx2 v[36:37], v125, s[8:11], s61 offen
    s_add_u32 s61, s60, 0xc80
    buffer_load_dwordx2 v[38:39], v125, s[8:11], s61 offen
    s_add_u32 s61, s60, 0x1080
    buffer_load_dwordx2 v[40:41], v125, s[8:11], s61 offen
    s_add_u32 s61, s60, 0x1480
    buffer_load_dwordx2 v[42:43], v125, s[8:11], s61 offen
    s_add_u32 s61, s60, 0x1880
    buffer_load_dwordx2 v[44:45], v125, s[8:11], s61 offen
    s_add_u32 s61, s60, 0x1c80
    buffer_load_dwordx2 v[46:47], v125, s[8:11], s61 offen
    s_add_u32 s61, s60, 0x8000
    buffer_load_dwordx2 v[48:49], v125, s[8:11], s61 offen
    s_add_u32 s61, s60, 0x8400
    buffer_load_dwordx2 v[50:51], v125, s[8:11], s61 offen
    s_add_u32 s61, s60, 0x8800
    buffer_load_dwordx2 v[52:53], v125, s[8:11], s61 offen
    s_add_u32 s61, s60, 0x8c00
    buffer_load_dwordx2 v[54:55], v125, s[8:11], s61 offen
    s_add_u32 s61, s60, 0x9000
    buffer_load_dwordx2 v[56:57], v125, s[8:11], s61 offen
    s_add_u32 s61, s60, 0x9400
    buffer_load_dwordx2 v[58:59], v125, s[8:11], s61 offen
    s_add_u32 s61, s60, 0x9800
    buffer_load_dwordx2 v[60:61], v125, s[8:11], s61 offen
    s_add_u32 s61, s60, 0x9c00
    buffer_load_dwordx2 v[62:63], v125, s[8:11], s61 offen
    s_add_u32 s61, s60, 0x8080
    buffer_load_dwordx2 v[64:65], v125, s[8:11], s61 offen
    s_add_u32 s61, s60, 0x8480
    buffer_load_dwordx2 v[66:67], v125, s[8:11], s61 offen
    s_add_u32 s61, s60, 0x8880
    buffer_load_dwordx2 v[68:69], v125, s[8:11], s61 offen
    s_add_u32 s61, s60, 0x8c80
    buffer_load_dwordx2 v[70:71], v125, s[8:11], s61 offen
    s_add_u32 s61, s60, 0x9080
    buffer_load_dwordx2 v[72:73], v125, s[8:11], s61 offen
    s_add_u32 s61, s60, 0x9480
    buffer_load_dwordx2 v[74:75], v125, s[8:11], s61 offen
    s_add_u32 s61, s60, 0x9880
    buffer_load_dwordx2 v[76:77], v125, s[8:11], s61 offen
    s_add_u32 s61, s60, 0x9c80
    buffer_load_dwordx2 v[78:79], v125, s[8:11], s61 offen
    s_waitcnt vmcnt(24)
    v_perm_b32 v80, v18, v16, s58
    v_perm_b32 v81, v22, v20, s58
    v_perm_b32 v82, v26, v24, s58
    v_perm_b32 v83, v30, v28, s58
    v_perm_b32 v84, v18, v16, s59
    v_perm_b32 v85, v22, v20, s59
    v_perm_b32 v86, v26, v24, s59
    v_perm_b32 v87, v30, v28, s59
    v_perm_b32 v88, v19, v17, s58
    v_perm_b32 v89, v23, v21, s58
    v_perm_b32 v90, v27, v25, s58
    v_perm_b32 v91, v31, v29, s58
    v_perm_b32 v92, v19, v17, s59
    v_perm_b32 v93, v23, v21, s59
    v_perm_b32 v94, v27, v25, s59
    v_perm_b32 v95, v31, v29, s59
    ds_write_b128 v126, v[80:83] offset:0
    ds_write_b128 v126, v[84:87] offset:16
    ds_write_b128 v126, v[88:91] offset:32
    ds_write_b128 v126, v[92:95] offset:48
    s_waitcnt lgkmcnt(0)
    s_add_u32 s61, s60, 0x10000
    buffer_load_dwordx2 v[16:17], v125, s[8:11], s61 offen
    s_add_u32 s61, s60, 0x10400
    buffer_load_dwordx2 v[18:19], v125, s[8:11], s61 offen
    s_add_u32 s61, s60, 0x10800
    buffer_load_dwordx2 v[20:21], v125, s[8:11], s61 offen
    s_add_u32 s61, s60, 0x10c00
    buffer_load_dwordx2 v[22:23], v125, s[8:11], s61 offen
    s_add_u32 s61, s60, 0x11000
    buffer_load_dwordx2 v[24:25], v125, s[8:11], s61 offen
    s_add_u32 s61, s60, 0x11400
    buffer_load_dwordx2 v[26:27], v125, s[8:11], s61 offen
    s_add_u32 s61, s60, 0x11800
    buffer_load_dwordx2 v[28:29], v125, s[8:11], s61 offen
    s_add_u32 s61, s60, 0x11c00
    buffer_load_dwordx2 v[30:31], v125, s[8:11], s61 offen
    s_waitcnt vmcnt(24)
    v_perm_b32 v80, v34, v32, s58
    v_perm_b32 v81, v38, v36, s58
    v_perm_b32 v82, v42, v40, s58
    v_perm_b32 v83, v46, v44, s58
    v_perm_b32 v84, v34, v32, s59
    v_perm_b32 v85, v38, v36, s59
    v_perm_b32 v86, v42, v40, s59
    v_perm_b32 v87, v46, v44, s59
    v_perm_b32 v88, v35, v33, s58
    v_perm_b32 v89, v39, v37, s58
    v_perm_b32 v90, v43, v41, s58
    v_perm_b32 v91, v47, v45, s58
    v_perm_b32 v92, v35, v33, s59
    v_perm_b32 v93, v39, v37, s59
    v_perm_b32 v94, v43, v41, s59
    v_perm_b32 v95, v47, v45, s59
    ds_write_b128 v126, v[80:83] offset:16384
    ds_write_b128 v126, v[84:87] offset:16400
    ds_write_b128 v126, v[88:91] offset:16416
    ds_write_b128 v126, v[92:95] offset:16432
    s_waitcnt lgkmcnt(0)
    s_add_u32 s61, s60, 0x10080
    buffer_load_dwordx2 v[32:33], v125, s[8:11], s61 offen
    s_add_u32 s61, s60, 0x10480
    buffer_load_dwordx2 v[34:35], v125, s[8:11], s61 offen
    s_add_u32 s61, s60, 0x10880
    buffer_load_dwordx2 v[36:37], v125, s[8:11], s61 offen
    s_add_u32 s61, s60, 0x10c80
    buffer_load_dwordx2 v[38:39], v125, s[8:11], s61 offen
    s_add_u32 s61, s60, 0x11080
    buffer_load_dwordx2 v[40:41], v125, s[8:11], s61 offen
    s_add_u32 s61, s60, 0x11480
    buffer_load_dwordx2 v[42:43], v125, s[8:11], s61 offen
    s_add_u32 s61, s60, 0x11880
    buffer_load_dwordx2 v[44:45], v125, s[8:11], s61 offen
    s_add_u32 s61, s60, 0x11c80
    buffer_load_dwordx2 v[46:47], v125, s[8:11], s61 offen
    s_waitcnt vmcnt(24)
    v_perm_b32 v80, v50, v48, s58
    v_perm_b32 v81, v54, v52, s58
    v_perm_b32 v82, v58, v56, s58
    v_perm_b32 v83, v62, v60, s58
    v_perm_b32 v84, v50, v48, s59
    v_perm_b32 v85, v54, v52, s59
    v_perm_b32 v86, v58, v56, s59
    v_perm_b32 v87, v62, v60, s59
    v_perm_b32 v88, v51, v49, s58
    v_perm_b32 v89, v55, v53, s58
    v_perm_b32 v90, v59, v57, s58
    v_perm_b32 v91, v63, v61, s58
    v_perm_b32 v92, v51, v49, s59
    v_perm_b32 v93, v55, v53, s59
    v_perm_b32 v94, v59, v57, s59
    v_perm_b32 v95, v63, v61, s59
    ds_write_b128 v126, v[80:83] offset:2048
    ds_write_b128 v126, v[84:87] offset:2064
    ds_write_b128 v126, v[88:91] offset:2080
    ds_write_b128 v126, v[92:95] offset:2096
    s_waitcnt lgkmcnt(0)
    s_add_u32 s61, s60, 0x18000
    buffer_load_dwordx2 v[48:49], v125, s[8:11], s61 offen
    s_add_u32 s61, s60, 0x18400
    buffer_load_dwordx2 v[50:51], v125, s[8:11], s61 offen
    s_add_u32 s61, s60, 0x18800
    buffer_load_dwordx2 v[52:53], v125, s[8:11], s61 offen
    s_add_u32 s61, s60, 0x18c00
    buffer_load_dwordx2 v[54:55], v125, s[8:11], s61 offen
    s_add_u32 s61, s60, 0x19000
    buffer_load_dwordx2 v[56:57], v125, s[8:11], s61 offen
    s_add_u32 s61, s60, 0x19400
    buffer_load_dwordx2 v[58:59], v125, s[8:11], s61 offen
    s_add_u32 s61, s60, 0x19800
    buffer_load_dwordx2 v[60:61], v125, s[8:11], s61 offen
    s_add_u32 s61, s60, 0x19c00
    buffer_load_dwordx2 v[62:63], v125, s[8:11], s61 offen
    s_waitcnt vmcnt(24)
    v_perm_b32 v80, v66, v64, s58
    v_perm_b32 v81, v70, v68, s58
    v_perm_b32 v82, v74, v72, s58
    v_perm_b32 v83, v78, v76, s58
    v_perm_b32 v84, v66, v64, s59
    v_perm_b32 v85, v70, v68, s59
    v_perm_b32 v86, v74, v72, s59
    v_perm_b32 v87, v78, v76, s59
    v_perm_b32 v88, v67, v65, s58
    v_perm_b32 v89, v71, v69, s58
    v_perm_b32 v90, v75, v73, s58
    v_perm_b32 v91, v79, v77, s58
    v_perm_b32 v92, v67, v65, s59
    v_perm_b32 v93, v71, v69, s59
    v_perm_b32 v94, v75, v73, s59
    v_perm_b32 v95, v79, v77, s59
    ds_write_b128 v126, v[80:83] offset:18432
    ds_write_b128 v126, v[84:87] offset:18448
    ds_write_b128 v126, v[88:91] offset:18464
    ds_write_b128 v126, v[92:95] offset:18480
    s_waitcnt lgkmcnt(0)
    s_add_u32 s61, s60, 0x18080
    buffer_load_dwordx2 v[64:65], v125, s[8:11], s61 offen
    s_add_u32 s61, s60, 0x18480
    buffer_load_dwordx2 v[66:67], v125, s[8:11], s61 offen
    s_add_u32 s61, s60, 0x18880
    buffer_load_dwordx2 v[68:69], v125, s[8:11], s61 offen
    s_add_u32 s61, s60, 0x18c80
    buffer_load_dwordx2 v[70:71], v125, s[8:11], s61 offen
    s_add_u32 s61, s60, 0x19080
    buffer_load_dwordx2 v[72:73], v125, s[8:11], s61 offen
    s_add_u32 s61, s60, 0x19480
    buffer_load_dwordx2 v[74:75], v125, s[8:11], s61 offen
    s_add_u32 s61, s60, 0x19880
    buffer_load_dwordx2 v[76:77], v125, s[8:11], s61 offen
    s_add_u32 s61, s60, 0x19c80
    buffer_load_dwordx2 v[78:79], v125, s[8:11], s61 offen
    s_waitcnt vmcnt(24)
    v_perm_b32 v80, v18, v16, s58
    v_perm_b32 v81, v22, v20, s58
    v_perm_b32 v82, v26, v24, s58
    v_perm_b32 v83, v30, v28, s58
    v_perm_b32 v84, v18, v16, s59
    v_perm_b32 v85, v22, v20, s59
    v_perm_b32 v86, v26, v24, s59
    v_perm_b32 v87, v30, v28, s59
    v_perm_b32 v88, v19, v17, s58
    v_perm_b32 v89, v23, v21, s58
    v_perm_b32 v90, v27, v25, s58
    v_perm_b32 v91, v31, v29, s58
    v_perm_b32 v92, v19, v17, s59
    v_perm_b32 v93, v23, v21, s59
    v_perm_b32 v94, v27, v25, s59
    v_perm_b32 v95, v31, v29, s59
    ds_write_b128 v126, v[80:83] offset:4096
    ds_write_b128 v126, v[84:87] offset:4112
    ds_write_b128 v126, v[88:91] offset:4128
    ds_write_b128 v126, v[92:95] offset:4144
    s_waitcnt lgkmcnt(0)
    s_waitcnt vmcnt(16)
    v_perm_b32 v80, v34, v32, s58
    v_perm_b32 v81, v38, v36, s58
    v_perm_b32 v82, v42, v40, s58
    v_perm_b32 v83, v46, v44, s58
    v_perm_b32 v84, v34, v32, s59
    v_perm_b32 v85, v38, v36, s59
    v_perm_b32 v86, v42, v40, s59
    v_perm_b32 v87, v46, v44, s59
    v_perm_b32 v88, v35, v33, s58
    v_perm_b32 v89, v39, v37, s58
    v_perm_b32 v90, v43, v41, s58
    v_perm_b32 v91, v47, v45, s58
    v_perm_b32 v92, v35, v33, s59
    v_perm_b32 v93, v39, v37, s59
    v_perm_b32 v94, v43, v41, s59
    v_perm_b32 v95, v47, v45, s59
    ds_write_b128 v126, v[80:83] offset:20480
    ds_write_b128 v126, v[84:87] offset:20496
    ds_write_b128 v126, v[88:91] offset:20512
    ds_write_b128 v126, v[92:95] offset:20528
    s_waitcnt lgkmcnt(0)
    s_waitcnt vmcnt(8)
    v_perm_b32 v80, v50, v48, s58
    v_perm_b32 v81, v54, v52, s58
    v_perm_b32 v82, v58, v56, s58
    v_perm_b32 v83, v62, v60, s58
    v_perm_b32 v84, v50, v48, s59
    v_perm_b32 v85, v54, v52, s59
    v_perm_b32 v86, v58, v56, s59
    v_perm_b32 v87, v62, v60, s59
    v_perm_b32 v88, v51, v49, s58
    v_perm_b32 v89, v55, v53, s58
    v_perm_b32 v90, v59, v57, s58
    v_perm_b32 v91, v63, v61, s58
    v_perm_b32 v92, v51, v49, s59
    v_perm_b32 v93, v55, v53, s59
    v_perm_b32 v94, v59, v57, s59
    v_perm_b32 v95, v63, v61, s59
    ds_write_b128 v126, v[80:83] offset:6144
    ds_write_b128 v126, v[84:87] offset:6160
    ds_write_b128 v126, v[88:91] offset:6176
    ds_write_b128 v126, v[92:95] offset:6192
    s_waitcnt lgkmcnt(0)
    s_waitcnt vmcnt(0)
    v_perm_b32 v80, v66, v64, s58
    v_perm_b32 v81, v70, v68, s58
    v_perm_b32 v82, v74, v72, s58
    v_perm_b32 v83, v78, v76, s58
    v_perm_b32 v84, v66, v64, s59
    v_perm_b32 v85, v70, v68, s59
    v_perm_b32 v86, v74, v72, s59
    v_perm_b32 v87, v78, v76, s59
    v_perm_b32 v88, v67, v65, s58
    v_perm_b32 v89, v71, v69, s58
    v_perm_b32 v90, v75, v73, s58
    v_perm_b32 v91, v79, v77, s58
    v_perm_b32 v92, v67, v65, s59
    v_perm_b32 v93, v71, v69, s59
    v_perm_b32 v94, v75, v73, s59
    v_perm_b32 v95, v79, v77, s59
    ds_write_b128 v126, v[80:83] offset:22528
    ds_write_b128 v126, v[84:87] offset:22544
    ds_write_b128 v126, v[88:91] offset:22560
    ds_write_b128 v126, v[92:95] offset:22576
    s_waitcnt lgkmcnt(0)
    s_add_u32 s44, s3, 0
    s_and_b32 s44, s44, 3
    s_lshl_b32 s44, s44, 11
    s_add_u32 s44, s44, 0
    v_add_u32 v124, s44, v1
    s_add_u32 s44, s3, 1
    s_and_b32 s44, s44, 3
    s_lshl_b32 s44, s44, 11
    s_add_u32 s44, s44, 0
    v_add_u32 v2, s44, v1
    s_add_u32 s44, s3, 2
    s_and_b32 s44, s44, 3
    s_lshl_b32 s44, s44, 11
    s_add_u32 s44, s44, 0
    v_add_u32 v52, s44, v1
    s_add_u32 s44, s3, 3
    s_and_b32 s44, s44, 3
    s_lshl_b32 s44, s44, 11
    s_add_u32 s44, s44, 0
    v_add_u32 v53, s44, v1
    s_mul_i32 s44, s3, 0xc00
    s_add_u32 s44, s44, 0x2000
    v_and_b32 v16, 15, v0
    v_lshrrev_b32 v17, 4, v0
    v_lshrrev_b32 v18, 2, v16
    v_lshlrev_b32 v18, 3, v18
    v_and_b32 v19, 3, v16
    v_add_u32 v18, v18, v19
    v_lshrrev_b32 v19, 1, v17
    v_lshl_add_u32 v18, v19, 2, v18
    v_lshlrev_b32 v54, 5, v18
    v_and_b32 v19, 1, v17
    v_lshl_add_u32 v54, v19, 3, v54
    v_add_u32 v54, s44, v54
    v_bfe_u32 v18, v0, 2, 2
    v_lshl_add_u32 v18, v17, 3, v18
    v_lshlrev_b32 v55, 5, v18
    v_and_b32 v19, 3, v0
    v_lshl_add_u32 v55, v19, 3, v55
    v_add_u32 v55, s44, v55
    v_cmp_gt_u32 vcc, 8, v16
    v_mov_b32 v18, 0xeeeeeeee
    v_mov_b32 v19, 0x44444444
    v_cndmask_b32 v51, v18, v19, vcc
    s_mov_b32 s67, 0
    s_mov_b32 s62, 0
    s_mov_b32 s63, 0
    s_mov_b32 s64, 0
    s_mov_b32 s66, 0
    s_add_u32 s8, s6, 0x3000
    s_addc_u32 s9, s7, 0
    s_and_b32 s9, s9, 0xffff
    s_mov_b32 s10, 0x10000
    s_mov_b32 s11, 0x20000
    v_mov_b32 v126, 0x80
rec_iw_1:
    buffer_load_dword v127, v126, s[96:99], 0 offen sc1
    s_waitcnt vmcnt(0)
    v_readfirstlane_b32 s61, v127
    s_add_u32 s67, s67, 1
    s_cmp_gt_u32 s67, 0x1e8480
    s_cbranch_scc1 main_kernel_exit
    s_cmp_lt_u32 s61, 1
    s_cbranch_scc1 rec_iw_1
    v_mov_b32 v126, 0xa0
rec_iw_2:
    buffer_load_dword v127, v126, s[96:99], 0 offen sc1
    s_waitcnt vmcnt(0)
    v_readfirstlane_b32 s61, v127
    s_add_u32 s67, s67, 1
    s_cmp_gt_u32 s67, 0x1e8480
    s_cbranch_scc1 main_kernel_exit
    s_cmp_lt_u32 s61, 24
    s_cbranch_scc1 rec_iw_2
    s_mov_b32 s60, 0
    s_lshr_b32 s60, s60, 3
    s_lshl_b32 s60, s60, 8
    s_add_u32 s60, s60, 0x2000
    v_mov_b32 v126, 0
kvw_4:
    buffer_load_dword v127, v126, s[8:11], s60 offen sc1
    s_waitcnt vmcnt(0)
    v_readfirstlane_b32 s61, v127
    s_add_u32 s67, s67, 1
    s_cmp_gt_u32 s67, 0x1e8480
    s_cbranch_scc1 main_kernel_exit
    s_cmp_lt_u32 s61, 0x80
    s_cbranch_scc1 kvw_4
kvw_skip_3:
    s_add_u32 s60, s63, s46
    buffer_load_dwordx4 v[104:107], v3, s[20:23], s60 offen
    buffer_load_dwordx4 v[108:111], v4, s[20:23], s60 offen
    s_add_u32 s60, s64, s47
    buffer_load_dwordx4 v[112:115], v5, s[24:27], s60 offen
    buffer_load_dwordx4 v[116:119], v6, s[24:27], s60 offen
    s_add_u32 s63, s63, 0x40000
    s_add_u32 s64, s64, 64
    v_mov_b32 v58, 0
    v_mov_b32 v59, 0
    v_mov_b32 v62, 0
    v_mov_b32 v63, 0
    s_add_u32 s60, s53, 0x2000
    v_and_b32 v126, 15, v0
    v_lshlrev_b32 v126, 7, v126
    buffer_load_dword v127, v126, s[28:31], s60 offen sc1
    s_add_u32 s60, s66, s53
    buffer_load_dwordx4 v[16:19], v1, s[28:31], s60 offen offset:0 sc1
    buffer_load_dwordx4 v[20:23], v1, s[28:31], s60 offen offset:1024 sc1
    v_mov_b32 v80, 0
    v_mov_b32 v81, 0
    v_mov_b32 v82, 0
    v_mov_b32 v83, 0
    v_mov_b32 v84, 0
    v_mov_b32 v85, 0
    v_mov_b32 v86, 0
    v_mov_b32 v87, 0
    v_mov_b32 v88, 0
    v_mov_b32 v89, 0
    v_mov_b32 v90, 0
    v_mov_b32 v91, 0
    v_mov_b32 v92, 0
    v_mov_b32 v93, 0
    v_mov_b32 v94, 0
    v_mov_b32 v95, 0
    v_mov_b32 v96, 0
    v_mov_b32 v97, 0
    v_mov_b32 v98, 0
    v_mov_b32 v99, 0
    v_mov_b32 v100, 0
    v_mov_b32 v101, 0
    v_mov_b32 v102, 0
    v_mov_b32 v103, 0
    s_branch main_kernel_mpolla_chk
main_kernel_mpolla:
    buffer_load_dwordx4 v[16:19], v1, s[28:31], s60 offen offset:0 sc1
    buffer_load_dwordx4 v[20:23], v1, s[28:31], s60 offen offset:1024 sc1
    s_add_u32 s67, s67, 1
    s_cmp_gt_u32 s67, 0x1e8480
    s_cbranch_scc1 main_kernel_exit
main_kernel_mpolla_chk:
    s_waitcnt vmcnt(0)
    v_max3_u32 v125, v16, v17, v18
    v_max3_u32 v126, v19, v20, v21
    v_max3_u32 v125, v125, v22, v23
    v_max_u32 v125, v125, v126
    v_cmp_eq_u32 vcc, -1, v125
    s_cbranch_vccnz main_kernel_mpolla
main_kernel_step:
    ds_write_b128 v124, v[16:19] offset:0
    ds_write_b128 v124, v[20:23] offset:1024
    s_cmp_eq_u32 s62, 63
    s_cbranch_scc1 main_kernel_exit_pub
    v_smfmac_f32_16x16x64_bf16 v[80:83], v[16:19], a[0:7], v51
    v_smfmac_f32_16x16x64_bf16 v[84:87], v[16:19], a[8:15], v51
    v_smfmac_f32_16x16x64_bf16 v[88:91], v[16:19], a[128:135], v51
    v_smfmac_f32_16x16x64_bf16 v[92:95], v[16:19], a[136:143], v51
    s_waitcnt lgkmcnt(0)
    s_barrier
    ds_read_b128 v[24:27], v2 offset:0
    ds_read_b128 v[28:31], v2 offset:1024
    ds_read_b128 v[32:35], v52 offset:0
    ds_read_b128 v[36:39], v52 offset:1024
    ds_read_b128 v[40:43], v53 offset:0
    ds_read_b128 v[44:47], v53 offset:1024
    v_smfmac_f32_16x16x64_bf16 v[80:83], v[20:23], a[16:23], v51
    v_smfmac_f32_16x16x64_bf16 v[84:87], v[20:23], a[24:31], v51
    v_smfmac_f32_16x16x64_bf16 v[88:91], v[20:23], a[144:151], v51
    v_smfmac_f32_16x16x64_bf16 v[92:95], v[20:23], a[152:159], v51
    s_waitcnt lgkmcnt(5)
    v_smfmac_f32_16x16x64_bf16 v[80:83], v[24:27], a[32:39], v51
    v_smfmac_f32_16x16x64_bf16 v[84:87], v[24:27], a[40:47], v51
    v_smfmac_f32_16x16x64_bf16 v[88:91], v[24:27], a[160:167], v51
    v_smfmac_f32_16x16x64_bf16 v[92:95], v[24:27], a[168:175], v51
    s_waitcnt lgkmcnt(4)
    v_smfmac_f32_16x16x64_bf16 v[80:83], v[28:31], a[48:55], v51
    v_smfmac_f32_16x16x64_bf16 v[84:87], v[28:31], a[56:63], v51
    v_smfmac_f32_16x16x64_bf16 v[88:91], v[28:31], a[176:183], v51
    v_smfmac_f32_16x16x64_bf16 v[92:95], v[28:31], a[184:191], v51
    s_waitcnt lgkmcnt(3)
    v_smfmac_f32_16x16x64_bf16 v[80:83], v[32:35], a[64:71], v51
    v_smfmac_f32_16x16x64_bf16 v[84:87], v[32:35], a[72:79], v51
    v_smfmac_f32_16x16x64_bf16 v[88:91], v[32:35], a[192:199], v51
    v_smfmac_f32_16x16x64_bf16 v[92:95], v[32:35], a[200:207], v51
    s_waitcnt lgkmcnt(2)
    v_smfmac_f32_16x16x64_bf16 v[80:83], v[36:39], a[80:87], v51
    v_smfmac_f32_16x16x64_bf16 v[84:87], v[36:39], a[88:95], v51
    v_smfmac_f32_16x16x64_bf16 v[88:91], v[36:39], a[208:215], v51
    v_smfmac_f32_16x16x64_bf16 v[92:95], v[36:39], a[216:223], v51
    s_waitcnt lgkmcnt(1)
    v_smfmac_f32_16x16x64_bf16 v[80:83], v[40:43], a[96:103], v51
    v_smfmac_f32_16x16x64_bf16 v[84:87], v[40:43], a[104:111], v51
    v_smfmac_f32_16x16x64_bf16 v[88:91], v[40:43], a[224:231], v51
    v_smfmac_f32_16x16x64_bf16 v[92:95], v[40:43], a[232:239], v51
    s_waitcnt lgkmcnt(0)
    v_smfmac_f32_16x16x64_bf16 v[80:83], v[44:47], a[112:119], v51
    v_smfmac_f32_16x16x64_bf16 v[84:87], v[44:47], a[120:127], v51
    v_smfmac_f32_16x16x64_bf16 v[88:91], v[44:47], a[240:247], v51
    v_smfmac_f32_16x16x64_bf16 v[92:95], v[44:47], a[248:255], v51
    v_smfmac_f32_16x16x64_bf16 v[96:99], v[16:19], v[128:135], v51
    v_smfmac_f32_16x16x64_bf16 v[100:103], v[16:19], v[136:143], v51
    s_nop 3
    v_permlane32_swap_b32 v80, v84
    v_permlane32_swap_b32 v81, v85
    v_smfmac_f32_16x16x64_bf16 v[96:99], v[20:23], v[144:151], v51
    v_permlane32_swap_b32 v82, v86
    v_permlane32_swap_b32 v83, v87
    v_smfmac_f32_16x16x64_bf16 v[100:103], v[20:23], v[152:159], v51
    v_add_f32 v80, v80, v84
    v_add_f32 v81, v81, v85
    v_add_f32 v82, v82, v86
    v_add_f32 v83, v83, v87
    v_smfmac_f32_16x16x64_bf16 v[96:99], v[24:27], v[160:167], v51
    v_cvt_pk_bf16_f32 v84, v80, v81
    v_cvt_pk_bf16_f32 v85, v82, v83
    ds_write_b64 v54, v[84:85] offset:0
    v_smfmac_f32_16x16x64_bf16 v[100:103], v[24:27], v[168:175], v51
    v_permlane32_swap_b32 v88, v92
    v_permlane32_swap_b32 v89, v93
    v_smfmac_f32_16x16x64_bf16 v[96:99], v[28:31], v[176:183], v51
    v_permlane32_swap_b32 v90, v94
    v_permlane32_swap_b32 v91, v95
    v_smfmac_f32_16x16x64_bf16 v[100:103], v[28:31], v[184:191], v51
    v_add_f32 v88, v88, v92
    v_add_f32 v89, v89, v93
    v_add_f32 v90, v90, v94
    v_add_f32 v91, v91, v95
    v_smfmac_f32_16x16x64_bf16 v[96:99], v[32:35], v[192:199], v51
    v_cvt_pk_bf16_f32 v92, v88, v89
    v_cvt_pk_bf16_f32 v93, v90, v91
    ds_write_b64 v54, v[92:93] offset:1024
    v_smfmac_f32_16x16x64_bf16 v[100:103], v[32:35], v[200:207], v51
    v_smfmac_f32_16x16x64_bf16 v[96:99], v[36:39], v[208:215], v51
    v_smfmac_f32_16x16x64_bf16 v[100:103], v[36:39], v[216:223], v51
    v_smfmac_f32_16x16x64_bf16 v[96:99], v[40:43], v[224:231], v51
    s_cmp_eq_u32 s62, 0
    s_cbranch_scc1 rec_nopub_5
    s_lshr_b32 s60, s62, 2
    s_lshl_b32 s60, s60, 15
    s_and_b32 s61, s62, 3
    s_lshl_b32 s61, s61, 6
    s_add_u32 s60, s60, s61
    s_add_u32 s60, s60, s48
    buffer_store_dword v9, v8, s[36:39], s60 offen sc1
rec_nopub_5:
    s_add_u32 s60, s62, 1
    s_and_b32 s61, s60, 7
    s_cmp_lg_u32 s61, 0
    s_cbranch_scc1 kvc_skip_6
    v_readfirstlane_b32 s61, v127
    s_cmp_ge_u32 s61, 0x80
    s_cbranch_scc1 kvc_skip_6
    s_add_u32 s60, s62, 1
    s_and_b32 s61, s60, 7
    s_cmp_lg_u32 s61, 0
    s_cbranch_scc1 kvw_skip_7
    s_cmp_ge_u32 s60, 64
    s_cbranch_scc1 kvw_skip_7
    s_lshr_b32 s60, s60, 3
    s_lshl_b32 s60, s60, 8
    s_add_u32 s60, s60, 0x2000
    v_mov_b32 v126, 0
kvw_8:
    buffer_load_dword v127, v126, s[8:11], s60 offen sc1
    s_waitcnt vmcnt(0)
    v_readfirstlane_b32 s61, v127
    s_add_u32 s67, s67, 1
    s_cmp_gt_u32 s67, 0x1e8480
    s_cbranch_scc1 main_kernel_exit
    s_cmp_lt_u32 s61, 0x80
    s_cbranch_scc1 kvw_8
kvw_skip_7:
kvc_skip_6:
    s_waitcnt lgkmcnt(0)
    ds_read_b64_tr_b16 v[80:81], v55 offset:0
    ds_read_b64_tr_b16 v[82:83], v55 offset:128
    ds_read_b64_tr_b16 v[84:85], v55 offset:1024
    ds_read_b64_tr_b16 v[86:87], v55 offset:1152
    v_smfmac_f32_16x16x64_bf16 v[100:103], v[40:43], v[232:239], v51
    v_smfmac_f32_16x16x64_bf16 v[96:99], v[44:47], v[240:247], v51
    v_smfmac_f32_16x16x64_bf16 v[100:103], v[44:47], v[248:255], v51
    s_add_u32 s58, s63, s46
    s_add_u32 s59, s64, s47
    buffer_load_dwordx4 v[64:67], v3, s[20:23], s58 offen
    s_waitcnt lgkmcnt(0)
    v_mfma_f32_16x16x32_bf16 v[16:19], v[84:87], v[80:83], 0
    v_mfma_f32_16x16x32_bf16 v[20:23], v[104:107], v[80:83], 0
    v_mfma_f32_16x16x32_bf16 v[24:27], v[108:111], v[80:83], 0
    s_nop 0
    v_permlane32_swap_b32 v96, v100
    v_permlane32_swap_b32 v97, v101
    v_permlane32_swap_b32 v98, v102
    v_permlane32_swap_b32 v99, v103
    v_add_f32 v96, v96, v100
    v_add_f32 v97, v97, v101
    v_add_f32 v98, v98, v102
    v_add_f32 v99, v99, v103
    ds_write_b128 v121, v[16:19] offset:0
    ds_write_b128 v121, v[20:23] offset:1024
    ds_write_b128 v121, v[24:27] offset:2048
    v_cvt_pk_bf16_f32 v56, v96, v97
    v_cvt_pk_bf16_f32 v57, v98, v99
    v_mov_b32 v100, v56
    v_mov_b32 v101, v57
    v_mov_b32 v60, v56
    v_mov_b32 v61, v57
    s_nop 0
    v_permlane32_swap_b32 v100, v60
    v_permlane32_swap_b32 v101, v61
    buffer_load_dwordx4 v[68:71], v4, s[20:23], s58 offen
    s_waitcnt lgkmcnt(0)
    s_barrier
    ds_read_b128 v[32:35], v10 offset:0
    ds_read_b32 v16, v11 offset:0
    ds_read_b128 v[36:39], v10 offset:3072
    ds_read_b32 v17, v11 offset:3072
    ds_read_b128 v[40:43], v10 offset:6144
    ds_read_b32 v18, v11 offset:6144
    ds_read_b128 v[44:47], v10 offset:9216
    ds_read_b32 v19, v11 offset:9216
    ds_read_b128 v[88:91], v14 offset:0
    ds_read_b128 v[92:95], v14 offset:2048
    ds_read_b128 v[96:99], v14 offset:4096
    ds_read_b128 v[100:103], v14 offset:6144
    ds_read_b128 v[24:27], v14 offset:1024
    ds_read_b128 v[28:31], v14 offset:3072
    buffer_load_dwordx4 v[72:75], v5, s[24:27], s59 offen
    buffer_load_dwordx4 v[76:79], v6, s[24:27], s59 offen
    s_add_u32 s63, s63, 0x40000
    s_add_u32 s64, s64, 64
    s_waitcnt lgkmcnt(10)
    v_add_f32 v32, v32, v36
    v_add_f32 v33, v33, v37
    v_add_f32 v34, v34, v38
    v_add_f32 v35, v35, v39
    v_add_f32 v16, v16, v17
    s_waitcnt lgkmcnt(6)
    v_add_f32 v40, v40, v44
    v_add_f32 v41, v41, v45
    v_add_f32 v42, v42, v46
    v_add_f32 v43, v43, v47
    v_add_f32 v18, v18, v19
    v_add_f32 v32, v32, v40
    v_add_f32 v33, v33, v41
    v_add_f32 v34, v34, v42
    v_add_f32 v35, v35, v43
    v_add_f32 v36, v16, v18
    v_cvt_pk_bf16_f32 v40, v32, v33
    v_cvt_pk_bf16_f32 v41, v34, v35
    v_cvt_pk_bf16_f32 v42, v36, v36
    v_lshlrev_b32 v32, 16, v40
    v_and_b32 v33, 0xffff0000, v40
    v_lshlrev_b32 v34, 16, v41
    v_and_b32 v35, 0xffff0000, v41
    v_lshlrev_b32 v36, 16, v42
    v_mul_f32 v32, 0x3db504f3, v32
    v_mul_f32 v33, 0x3db504f3, v33
    v_mul_f32 v34, 0x3db504f3, v34
    v_mul_f32 v35, 0x3db504f3, v35
    v_mul_f32 v36, 0x3db504f3, v36
    v_cvt_pk_bf16_f32 v40, v32, v33
    v_cvt_pk_bf16_f32 v41, v34, v35
    v_cvt_pk_bf16_f32 v42, v36, v36
    v_lshlrev_b32 v32, 16, v40
    v_and_b32 v33, 0xffff0000, v40
    v_lshlrev_b32 v34, 16, v41
    v_and_b32 v35, 0xffff0000, v41
    v_lshlrev_b32 v36, 16, v42
    v_max3_f32 v40, v32, v33, v34
    v_max3_f32 v40, v40, v35, v36
    s_nop 1
    v_max_f32_dpp v40, v40, v40 row_ror:8 row_mask:0xf bank_mask:0xf
    v_mov_b32 v41, v40
    s_nop 1
    v_permlane16_swap_b32 v40, v41
    v_max_f32 v40, v40, v41
    v_mov_b32 v41, v40
    s_nop 1
    v_permlane32_swap_b32 v40, v41
    v_max_f32 v40, v40, v41
    v_mul_f32 v40, 0xbfb8aa3b, v40
    v_mov_b32 v41, 0x3fb8aa3b
    v_fma_f32 v32, v32, v41, v40
    v_fma_f32 v33, v33, v41, v40
    v_fma_f32 v34, v34, v41, v40
    v_fma_f32 v35, v35, v41, v40
    v_fma_f32 v36, v36, v41, v40
    v_exp_f32 v32, v32
    v_exp_f32 v33, v33
    v_exp_f32 v34, v34
    v_exp_f32 v35, v35
    v_exp_f32 v36, v36
    v_add_f32 v40, v32, v33
    v_add_f32 v41, v34, v35
    v_add_f32 v40, v40, v36
    v_add_f32 v40, v40, v41
    s_nop 1
    v_add_f32_dpp v40, v40, v40 row_ror:8 row_mask:0xf bank_mask:0xf
    v_mov_b32 v41, v40
    s_nop 1
    v_permlane16_swap_b32 v40, v41
    v_add_f32 v40, v40, v41
    v_mov_b32 v41, v40
    s_nop 1
    v_permlane32_swap_b32 v40, v41
    v_add_f32 v40, v40, v41
    v_rcp_f32 v40, v40
    s_nop 0
    v_mul_f32 v32, v32, v40
    v_mul_f32 v33, v33, v40
    v_mul_f32 v34, v34, v40
    v_mul_f32 v35, v35, v40
    v_mul_f32 v36, v36, v40
    v_cvt_pk_bf16_f32 v40, v32, v33
    v_cvt_pk_bf16_f32 v41, v34, v35
    v_cvt_pk_bf16_f32 v42, v36, v36
    ds_write_b64 v12, v[40:41]
    ds_write_b16 v13, v42
    v_mov_b32 v18, 0
    v_mov_b32 v19, 0
    s_add_u32 s60, s66, s53
    s_add_u32 s60, s60, 0x4000
    v_and_b32 v126, 15, v0
    v_lshlrev_b32 v126, 7, v126
    buffer_load_dword v126, v126, s[28:31], s60 offen sc1
    s_waitcnt lgkmcnt(0)
    ds_read_b128 v[44:47], v15
    ds_read_b64 v[16:17], v120
    s_add_u32 s60, s62, 2
    s_and_b32 s61, s60, 7
    s_cmp_lg_u32 s61, 0
    s_cbranch_scc1 kvf_skip_9
    s_lshr_b32 s60, s60, 3
    s_lshl_b32 s60, s60, 8
    s_add_u32 s60, s60, 0x2000
    v_mov_b32 v127, 0
    buffer_load_dword v127, v127, s[8:11], s60 offen sc1
kvf_skip_9:
    s_waitcnt lgkmcnt(0)
    v_cndmask_b32 v16, v16, 0, s[56:57]
    v_cndmask_b32 v17, v17, 0, s[56:57]
    v_mfma_f32_16x16x32_bf16 v[80:83], v[112:115], v[44:47], 0
    v_mfma_f32_16x16x32_bf16 v[84:87], v[116:119], v[44:47], 0
    v_mfma_f32_16x16x32_bf16 v[80:83], v[56:59], v[16:19], v[80:83]
    v_mfma_f32_16x16x32_bf16 v[84:87], v[60:63], v[16:19], v[84:87]
    ds_read_b128 v[32:35], v14 offset:8192
    ds_read_b128 v[36:39], v14 offset:10240
    ds_read_b128 v[112:115], v14 offset:5120
    ds_read_b128 v[116:119], v14 offset:7168
    s_nop 2
    v_cvt_pk_bf16_f32 v20, v80, v81
    v_cvt_pk_bf16_f32 v22, v82, v83
    v_cvt_pk_bf16_f32 v21, v84, v85
    v_cvt_pk_bf16_f32 v23, v86, v87
    ds_write_b64 v122, v[20:21]
    ds_write_b64 v122, v[22:23] offset:128
    ds_read_b128 v[40:43], v14 offset:12288
    ds_read_b128 v[44:47], v14 offset:14336
    v_mov_b32 v104, 0
    v_mov_b32 v105, 0
    v_mov_b32 v106, 0
    v_mov_b32 v107, 0
    v_mov_b32 v108, 0
    v_mov_b32 v109, 0
    v_mov_b32 v110, 0
    v_mov_b32 v111, 0
    s_waitcnt lgkmcnt(2)
    s_barrier
    ds_read_b128 v[16:19], v1 offset:20480
    ds_read_b128 v[20:23], v1 offset:21504
    v_mov_b32 v80, 0
    v_mov_b32 v81, 0
    v_mov_b32 v82, 0
    v_mov_b32 v83, 0
    v_mov_b32 v84, 0
    v_mov_b32 v85, 0
    v_mov_b32 v86, 0
    v_mov_b32 v87, 0
    s_and_b32 s60, s62, 1
    v_mov_b32 v125, s60
    s_cmp_lg_u32 s13, 0
    s_cbranch_scc1 rec_wslow_10
    s_waitcnt lgkmcnt(1)
    v_smfmac_f32_16x16x64_bf16 v[80:83], v[16:19], v[88:95], v51
    ds_read_b128 v[88:91], v14 offset:9216
    ds_read_b128 v[92:95], v14 offset:11264
    s_waitcnt lgkmcnt(2)
    v_smfmac_f32_16x16x64_bf16 v[80:83], v[20:23], v[96:103], v51
    ds_read_b128 v[96:99], v14 offset:13312
    ds_read_b128 v[100:103], v14 offset:15360
    v_smfmac_f32_16x16x64_bf16 v[84:87], v[16:19], v[24:31], v51
    ds_read_b128 v[24:27], v14 offset:16384
    ds_read_b128 v[28:31], v14 offset:18432
    v_smfmac_f32_16x16x64_bf16 v[84:87], v[20:23], v[112:119], v51
    ds_read_b128 v[112:115], v14 offset:20480
    ds_read_b128 v[116:119], v14 offset:22528
    v_smfmac_f32_16x16x64_bf16 v[104:107], v[16:19], v[32:39], v51
    ds_read_b128 v[32:35], v14 offset:17408
    ds_read_b128 v[36:39], v14 offset:19456
    v_smfmac_f32_16x16x64_bf16 v[104:107], v[20:23], v[40:47], v51
    ds_read_b128 v[40:43], v14 offset:21504
    ds_read_b128 v[44:47], v14 offset:23552
    v_permlane32_swap_b32 v80, v84
    v_permlane32_swap_b32 v81, v85
    v_permlane32_swap_b32 v82, v86
    v_permlane32_swap_b32 v83, v87
    v_add_f32 v80, v80, v84
    v_add_f32 v81, v81, v85
    v_add_f32 v82, v82, v86
    v_add_f32 v83, v83, v87
    v_bfi_b32 v84, 1, v125, v80
    v_bfi_b32 v85, 1, v125, v81
    v_bfi_b32 v86, 1, v125, v82
    v_bfi_b32 v87, 1, v125, v83
    buffer_store_dwordx4 v[84:87], v7, s[32:35], s80 offen
    v_mov_b32 v80, 0
    v_mov_b32 v81, 0
    v_mov_b32 v82, 0
    v_mov_b32 v83, 0
    s_nop 0
    v_mov_b32 v84, 0
    v_mov_b32 v85, 0
    v_mov_b32 v86, 0
    v_mov_b32 v87, 0
    s_waitcnt lgkmcnt(10)
    v_smfmac_f32_16x16x64_bf16 v[108:111], v[16:19], v[88:95], v51
    ds_read_b128 v[88:91], v14 offset:24576
    ds_read_b128 v[92:95], v14 offset:26624
    s_waitcnt lgkmcnt(10)
    v_smfmac_f32_16x16x64_bf16 v[108:111], v[20:23], v[96:103], v51
    ds_read_b128 v[96:99], v14 offset:28672
    ds_read_b128 v[100:103], v14 offset:30720
    s_waitcnt lgkmcnt(10)
    v_smfmac_f32_16x16x64_bf16 v[80:83], v[16:19], v[24:31], v51
    ds_read_b128 v[24:27], v14 offset:25600
    ds_read_b128 v[28:31], v14 offset:27648
    s_waitcnt lgkmcnt(10)
    v_smfmac_f32_16x16x64_bf16 v[80:83], v[20:23], v[112:119], v51
    ds_read_b128 v[112:115], v14 offset:29696
    ds_read_b128 v[116:119], v14 offset:31744
    v_permlane32_swap_b32 v104, v108
    v_permlane32_swap_b32 v105, v109
    v_permlane32_swap_b32 v106, v110
    v_permlane32_swap_b32 v107, v111
    v_add_f32 v104, v104, v108
    v_add_f32 v105, v105, v109
    v_add_f32 v106, v106, v110
    v_add_f32 v107, v107, v111
    v_bfi_b32 v108, 1, v125, v104
    v_bfi_b32 v109, 1, v125, v105
    v_bfi_b32 v110, 1, v125, v106
    v_bfi_b32 v111, 1, v125, v107
    buffer_store_dwordx4 v[108:111], v7, s[32:35], s81 offen
    v_mov_b32 v104, 0
    v_mov_b32 v105, 0
    v_mov_b32 v106, 0
    v_mov_b32 v107, 0
    s_nop 0
    v_mov_b32 v108, 0
    v_mov_b32 v109, 0
    v_mov_b32 v110, 0
    v_mov_b32 v111, 0
    s_waitcnt lgkmcnt(10)
    v_smfmac_f32_16x16x64_bf16 v[84:87], v[16:19], v[32:39], v51
    s_waitcnt lgkmcnt(8)
    v_smfmac_f32_16x16x64_bf16 v[84:87], v[20:23], v[40:47], v51
    s_waitcnt lgkmcnt(6)
    v_smfmac_f32_16x16x64_bf16 v[104:107], v[16:19], v[88:95], v51
    s_waitcnt lgkmcnt(4)
    v_smfmac_f32_16x16x64_bf16 v[104:107], v[20:23], v[96:103], v51
    s_nop 3
    v_permlane32_swap_b32 v80, v84
    v_permlane32_swap_b32 v81, v85
    v_permlane32_swap_b32 v82, v86
    v_permlane32_swap_b32 v83, v87
    v_add_f32 v80, v80, v84
    v_add_f32 v81, v81, v85
    v_add_f32 v82, v82, v86
    v_add_f32 v83, v83, v87
    v_bfi_b32 v84, 1, v125, v80
    v_bfi_b32 v85, 1, v125, v81
    v_bfi_b32 v86, 1, v125, v82
    v_bfi_b32 v87, 1, v125, v83
    buffer_store_dwordx4 v[84:87], v7, s[32:35], s82 offen
    s_waitcnt lgkmcnt(2)
    v_smfmac_f32_16x16x64_bf16 v[108:111], v[16:19], v[24:31], v51
    s_waitcnt lgkmcnt(0)
    v_smfmac_f32_16x16x64_bf16 v[108:111], v[20:23], v[112:119], v51
    s_nop 7
    v_permlane32_swap_b32 v104, v108
    v_permlane32_swap_b32 v105, v109
    v_permlane32_swap_b32 v106, v110
    v_permlane32_swap_b32 v107, v111
    v_add_f32 v104, v104, v108
    v_add_f32 v105, v105, v109
    v_add_f32 v106, v106, v110
    v_add_f32 v107, v107, v111
    v_bfi_b32 v108, 1, v125, v104
    v_bfi_b32 v109, 1, v125, v105
    v_bfi_b32 v110, 1, v125, v106
    v_bfi_b32 v111, 1, v125, v107
    buffer_store_dwordx4 v[108:111], v7, s[32:35], s83 offen
    s_cmp_lg_u32 s60, 0
    s_cbranch_scc1 rec_rodd_12
rec_rpoll_14:
    buffer_load_dwordx4 v[32:35], v1, s[32:35], s51 offen offset:0 sc1
    buffer_load_dwordx4 v[36:39], v1, s[32:35], s51 offen offset:1024 sc1
    buffer_load_dwordx4 v[40:43], v1, s[32:35], s51 offen offset:2048 sc1
    buffer_load_dwordx4 v[44:47], v1, s[32:35], s51 offen offset:3072 sc1
    s_add_u32 s67, s67, 1
    s_cmp_gt_u32 s67, 0x1e8480
    s_cbranch_scc1 main_kernel_exit
    s_waitcnt vmcnt(0)
    v_or3_b32 v125, v32, v33, v34
    v_or3_b32 v126, v35, v36, v37
    v_or3_b32 v125, v125, v38, v39
    v_or3_b32 v126, v126, v40, v41
    v_or3_b32 v125, v125, v42, v43
    v_or3_b32 v126, v126, v44, v45
    v_or3_b32 v125, v125, v46, v47
    v_or_b32 v125, v125, v126
    v_and_b32 v125, 1, v125
    v_cmp_ne_u32 vcc, 0, v125
    s_cbranch_vccnz rec_rpoll_14
    s_branch rec_rdone_13
rec_rodd_12:
rec_rpoll_15:
    buffer_load_dwordx4 v[32:35], v1, s[32:35], s51 offen offset:0 sc1
    buffer_load_dwordx4 v[36:39], v1, s[32:35], s51 offen offset:1024 sc1
    buffer_load_dwordx4 v[40:43], v1, s[32:35], s51 offen offset:2048 sc1
    buffer_load_dwordx4 v[44:47], v1, s[32:35], s51 offen offset:3072 sc1
    s_add_u32 s67, s67, 1
    s_cmp_gt_u32 s67, 0x1e8480
    s_cbranch_scc1 main_kernel_exit
    s_waitcnt vmcnt(0)
    v_and_b32 v125, v32, v33
    v_and_b32 v126, v34, v35
    v_and_b32 v125, v125, v36
    v_and_b32 v126, v126, v37
    v_and_b32 v125, v125, v38
    v_and_b32 v126, v126, v39
    v_and_b32 v125, v125, v40
    v_and_b32 v126, v126, v41
    v_and_b32 v125, v125, v42
    v_and_b32 v126, v126, v43
    v_and_b32 v125, v125, v44
    v_and_b32 v126, v126, v45
    v_and_b32 v125, v125, v46
    v_and_b32 v126, v126, v47
    v_and_b32 v125, v125, v126
    v_and_b32 v125, 1, v125
    v_cmp_ne_u32 vcc, 1, v125
    s_cbranch_vccnz rec_rpoll_15
rec_rdone_13:
    v_add_f32 v32, v32, v36
    v_add_f32 v40, v40, v44
    v_add_f32 v33, v33, v37
    v_add_f32 v41, v41, v45
    v_add_f32 v34, v34, v38
    v_add_f32 v42, v42, v46
    v_add_f32 v35, v35, v39
    v_add_f32 v43, v43, v47
    v_add_f32 v32, v32, v40
    v_add_f32 v33, v33, v41
    v_add_f32 v34, v34, v42
    v_add_f32 v35, v35, v43
    s_nop 0
    v_permlane32_swap_b32 v32, v34
    v_permlane32_swap_b32 v33, v35
    v_add_f32 v32, v32, v34
    v_add_f32 v33, v33, v35
    s_nop 1
    v_permlane16_swap_b32 v32, v33
    v_add_f32 v32, v32, v33
    s_nop 1
    v_add_f32_dpp v32, v32, v32 row_ror:8 row_mask:0xf bank_mask:0xf
    s_nop 1
    v_mov_b32_dpp v33, v32 quad_perm:[2,3,0,1] row_mask:0xf bank_mask:0xf
    v_cvt_pk_bf16_f32 v9, v32, v33
    v_min_u32 v9, -2, v9
    s_add_u32 s66, s66, 0x2000
    s_add_u32 s60, s66, s52
    buffer_store_dword v9, v123, s[28:31], s60 offen
    s_branch rec_wjoin_11
rec_wslow_10:
    s_waitcnt lgkmcnt(1)
    v_smfmac_f32_16x16x64_bf16 v[80:83], v[16:19], v[88:95], v51
    ds_read_b128 v[88:91], v14 offset:9216
    ds_read_b128 v[92:95], v14 offset:11264
    s_waitcnt lgkmcnt(2)
    v_smfmac_f32_16x16x64_bf16 v[80:83], v[20:23], v[96:103], v51
    ds_read_b128 v[96:99], v14 offset:13312
    ds_read_b128 v[100:103], v14 offset:15360
    v_smfmac_f32_16x16x64_bf16 v[84:87], v[16:19], v[24:31], v51
    ds_read_b128 v[24:27], v14 offset:16384
    ds_read_b128 v[28:31], v14 offset:18432
    v_smfmac_f32_16x16x64_bf16 v[84:87], v[20:23], v[112:119], v51
    ds_read_b128 v[112:115], v14 offset:20480
    ds_read_b128 v[116:119], v14 offset:22528
    v_smfmac_f32_16x16x64_bf16 v[104:107], v[16:19], v[32:39], v51
    ds_read_b128 v[32:35], v14 offset:17408
    ds_read_b128 v[36:39], v14 offset:19456
    v_smfmac_f32_16x16x64_bf16 v[104:107], v[20:23], v[40:47], v51
    ds_read_b128 v[40:43], v14 offset:21504
    ds_read_b128 v[44:47], v14 offset:23552
    v_permlane32_swap_b32 v80, v84
    v_permlane32_swap_b32 v81, v85
    v_permlane32_swap_b32 v82, v86
    v_permlane32_swap_b32 v83, v87
    v_add_f32 v80, v80, v84
    v_add_f32 v81, v81, v85
    v_add_f32 v82, v82, v86
    v_add_f32 v83, v83, v87
    v_bfi_b32 v84, 1, v125, v80
    v_bfi_b32 v85, 1, v125, v81
    v_bfi_b32 v86, 1, v125, v82
    v_bfi_b32 v87, 1, v125, v83
    buffer_store_dwordx4 v[84:87], v7, s[32:35], s80 offen sc1
    v_mov_b32 v80, 0
    v_mov_b32 v81, 0
    v_mov_b32 v82, 0
    v_mov_b32 v83, 0
    s_nop 0
    v_mov_b32 v84, 0
    v_mov_b32 v85, 0
    v_mov_b32 v86, 0
    v_mov_b32 v87, 0
    s_waitcnt lgkmcnt(10)
    v_smfmac_f32_16x16x64_bf16 v[108:111], v[16:19], v[88:95], v51
    ds_read_b128 v[88:91], v14 offset:24576
    ds_read_b128 v[92:95], v14 offset:26624
    s_waitcnt lgkmcnt(10)
    v_smfmac_f32_16x16x64_bf16 v[108:111], v[20:23], v[96:103], v51
    ds_read_b128 v[96:99], v14 offset:28672
    ds_read_b128 v[100:103], v14 offset:30720
    s_waitcnt lgkmcnt(10)
    v_smfmac_f32_16x16x64_bf16 v[80:83], v[16:19], v[24:31], v51
    ds_read_b128 v[24:27], v14 offset:25600
    ds_read_b128 v[28:31], v14 offset:27648
    s_waitcnt lgkmcnt(10)
    v_smfmac_f32_16x16x64_bf16 v[80:83], v[20:23], v[112:119], v51
    ds_read_b128 v[112:115], v14 offset:29696
    ds_read_b128 v[116:119], v14 offset:31744
    v_permlane32_swap_b32 v104, v108
    v_permlane32_swap_b32 v105, v109
    v_permlane32_swap_b32 v106, v110
    v_permlane32_swap_b32 v107, v111
    v_add_f32 v104, v104, v108
    v_add_f32 v105, v105, v109
    v_add_f32 v106, v106, v110
    v_add_f32 v107, v107, v111
    v_bfi_b32 v108, 1, v125, v104
    v_bfi_b32 v109, 1, v125, v105
    v_bfi_b32 v110, 1, v125, v106
    v_bfi_b32 v111, 1, v125, v107
    buffer_store_dwordx4 v[108:111], v7, s[32:35], s81 offen sc1
    v_mov_b32 v104, 0
    v_mov_b32 v105, 0
    v_mov_b32 v106, 0
    v_mov_b32 v107, 0
    s_nop 0
    v_mov_b32 v108, 0
    v_mov_b32 v109, 0
    v_mov_b32 v110, 0
    v_mov_b32 v111, 0
    s_waitcnt lgkmcnt(10)
    v_smfmac_f32_16x16x64_bf16 v[84:87], v[16:19], v[32:39], v51
    s_waitcnt lgkmcnt(8)
    v_smfmac_f32_16x16x64_bf16 v[84:87], v[20:23], v[40:47], v51
    s_waitcnt lgkmcnt(6)
    v_smfmac_f32_16x16x64_bf16 v[104:107], v[16:19], v[88:95], v51
    s_waitcnt lgkmcnt(4)
    v_smfmac_f32_16x16x64_bf16 v[104:107], v[20:23], v[96:103], v51
    s_nop 3
    v_permlane32_swap_b32 v80, v84
    v_permlane32_swap_b32 v81, v85
    v_permlane32_swap_b32 v82, v86
    v_permlane32_swap_b32 v83, v87
    v_add_f32 v80, v80, v84
    v_add_f32 v81, v81, v85
    v_add_f32 v82, v82, v86
    v_add_f32 v83, v83, v87
    v_bfi_b32 v84, 1, v125, v80
    v_bfi_b32 v85, 1, v125, v81
    v_bfi_b32 v86, 1, v125, v82
    v_bfi_b32 v87, 1, v125, v83
    buffer_store_dwordx4 v[84:87], v7, s[32:35], s82 offen sc1
    s_waitcnt lgkmcnt(2)
    v_smfmac_f32_16x16x64_bf16 v[108:111], v[16:19], v[24:31], v51
    s_waitcnt lgkmcnt(0)
    v_smfmac_f32_16x16x64_bf16 v[108:111], v[20:23], v[112:119], v51
    s_nop 7
    v_permlane32_swap_b32 v104, v108
    v_permlane32_swap_b32 v105, v109
    v_permlane32_swap_b32 v106, v110
    v_permlane32_swap_b32 v107, v111
    v_add_f32 v104, v104, v108
    v_add_f32 v105, v105, v109
    v_add_f32 v106, v106, v110
    v_add_f32 v107, v107, v111
    v_bfi_b32 v108, 1, v125, v104
    v_bfi_b32 v109, 1, v125, v105
    v_bfi_b32 v110, 1, v125, v106
    v_bfi_b32 v111, 1, v125, v107
    buffer_store_dwordx4 v[108:111], v7, s[32:35], s83 offen sc1
    s_cmp_lg_u32 s60, 0
    s_cbranch_scc1 rec_rodd_16
rec_rpoll_18:
    buffer_load_dwordx4 v[32:35], v1, s[32:35], s51 offen offset:0 sc1
    buffer_load_dwordx4 v[36:39], v1, s[32:35], s51 offen offset:1024 sc1
    buffer_load_dwordx4 v[40:43], v1, s[32:35], s51 offen offset:2048 sc1
    buffer_load_dwordx4 v[44:47], v1, s[32:35], s51 offen offset:3072 sc1
    s_add_u32 s67, s67, 1
    s_cmp_gt_u32 s67, 0x1e8480
    s_cbranch_scc1 main_kernel_exit
    s_waitcnt vmcnt(0)
    v_or3_b32 v125, v32, v33, v34
    v_or3_b32 v126, v35, v36, v37
    v_or3_b32 v125, v125, v38, v39
    v_or3_b32 v126, v126, v40, v41
    v_or3_b32 v125, v125, v42, v43
    v_or3_b32 v126, v126, v44, v45
    v_or3_b32 v125, v125, v46, v47
    v_or_b32 v125, v125, v126
    v_and_b32 v125, 1, v125
    v_cmp_ne_u32 vcc, 0, v125
    s_cbranch_vccnz rec_rpoll_18
    s_branch rec_rdone_17
rec_rodd_16:
rec_rpoll_19:
    buffer_load_dwordx4 v[32:35], v1, s[32:35], s51 offen offset:0 sc1
    buffer_load_dwordx4 v[36:39], v1, s[32:35], s51 offen offset:1024 sc1
    buffer_load_dwordx4 v[40:43], v1, s[32:35], s51 offen offset:2048 sc1
    buffer_load_dwordx4 v[44:47], v1, s[32:35], s51 offen offset:3072 sc1
    s_add_u32 s67, s67, 1
    s_cmp_gt_u32 s67, 0x1e8480
    s_cbranch_scc1 main_kernel_exit
    s_waitcnt vmcnt(0)
    v_and_b32 v125, v32, v33
    v_and_b32 v126, v34, v35
    v_and_b32 v125, v125, v36
    v_and_b32 v126, v126, v37
    v_and_b32 v125, v125, v38
    v_and_b32 v126, v126, v39
    v_and_b32 v125, v125, v40
    v_and_b32 v126, v126, v41
    v_and_b32 v125, v125, v42
    v_and_b32 v126, v126, v43
    v_and_b32 v125, v125, v44
    v_and_b32 v126, v126, v45
    v_and_b32 v125, v125, v46
    v_and_b32 v126, v126, v47
    v_and_b32 v125, v125, v126
    v_and_b32 v125, 1, v125
    v_cmp_ne_u32 vcc, 1, v125
    s_cbranch_vccnz rec_rpoll_19
rec_rdone_17:
    v_add_f32 v32, v32, v36
    v_add_f32 v40, v40, v44
    v_add_f32 v33, v33, v37
    v_add_f32 v41, v41, v45
    v_add_f32 v34, v34, v38
    v_add_f32 v42, v42, v46
    v_add_f32 v35, v35, v39
    v_add_f32 v43, v43, v47
    v_add_f32 v32, v32, v40
    v_add_f32 v33, v33, v41
    v_add_f32 v34, v34, v42
    v_add_f32 v35, v35, v43
    s_nop 0
    v_permlane32_swap_b32 v32, v34
    v_permlane32_swap_b32 v33, v35
    v_add_f32 v32, v32, v34
    v_add_f32 v33, v33, v35
    s_nop 1
    v_permlane16_swap_b32 v32, v33
    v_add_f32 v32, v32, v33
    s_nop 1
    v_add_f32_dpp v32, v32, v32 row_ror:8 row_mask:0xf bank_mask:0xf
    s_nop 1
    v_mov_b32_dpp v33, v32 quad_perm:[2,3,0,1] row_mask:0xf bank_mask:0xf
    v_cvt_pk_bf16_f32 v9, v32, v33
    v_min_u32 v9, -2, v9
    s_add_u32 s66, s66, 0x2000
    s_add_u32 s60, s66, s52
    buffer_store_dword v9, v123, s[28:31], s60 offen sc1
rec_wjoin_11:
    s_add_u32 s62, s62, 1
    s_add_u32 s60, s66, s53
    buffer_load_dwordx4 v[16:19], v1, s[28:31], s60 offen offset:0 sc1
    buffer_load_dwordx4 v[20:23], v1, s[28:31], s60 offen offset:1024 sc1
    v_mov_b32 v104, v64
    v_mov_b32 v105, v65
    v_mov_b32 v106, v66
    v_mov_b32 v107, v67
    v_mov_b32 v108, v68
    v_mov_b32 v109, v69
    v_mov_b32 v110, v70
    v_mov_b32 v111, v71
    v_mov_b32 v112, v72
    v_mov_b32 v113, v73
    v_mov_b32 v114, v74
    v_mov_b32 v115, v75
    v_mov_b32 v116, v76
    v_mov_b32 v117, v77
    v_mov_b32 v118, v78
    v_mov_b32 v119, v79
    v_mov_b32 v80, 0
    v_mov_b32 v81, 0
    v_mov_b32 v82, 0
    v_mov_b32 v83, 0
    v_mov_b32 v84, 0
    v_mov_b32 v85, 0
    v_mov_b32 v86, 0
    v_mov_b32 v87, 0
    v_mov_b32 v88, 0
    v_mov_b32 v89, 0
    v_mov_b32 v90, 0
    v_mov_b32 v91, 0
    v_mov_b32 v92, 0
    v_mov_b32 v93, 0
    v_mov_b32 v94, 0
    v_mov_b32 v95, 0
    v_mov_b32 v96, 0
    v_mov_b32 v97, 0
    v_mov_b32 v98, 0
    v_mov_b32 v99, 0
    v_mov_b32 v100, 0
    v_mov_b32 v101, 0
    v_mov_b32 v102, 0
    v_mov_b32 v103, 0
    s_branch main_kernel_mpollb_chk
main_kernel_mpollb:
    buffer_load_dwordx4 v[16:19], v1, s[28:31], s60 offen offset:0 sc1
    buffer_load_dwordx4 v[20:23], v1, s[28:31], s60 offen offset:1024 sc1
    s_add_u32 s67, s67, 1
    s_cmp_gt_u32 s67, 0x1e8480
    s_cbranch_scc1 main_kernel_exit
main_kernel_mpollb_chk:
    s_waitcnt vmcnt(0)
    v_max3_u32 v125, v16, v17, v18
    v_max3_u32 v126, v19, v20, v21
    v_max3_u32 v125, v125, v22, v23
    v_max_u32 v125, v125, v126
    v_cmp_eq_u32 vcc, -1, v125
    s_cbranch_vccnz main_kernel_mpollb
    s_branch main_kernel_step
main_kernel_exit_pub:
    s_lshr_b32 s60, s62, 2
    s_lshl_b32 s60, s60, 15
    s_and_b32 s61, s62, 3
    s_lshl_b32 s61, s61, 6
    s_add_u32 s60, s60, s61
    s_add_u32 s60, s60, s48
    buffer_store_dword v9, v8, s[36:39], s60 offen sc1
main_kernel_exit_st:
main_kernel_exit:
    s_endpgm
w_entry:
    s_mov_b32 s92, 0
    s_mov_b32 s93, 0
w_loop:
    s_add_u32 s8, s6, 0x3000
    s_addc_u32 s9, s7, 0
    s_and_b32 s9, s9, 0xffff
    s_mov_b32 s10, 0x10000
    s_mov_b32 s11, 0x20000
    s_cmp_lg_u32 s3, 0
    s_cbranch_scc1 w_nz_20
    s_mov_b64 exec, 1
    v_mov_b32 v250, 0x48
    v_mov_b32 v251, 1
    buffer_atomic_add v251, v250, s[96:99], 0 offen sc0
    v_mov_b32 v250, 0x10000
    s_waitcnt vmcnt(0)
    ds_write_b32 v250, v251
    s_waitcnt lgkmcnt(0)
    s_mov_b64 exec, -1
w_nz_20:
    s_barrier
    v_mov_b32 v250, 0x10000
    ds_read_b32 v251, v250
    s_waitcnt lgkmcnt(0)
    v_readfirstlane_b32 s5, v251
    s_barrier
    s_cmp_ge_u32 s5, 0x170d
    s_cbranch_scc1 main_kernel_exit_w
    s_cmp_ge_u32 s5, 49
    s_cbranch_scc1 w_nb_31
    s_mov_b32 s24, 24
    s_cmp_eq_u32 s5, 0
    s_cbranch_scc1 w_ini_32
    s_sub_u32 s24, s5, 1
    s_cmp_lt_u32 s5, 25
    s_cbranch_scc1 w_md_33
    s_sub_u32 s24, s5, 25
w_ini_32:
    s_load_dwordx2 s[20:21], s[0:1], 8
    s_lshl_b32 s25, s3, 6
    v_add_u32 v1, s25, v0
    s_waitcnt lgkmcnt(0)
    s_cmp_eq_u32 s24, 24
    s_cbranch_scc1 init_m0_34
    s_add_u32 s40, s6, 0x16000
    s_addc_u32 s41, s7, 0
    s_and_b32 s41, s41, 0xffff
    s_mov_b32 s42, 0x180000
    s_mov_b32 s43, 0x20000
    s_lshl_b32 s25, s24, 16
    v_lshlrev_b32 v3, 4, v1
    v_mov_b32 v4, -1
    v_mov_b32 v5, -1
    v_mov_b32 v6, -1
    v_mov_b32 v7, -1
    v_and_b32 v8, 15, v1
    v_cmp_gt_u32 vcc, 4, v8
    v_mov_b32 v9, 0x7ffffff0
    s_nop 0
    v_cndmask_b32 v9, v3, v9, vcc
    s_cmp_eq_u32 s24, 16
    s_cselect_b32 s26, 1, 0
    s_cmp_eq_u32 s26, 1
    s_cbranch_scc1 init_pl_35
    buffer_store_dwordx4 v[4:7], v3, s[40:43], s25 offen sc1
    s_branch init_pq_36
init_pl_35:
    buffer_store_dwordx4 v[4:7], v9, s[40:43], s25 offen sc1
init_pq_36:
    s_nop 0
    s_add_u32 s25, s25, 0x1000
    s_cmp_eq_u32 s26, 1
    s_cbranch_scc1 init_pl_37
    buffer_store_dwordx4 v[4:7], v3, s[40:43], s25 offen sc1
    s_branch init_pq_38
init_pl_37:
    buffer_store_dwordx4 v[4:7], v9, s[40:43], s25 offen sc1
init_pq_38:
    s_nop 0
    s_add_u32 s25, s25, 0x1000
    s_cmp_eq_u32 s26, 1
    s_cbranch_scc1 init_pl_39
    buffer_store_dwordx4 v[4:7], v3, s[40:43], s25 offen sc1
    s_branch init_pq_40
init_pl_39:
    buffer_store_dwordx4 v[4:7], v9, s[40:43], s25 offen sc1
init_pq_40:
    s_nop 0
    s_add_u32 s25, s25, 0x1000
    s_cmp_eq_u32 s26, 1
    s_cbranch_scc1 init_pl_41
    buffer_store_dwordx4 v[4:7], v3, s[40:43], s25 offen sc1
    s_branch init_pq_42
init_pl_41:
    buffer_store_dwordx4 v[4:7], v9, s[40:43], s25 offen sc1
init_pq_42:
    s_nop 0
    s_add_u32 s25, s25, 0x1000
    s_cmp_eq_u32 s26, 1
    s_cbranch_scc1 init_pl_43
    buffer_store_dwordx4 v[4:7], v3, s[40:43], s25 offen sc1
    s_branch init_pq_44
init_pl_43:
    buffer_store_dwordx4 v[4:7], v9, s[40:43], s25 offen sc1
init_pq_44:
    s_nop 0
    s_add_u32 s25, s25, 0x1000
    s_cmp_eq_u32 s26, 1
    s_cbranch_scc1 init_pl_45
    buffer_store_dwordx4 v[4:7], v3, s[40:43], s25 offen sc1
    s_branch init_pq_46
init_pl_45:
    buffer_store_dwordx4 v[4:7], v9, s[40:43], s25 offen sc1
init_pq_46:
    s_nop 0
    s_add_u32 s25, s25, 0x1000
    s_cmp_eq_u32 s26, 1
    s_cbranch_scc1 init_pl_47
    buffer_store_dwordx4 v[4:7], v3, s[40:43], s25 offen sc1
    s_branch init_pq_48
init_pl_47:
    buffer_store_dwordx4 v[4:7], v9, s[40:43], s25 offen sc1
init_pq_48:
    s_nop 0
    s_add_u32 s25, s25, 0x1000
    s_cmp_eq_u32 s26, 1
    s_cbranch_scc1 init_pl_49
    buffer_store_dwordx4 v[4:7], v3, s[40:43], s25 offen sc1
    s_branch init_pq_50
init_pl_49:
    buffer_store_dwordx4 v[4:7], v9, s[40:43], s25 offen sc1
init_pq_50:
    s_nop 0
    s_add_u32 s25, s25, 0x1000
    buffer_store_dwordx4 v[4:7], v3, s[40:43], s25 offen sc1
    s_nop 0
    s_add_u32 s25, s25, 0x1000
    buffer_store_dwordx4 v[4:7], v3, s[40:43], s25 offen sc1
    s_nop 0
    s_add_u32 s25, s25, 0x1000
    buffer_store_dwordx4 v[4:7], v3, s[40:43], s25 offen sc1
    s_nop 0
    s_add_u32 s25, s25, 0x1000
    buffer_store_dwordx4 v[4:7], v3, s[40:43], s25 offen sc1
    s_nop 0
    s_add_u32 s25, s25, 0x1000
    buffer_store_dwordx4 v[4:7], v3, s[40:43], s25 offen sc1
    s_nop 0
    s_add_u32 s25, s25, 0x1000
    buffer_store_dwordx4 v[4:7], v3, s[40:43], s25 offen sc1
    s_nop 0
    s_add_u32 s25, s25, 0x1000
    buffer_store_dwordx4 v[4:7], v3, s[40:43], s25 offen sc1
    s_nop 0
    s_add_u32 s25, s25, 0x1000
    buffer_store_dwordx4 v[4:7], v3, s[40:43], s25 offen sc1
    s_nop 0
    s_add_u32 s25, s25, 0x1000
    s_waitcnt vmcnt(0)
    s_barrier
    s_cmp_lg_u32 s3, 0
    s_cbranch_scc1 w_loop
    s_mov_b64 exec, 1
    v_mov_b32 v250, 0xa0
    v_mov_b32 v251, 1
    buffer_atomic_add v251, v250, s[96:99], 0 offen
    s_mov_b64 exec, -1
    s_branch w_loop
init_m0_34:
    s_mov_b32 s40, s20
    s_mov_b32 s41, s21
    s_and_b32 s41, s41, 0xffff
    s_mov_b32 s42, 0x2000
    s_mov_b32 s43, 0x20000
    s_add_u32 s44, s6, 0x14000
    s_addc_u32 s45, s7, 0
    s_and_b32 s45, s45, 0xffff
    s_mov_b32 s46, 0x2000
    s_mov_b32 s47, 0x20000
    s_add_u32 s48, s6, 0x3000
    s_addc_u32 s49, s7, 0
    s_and_b32 s49, s49, 0xffff
    s_mov_b32 s50, 0x10000
    s_mov_b32 s51, 0x20000
    s_add_u32 s52, s6, 0x116000
    s_addc_u32 s53, s7, 0
    s_and_b32 s53, s53, 0xffff
    s_mov_b32 s54, 0x80000
    s_mov_b32 s55, 0x20000
    v_lshlrev_b32 v4, 4, v1
    v_mov_b32 v16, 0
    v_mov_b32 v17, 0
    v_mov_b32 v18, 0
    v_mov_b32 v19, 0
    s_mov_b32 s26, 0
    buffer_store_dwordx4 v[16:19], v4, s[48:51], s26 offen sc1
    s_nop 0
    s_add_u32 s26, s26, 0x1000
    buffer_store_dwordx4 v[16:19], v4, s[48:51], s26 offen sc1
    s_nop 0
    s_add_u32 s26, s26, 0x1000
    buffer_store_dwordx4 v[16:19], v4, s[48:51], s26 offen sc1
    s_nop 0
    s_add_u32 s26, s26, 0x1000
    buffer_store_dwordx4 v[16:19], v4, s[48:51], s26 offen sc1
    s_nop 0
    s_add_u32 s26, s26, 0x1000
    buffer_store_dwordx4 v[16:19], v4, s[48:51], s26 offen sc1
    s_nop 0
    s_add_u32 s26, s26, 0x1000
    buffer_store_dwordx4 v[16:19], v4, s[48:51], s26 offen sc1
    s_nop 0
    s_add_u32 s26, s26, 0x1000
    buffer_store_dwordx4 v[16:19], v4, s[48:51], s26 offen sc1
    s_nop 0
    s_add_u32 s26, s26, 0x1000
    buffer_store_dwordx4 v[16:19], v4, s[48:51], s26 offen sc1
    s_nop 0
    s_add_u32 s26, s26, 0x1000
    buffer_store_dwordx4 v[16:19], v4, s[48:51], s26 offen sc1
    s_nop 0
    s_add_u32 s26, s26, 0x1000
    buffer_store_dwordx4 v[16:19], v4, s[48:51], s26 offen sc1
    s_nop 0
    s_add_u32 s26, s26, 0x1000
    buffer_store_dwordx4 v[16:19], v4, s[48:51], s26 offen sc1
    s_nop 0
    s_add_u32 s26, s26, 0x1000
    buffer_store_dwordx4 v[16:19], v4, s[48:51], s26 offen sc1
    s_nop 0
    s_add_u32 s26, s26, 0x1000
    buffer_store_dwordx4 v[16:19], v4, s[48:51], s26 offen sc1
    s_nop 0
    s_add_u32 s26, s26, 0x1000
    buffer_store_dwordx4 v[16:19], v4, s[48:51], s26 offen sc1
    s_nop 0
    s_add_u32 s26, s26, 0x1000
    buffer_store_dwordx4 v[16:19], v4, s[48:51], s26 offen sc1
    s_nop 0
    s_add_u32 s26, s26, 0x1000
    buffer_store_dwordx4 v[16:19], v4, s[48:51], s26 offen sc1
    s_nop 0
    s_add_u32 s26, s26, 0x1000
    v_and_b32 v3, 7, v1
    v_lshlrev_b32 v3, 10, v3
    v_lshrrev_b32 v5, 3, v1
    v_lshl_add_u32 v3, v5, 4, v3
    buffer_load_dwordx4 v[8:11], v3, s[40:43], 0 offen
    buffer_load_dwordx4 v[12:15], v3, s[40:43], 0 offen offset:512
    v_and_b32 v20, 7, v1
    v_lshlrev_b32 v20, 10, v20
    v_lshrrev_b32 v21, 4, v1
    v_lshl_add_u32 v20, v21, 5, v20
    buffer_load_dwordx4 v[24:27], v20, s[40:43], 0 offen offset:0
    buffer_load_dwordx4 v[28:31], v20, s[40:43], 0 offen offset:16
    buffer_load_dwordx4 v[32:35], v20, s[40:43], 0 offen offset:512
    buffer_load_dwordx4 v[36:39], v20, s[40:43], 0 offen offset:528
    v_and_b32 v21, 8, v1
    v_cmp_ne_u32 vcc, 0, v21
    s_waitcnt vmcnt(0)
    v_min_u32 v8, -2, v8
    v_min_u32 v9, -2, v9
    v_min_u32 v10, -2, v10
    v_min_u32 v11, -2, v11
    v_min_u32 v12, -2, v12
    v_min_u32 v13, -2, v13
    v_min_u32 v14, -2, v14
    v_min_u32 v15, -2, v15
    v_cndmask_b32 v40, v24, v25, vcc
    v_min_u32 v40, -2, v40
    v_cndmask_b32 v41, v26, v27, vcc
    v_min_u32 v41, -2, v41
    v_cndmask_b32 v42, v28, v29, vcc
    v_min_u32 v42, -2, v42
    v_cndmask_b32 v43, v30, v31, vcc
    v_min_u32 v43, -2, v43
    v_cndmask_b32 v44, v32, v33, vcc
    v_min_u32 v44, -2, v44
    v_cndmask_b32 v45, v34, v35, vcc
    v_min_u32 v45, -2, v45
    v_cndmask_b32 v46, v36, v37, vcc
    v_min_u32 v46, -2, v46
    v_cndmask_b32 v47, v38, v39, vcc
    v_min_u32 v47, -2, v47
    buffer_store_dwordx4 v[40:43], v4, s[44:47], 0 offen sc1
    s_mov_b32 s25, 0x1000
    buffer_store_dwordx4 v[44:47], v4, s[44:47], s25 offen sc1
    v_lshrrev_b32 v5, 5, v1
    v_lshlrev_b32 v5, 11, v5
    v_bfe_u32 v6, v1, 2, 1
    v_lshl_add_u32 v5, v6, 10, v5
    v_and_b32 v6, 3, v1
    v_lshl_add_u32 v5, v6, 4, v5
    v_bfe_u32 v6, v1, 3, 2
    v_lshl_add_u32 v5, v6, 8, v5
    s_mov_b32 s25, 0x4000
    buffer_store_dwordx4 v[8:11], v5, s[52:55], 0 offen sc1
    buffer_store_dwordx4 v[12:15], v5, s[52:55], s25 offen sc1
    s_waitcnt vmcnt(0)
    s_barrier
    s_cmp_lg_u32 s3, 0
    s_cbranch_scc1 w_loop
    s_mov_b64 exec, 1
    v_mov_b32 v250, 0x80
    v_mov_b32 v251, 1
    buffer_atomic_add v251, v250, s[96:99], 0 offen
    s_mov_b64 exec, -1
    s_branch w_loop
w_md_33:
    s_load_dwordx4 s[16:19], s[0:1], 0x60
    s_waitcnt lgkmcnt(0)
    s_mov_b32 s40, s16
    s_mov_b32 s41, s17
    s_and_b32 s41, s41, 0xffff
    s_mov_b32 s42, 0x400
    s_mov_b32 s43, 0x20000
    s_mov_b32 s44, s18
    s_mov_b32 s45, s19
    s_and_b32 s45, s45, 0xffff
    s_mov_b32 s46, 0x300000
    s_mov_b32 s47, 0x20000
    s_mov_b32 s48, s6
    s_mov_b32 s49, s7
    s_and_b32 s49, s49, 0xffff
    s_mov_b32 s50, 0x3000
    s_mov_b32 s51, 0x20000
    s_lshl_b32 s25, s3, 8
    v_lshlrev_b32 v3, 1, v0
    buffer_load_ushort v4, v3, s[40:43], s25 offen
    buffer_load_ushort v5, v3, s[40:43], s25 offen offset:128
    v_lshlrev_b32 v3, 2, v0
    s_mul_i32 s26, s3, 0xc0000
    s_lshl_b32 s27, s24, 8
    s_add_u32 s26, s26, s27
    buffer_load_dword v16, v3, s[44:47], s26 offen
    s_add_u32 s26, s26, 0x1800
    buffer_load_dword v17, v3, s[44:47], s26 offen
    s_add_u32 s26, s26, 0x1800
    buffer_load_dword v18, v3, s[44:47], s26 offen
    s_add_u32 s26, s26, 0x1800
    buffer_load_dword v19, v3, s[44:47], s26 offen
    s_add_u32 s26, s26, 0x1800
    buffer_load_dword v20, v3, s[44:47], s26 offen
    s_add_u32 s26, s26, 0x1800
    buffer_load_dword v21, v3, s[44:47], s26 offen
    s_add_u32 s26, s26, 0x1800
    buffer_load_dword v22, v3, s[44:47], s26 offen
    s_add_u32 s26, s26, 0x1800
    buffer_load_dword v23, v3, s[44:47], s26 offen
    s_add_u32 s26, s26, 0x1800
    buffer_load_dword v24, v3, s[44:47], s26 offen
    s_add_u32 s26, s26, 0x1800
    buffer_load_dword v25, v3, s[44:47], s26 offen
    s_add_u32 s26, s26, 0x1800
    buffer_load_dword v26, v3, s[44:47], s26 offen
    s_add_u32 s26, s26, 0x1800
    buffer_load_dword v27, v3, s[44:47], s26 offen
    s_add_u32 s26, s26, 0x1800
    buffer_load_dword v28, v3, s[44:47], s26 offen
    s_add_u32 s26, s26, 0x1800
    buffer_load_dword v29, v3, s[44:47], s26 offen
    s_add_u32 s26, s26, 0x1800
    buffer_load_dword v30, v3, s[44:47], s26 offen
    s_add_u32 s26, s26, 0x1800
    buffer_load_dword v31, v3, s[44:47], s26 offen
    s_add_u32 s26, s26, 0x1800
    buffer_load_dword v32, v3, s[44:47], s26 offen
    s_add_u32 s26, s26, 0x1800
    buffer_load_dword v33, v3, s[44:47], s26 offen
    s_add_u32 s26, s26, 0x1800
    buffer_load_dword v34, v3, s[44:47], s26 offen
    s_add_u32 s26, s26, 0x1800
    buffer_load_dword v35, v3, s[44:47], s26 offen
    s_add_u32 s26, s26, 0x1800
    buffer_load_dword v36, v3, s[44:47], s26 offen
    s_add_u32 s26, s26, 0x1800
    buffer_load_dword v37, v3, s[44:47], s26 offen
    s_add_u32 s26, s26, 0x1800
    buffer_load_dword v38, v3, s[44:47], s26 offen
    s_add_u32 s26, s26, 0x1800
    buffer_load_dword v39, v3, s[44:47], s26 offen
    s_add_u32 s26, s26, 0x1800
    buffer_load_dword v40, v3, s[44:47], s26 offen
    s_add_u32 s26, s26, 0x1800
    buffer_load_dword v41, v3, s[44:47], s26 offen
    s_add_u32 s26, s26, 0x1800
    buffer_load_dword v42, v3, s[44:47], s26 offen
    s_add_u32 s26, s26, 0x1800
    buffer_load_dword v43, v3, s[44:47], s26 offen
    s_add_u32 s26, s26, 0x1800
    buffer_load_dword v44, v3, s[44:47], s26 offen
    s_add_u32 s26, s26, 0x1800
    buffer_load_dword v45, v3, s[44:47], s26 offen
    s_add_u32 s26, s26, 0x1800
    buffer_load_dword v46, v3, s[44:47], s26 offen
    s_add_u32 s26, s26, 0x1800
    buffer_load_dword v47, v3, s[44:47], s26 offen
    s_add_u32 s26, s26, 0x1800
    buffer_load_dword v48, v3, s[44:47], s26 offen
    s_add_u32 s26, s26, 0x1800
    buffer_load_dword v49, v3, s[44:47], s26 offen
    s_add_u32 s26, s26, 0x1800
    buffer_load_dword v50, v3, s[44:47], s26 offen
    s_add_u32 s26, s26, 0x1800
    buffer_load_dword v51, v3, s[44:47], s26 offen
    s_add_u32 s26, s26, 0x1800
    buffer_load_dword v52, v3, s[44:47], s26 offen
    s_add_u32 s26, s26, 0x1800
    buffer_load_dword v53, v3, s[44:47], s26 offen
    s_add_u32 s26, s26, 0x1800
    buffer_load_dword v54, v3, s[44:47], s26 offen
    s_add_u32 s26, s26, 0x1800
    buffer_load_dword v55, v3, s[44:47], s26 offen
    s_add_u32 s26, s26, 0x1800
    buffer_load_dword v56, v3, s[44:47], s26 offen
    s_add_u32 s26, s26, 0x1800
    buffer_load_dword v57, v3, s[44:47], s26 offen
    s_add_u32 s26, s26, 0x1800
    buffer_load_dword v58, v3, s[44:47], s26 offen
    s_add_u32 s26, s26, 0x1800
    buffer_load_dword v59, v3, s[44:47], s26 offen
    s_add_u32 s26, s26, 0x1800
    buffer_load_dword v60, v3, s[44:47], s26 offen
    s_add_u32 s26, s26, 0x1800
    buffer_load_dword v61, v3, s[44:47], s26 offen
    s_add_u32 s26, s26, 0x1800
    buffer_load_dword v62, v3, s[44:47], s26 offen
    s_add_u32 s26, s26, 0x1800
    buffer_load_dword v63, v3, s[44:47], s26 offen
    s_add_u32 s26, s26, 0x1800
    buffer_load_dword v64, v3, s[44:47], s26 offen
    s_add_u32 s26, s26, 0x1800
    buffer_load_dword v65, v3, s[44:47], s26 offen
    s_add_u32 s26, s26, 0x1800
    buffer_load_dword v66, v3, s[44:47], s26 offen
    s_add_u32 s26, s26, 0x1800
    buffer_load_dword v67, v3, s[44:47], s26 offen
    s_add_u32 s26, s26, 0x1800
    buffer_load_dword v68, v3, s[44:47], s26 offen
    s_add_u32 s26, s26, 0x1800
    buffer_load_dword v69, v3, s[44:47], s26 offen
    s_add_u32 s26, s26, 0x1800
    buffer_load_dword v70, v3, s[44:47], s26 offen
    s_add_u32 s26, s26, 0x1800
    buffer_load_dword v71, v3, s[44:47], s26 offen
    s_add_u32 s26, s26, 0x1800
    buffer_load_dword v72, v3, s[44:47], s26 offen
    s_add_u32 s26, s26, 0x1800
    buffer_load_dword v73, v3, s[44:47], s26 offen
    s_add_u32 s26, s26, 0x1800
    buffer_load_dword v74, v3, s[44:47], s26 offen
    s_add_u32 s26, s26, 0x1800
    buffer_load_dword v75, v3, s[44:47], s26 offen
    s_add_u32 s26, s26, 0x1800
    s_waitcnt vmcnt(60)
    v_lshlrev_b32 v4, 16, v4
    v_mul_f32 v6, 0xbfb8aa3b, v4
    v_exp_f32 v6, v6
    s_nop 0
    v_add_f32 v6, 1.0, v6
    v_rcp_f32 v6, v6
    s_nop 0
    v_mul_f32 v4, v4, v6
    v_cvt_pk_bf16_f32 v4, v4, v4
    v_lshlrev_b32 v4, 16, v4
    v_lshlrev_b32 v5, 16, v5
    v_mul_f32 v6, 0xbfb8aa3b, v5
    v_exp_f32 v6, v6
    s_nop 0
    v_add_f32 v6, 1.0, v6
    v_rcp_f32 v6, v6
    s_nop 0
    v_mul_f32 v5, v5, v6
    v_cvt_pk_bf16_f32 v5, v5, v5
    v_lshlrev_b32 v5, 16, v5
    v_mov_b32 v8, 0
    v_mov_b32 v9, 0
    buffer_load_dword v76, v3, s[44:47], s26 offen
    s_add_u32 s26, s26, 0x1800
    v_readlane_b32 s28, v4, 0
    s_waitcnt vmcnt(60)
    v_lshlrev_b32 v10, 16, v16
    v_and_b32 v11, 0xffff0000, v16
    v_fmac_f32 v8, s28, v10
    v_fmac_f32 v9, s28, v11
    buffer_load_dword v77, v3, s[44:47], s26 offen
    s_add_u32 s26, s26, 0x1800
    v_readlane_b32 s28, v4, 1
    s_waitcnt vmcnt(60)
    v_lshlrev_b32 v10, 16, v17
    v_and_b32 v11, 0xffff0000, v17
    v_fmac_f32 v8, s28, v10
    v_fmac_f32 v9, s28, v11
    buffer_load_dword v78, v3, s[44:47], s26 offen
    s_add_u32 s26, s26, 0x1800
    v_readlane_b32 s28, v4, 2
    s_waitcnt vmcnt(60)
    v_lshlrev_b32 v10, 16, v18
    v_and_b32 v11, 0xffff0000, v18
    v_fmac_f32 v8, s28, v10
    v_fmac_f32 v9, s28, v11
    buffer_load_dword v79, v3, s[44:47], s26 offen
    s_add_u32 s26, s26, 0x1800
    v_readlane_b32 s28, v4, 3
    s_waitcnt vmcnt(60)
    v_lshlrev_b32 v10, 16, v19
    v_and_b32 v11, 0xffff0000, v19
    v_fmac_f32 v8, s28, v10
    v_fmac_f32 v9, s28, v11
    buffer_load_dword v80, v3, s[44:47], s26 offen
    s_add_u32 s26, s26, 0x1800
    v_readlane_b32 s28, v4, 4
    s_waitcnt vmcnt(60)
    v_lshlrev_b32 v10, 16, v20
    v_and_b32 v11, 0xffff0000, v20
    v_fmac_f32 v8, s28, v10
    v_fmac_f32 v9, s28, v11
    buffer_load_dword v81, v3, s[44:47], s26 offen
    s_add_u32 s26, s26, 0x1800
    v_readlane_b32 s28, v4, 5
    s_waitcnt vmcnt(60)
    v_lshlrev_b32 v10, 16, v21
    v_and_b32 v11, 0xffff0000, v21
    v_fmac_f32 v8, s28, v10
    v_fmac_f32 v9, s28, v11
    buffer_load_dword v82, v3, s[44:47], s26 offen
    s_add_u32 s26, s26, 0x1800
    v_readlane_b32 s28, v4, 6
    s_waitcnt vmcnt(60)
    v_lshlrev_b32 v10, 16, v22
    v_and_b32 v11, 0xffff0000, v22
    v_fmac_f32 v8, s28, v10
    v_fmac_f32 v9, s28, v11
    buffer_load_dword v83, v3, s[44:47], s26 offen
    s_add_u32 s26, s26, 0x1800
    v_readlane_b32 s28, v4, 7
    s_waitcnt vmcnt(60)
    v_lshlrev_b32 v10, 16, v23
    v_and_b32 v11, 0xffff0000, v23
    v_fmac_f32 v8, s28, v10
    v_fmac_f32 v9, s28, v11
    buffer_load_dword v84, v3, s[44:47], s26 offen
    s_add_u32 s26, s26, 0x1800
    v_readlane_b32 s28, v4, 8
    s_waitcnt vmcnt(60)
    v_lshlrev_b32 v10, 16, v24
    v_and_b32 v11, 0xffff0000, v24
    v_fmac_f32 v8, s28, v10
    v_fmac_f32 v9, s28, v11
    buffer_load_dword v85, v3, s[44:47], s26 offen
    s_add_u32 s26, s26, 0x1800
    v_readlane_b32 s28, v4, 9
    s_waitcnt vmcnt(60)
    v_lshlrev_b32 v10, 16, v25
    v_and_b32 v11, 0xffff0000, v25
    v_fmac_f32 v8, s28, v10
    v_fmac_f32 v9, s28, v11
    buffer_load_dword v86, v3, s[44:47], s26 offen
    s_add_u32 s26, s26, 0x1800
    v_readlane_b32 s28, v4, 10
    s_waitcnt vmcnt(60)
    v_lshlrev_b32 v10, 16, v26
    v_and_b32 v11, 0xffff0000, v26
    v_fmac_f32 v8, s28, v10
    v_fmac_f32 v9, s28, v11
    buffer_load_dword v87, v3, s[44:47], s26 offen
    s_add_u32 s26, s26, 0x1800
    v_readlane_b32 s28, v4, 11
    s_waitcnt vmcnt(60)
    v_lshlrev_b32 v10, 16, v27
    v_and_b32 v11, 0xffff0000, v27
    v_fmac_f32 v8, s28, v10
    v_fmac_f32 v9, s28, v11
    buffer_load_dword v88, v3, s[44:47], s26 offen
    s_add_u32 s26, s26, 0x1800
    v_readlane_b32 s28, v4, 12
    s_waitcnt vmcnt(60)
    v_lshlrev_b32 v10, 16, v28
    v_and_b32 v11, 0xffff0000, v28
    v_fmac_f32 v8, s28, v10
    v_fmac_f32 v9, s28, v11
    buffer_load_dword v89, v3, s[44:47], s26 offen
    s_add_u32 s26, s26, 0x1800
    v_readlane_b32 s28, v4, 13
    s_waitcnt vmcnt(60)
    v_lshlrev_b32 v10, 16, v29
    v_and_b32 v11, 0xffff0000, v29
    v_fmac_f32 v8, s28, v10
    v_fmac_f32 v9, s28, v11
    buffer_load_dword v90, v3, s[44:47], s26 offen
    s_add_u32 s26, s26, 0x1800
    v_readlane_b32 s28, v4, 14
    s_waitcnt vmcnt(60)
    v_lshlrev_b32 v10, 16, v30
    v_and_b32 v11, 0xffff0000, v30
    v_fmac_f32 v8, s28, v10
    v_fmac_f32 v9, s28, v11
    buffer_load_dword v91, v3, s[44:47], s26 offen
    s_add_u32 s26, s26, 0x1800
    v_readlane_b32 s28, v4, 15
    s_waitcnt vmcnt(60)
    v_lshlrev_b32 v10, 16, v31
    v_and_b32 v11, 0xffff0000, v31
    v_fmac_f32 v8, s28, v10
    v_fmac_f32 v9, s28, v11
    buffer_load_dword v92, v3, s[44:47], s26 offen
    s_add_u32 s26, s26, 0x1800
    v_readlane_b32 s28, v4, 16
    s_waitcnt vmcnt(60)
    v_lshlrev_b32 v10, 16, v32
    v_and_b32 v11, 0xffff0000, v32
    v_fmac_f32 v8, s28, v10
    v_fmac_f32 v9, s28, v11
    buffer_load_dword v93, v3, s[44:47], s26 offen
    s_add_u32 s26, s26, 0x1800
    v_readlane_b32 s28, v4, 17
    s_waitcnt vmcnt(60)
    v_lshlrev_b32 v10, 16, v33
    v_and_b32 v11, 0xffff0000, v33
    v_fmac_f32 v8, s28, v10
    v_fmac_f32 v9, s28, v11
    buffer_load_dword v94, v3, s[44:47], s26 offen
    s_add_u32 s26, s26, 0x1800
    v_readlane_b32 s28, v4, 18
    s_waitcnt vmcnt(60)
    v_lshlrev_b32 v10, 16, v34
    v_and_b32 v11, 0xffff0000, v34
    v_fmac_f32 v8, s28, v10
    v_fmac_f32 v9, s28, v11
    buffer_load_dword v95, v3, s[44:47], s26 offen
    s_add_u32 s26, s26, 0x1800
    v_readlane_b32 s28, v4, 19
    s_waitcnt vmcnt(60)
    v_lshlrev_b32 v10, 16, v35
    v_and_b32 v11, 0xffff0000, v35
    v_fmac_f32 v8, s28, v10
    v_fmac_f32 v9, s28, v11
    buffer_load_dword v96, v3, s[44:47], s26 offen
    s_add_u32 s26, s26, 0x1800
    v_readlane_b32 s28, v4, 20
    s_waitcnt vmcnt(60)
    v_lshlrev_b32 v10, 16, v36
    v_and_b32 v11, 0xffff0000, v36
    v_fmac_f32 v8, s28, v10
    v_fmac_f32 v9, s28, v11
    buffer_load_dword v97, v3, s[44:47], s26 offen
    s_add_u32 s26, s26, 0x1800
    v_readlane_b32 s28, v4, 21
    s_waitcnt vmcnt(60)
    v_lshlrev_b32 v10, 16, v37
    v_and_b32 v11, 0xffff0000, v37
    v_fmac_f32 v8, s28, v10
    v_fmac_f32 v9, s28, v11
    buffer_load_dword v98, v3, s[44:47], s26 offen
    s_add_u32 s26, s26, 0x1800
    v_readlane_b32 s28, v4, 22
    s_waitcnt vmcnt(60)
    v_lshlrev_b32 v10, 16, v38
    v_and_b32 v11, 0xffff0000, v38
    v_fmac_f32 v8, s28, v10
    v_fmac_f32 v9, s28, v11
    buffer_load_dword v99, v3, s[44:47], s26 offen
    s_add_u32 s26, s26, 0x1800
    v_readlane_b32 s28, v4, 23
    s_waitcnt vmcnt(60)
    v_lshlrev_b32 v10, 16, v39
    v_and_b32 v11, 0xffff0000, v39
    v_fmac_f32 v8, s28, v10
    v_fmac_f32 v9, s28, v11
    buffer_load_dword v100, v3, s[44:47], s26 offen
    s_add_u32 s26, s26, 0x1800
    v_readlane_b32 s28, v4, 24
    s_waitcnt vmcnt(60)
    v_lshlrev_b32 v10, 16, v40
    v_and_b32 v11, 0xffff0000, v40
    v_fmac_f32 v8, s28, v10
    v_fmac_f32 v9, s28, v11
    buffer_load_dword v101, v3, s[44:47], s26 offen
    s_add_u32 s26, s26, 0x1800
    v_readlane_b32 s28, v4, 25
    s_waitcnt vmcnt(60)
    v_lshlrev_b32 v10, 16, v41
    v_and_b32 v11, 0xffff0000, v41
    v_fmac_f32 v8, s28, v10
    v_fmac_f32 v9, s28, v11
    buffer_load_dword v102, v3, s[44:47], s26 offen
    s_add_u32 s26, s26, 0x1800
    v_readlane_b32 s28, v4, 26
    s_waitcnt vmcnt(60)
    v_lshlrev_b32 v10, 16, v42
    v_and_b32 v11, 0xffff0000, v42
    v_fmac_f32 v8, s28, v10
    v_fmac_f32 v9, s28, v11
    buffer_load_dword v103, v3, s[44:47], s26 offen
    s_add_u32 s26, s26, 0x1800
    v_readlane_b32 s28, v4, 27
    s_waitcnt vmcnt(60)
    v_lshlrev_b32 v10, 16, v43
    v_and_b32 v11, 0xffff0000, v43
    v_fmac_f32 v8, s28, v10
    v_fmac_f32 v9, s28, v11
    buffer_load_dword v104, v3, s[44:47], s26 offen
    s_add_u32 s26, s26, 0x1800
    v_readlane_b32 s28, v4, 28
    s_waitcnt vmcnt(60)
    v_lshlrev_b32 v10, 16, v44
    v_and_b32 v11, 0xffff0000, v44
    v_fmac_f32 v8, s28, v10
    v_fmac_f32 v9, s28, v11
    buffer_load_dword v105, v3, s[44:47], s26 offen
    s_add_u32 s26, s26, 0x1800
    v_readlane_b32 s28, v4, 29
    s_waitcnt vmcnt(60)
    v_lshlrev_b32 v10, 16, v45
    v_and_b32 v11, 0xffff0000, v45
    v_fmac_f32 v8, s28, v10
    v_fmac_f32 v9, s28, v11
    buffer_load_dword v106, v3, s[44:47], s26 offen
    s_add_u32 s26, s26, 0x1800
    v_readlane_b32 s28, v4, 30
    s_waitcnt vmcnt(60)
    v_lshlrev_b32 v10, 16, v46
    v_and_b32 v11, 0xffff0000, v46
    v_fmac_f32 v8, s28, v10
    v_fmac_f32 v9, s28, v11
    buffer_load_dword v107, v3, s[44:47], s26 offen
    s_add_u32 s26, s26, 0x1800
    v_readlane_b32 s28, v4, 31
    s_waitcnt vmcnt(60)
    v_lshlrev_b32 v10, 16, v47
    v_and_b32 v11, 0xffff0000, v47
    v_fmac_f32 v8, s28, v10
    v_fmac_f32 v9, s28, v11
    buffer_load_dword v108, v3, s[44:47], s26 offen
    s_add_u32 s26, s26, 0x1800
    v_readlane_b32 s28, v4, 32
    s_waitcnt vmcnt(60)
    v_lshlrev_b32 v10, 16, v48
    v_and_b32 v11, 0xffff0000, v48
    v_fmac_f32 v8, s28, v10
    v_fmac_f32 v9, s28, v11
    buffer_load_dword v109, v3, s[44:47], s26 offen
    s_add_u32 s26, s26, 0x1800
    v_readlane_b32 s28, v4, 33
    s_waitcnt vmcnt(60)
    v_lshlrev_b32 v10, 16, v49
    v_and_b32 v11, 0xffff0000, v49
    v_fmac_f32 v8, s28, v10
    v_fmac_f32 v9, s28, v11
    buffer_load_dword v110, v3, s[44:47], s26 offen
    s_add_u32 s26, s26, 0x1800
    v_readlane_b32 s28, v4, 34
    s_waitcnt vmcnt(60)
    v_lshlrev_b32 v10, 16, v50
    v_and_b32 v11, 0xffff0000, v50
    v_fmac_f32 v8, s28, v10
    v_fmac_f32 v9, s28, v11
    buffer_load_dword v111, v3, s[44:47], s26 offen
    s_add_u32 s26, s26, 0x1800
    v_readlane_b32 s28, v4, 35
    s_waitcnt vmcnt(60)
    v_lshlrev_b32 v10, 16, v51
    v_and_b32 v11, 0xffff0000, v51
    v_fmac_f32 v8, s28, v10
    v_fmac_f32 v9, s28, v11
    buffer_load_dword v112, v3, s[44:47], s26 offen
    s_add_u32 s26, s26, 0x1800
    v_readlane_b32 s28, v4, 36
    s_waitcnt vmcnt(60)
    v_lshlrev_b32 v10, 16, v52
    v_and_b32 v11, 0xffff0000, v52
    v_fmac_f32 v8, s28, v10
    v_fmac_f32 v9, s28, v11
    buffer_load_dword v113, v3, s[44:47], s26 offen
    s_add_u32 s26, s26, 0x1800
    v_readlane_b32 s28, v4, 37
    s_waitcnt vmcnt(60)
    v_lshlrev_b32 v10, 16, v53
    v_and_b32 v11, 0xffff0000, v53
    v_fmac_f32 v8, s28, v10
    v_fmac_f32 v9, s28, v11
    buffer_load_dword v114, v3, s[44:47], s26 offen
    s_add_u32 s26, s26, 0x1800
    v_readlane_b32 s28, v4, 38
    s_waitcnt vmcnt(60)
    v_lshlrev_b32 v10, 16, v54
    v_and_b32 v11, 0xffff0000, v54
    v_fmac_f32 v8, s28, v10
    v_fmac_f32 v9, s28, v11
    buffer_load_dword v115, v3, s[44:47], s26 offen
    s_add_u32 s26, s26, 0x1800
    v_readlane_b32 s28, v4, 39
    s_waitcnt vmcnt(60)
    v_lshlrev_b32 v10, 16, v55
    v_and_b32 v11, 0xffff0000, v55
    v_fmac_f32 v8, s28, v10
    v_fmac_f32 v9, s28, v11
    buffer_load_dword v116, v3, s[44:47], s26 offen
    s_add_u32 s26, s26, 0x1800
    v_readlane_b32 s28, v4, 40
    s_waitcnt vmcnt(60)
    v_lshlrev_b32 v10, 16, v56
    v_and_b32 v11, 0xffff0000, v56
    v_fmac_f32 v8, s28, v10
    v_fmac_f32 v9, s28, v11
    buffer_load_dword v117, v3, s[44:47], s26 offen
    s_add_u32 s26, s26, 0x1800
    v_readlane_b32 s28, v4, 41
    s_waitcnt vmcnt(60)
    v_lshlrev_b32 v10, 16, v57
    v_and_b32 v11, 0xffff0000, v57
    v_fmac_f32 v8, s28, v10
    v_fmac_f32 v9, s28, v11
    buffer_load_dword v118, v3, s[44:47], s26 offen
    s_add_u32 s26, s26, 0x1800
    v_readlane_b32 s28, v4, 42
    s_waitcnt vmcnt(60)
    v_lshlrev_b32 v10, 16, v58
    v_and_b32 v11, 0xffff0000, v58
    v_fmac_f32 v8, s28, v10
    v_fmac_f32 v9, s28, v11
    buffer_load_dword v119, v3, s[44:47], s26 offen
    s_add_u32 s26, s26, 0x1800
    v_readlane_b32 s28, v4, 43
    s_waitcnt vmcnt(60)
    v_lshlrev_b32 v10, 16, v59
    v_and_b32 v11, 0xffff0000, v59
    v_fmac_f32 v8, s28, v10
    v_fmac_f32 v9, s28, v11
    buffer_load_dword v120, v3, s[44:47], s26 offen
    s_add_u32 s26, s26, 0x1800
    v_readlane_b32 s28, v4, 44
    s_waitcnt vmcnt(60)
    v_lshlrev_b32 v10, 16, v60
    v_and_b32 v11, 0xffff0000, v60
    v_fmac_f32 v8, s28, v10
    v_fmac_f32 v9, s28, v11
    buffer_load_dword v121, v3, s[44:47], s26 offen
    s_add_u32 s26, s26, 0x1800
    v_readlane_b32 s28, v4, 45
    s_waitcnt vmcnt(60)
    v_lshlrev_b32 v10, 16, v61
    v_and_b32 v11, 0xffff0000, v61
    v_fmac_f32 v8, s28, v10
    v_fmac_f32 v9, s28, v11
    buffer_load_dword v122, v3, s[44:47], s26 offen
    s_add_u32 s26, s26, 0x1800
    v_readlane_b32 s28, v4, 46
    s_waitcnt vmcnt(60)
    v_lshlrev_b32 v10, 16, v62
    v_and_b32 v11, 0xffff0000, v62
    v_fmac_f32 v8, s28, v10
    v_fmac_f32 v9, s28, v11
    buffer_load_dword v123, v3, s[44:47], s26 offen
    s_add_u32 s26, s26, 0x1800
    v_readlane_b32 s28, v4, 47
    s_waitcnt vmcnt(60)
    v_lshlrev_b32 v10, 16, v63
    v_and_b32 v11, 0xffff0000, v63
    v_fmac_f32 v8, s28, v10
    v_fmac_f32 v9, s28, v11
    buffer_load_dword v124, v3, s[44:47], s26 offen
    s_add_u32 s26, s26, 0x1800
    v_readlane_b32 s28, v4, 48
    s_waitcnt vmcnt(60)
    v_lshlrev_b32 v10, 16, v64
    v_and_b32 v11, 0xffff0000, v64
    v_fmac_f32 v8, s28, v10
    v_fmac_f32 v9, s28, v11
    buffer_load_dword v125, v3, s[44:47], s26 offen
    s_add_u32 s26, s26, 0x1800
    v_readlane_b32 s28, v4, 49
    s_waitcnt vmcnt(60)
    v_lshlrev_b32 v10, 16, v65
    v_and_b32 v11, 0xffff0000, v65
    v_fmac_f32 v8, s28, v10
    v_fmac_f32 v9, s28, v11
    buffer_load_dword v126, v3, s[44:47], s26 offen
    s_add_u32 s26, s26, 0x1800
    v_readlane_b32 s28, v4, 50
    s_waitcnt vmcnt(60)
    v_lshlrev_b32 v10, 16, v66
    v_and_b32 v11, 0xffff0000, v66
    v_fmac_f32 v8, s28, v10
    v_fmac_f32 v9, s28, v11
    buffer_load_dword v127, v3, s[44:47], s26 offen
    s_add_u32 s26, s26, 0x1800
    v_readlane_b32 s28, v4, 51
    s_waitcnt vmcnt(60)
    v_lshlrev_b32 v10, 16, v67
    v_and_b32 v11, 0xffff0000, v67
    v_fmac_f32 v8, s28, v10
    v_fmac_f32 v9, s28, v11
    buffer_load_dword v128, v3, s[44:47], s26 offen
    s_add_u32 s26, s26, 0x1800
    v_readlane_b32 s28, v4, 52
    s_waitcnt vmcnt(60)
    v_lshlrev_b32 v10, 16, v68
    v_and_b32 v11, 0xffff0000, v68
    v_fmac_f32 v8, s28, v10
    v_fmac_f32 v9, s28, v11
    buffer_load_dword v129, v3, s[44:47], s26 offen
    s_add_u32 s26, s26, 0x1800
    v_readlane_b32 s28, v4, 53
    s_waitcnt vmcnt(60)
    v_lshlrev_b32 v10, 16, v69
    v_and_b32 v11, 0xffff0000, v69
    v_fmac_f32 v8, s28, v10
    v_fmac_f32 v9, s28, v11
    buffer_load_dword v130, v3, s[44:47], s26 offen
    s_add_u32 s26, s26, 0x1800
    v_readlane_b32 s28, v4, 54
    s_waitcnt vmcnt(60)
    v_lshlrev_b32 v10, 16, v70
    v_and_b32 v11, 0xffff0000, v70
    v_fmac_f32 v8, s28, v10
    v_fmac_f32 v9, s28, v11
    buffer_load_dword v131, v3, s[44:47], s26 offen
    s_add_u32 s26, s26, 0x1800
    v_readlane_b32 s28, v4, 55
    s_waitcnt vmcnt(60)
    v_lshlrev_b32 v10, 16, v71
    v_and_b32 v11, 0xffff0000, v71
    v_fmac_f32 v8, s28, v10
    v_fmac_f32 v9, s28, v11
    buffer_load_dword v132, v3, s[44:47], s26 offen
    s_add_u32 s26, s26, 0x1800
    v_readlane_b32 s28, v4, 56
    s_waitcnt vmcnt(60)
    v_lshlrev_b32 v10, 16, v72
    v_and_b32 v11, 0xffff0000, v72
    v_fmac_f32 v8, s28, v10
    v_fmac_f32 v9, s28, v11
    buffer_load_dword v133, v3, s[44:47], s26 offen
    s_add_u32 s26, s26, 0x1800
    v_readlane_b32 s28, v4, 57
    s_waitcnt vmcnt(60)
    v_lshlrev_b32 v10, 16, v73
    v_and_b32 v11, 0xffff0000, v73
    v_fmac_f32 v8, s28, v10
    v_fmac_f32 v9, s28, v11
    buffer_load_dword v134, v3, s[44:47], s26 offen
    s_add_u32 s26, s26, 0x1800
    v_readlane_b32 s28, v4, 58
    s_waitcnt vmcnt(60)
    v_lshlrev_b32 v10, 16, v74
    v_and_b32 v11, 0xffff0000, v74
    v_fmac_f32 v8, s28, v10
    v_fmac_f32 v9, s28, v11
    buffer_load_dword v135, v3, s[44:47], s26 offen
    s_add_u32 s26, s26, 0x1800
    v_readlane_b32 s28, v4, 59
    s_waitcnt vmcnt(60)
    v_lshlrev_b32 v10, 16, v75
    v_and_b32 v11, 0xffff0000, v75
    v_fmac_f32 v8, s28, v10
    v_fmac_f32 v9, s28, v11
    buffer_load_dword v136, v3, s[44:47], s26 offen
    s_add_u32 s26, s26, 0x1800
    v_readlane_b32 s28, v4, 60
    s_waitcnt vmcnt(60)
    v_lshlrev_b32 v10, 16, v76
    v_and_b32 v11, 0xffff0000, v76
    v_fmac_f32 v8, s28, v10
    v_fmac_f32 v9, s28, v11
    buffer_load_dword v137, v3, s[44:47], s26 offen
    s_add_u32 s26, s26, 0x1800
    v_readlane_b32 s28, v4, 61
    s_waitcnt vmcnt(60)
    v_lshlrev_b32 v10, 16, v77
    v_and_b32 v11, 0xffff0000, v77
    v_fmac_f32 v8, s28, v10
    v_fmac_f32 v9, s28, v11
    buffer_load_dword v138, v3, s[44:47], s26 offen
    s_add_u32 s26, s26, 0x1800
    v_readlane_b32 s28, v4, 62
    s_waitcnt vmcnt(60)
    v_lshlrev_b32 v10, 16, v78
    v_and_b32 v11, 0xffff0000, v78
    v_fmac_f32 v8, s28, v10
    v_fmac_f32 v9, s28, v11
    buffer_load_dword v139, v3, s[44:47], s26 offen
    s_add_u32 s26, s26, 0x1800
    v_readlane_b32 s28, v4, 63
    s_waitcnt vmcnt(60)
    v_lshlrev_b32 v10, 16, v79
    v_and_b32 v11, 0xffff0000, v79
    v_fmac_f32 v8, s28, v10
    v_fmac_f32 v9, s28, v11
    buffer_load_dword v140, v3, s[44:47], s26 offen
    s_add_u32 s26, s26, 0x1800
    v_readlane_b32 s28, v5, 0
    s_waitcnt vmcnt(60)
    v_lshlrev_b32 v10, 16, v80
    v_and_b32 v11, 0xffff0000, v80
    v_fmac_f32 v8, s28, v10
    v_fmac_f32 v9, s28, v11
    buffer_load_dword v141, v3, s[44:47], s26 offen
    s_add_u32 s26, s26, 0x1800
    v_readlane_b32 s28, v5, 1
    s_waitcnt vmcnt(60)
    v_lshlrev_b32 v10, 16, v81
    v_and_b32 v11, 0xffff0000, v81
    v_fmac_f32 v8, s28, v10
    v_fmac_f32 v9, s28, v11
    buffer_load_dword v142, v3, s[44:47], s26 offen
    s_add_u32 s26, s26, 0x1800
    v_readlane_b32 s28, v5, 2
    s_waitcnt vmcnt(60)
    v_lshlrev_b32 v10, 16, v82
    v_and_b32 v11, 0xffff0000, v82
    v_fmac_f32 v8, s28, v10
    v_fmac_f32 v9, s28, v11
    buffer_load_dword v143, v3, s[44:47], s26 offen
    s_add_u32 s26, s26, 0x1800
    v_readlane_b32 s28, v5, 3
    s_waitcnt vmcnt(60)
    v_lshlrev_b32 v10, 16, v83
    v_and_b32 v11, 0xffff0000, v83
    v_fmac_f32 v8, s28, v10
    v_fmac_f32 v9, s28, v11
    v_readlane_b32 s28, v5, 4
    s_waitcnt vmcnt(59)
    v_lshlrev_b32 v10, 16, v84
    v_and_b32 v11, 0xffff0000, v84
    v_fmac_f32 v8, s28, v10
    v_fmac_f32 v9, s28, v11
    v_readlane_b32 s28, v5, 5
    s_waitcnt vmcnt(58)
    v_lshlrev_b32 v10, 16, v85
    v_and_b32 v11, 0xffff0000, v85
    v_fmac_f32 v8, s28, v10
    v_fmac_f32 v9, s28, v11
    v_readlane_b32 s28, v5, 6
    s_waitcnt vmcnt(57)
    v_lshlrev_b32 v10, 16, v86
    v_and_b32 v11, 0xffff0000, v86
    v_fmac_f32 v8, s28, v10
    v_fmac_f32 v9, s28, v11
    v_readlane_b32 s28, v5, 7
    s_waitcnt vmcnt(56)
    v_lshlrev_b32 v10, 16, v87
    v_and_b32 v11, 0xffff0000, v87
    v_fmac_f32 v8, s28, v10
    v_fmac_f32 v9, s28, v11
    v_readlane_b32 s28, v5, 8
    s_waitcnt vmcnt(55)
    v_lshlrev_b32 v10, 16, v88
    v_and_b32 v11, 0xffff0000, v88
    v_fmac_f32 v8, s28, v10
    v_fmac_f32 v9, s28, v11
    v_readlane_b32 s28, v5, 9
    s_waitcnt vmcnt(54)
    v_lshlrev_b32 v10, 16, v89
    v_and_b32 v11, 0xffff0000, v89
    v_fmac_f32 v8, s28, v10
    v_fmac_f32 v9, s28, v11
    v_readlane_b32 s28, v5, 10
    s_waitcnt vmcnt(53)
    v_lshlrev_b32 v10, 16, v90
    v_and_b32 v11, 0xffff0000, v90
    v_fmac_f32 v8, s28, v10
    v_fmac_f32 v9, s28, v11
    v_readlane_b32 s28, v5, 11
    s_waitcnt vmcnt(52)
    v_lshlrev_b32 v10, 16, v91
    v_and_b32 v11, 0xffff0000, v91
    v_fmac_f32 v8, s28, v10
    v_fmac_f32 v9, s28, v11
    v_readlane_b32 s28, v5, 12
    s_waitcnt vmcnt(51)
    v_lshlrev_b32 v10, 16, v92
    v_and_b32 v11, 0xffff0000, v92
    v_fmac_f32 v8, s28, v10
    v_fmac_f32 v9, s28, v11
    v_readlane_b32 s28, v5, 13
    s_waitcnt vmcnt(50)
    v_lshlrev_b32 v10, 16, v93
    v_and_b32 v11, 0xffff0000, v93
    v_fmac_f32 v8, s28, v10
    v_fmac_f32 v9, s28, v11
    v_readlane_b32 s28, v5, 14
    s_waitcnt vmcnt(49)
    v_lshlrev_b32 v10, 16, v94
    v_and_b32 v11, 0xffff0000, v94
    v_fmac_f32 v8, s28, v10
    v_fmac_f32 v9, s28, v11
    v_readlane_b32 s28, v5, 15
    s_waitcnt vmcnt(48)
    v_lshlrev_b32 v10, 16, v95
    v_and_b32 v11, 0xffff0000, v95
    v_fmac_f32 v8, s28, v10
    v_fmac_f32 v9, s28, v11
    v_readlane_b32 s28, v5, 16
    s_waitcnt vmcnt(47)
    v_lshlrev_b32 v10, 16, v96
    v_and_b32 v11, 0xffff0000, v96
    v_fmac_f32 v8, s28, v10
    v_fmac_f32 v9, s28, v11
    v_readlane_b32 s28, v5, 17
    s_waitcnt vmcnt(46)
    v_lshlrev_b32 v10, 16, v97
    v_and_b32 v11, 0xffff0000, v97
    v_fmac_f32 v8, s28, v10
    v_fmac_f32 v9, s28, v11
    v_readlane_b32 s28, v5, 18
    s_waitcnt vmcnt(45)
    v_lshlrev_b32 v10, 16, v98
    v_and_b32 v11, 0xffff0000, v98
    v_fmac_f32 v8, s28, v10
    v_fmac_f32 v9, s28, v11
    v_readlane_b32 s28, v5, 19
    s_waitcnt vmcnt(44)
    v_lshlrev_b32 v10, 16, v99
    v_and_b32 v11, 0xffff0000, v99
    v_fmac_f32 v8, s28, v10
    v_fmac_f32 v9, s28, v11
    v_readlane_b32 s28, v5, 20
    s_waitcnt vmcnt(43)
    v_lshlrev_b32 v10, 16, v100
    v_and_b32 v11, 0xffff0000, v100
    v_fmac_f32 v8, s28, v10
    v_fmac_f32 v9, s28, v11
    v_readlane_b32 s28, v5, 21
    s_waitcnt vmcnt(42)
    v_lshlrev_b32 v10, 16, v101
    v_and_b32 v11, 0xffff0000, v101
    v_fmac_f32 v8, s28, v10
    v_fmac_f32 v9, s28, v11
    v_readlane_b32 s28, v5, 22
    s_waitcnt vmcnt(41)
    v_lshlrev_b32 v10, 16, v102
    v_and_b32 v11, 0xffff0000, v102
    v_fmac_f32 v8, s28, v10
    v_fmac_f32 v9, s28, v11
    v_readlane_b32 s28, v5, 23
    s_waitcnt vmcnt(40)
    v_lshlrev_b32 v10, 16, v103
    v_and_b32 v11, 0xffff0000, v103
    v_fmac_f32 v8, s28, v10
    v_fmac_f32 v9, s28, v11
    v_readlane_b32 s28, v5, 24
    s_waitcnt vmcnt(39)
    v_lshlrev_b32 v10, 16, v104
    v_and_b32 v11, 0xffff0000, v104
    v_fmac_f32 v8, s28, v10
    v_fmac_f32 v9, s28, v11
    v_readlane_b32 s28, v5, 25
    s_waitcnt vmcnt(38)
    v_lshlrev_b32 v10, 16, v105
    v_and_b32 v11, 0xffff0000, v105
    v_fmac_f32 v8, s28, v10
    v_fmac_f32 v9, s28, v11
    v_readlane_b32 s28, v5, 26
    s_waitcnt vmcnt(37)
    v_lshlrev_b32 v10, 16, v106
    v_and_b32 v11, 0xffff0000, v106
    v_fmac_f32 v8, s28, v10
    v_fmac_f32 v9, s28, v11
    v_readlane_b32 s28, v5, 27
    s_waitcnt vmcnt(36)
    v_lshlrev_b32 v10, 16, v107
    v_and_b32 v11, 0xffff0000, v107
    v_fmac_f32 v8, s28, v10
    v_fmac_f32 v9, s28, v11
    v_readlane_b32 s28, v5, 28
    s_waitcnt vmcnt(35)
    v_lshlrev_b32 v10, 16, v108
    v_and_b32 v11, 0xffff0000, v108
    v_fmac_f32 v8, s28, v10
    v_fmac_f32 v9, s28, v11
    v_readlane_b32 s28, v5, 29
    s_waitcnt vmcnt(34)
    v_lshlrev_b32 v10, 16, v109
    v_and_b32 v11, 0xffff0000, v109
    v_fmac_f32 v8, s28, v10
    v_fmac_f32 v9, s28, v11
    v_readlane_b32 s28, v5, 30
    s_waitcnt vmcnt(33)
    v_lshlrev_b32 v10, 16, v110
    v_and_b32 v11, 0xffff0000, v110
    v_fmac_f32 v8, s28, v10
    v_fmac_f32 v9, s28, v11
    v_readlane_b32 s28, v5, 31
    s_waitcnt vmcnt(32)
    v_lshlrev_b32 v10, 16, v111
    v_and_b32 v11, 0xffff0000, v111
    v_fmac_f32 v8, s28, v10
    v_fmac_f32 v9, s28, v11
    v_readlane_b32 s28, v5, 32
    s_waitcnt vmcnt(31)
    v_lshlrev_b32 v10, 16, v112
    v_and_b32 v11, 0xffff0000, v112
    v_fmac_f32 v8, s28, v10
    v_fmac_f32 v9, s28, v11
    v_readlane_b32 s28, v5, 33
    s_waitcnt vmcnt(30)
    v_lshlrev_b32 v10, 16, v113
    v_and_b32 v11, 0xffff0000, v113
    v_fmac_f32 v8, s28, v10
    v_fmac_f32 v9, s28, v11
    v_readlane_b32 s28, v5, 34
    s_waitcnt vmcnt(29)
    v_lshlrev_b32 v10, 16, v114
    v_and_b32 v11, 0xffff0000, v114
    v_fmac_f32 v8, s28, v10
    v_fmac_f32 v9, s28, v11
    v_readlane_b32 s28, v5, 35
    s_waitcnt vmcnt(28)
    v_lshlrev_b32 v10, 16, v115
    v_and_b32 v11, 0xffff0000, v115
    v_fmac_f32 v8, s28, v10
    v_fmac_f32 v9, s28, v11
    v_readlane_b32 s28, v5, 36
    s_waitcnt vmcnt(27)
    v_lshlrev_b32 v10, 16, v116
    v_and_b32 v11, 0xffff0000, v116
    v_fmac_f32 v8, s28, v10
    v_fmac_f32 v9, s28, v11
    v_readlane_b32 s28, v5, 37
    s_waitcnt vmcnt(26)
    v_lshlrev_b32 v10, 16, v117
    v_and_b32 v11, 0xffff0000, v117
    v_fmac_f32 v8, s28, v10
    v_fmac_f32 v9, s28, v11
    v_readlane_b32 s28, v5, 38
    s_waitcnt vmcnt(25)
    v_lshlrev_b32 v10, 16, v118
    v_and_b32 v11, 0xffff0000, v118
    v_fmac_f32 v8, s28, v10
    v_fmac_f32 v9, s28, v11
    v_readlane_b32 s28, v5, 39
    s_waitcnt vmcnt(24)
    v_lshlrev_b32 v10, 16, v119
    v_and_b32 v11, 0xffff0000, v119
    v_fmac_f32 v8, s28, v10
    v_fmac_f32 v9, s28, v11
    v_readlane_b32 s28, v5, 40
    s_waitcnt vmcnt(23)
    v_lshlrev_b32 v10, 16, v120
    v_and_b32 v11, 0xffff0000, v120
    v_fmac_f32 v8, s28, v10
    v_fmac_f32 v9, s28, v11
    v_readlane_b32 s28, v5, 41
    s_waitcnt vmcnt(22)
    v_lshlrev_b32 v10, 16, v121
    v_and_b32 v11, 0xffff0000, v121
    v_fmac_f32 v8, s28, v10
    v_fmac_f32 v9, s28, v11
    v_readlane_b32 s28, v5, 42
    s_waitcnt vmcnt(21)
    v_lshlrev_b32 v10, 16, v122
    v_and_b32 v11, 0xffff0000, v122
    v_fmac_f32 v8, s28, v10
    v_fmac_f32 v9, s28, v11
    v_readlane_b32 s28, v5, 43
    s_waitcnt vmcnt(20)
    v_lshlrev_b32 v10, 16, v123
    v_and_b32 v11, 0xffff0000, v123
    v_fmac_f32 v8, s28, v10
    v_fmac_f32 v9, s28, v11
    v_readlane_b32 s28, v5, 44
    s_waitcnt vmcnt(19)
    v_lshlrev_b32 v10, 16, v124
    v_and_b32 v11, 0xffff0000, v124
    v_fmac_f32 v8, s28, v10
    v_fmac_f32 v9, s28, v11
    v_readlane_b32 s28, v5, 45
    s_waitcnt vmcnt(18)
    v_lshlrev_b32 v10, 16, v125
    v_and_b32 v11, 0xffff0000, v125
    v_fmac_f32 v8, s28, v10
    v_fmac_f32 v9, s28, v11
    v_readlane_b32 s28, v5, 46
    s_waitcnt vmcnt(17)
    v_lshlrev_b32 v10, 16, v126
    v_and_b32 v11, 0xffff0000, v126
    v_fmac_f32 v8, s28, v10
    v_fmac_f32 v9, s28, v11
    v_readlane_b32 s28, v5, 47
    s_waitcnt vmcnt(16)
    v_lshlrev_b32 v10, 16, v127
    v_and_b32 v11, 0xffff0000, v127
    v_fmac_f32 v8, s28, v10
    v_fmac_f32 v9, s28, v11
    v_readlane_b32 s28, v5, 48
    s_waitcnt vmcnt(15)
    v_lshlrev_b32 v10, 16, v128
    v_and_b32 v11, 0xffff0000, v128
    v_fmac_f32 v8, s28, v10
    v_fmac_f32 v9, s28, v11
    v_readlane_b32 s28, v5, 49
    s_waitcnt vmcnt(14)
    v_lshlrev_b32 v10, 16, v129
    v_and_b32 v11, 0xffff0000, v129
    v_fmac_f32 v8, s28, v10
    v_fmac_f32 v9, s28, v11
    v_readlane_b32 s28, v5, 50
    s_waitcnt vmcnt(13)
    v_lshlrev_b32 v10, 16, v130
    v_and_b32 v11, 0xffff0000, v130
    v_fmac_f32 v8, s28, v10
    v_fmac_f32 v9, s28, v11
    v_readlane_b32 s28, v5, 51
    s_waitcnt vmcnt(12)
    v_lshlrev_b32 v10, 16, v131
    v_and_b32 v11, 0xffff0000, v131
    v_fmac_f32 v8, s28, v10
    v_fmac_f32 v9, s28, v11
    v_readlane_b32 s28, v5, 52
    s_waitcnt vmcnt(11)
    v_lshlrev_b32 v10, 16, v132
    v_and_b32 v11, 0xffff0000, v132
    v_fmac_f32 v8, s28, v10
    v_fmac_f32 v9, s28, v11
    v_readlane_b32 s28, v5, 53
    s_waitcnt vmcnt(10)
    v_lshlrev_b32 v10, 16, v133
    v_and_b32 v11, 0xffff0000, v133
    v_fmac_f32 v8, s28, v10
    v_fmac_f32 v9, s28, v11
    v_readlane_b32 s28, v5, 54
    s_waitcnt vmcnt(9)
    v_lshlrev_b32 v10, 16, v134
    v_and_b32 v11, 0xffff0000, v134
    v_fmac_f32 v8, s28, v10
    v_fmac_f32 v9, s28, v11
    v_readlane_b32 s28, v5, 55
    s_waitcnt vmcnt(8)
    v_lshlrev_b32 v10, 16, v135
    v_and_b32 v11, 0xffff0000, v135
    v_fmac_f32 v8, s28, v10
    v_fmac_f32 v9, s28, v11
    v_readlane_b32 s28, v5, 56
    s_waitcnt vmcnt(7)
    v_lshlrev_b32 v10, 16, v136
    v_and_b32 v11, 0xffff0000, v136
    v_fmac_f32 v8, s28, v10
    v_fmac_f32 v9, s28, v11
    v_readlane_b32 s28, v5, 57
    s_waitcnt vmcnt(6)
    v_lshlrev_b32 v10, 16, v137
    v_and_b32 v11, 0xffff0000, v137
    v_fmac_f32 v8, s28, v10
    v_fmac_f32 v9, s28, v11
    v_readlane_b32 s28, v5, 58
    s_waitcnt vmcnt(5)
    v_lshlrev_b32 v10, 16, v138
    v_and_b32 v11, 0xffff0000, v138
    v_fmac_f32 v8, s28, v10
    v_fmac_f32 v9, s28, v11
    v_readlane_b32 s28, v5, 59
    s_waitcnt vmcnt(4)
    v_lshlrev_b32 v10, 16, v139
    v_and_b32 v11, 0xffff0000, v139
    v_fmac_f32 v8, s28, v10
    v_fmac_f32 v9, s28, v11
    v_readlane_b32 s28, v5, 60
    s_waitcnt vmcnt(3)
    v_lshlrev_b32 v10, 16, v140
    v_and_b32 v11, 0xffff0000, v140
    v_fmac_f32 v8, s28, v10
    v_fmac_f32 v9, s28, v11
    v_readlane_b32 s28, v5, 61
    s_waitcnt vmcnt(2)
    v_lshlrev_b32 v10, 16, v141
    v_and_b32 v11, 0xffff0000, v141
    v_fmac_f32 v8, s28, v10
    v_fmac_f32 v9, s28, v11
    v_readlane_b32 s28, v5, 62
    s_waitcnt vmcnt(1)
    v_lshlrev_b32 v10, 16, v142
    v_and_b32 v11, 0xffff0000, v142
    v_fmac_f32 v8, s28, v10
    v_fmac_f32 v9, s28, v11
    v_readlane_b32 s28, v5, 63
    s_waitcnt vmcnt(0)
    v_lshlrev_b32 v10, 16, v143
    v_and_b32 v11, 0xffff0000, v143
    v_fmac_f32 v8, s28, v10
    v_fmac_f32 v9, s28, v11
    s_lshl_b32 s25, s3, 9
    v_lshlrev_b32 v3, 3, v0
    v_add_u32 v4, s25, v3
    ds_write_b64 v4, v[8:9]
    s_waitcnt lgkmcnt(0)
    s_barrier
    s_cmp_lg_u32 s3, 0
    s_cbranch_scc1 mod_skip_51
    ds_read_b64 v[10:11], v3 offset:512
    ds_read_b64 v[12:13], v3 offset:1024
    ds_read_b64 v[14:15], v3 offset:1536
    s_waitcnt lgkmcnt(0)
    v_add_f32 v8, v8, v10
    v_add_f32 v12, v12, v14
    v_add_f32 v8, v8, v12
    v_cvt_pk_bf16_f32 v8, v8, v8
    v_lshlrev_b32 v8, 16, v8
    v_add_f32 v9, v9, v11
    v_add_f32 v13, v13, v15
    v_add_f32 v9, v9, v13
    v_cvt_pk_bf16_f32 v9, v9, v9
    v_lshlrev_b32 v9, 16, v9
    s_lshl_b32 s27, s24, 9
    buffer_store_dwordx2 v[8:9], v3, s[48:51], s27 offen sc1
mod_skip_51:
    s_waitcnt vmcnt(0)
    s_barrier
    s_cmp_lg_u32 s3, 0
    s_cbranch_scc1 w_loop
    s_mov_b64 exec, 1
    v_mov_b32 v250, 0xc0
    v_mov_b32 v251, 1
    buffer_atomic_add v251, v250, s[96:99], 0 offen
    s_mov_b64 exec, -1
    s_branch w_loop
w_nb_31:
    s_sub_u32 s5, s5, 49
    s_cmp_lg_u32 s93, 0
    s_cbranch_scc1 w_zd_52
    s_cmp_lg_u32 s3, 0
    s_cbranch_scc1 dwd_54
    v_mov_b32 v250, 0x80
dw_53:
    buffer_load_dword v251, v250, s[96:99], 0 offen sc1
    s_waitcnt vmcnt(0)
    v_readfirstlane_b32 s91, v251
    s_cmp_ge_u32 s91, 1
    s_cbranch_scc1 dwd_54
    s_sleep 4
    s_add_u32 s92, s92, 1
    s_cmp_gt_u32 s92, 0x1e8480
    s_cbranch_scc1 main_kernel_exit_w
    s_branch dw_53
dwd_54:
    s_waitcnt vmcnt(0)
    s_barrier
    s_mov_b32 s93, 1
w_zd_52:
    s_cmp_ge_u32 s5, 0x4d0
    s_cbranch_scc1 w_r_22
    s_cmp_ge_u32 s5, 0x450
    s_cbranch_scc1 w_q_21
    s_cmp_ge_u32 s5, 0x2e0
    s_cbranch_scc1 w_wp2_27
    s_cmp_ge_u32 s5, 0x200
    s_cbranch_scc1 w_c_30
    s_cmp_ge_u32 s5, 0x190
    s_cbranch_scc1 w_b_29
    s_cmp_ge_u32 s5, 0x90
    s_cbranch_scc1 w_a_28
    s_mov_b32 s21, s5
    s_cmp_lt_u32 s5, 16
    s_cbranch_scc1 w_ln1_25
    s_sub_u32 s21, s5, 16
    s_add_u32 s8, s6, 0x3000
    s_addc_u32 s9, s7, 0
    s_and_b32 s9, s9, 0xffff
    s_mov_b32 s10, 0x10000
    s_mov_b32 s11, 0x20000
    s_load_dwordx4 s[44:47], s[0:1], 24
    s_and_b32 s30, s21, 31
    s_lshl_b32 s30, s30, 2
    s_add_u32 s30, s30, s3
    s_lshr_b32 s31, s21, 5
    s_waitcnt lgkmcnt(0)
    s_cmp_ge_u32 s30, 64
    s_cselect_b32 s44, s46, s44
    s_cselect_b32 s45, s47, s45
    s_mov_b32 s12, s44
    s_mov_b32 s13, s45
    s_and_b32 s13, s13, 0xffff
    s_mov_b32 s14, 0x400000
    s_mov_b32 s15, 0x20000
    s_add_u32 s16, s6, 0x196000
    s_addc_u32 s17, s7, 0
    s_and_b32 s17, s17, 0xffff
    s_mov_b32 s18, 0x200000
    s_mov_b32 s19, 0x20000
    s_and_b32 s24, s30, 63
    s_lshl_b32 s24, s24, 7
    s_lshl_b32 s25, s31, 16
    v_lshlrev_b32 v2, 4, v0
    v_and_b32 v8, 15, v0
    v_lshrrev_b32 v9, 4, v0
    v_add_u32 v4, 0, v2
    v_add_u32 v5, 0x8000, v2
    s_mul_i32 s26, s3, 0x4800
    v_lshrrev_b32 v10, 3, v0
    v_and_b32 v11, 7, v0
    v_lshlrev_b32 v12, 13, v10
    v_lshl_add_u32 v12, v11, 4, v12
    v_mul_u32_u24 v13, 0x90, v10
    v_lshl_add_u32 v13, v11, 4, v13
    v_add_u32 v13, s26, v13
    v_bfe_u32 v10, v0, 2, 2
    v_lshl_add_u32 v10, v9, 3, v10
    v_mul_u32_u24 v14, 0x90, v10
    v_and_b32 v11, 3, v0
    v_lshl_add_u32 v14, v11, 4, v14
    v_add_u32 v14, s26, v14
    buffer_load_dwordx4 v[16:19], v12, s[12:15], s24 offen
    s_add_u32 s24, s24, 0x10000
    buffer_load_dwordx4 v[20:23], v12, s[12:15], s24 offen
    s_add_u32 s24, s24, 0x10000
    buffer_load_dwordx4 v[24:27], v12, s[12:15], s24 offen
    s_add_u32 s24, s24, 0x10000
    buffer_load_dwordx4 v[28:31], v12, s[12:15], s24 offen
    s_add_u32 s24, s24, 0x10000
    buffer_load_dwordx4 v[32:35], v12, s[12:15], s24 offen
    s_add_u32 s24, s24, 0x10000
    buffer_load_dwordx4 v[36:39], v12, s[12:15], s24 offen
    s_add_u32 s24, s24, 0x10000
    buffer_load_dwordx4 v[40:43], v12, s[12:15], s24 offen
    s_add_u32 s24, s24, 0x10000
    buffer_load_dwordx4 v[44:47], v12, s[12:15], s24 offen
    s_add_u32 s24, s24, 0x10000
    buffer_load_dwordx4 v[48:51], v12, s[12:15], s24 offen
    s_add_u32 s24, s24, 0x10000
    buffer_load_dwordx4 v[52:55], v12, s[12:15], s24 offen
    s_add_u32 s24, s24, 0x10000
    buffer_load_dwordx4 v[56:59], v12, s[12:15], s24 offen
    s_add_u32 s24, s24, 0x10000
    buffer_load_dwordx4 v[60:63], v12, s[12:15], s24 offen
    s_add_u32 s24, s24, 0x10000
    buffer_load_dwordx4 v[64:67], v12, s[12:15], s24 offen
    s_add_u32 s24, s24, 0x10000
    buffer_load_dwordx4 v[68:71], v12, s[12:15], s24 offen
    s_add_u32 s24, s24, 0x10000
    buffer_load_dwordx4 v[72:75], v12, s[12:15], s24 offen
    s_add_u32 s24, s24, 0x10000
    buffer_load_dwordx4 v[76:79], v12, s[12:15], s24 offen
    s_add_u32 s24, s24, 0x10000
    buffer_load_dwordx4 v[80:83], v12, s[12:15], s24 offen
    s_add_u32 s24, s24, 0x10000
    buffer_load_dwordx4 v[84:87], v12, s[12:15], s24 offen
    s_add_u32 s24, s24, 0x10000
    buffer_load_dwordx4 v[88:91], v12, s[12:15], s24 offen
    s_add_u32 s24, s24, 0x10000
    buffer_load_dwordx4 v[92:95], v12, s[12:15], s24 offen
    s_add_u32 s24, s24, 0x10000
    buffer_load_dwordx4 v[96:99], v12, s[12:15], s24 offen
    s_add_u32 s24, s24, 0x10000
    buffer_load_dwordx4 v[100:103], v12, s[12:15], s24 offen
    s_add_u32 s24, s24, 0x10000
    buffer_load_dwordx4 v[104:107], v12, s[12:15], s24 offen
    s_add_u32 s24, s24, 0x10000
    buffer_load_dwordx4 v[108:111], v12, s[12:15], s24 offen
    s_add_u32 s24, s24, 0x10000
    s_waitcnt vmcnt(23)
    ds_write_b128 v13, v[16:19] offset:0
    s_waitcnt vmcnt(22)
    ds_write_b128 v13, v[20:23] offset:1152
    s_waitcnt vmcnt(21)
    ds_write_b128 v13, v[24:27] offset:2304
    s_waitcnt vmcnt(20)
    ds_write_b128 v13, v[28:31] offset:3456
    s_waitcnt vmcnt(19)
    ds_write_b128 v13, v[32:35] offset:4608
    s_waitcnt vmcnt(18)
    ds_write_b128 v13, v[36:39] offset:5760
    s_waitcnt vmcnt(17)
    ds_write_b128 v13, v[40:43] offset:6912
    s_waitcnt vmcnt(16)
    ds_write_b128 v13, v[44:47] offset:8064
    s_waitcnt lgkmcnt(0)
    ds_read_b64_tr_b16 a[0:1], v14 offset:0
    ds_read_b64_tr_b16 a[2:3], v14 offset:576
    ds_read_b64_tr_b16 a[4:5], v14 offset:8
    ds_read_b64_tr_b16 a[6:7], v14 offset:584
    ds_read_b64_tr_b16 a[8:9], v14 offset:64
    ds_read_b64_tr_b16 a[10:11], v14 offset:640
    ds_read_b64_tr_b16 a[12:13], v14 offset:72
    ds_read_b64_tr_b16 a[14:15], v14 offset:648
    ds_read_b64_tr_b16 a[16:17], v14 offset:4608
    ds_read_b64_tr_b16 a[18:19], v14 offset:5184
    ds_read_b64_tr_b16 a[20:21], v14 offset:4616
    ds_read_b64_tr_b16 a[22:23], v14 offset:5192
    ds_read_b64_tr_b16 a[24:25], v14 offset:4672
    ds_read_b64_tr_b16 a[26:27], v14 offset:5248
    ds_read_b64_tr_b16 a[28:29], v14 offset:4680
    ds_read_b64_tr_b16 a[30:31], v14 offset:5256
    buffer_load_dwordx4 v[16:19], v12, s[12:15], s24 offen
    s_add_u32 s24, s24, 0x10000
    buffer_load_dwordx4 v[20:23], v12, s[12:15], s24 offen
    s_add_u32 s24, s24, 0x10000
    buffer_load_dwordx4 v[24:27], v12, s[12:15], s24 offen
    s_add_u32 s24, s24, 0x10000
    buffer_load_dwordx4 v[28:31], v12, s[12:15], s24 offen
    s_add_u32 s24, s24, 0x10000
    buffer_load_dwordx4 v[32:35], v12, s[12:15], s24 offen
    s_add_u32 s24, s24, 0x10000
    buffer_load_dwordx4 v[36:39], v12, s[12:15], s24 offen
    s_add_u32 s24, s24, 0x10000
    buffer_load_dwordx4 v[40:43], v12, s[12:15], s24 offen
    s_add_u32 s24, s24, 0x10000
    buffer_load_dwordx4 v[44:47], v12, s[12:15], s24 offen
    s_add_u32 s24, s24, 0x10000
    s_waitcnt vmcnt(23)
    ds_write_b128 v13, v[48:51] offset:9216
    s_waitcnt vmcnt(22)
    ds_write_b128 v13, v[52:55] offset:10368
    s_waitcnt vmcnt(21)
    ds_write_b128 v13, v[56:59] offset:11520
    s_waitcnt vmcnt(20)
    ds_write_b128 v13, v[60:63] offset:12672
    s_waitcnt vmcnt(19)
    ds_write_b128 v13, v[64:67] offset:13824
    s_waitcnt vmcnt(18)
    ds_write_b128 v13, v[68:71] offset:14976
    s_waitcnt vmcnt(17)
    ds_write_b128 v13, v[72:75] offset:16128
    s_waitcnt vmcnt(16)
    ds_write_b128 v13, v[76:79] offset:17280
    s_waitcnt lgkmcnt(0)
    ds_read_b64_tr_b16 a[32:33], v14 offset:9216
    ds_read_b64_tr_b16 a[34:35], v14 offset:9792
    ds_read_b64_tr_b16 a[36:37], v14 offset:9224
    ds_read_b64_tr_b16 a[38:39], v14 offset:9800
    ds_read_b64_tr_b16 a[40:41], v14 offset:9280
    ds_read_b64_tr_b16 a[42:43], v14 offset:9856
    ds_read_b64_tr_b16 a[44:45], v14 offset:9288
    ds_read_b64_tr_b16 a[46:47], v14 offset:9864
    ds_read_b64_tr_b16 a[48:49], v14 offset:13824
    ds_read_b64_tr_b16 a[50:51], v14 offset:14400
    ds_read_b64_tr_b16 a[52:53], v14 offset:13832
    ds_read_b64_tr_b16 a[54:55], v14 offset:14408
    ds_read_b64_tr_b16 a[56:57], v14 offset:13888
    ds_read_b64_tr_b16 a[58:59], v14 offset:14464
    ds_read_b64_tr_b16 a[60:61], v14 offset:13896
    ds_read_b64_tr_b16 a[62:63], v14 offset:14472
    buffer_load_dwordx4 v[48:51], v12, s[12:15], s24 offen
    s_add_u32 s24, s24, 0x10000
    buffer_load_dwordx4 v[52:55], v12, s[12:15], s24 offen
    s_add_u32 s24, s24, 0x10000
    buffer_load_dwordx4 v[56:59], v12, s[12:15], s24 offen
    s_add_u32 s24, s24, 0x10000
    buffer_load_dwordx4 v[60:63], v12, s[12:15], s24 offen
    s_add_u32 s24, s24, 0x10000
    buffer_load_dwordx4 v[64:67], v12, s[12:15], s24 offen
    s_add_u32 s24, s24, 0x10000
    buffer_load_dwordx4 v[68:71], v12, s[12:15], s24 offen
    s_add_u32 s24, s24, 0x10000
    buffer_load_dwordx4 v[72:75], v12, s[12:15], s24 offen
    s_add_u32 s24, s24, 0x10000
    buffer_load_dwordx4 v[76:79], v12, s[12:15], s24 offen
    s_add_u32 s24, s24, 0x10000
    s_waitcnt vmcnt(23)
    ds_write_b128 v13, v[80:83] offset:0
    s_waitcnt vmcnt(22)
    ds_write_b128 v13, v[84:87] offset:1152
    s_waitcnt vmcnt(21)
    ds_write_b128 v13, v[88:91] offset:2304
    s_waitcnt vmcnt(20)
    ds_write_b128 v13, v[92:95] offset:3456
    s_waitcnt vmcnt(19)
    ds_write_b128 v13, v[96:99] offset:4608
    s_waitcnt vmcnt(18)
    ds_write_b128 v13, v[100:103] offset:5760
    s_waitcnt vmcnt(17)
    ds_write_b128 v13, v[104:107] offset:6912
    s_waitcnt vmcnt(16)
    ds_write_b128 v13, v[108:111] offset:8064
    s_waitcnt lgkmcnt(0)
    ds_read_b64_tr_b16 a[64:65], v14 offset:0
    ds_read_b64_tr_b16 a[66:67], v14 offset:576
    ds_read_b64_tr_b16 a[68:69], v14 offset:8
    ds_read_b64_tr_b16 a[70:71], v14 offset:584
    ds_read_b64_tr_b16 a[72:73], v14 offset:64
    ds_read_b64_tr_b16 a[74:75], v14 offset:640
    ds_read_b64_tr_b16 a[76:77], v14 offset:72
    ds_read_b64_tr_b16 a[78:79], v14 offset:648
    ds_read_b64_tr_b16 a[80:81], v14 offset:4608
    ds_read_b64_tr_b16 a[82:83], v14 offset:5184
    ds_read_b64_tr_b16 a[84:85], v14 offset:4616
    ds_read_b64_tr_b16 a[86:87], v14 offset:5192
    ds_read_b64_tr_b16 a[88:89], v14 offset:4672
    ds_read_b64_tr_b16 a[90:91], v14 offset:5248
    ds_read_b64_tr_b16 a[92:93], v14 offset:4680
    ds_read_b64_tr_b16 a[94:95], v14 offset:5256
    buffer_load_dwordx4 v[80:83], v12, s[12:15], s24 offen
    s_add_u32 s24, s24, 0x10000
    buffer_load_dwordx4 v[84:87], v12, s[12:15], s24 offen
    s_add_u32 s24, s24, 0x10000
    buffer_load_dwordx4 v[88:91], v12, s[12:15], s24 offen
    s_add_u32 s24, s24, 0x10000
    buffer_load_dwordx4 v[92:95], v12, s[12:15], s24 offen
    s_add_u32 s24, s24, 0x10000
    buffer_load_dwordx4 v[96:99], v12, s[12:15], s24 offen
    s_add_u32 s24, s24, 0x10000
    buffer_load_dwordx4 v[100:103], v12, s[12:15], s24 offen
    s_add_u32 s24, s24, 0x10000
    buffer_load_dwordx4 v[104:107], v12, s[12:15], s24 offen
    s_add_u32 s24, s24, 0x10000
    buffer_load_dwordx4 v[108:111], v12, s[12:15], s24 offen
    s_add_u32 s24, s24, 0x10000
    s_waitcnt vmcnt(23)
    ds_write_b128 v13, v[16:19] offset:9216
    s_waitcnt vmcnt(22)
    ds_write_b128 v13, v[20:23] offset:10368
    s_waitcnt vmcnt(21)
    ds_write_b128 v13, v[24:27] offset:11520
    s_waitcnt vmcnt(20)
    ds_write_b128 v13, v[28:31] offset:12672
    s_waitcnt vmcnt(19)
    ds_write_b128 v13, v[32:35] offset:13824
    s_waitcnt vmcnt(18)
    ds_write_b128 v13, v[36:39] offset:14976
    s_waitcnt vmcnt(17)
    ds_write_b128 v13, v[40:43] offset:16128
    s_waitcnt vmcnt(16)
    ds_write_b128 v13, v[44:47] offset:17280
    s_waitcnt lgkmcnt(0)
    ds_read_b64_tr_b16 a[96:97], v14 offset:9216
    ds_read_b64_tr_b16 a[98:99], v14 offset:9792
    ds_read_b64_tr_b16 a[100:101], v14 offset:9224
    ds_read_b64_tr_b16 a[102:103], v14 offset:9800
    ds_read_b64_tr_b16 a[104:105], v14 offset:9280
    ds_read_b64_tr_b16 a[106:107], v14 offset:9856
    ds_read_b64_tr_b16 a[108:109], v14 offset:9288
    ds_read_b64_tr_b16 a[110:111], v14 offset:9864
    ds_read_b64_tr_b16 a[112:113], v14 offset:13824
    ds_read_b64_tr_b16 a[114:115], v14 offset:14400
    ds_read_b64_tr_b16 a[116:117], v14 offset:13832
    ds_read_b64_tr_b16 a[118:119], v14 offset:14408
    ds_read_b64_tr_b16 a[120:121], v14 offset:13888
    ds_read_b64_tr_b16 a[122:123], v14 offset:14464
    ds_read_b64_tr_b16 a[124:125], v14 offset:13896
    ds_read_b64_tr_b16 a[126:127], v14 offset:14472
    buffer_load_dwordx4 v[16:19], v12, s[12:15], s24 offen
    s_add_u32 s24, s24, 0x10000
    buffer_load_dwordx4 v[20:23], v12, s[12:15], s24 offen
    s_add_u32 s24, s24, 0x10000
    buffer_load_dwordx4 v[24:27], v12, s[12:15], s24 offen
    s_add_u32 s24, s24, 0x10000
    buffer_load_dwordx4 v[28:31], v12, s[12:15], s24 offen
    s_add_u32 s24, s24, 0x10000
    buffer_load_dwordx4 v[32:35], v12, s[12:15], s24 offen
    s_add_u32 s24, s24, 0x10000
    buffer_load_dwordx4 v[36:39], v12, s[12:15], s24 offen
    s_add_u32 s24, s24, 0x10000
    buffer_load_dwordx4 v[40:43], v12, s[12:15], s24 offen
    s_add_u32 s24, s24, 0x10000
    buffer_load_dwordx4 v[44:47], v12, s[12:15], s24 offen
    s_add_u32 s24, s24, 0x10000
    s_waitcnt vmcnt(23)
    ds_write_b128 v13, v[48:51] offset:0
    s_waitcnt vmcnt(22)
    ds_write_b128 v13, v[52:55] offset:1152
    s_waitcnt vmcnt(21)
    ds_write_b128 v13, v[56:59] offset:2304
    s_waitcnt vmcnt(20)
    ds_write_b128 v13, v[60:63] offset:3456
    s_waitcnt vmcnt(19)
    ds_write_b128 v13, v[64:67] offset:4608
    s_waitcnt vmcnt(18)
    ds_write_b128 v13, v[68:71] offset:5760
    s_waitcnt vmcnt(17)
    ds_write_b128 v13, v[72:75] offset:6912
    s_waitcnt vmcnt(16)
    ds_write_b128 v13, v[76:79] offset:8064
    s_waitcnt lgkmcnt(0)
    ds_read_b64_tr_b16 a[128:129], v14 offset:0
    ds_read_b64_tr_b16 a[130:131], v14 offset:576
    ds_read_b64_tr_b16 a[132:133], v14 offset:8
    ds_read_b64_tr_b16 a[134:135], v14 offset:584
    ds_read_b64_tr_b16 a[136:137], v14 offset:64
    ds_read_b64_tr_b16 a[138:139], v14 offset:640
    ds_read_b64_tr_b16 a[140:141], v14 offset:72
    ds_read_b64_tr_b16 a[142:143], v14 offset:648
    ds_read_b64_tr_b16 a[144:145], v14 offset:4608
    ds_read_b64_tr_b16 a[146:147], v14 offset:5184
    ds_read_b64_tr_b16 a[148:149], v14 offset:4616
    ds_read_b64_tr_b16 a[150:151], v14 offset:5192
    ds_read_b64_tr_b16 a[152:153], v14 offset:4672
    ds_read_b64_tr_b16 a[154:155], v14 offset:5248
    ds_read_b64_tr_b16 a[156:157], v14 offset:4680
    ds_read_b64_tr_b16 a[158:159], v14 offset:5256
    buffer_load_dwordx4 v[48:51], v12, s[12:15], s24 offen
    s_add_u32 s24, s24, 0x10000
    buffer_load_dwordx4 v[52:55], v12, s[12:15], s24 offen
    s_add_u32 s24, s24, 0x10000
    buffer_load_dwordx4 v[56:59], v12, s[12:15], s24 offen
    s_add_u32 s24, s24, 0x10000
    buffer_load_dwordx4 v[60:63], v12, s[12:15], s24 offen
    s_add_u32 s24, s24, 0x10000
    buffer_load_dwordx4 v[64:67], v12, s[12:15], s24 offen
    s_add_u32 s24, s24, 0x10000
    buffer_load_dwordx4 v[68:71], v12, s[12:15], s24 offen
    s_add_u32 s24, s24, 0x10000
    buffer_load_dwordx4 v[72:75], v12, s[12:15], s24 offen
    s_add_u32 s24, s24, 0x10000
    buffer_load_dwordx4 v[76:79], v12, s[12:15], s24 offen
    s_add_u32 s24, s24, 0x10000
    s_waitcnt vmcnt(23)
    ds_write_b128 v13, v[80:83] offset:9216
    s_waitcnt vmcnt(22)
    ds_write_b128 v13, v[84:87] offset:10368
    s_waitcnt vmcnt(21)
    ds_write_b128 v13, v[88:91] offset:11520
    s_waitcnt vmcnt(20)
    ds_write_b128 v13, v[92:95] offset:12672
    s_waitcnt vmcnt(19)
    ds_write_b128 v13, v[96:99] offset:13824
    s_waitcnt vmcnt(18)
    ds_write_b128 v13, v[100:103] offset:14976
    s_waitcnt vmcnt(17)
    ds_write_b128 v13, v[104:107] offset:16128
    s_waitcnt vmcnt(16)
    ds_write_b128 v13, v[108:111] offset:17280
    s_waitcnt lgkmcnt(0)
    ds_read_b64_tr_b16 a[160:161], v14 offset:9216
    ds_read_b64_tr_b16 a[162:163], v14 offset:9792
    ds_read_b64_tr_b16 a[164:165], v14 offset:9224
    ds_read_b64_tr_b16 a[166:167], v14 offset:9800
    ds_read_b64_tr_b16 a[168:169], v14 offset:9280
    ds_read_b64_tr_b16 a[170:171], v14 offset:9856
    ds_read_b64_tr_b16 a[172:173], v14 offset:9288
    ds_read_b64_tr_b16 a[174:175], v14 offset:9864
    ds_read_b64_tr_b16 a[176:177], v14 offset:13824
    ds_read_b64_tr_b16 a[178:179], v14 offset:14400
    ds_read_b64_tr_b16 a[180:181], v14 offset:13832
    ds_read_b64_tr_b16 a[182:183], v14 offset:14408
    ds_read_b64_tr_b16 a[184:185], v14 offset:13888
    ds_read_b64_tr_b16 a[186:187], v14 offset:14464
    ds_read_b64_tr_b16 a[188:189], v14 offset:13896
    ds_read_b64_tr_b16 a[190:191], v14 offset:14472
    s_waitcnt vmcnt(15)
    ds_write_b128 v13, v[16:19] offset:0
    s_waitcnt vmcnt(14)
    ds_write_b128 v13, v[20:23] offset:1152
    s_waitcnt vmcnt(13)
    ds_write_b128 v13, v[24:27] offset:2304
    s_waitcnt vmcnt(12)
    ds_write_b128 v13, v[28:31] offset:3456
    s_waitcnt vmcnt(11)
    ds_write_b128 v13, v[32:35] offset:4608
    s_waitcnt vmcnt(10)
    ds_write_b128 v13, v[36:39] offset:5760
    s_waitcnt vmcnt(9)
    ds_write_b128 v13, v[40:43] offset:6912
    s_waitcnt vmcnt(8)
    ds_write_b128 v13, v[44:47] offset:8064
    s_waitcnt lgkmcnt(0)
    ds_read_b64_tr_b16 a[192:193], v14 offset:0
    ds_read_b64_tr_b16 a[194:195], v14 offset:576
    ds_read_b64_tr_b16 a[196:197], v14 offset:8
    ds_read_b64_tr_b16 a[198:199], v14 offset:584
    ds_read_b64_tr_b16 a[200:201], v14 offset:64
    ds_read_b64_tr_b16 a[202:203], v14 offset:640
    ds_read_b64_tr_b16 a[204:205], v14 offset:72
    ds_read_b64_tr_b16 a[206:207], v14 offset:648
    ds_read_b64_tr_b16 a[208:209], v14 offset:4608
    ds_read_b64_tr_b16 a[210:211], v14 offset:5184
    ds_read_b64_tr_b16 a[212:213], v14 offset:4616
    ds_read_b64_tr_b16 a[214:215], v14 offset:5192
    ds_read_b64_tr_b16 a[216:217], v14 offset:4672
    ds_read_b64_tr_b16 a[218:219], v14 offset:5248
    ds_read_b64_tr_b16 a[220:221], v14 offset:4680
    ds_read_b64_tr_b16 a[222:223], v14 offset:5256
    s_waitcnt vmcnt(7)
    ds_write_b128 v13, v[48:51] offset:9216
    s_waitcnt vmcnt(6)
    ds_write_b128 v13, v[52:55] offset:10368
    s_waitcnt vmcnt(5)
    ds_write_b128 v13, v[56:59] offset:11520
    s_waitcnt vmcnt(4)
    ds_write_b128 v13, v[60:63] offset:12672
    s_waitcnt vmcnt(3)
    ds_write_b128 v13, v[64:67] offset:13824
    s_waitcnt vmcnt(2)
    ds_write_b128 v13, v[68:71] offset:14976
    s_waitcnt vmcnt(1)
    ds_write_b128 v13, v[72:75] offset:16128
    s_waitcnt vmcnt(0)
    ds_write_b128 v13, v[76:79] offset:17280
    s_waitcnt lgkmcnt(0)
    ds_read_b64_tr_b16 a[224:225], v14 offset:9216
    ds_read_b64_tr_b16 a[226:227], v14 offset:9792
    ds_read_b64_tr_b16 a[228:229], v14 offset:9224
    ds_read_b64_tr_b16 a[230:231], v14 offset:9800
    ds_read_b64_tr_b16 a[232:233], v14 offset:9280
    ds_read_b64_tr_b16 a[234:235], v14 offset:9856
    ds_read_b64_tr_b16 a[236:237], v14 offset:9288
    ds_read_b64_tr_b16 a[238:239], v14 offset:9864
    ds_read_b64_tr_b16 a[240:241], v14 offset:13824
    ds_read_b64_tr_b16 a[242:243], v14 offset:14400
    ds_read_b64_tr_b16 a[244:245], v14 offset:13832
    ds_read_b64_tr_b16 a[246:247], v14 offset:14408
    ds_read_b64_tr_b16 a[248:249], v14 offset:13888
    ds_read_b64_tr_b16 a[250:251], v14 offset:14464
    ds_read_b64_tr_b16 a[252:253], v14 offset:13896
    ds_read_b64_tr_b16 a[254:255], v14 offset:14472
    s_waitcnt lgkmcnt(0)
    s_mov_b32 s23, 0
    s_cmp_lg_u32 s3, 0
    s_cbranch_scc1 wcd_56
    s_lshl_b32 s90, s23, 8
    s_add_u32 s90, s90, 0xc000
    v_mov_b32 v250, 0
wc_55:
    buffer_load_dword v251, v250, s[8:11], s90 offen sc1
    s_waitcnt vmcnt(0)
    v_readfirstlane_b32 s91, v251
    s_cmp_ge_u32 s91, 16
    s_cbranch_scc1 wcd_56
    s_sleep 2
    s_add_u32 s92, s92, 1
    s_cmp_gt_u32 s92, 0x1e8480
    s_cbranch_scc1 main_kernel_exit_w
    s_branch wc_55
wcd_56:
    s_waitcnt vmcnt(0)
    s_barrier
    s_cmp_ge_u32 s30, 64
    s_cbranch_scc1 kv0_v_57
    buffer_load_dwordx4 v[16:19], v4, s[16:19], s25 offen offset:0
    buffer_load_dwordx4 v[20:23], v4, s[16:19], s25 offen offset:1024
    buffer_load_dwordx4 v[24:27], v5, s[16:19], s25 offen offset:0
    buffer_load_dwordx4 v[28:31], v5, s[16:19], s25 offen offset:1024
    s_add_u32 s25, s25, 0x800
    buffer_load_dwordx4 v[32:35], v4, s[16:19], s25 offen offset:0
    buffer_load_dwordx4 v[36:39], v4, s[16:19], s25 offen offset:1024
    buffer_load_dwordx4 v[40:43], v5, s[16:19], s25 offen offset:0
    buffer_load_dwordx4 v[44:47], v5, s[16:19], s25 offen offset:1024
    s_add_u32 s25, s25, 0x800
    buffer_load_dwordx4 v[48:51], v4, s[16:19], s25 offen offset:0
    buffer_load_dwordx4 v[52:55], v4, s[16:19], s25 offen offset:1024
    buffer_load_dwordx4 v[56:59], v5, s[16:19], s25 offen offset:0
    buffer_load_dwordx4 v[60:63], v5, s[16:19], s25 offen offset:1024
    s_add_u32 s25, s25, 0x800
    buffer_load_dwordx4 v[64:67], v4, s[16:19], s25 offen offset:0
    buffer_load_dwordx4 v[68:71], v4, s[16:19], s25 offen offset:1024
    buffer_load_dwordx4 v[72:75], v5, s[16:19], s25 offen offset:0
    buffer_load_dwordx4 v[76:79], v5, s[16:19], s25 offen offset:1024
    s_add_u32 s25, s25, 0x800
    buffer_load_dwordx4 v[80:83], v4, s[16:19], s25 offen offset:0
    buffer_load_dwordx4 v[84:87], v4, s[16:19], s25 offen offset:1024
    buffer_load_dwordx4 v[88:91], v5, s[16:19], s25 offen offset:0
    buffer_load_dwordx4 v[92:95], v5, s[16:19], s25 offen offset:1024
    s_add_u32 s25, s25, 0x800
    buffer_load_dwordx4 v[96:99], v4, s[16:19], s25 offen offset:0
    buffer_load_dwordx4 v[100:103], v4, s[16:19], s25 offen offset:1024
    buffer_load_dwordx4 v[104:107], v5, s[16:19], s25 offen offset:0
    buffer_load_dwordx4 v[108:111], v5, s[16:19], s25 offen offset:1024
    s_add_u32 s25, s25, 0x800
    buffer_load_dwordx4 v[112:115], v4, s[16:19], s25 offen offset:0
    buffer_load_dwordx4 v[116:119], v4, s[16:19], s25 offen offset:1024
    buffer_load_dwordx4 v[120:123], v5, s[16:19], s25 offen offset:0
    buffer_load_dwordx4 v[124:127], v5, s[16:19], s25 offen offset:1024
    s_add_u32 s25, s25, 0x800
    buffer_load_dwordx4 v[128:131], v4, s[16:19], s25 offen offset:0
    buffer_load_dwordx4 v[132:135], v4, s[16:19], s25 offen offset:1024
    buffer_load_dwordx4 v[136:139], v5, s[16:19], s25 offen offset:0
    buffer_load_dwordx4 v[140:143], v5, s[16:19], s25 offen offset:1024
    s_add_u32 s25, s25, 0x800
    s_waitcnt vmcnt(28)
    v_mfma_f32_16x16x32_bf16 v[144:147], a[0:3], v[16:19], 0
    v_mfma_f32_16x16x32_bf16 v[148:151], a[0:3], v[20:23], 0
    v_mfma_f32_16x16x32_bf16 v[152:155], a[0:3], v[24:27], 0
    v_mfma_f32_16x16x32_bf16 v[156:159], a[0:3], v[28:31], 0
    v_mfma_f32_16x16x32_bf16 v[160:163], a[4:7], v[16:19], 0
    v_mfma_f32_16x16x32_bf16 v[164:167], a[4:7], v[20:23], 0
    v_mfma_f32_16x16x32_bf16 v[168:171], a[4:7], v[24:27], 0
    v_mfma_f32_16x16x32_bf16 v[172:175], a[4:7], v[28:31], 0
    v_mfma_f32_16x16x32_bf16 v[176:179], a[8:11], v[16:19], 0
    v_mfma_f32_16x16x32_bf16 v[180:183], a[8:11], v[20:23], 0
    v_mfma_f32_16x16x32_bf16 v[184:187], a[8:11], v[24:27], 0
    v_mfma_f32_16x16x32_bf16 v[188:191], a[8:11], v[28:31], 0
    v_mfma_f32_16x16x32_bf16 v[192:195], a[12:15], v[16:19], 0
    v_mfma_f32_16x16x32_bf16 v[196:199], a[12:15], v[20:23], 0
    v_mfma_f32_16x16x32_bf16 v[200:203], a[12:15], v[24:27], 0
    v_mfma_f32_16x16x32_bf16 v[204:207], a[12:15], v[28:31], 0
    buffer_load_dwordx4 v[16:19], v4, s[16:19], s25 offen offset:0
    buffer_load_dwordx4 v[20:23], v4, s[16:19], s25 offen offset:1024
    buffer_load_dwordx4 v[24:27], v5, s[16:19], s25 offen offset:0
    buffer_load_dwordx4 v[28:31], v5, s[16:19], s25 offen offset:1024
    s_add_u32 s25, s25, 0x800
    s_waitcnt vmcnt(28)
    v_mfma_f32_16x16x32_bf16 v[144:147], a[16:19], v[32:35], v[144:147]
    v_mfma_f32_16x16x32_bf16 v[148:151], a[16:19], v[36:39], v[148:151]
    v_mfma_f32_16x16x32_bf16 v[152:155], a[16:19], v[40:43], v[152:155]
    v_mfma_f32_16x16x32_bf16 v[156:159], a[16:19], v[44:47], v[156:159]
    v_mfma_f32_16x16x32_bf16 v[160:163], a[20:23], v[32:35], v[160:163]
    v_mfma_f32_16x16x32_bf16 v[164:167], a[20:23], v[36:39], v[164:167]
    v_mfma_f32_16x16x32_bf16 v[168:171], a[20:23], v[40:43], v[168:171]
    v_mfma_f32_16x16x32_bf16 v[172:175], a[20:23], v[44:47], v[172:175]
    v_mfma_f32_16x16x32_bf16 v[176:179], a[24:27], v[32:35], v[176:179]
    v_mfma_f32_16x16x32_bf16 v[180:183], a[24:27], v[36:39], v[180:183]
    v_mfma_f32_16x16x32_bf16 v[184:187], a[24:27], v[40:43], v[184:187]
    v_mfma_f32_16x16x32_bf16 v[188:191], a[24:27], v[44:47], v[188:191]
    v_mfma_f32_16x16x32_bf16 v[192:195], a[28:31], v[32:35], v[192:195]
    v_mfma_f32_16x16x32_bf16 v[196:199], a[28:31], v[36:39], v[196:199]
    v_mfma_f32_16x16x32_bf16 v[200:203], a[28:31], v[40:43], v[200:203]
    v_mfma_f32_16x16x32_bf16 v[204:207], a[28:31], v[44:47], v[204:207]
    buffer_load_dwordx4 v[32:35], v4, s[16:19], s25 offen offset:0
    buffer_load_dwordx4 v[36:39], v4, s[16:19], s25 offen offset:1024
    buffer_load_dwordx4 v[40:43], v5, s[16:19], s25 offen offset:0
    buffer_load_dwordx4 v[44:47], v5, s[16:19], s25 offen offset:1024
    s_add_u32 s25, s25, 0x800
    s_waitcnt vmcnt(28)
    v_mfma_f32_16x16x32_bf16 v[144:147], a[32:35], v[48:51], v[144:147]
    v_mfma_f32_16x16x32_bf16 v[148:151], a[32:35], v[52:55], v[148:151]
    v_mfma_f32_16x16x32_bf16 v[152:155], a[32:35], v[56:59], v[152:155]
    v_mfma_f32_16x16x32_bf16 v[156:159], a[32:35], v[60:63], v[156:159]
    v_mfma_f32_16x16x32_bf16 v[160:163], a[36:39], v[48:51], v[160:163]
    v_mfma_f32_16x16x32_bf16 v[164:167], a[36:39], v[52:55], v[164:167]
    v_mfma_f32_16x16x32_bf16 v[168:171], a[36:39], v[56:59], v[168:171]
    v_mfma_f32_16x16x32_bf16 v[172:175], a[36:39], v[60:63], v[172:175]
    v_mfma_f32_16x16x32_bf16 v[176:179], a[40:43], v[48:51], v[176:179]
    v_mfma_f32_16x16x32_bf16 v[180:183], a[40:43], v[52:55], v[180:183]
    v_mfma_f32_16x16x32_bf16 v[184:187], a[40:43], v[56:59], v[184:187]
    v_mfma_f32_16x16x32_bf16 v[188:191], a[40:43], v[60:63], v[188:191]
    v_mfma_f32_16x16x32_bf16 v[192:195], a[44:47], v[48:51], v[192:195]
    v_mfma_f32_16x16x32_bf16 v[196:199], a[44:47], v[52:55], v[196:199]
    v_mfma_f32_16x16x32_bf16 v[200:203], a[44:47], v[56:59], v[200:203]
    v_mfma_f32_16x16x32_bf16 v[204:207], a[44:47], v[60:63], v[204:207]
    buffer_load_dwordx4 v[48:51], v4, s[16:19], s25 offen offset:0
    buffer_load_dwordx4 v[52:55], v4, s[16:19], s25 offen offset:1024
    buffer_load_dwordx4 v[56:59], v5, s[16:19], s25 offen offset:0
    buffer_load_dwordx4 v[60:63], v5, s[16:19], s25 offen offset:1024
    s_add_u32 s25, s25, 0x800
    s_waitcnt vmcnt(28)
    v_mfma_f32_16x16x32_bf16 v[144:147], a[48:51], v[64:67], v[144:147]
    v_mfma_f32_16x16x32_bf16 v[148:151], a[48:51], v[68:71], v[148:151]
    v_mfma_f32_16x16x32_bf16 v[152:155], a[48:51], v[72:75], v[152:155]
    v_mfma_f32_16x16x32_bf16 v[156:159], a[48:51], v[76:79], v[156:159]
    v_mfma_f32_16x16x32_bf16 v[160:163], a[52:55], v[64:67], v[160:163]
    v_mfma_f32_16x16x32_bf16 v[164:167], a[52:55], v[68:71], v[164:167]
    v_mfma_f32_16x16x32_bf16 v[168:171], a[52:55], v[72:75], v[168:171]
    v_mfma_f32_16x16x32_bf16 v[172:175], a[52:55], v[76:79], v[172:175]
    v_mfma_f32_16x16x32_bf16 v[176:179], a[56:59], v[64:67], v[176:179]
    v_mfma_f32_16x16x32_bf16 v[180:183], a[56:59], v[68:71], v[180:183]
    v_mfma_f32_16x16x32_bf16 v[184:187], a[56:59], v[72:75], v[184:187]
    v_mfma_f32_16x16x32_bf16 v[188:191], a[56:59], v[76:79], v[188:191]
    v_mfma_f32_16x16x32_bf16 v[192:195], a[60:63], v[64:67], v[192:195]
    v_mfma_f32_16x16x32_bf16 v[196:199], a[60:63], v[68:71], v[196:199]
    v_mfma_f32_16x16x32_bf16 v[200:203], a[60:63], v[72:75], v[200:203]
    v_mfma_f32_16x16x32_bf16 v[204:207], a[60:63], v[76:79], v[204:207]
    buffer_load_dwordx4 v[64:67], v4, s[16:19], s25 offen offset:0
    buffer_load_dwordx4 v[68:71], v4, s[16:19], s25 offen offset:1024
    buffer_load_dwordx4 v[72:75], v5, s[16:19], s25 offen offset:0
    buffer_load_dwordx4 v[76:79], v5, s[16:19], s25 offen offset:1024
    s_add_u32 s25, s25, 0x800
    s_waitcnt vmcnt(28)
    v_mfma_f32_16x16x32_bf16 v[144:147], a[64:67], v[80:83], v[144:147]
    v_mfma_f32_16x16x32_bf16 v[148:151], a[64:67], v[84:87], v[148:151]
    v_mfma_f32_16x16x32_bf16 v[152:155], a[64:67], v[88:91], v[152:155]
    v_mfma_f32_16x16x32_bf16 v[156:159], a[64:67], v[92:95], v[156:159]
    v_mfma_f32_16x16x32_bf16 v[160:163], a[68:71], v[80:83], v[160:163]
    v_mfma_f32_16x16x32_bf16 v[164:167], a[68:71], v[84:87], v[164:167]
    v_mfma_f32_16x16x32_bf16 v[168:171], a[68:71], v[88:91], v[168:171]
    v_mfma_f32_16x16x32_bf16 v[172:175], a[68:71], v[92:95], v[172:175]
    v_mfma_f32_16x16x32_bf16 v[176:179], a[72:75], v[80:83], v[176:179]
    v_mfma_f32_16x16x32_bf16 v[180:183], a[72:75], v[84:87], v[180:183]
    v_mfma_f32_16x16x32_bf16 v[184:187], a[72:75], v[88:91], v[184:187]
    v_mfma_f32_16x16x32_bf16 v[188:191], a[72:75], v[92:95], v[188:191]
    v_mfma_f32_16x16x32_bf16 v[192:195], a[76:79], v[80:83], v[192:195]
    v_mfma_f32_16x16x32_bf16 v[196:199], a[76:79], v[84:87], v[196:199]
    v_mfma_f32_16x16x32_bf16 v[200:203], a[76:79], v[88:91], v[200:203]
    v_mfma_f32_16x16x32_bf16 v[204:207], a[76:79], v[92:95], v[204:207]
    buffer_load_dwordx4 v[80:83], v4, s[16:19], s25 offen offset:0
    buffer_load_dwordx4 v[84:87], v4, s[16:19], s25 offen offset:1024
    buffer_load_dwordx4 v[88:91], v5, s[16:19], s25 offen offset:0
    buffer_load_dwordx4 v[92:95], v5, s[16:19], s25 offen offset:1024
    s_add_u32 s25, s25, 0x800
    s_waitcnt vmcnt(28)
    v_mfma_f32_16x16x32_bf16 v[144:147], a[80:83], v[96:99], v[144:147]
    v_mfma_f32_16x16x32_bf16 v[148:151], a[80:83], v[100:103], v[148:151]
    v_mfma_f32_16x16x32_bf16 v[152:155], a[80:83], v[104:107], v[152:155]
    v_mfma_f32_16x16x32_bf16 v[156:159], a[80:83], v[108:111], v[156:159]
    v_mfma_f32_16x16x32_bf16 v[160:163], a[84:87], v[96:99], v[160:163]
    v_mfma_f32_16x16x32_bf16 v[164:167], a[84:87], v[100:103], v[164:167]
    v_mfma_f32_16x16x32_bf16 v[168:171], a[84:87], v[104:107], v[168:171]
    v_mfma_f32_16x16x32_bf16 v[172:175], a[84:87], v[108:111], v[172:175]
    v_mfma_f32_16x16x32_bf16 v[176:179], a[88:91], v[96:99], v[176:179]
    v_mfma_f32_16x16x32_bf16 v[180:183], a[88:91], v[100:103], v[180:183]
    v_mfma_f32_16x16x32_bf16 v[184:187], a[88:91], v[104:107], v[184:187]
    v_mfma_f32_16x16x32_bf16 v[188:191], a[88:91], v[108:111], v[188:191]
    v_mfma_f32_16x16x32_bf16 v[192:195], a[92:95], v[96:99], v[192:195]
    v_mfma_f32_16x16x32_bf16 v[196:199], a[92:95], v[100:103], v[196:199]
    v_mfma_f32_16x16x32_bf16 v[200:203], a[92:95], v[104:107], v[200:203]
    v_mfma_f32_16x16x32_bf16 v[204:207], a[92:95], v[108:111], v[204:207]
    buffer_load_dwordx4 v[96:99], v4, s[16:19], s25 offen offset:0
    buffer_load_dwordx4 v[100:103], v4, s[16:19], s25 offen offset:1024
    buffer_load_dwordx4 v[104:107], v5, s[16:19], s25 offen offset:0
    buffer_load_dwordx4 v[108:111], v5, s[16:19], s25 offen offset:1024
    s_add_u32 s25, s25, 0x800
    s_waitcnt vmcnt(28)
    v_mfma_f32_16x16x32_bf16 v[144:147], a[96:99], v[112:115], v[144:147]
    v_mfma_f32_16x16x32_bf16 v[148:151], a[96:99], v[116:119], v[148:151]
    v_mfma_f32_16x16x32_bf16 v[152:155], a[96:99], v[120:123], v[152:155]
    v_mfma_f32_16x16x32_bf16 v[156:159], a[96:99], v[124:127], v[156:159]
    v_mfma_f32_16x16x32_bf16 v[160:163], a[100:103], v[112:115], v[160:163]
    v_mfma_f32_16x16x32_bf16 v[164:167], a[100:103], v[116:119], v[164:167]
    v_mfma_f32_16x16x32_bf16 v[168:171], a[100:103], v[120:123], v[168:171]
    v_mfma_f32_16x16x32_bf16 v[172:175], a[100:103], v[124:127], v[172:175]
    v_mfma_f32_16x16x32_bf16 v[176:179], a[104:107], v[112:115], v[176:179]
    v_mfma_f32_16x16x32_bf16 v[180:183], a[104:107], v[116:119], v[180:183]
    v_mfma_f32_16x16x32_bf16 v[184:187], a[104:107], v[120:123], v[184:187]
    v_mfma_f32_16x16x32_bf16 v[188:191], a[104:107], v[124:127], v[188:191]
    v_mfma_f32_16x16x32_bf16 v[192:195], a[108:111], v[112:115], v[192:195]
    v_mfma_f32_16x16x32_bf16 v[196:199], a[108:111], v[116:119], v[196:199]
    v_mfma_f32_16x16x32_bf16 v[200:203], a[108:111], v[120:123], v[200:203]
    v_mfma_f32_16x16x32_bf16 v[204:207], a[108:111], v[124:127], v[204:207]
    buffer_load_dwordx4 v[112:115], v4, s[16:19], s25 offen offset:0
    buffer_load_dwordx4 v[116:119], v4, s[16:19], s25 offen offset:1024
    buffer_load_dwordx4 v[120:123], v5, s[16:19], s25 offen offset:0
    buffer_load_dwordx4 v[124:127], v5, s[16:19], s25 offen offset:1024
    s_add_u32 s25, s25, 0x800
    s_waitcnt vmcnt(28)
    v_mfma_f32_16x16x32_bf16 v[144:147], a[112:115], v[128:131], v[144:147]
    v_mfma_f32_16x16x32_bf16 v[148:151], a[112:115], v[132:135], v[148:151]
    v_mfma_f32_16x16x32_bf16 v[152:155], a[112:115], v[136:139], v[152:155]
    v_mfma_f32_16x16x32_bf16 v[156:159], a[112:115], v[140:143], v[156:159]
    v_mfma_f32_16x16x32_bf16 v[160:163], a[116:119], v[128:131], v[160:163]
    v_mfma_f32_16x16x32_bf16 v[164:167], a[116:119], v[132:135], v[164:167]
    v_mfma_f32_16x16x32_bf16 v[168:171], a[116:119], v[136:139], v[168:171]
    v_mfma_f32_16x16x32_bf16 v[172:175], a[116:119], v[140:143], v[172:175]
    v_mfma_f32_16x16x32_bf16 v[176:179], a[120:123], v[128:131], v[176:179]
    v_mfma_f32_16x16x32_bf16 v[180:183], a[120:123], v[132:135], v[180:183]
    v_mfma_f32_16x16x32_bf16 v[184:187], a[120:123], v[136:139], v[184:187]
    v_mfma_f32_16x16x32_bf16 v[188:191], a[120:123], v[140:143], v[188:191]
    v_mfma_f32_16x16x32_bf16 v[192:195], a[124:127], v[128:131], v[192:195]
    v_mfma_f32_16x16x32_bf16 v[196:199], a[124:127], v[132:135], v[196:199]
    v_mfma_f32_16x16x32_bf16 v[200:203], a[124:127], v[136:139], v[200:203]
    v_mfma_f32_16x16x32_bf16 v[204:207], a[124:127], v[140:143], v[204:207]
    buffer_load_dwordx4 v[128:131], v4, s[16:19], s25 offen offset:0
    buffer_load_dwordx4 v[132:135], v4, s[16:19], s25 offen offset:1024
    buffer_load_dwordx4 v[136:139], v5, s[16:19], s25 offen offset:0
    buffer_load_dwordx4 v[140:143], v5, s[16:19], s25 offen offset:1024
    s_add_u32 s25, s25, 0x800
    s_waitcnt vmcnt(28)
    v_mfma_f32_16x16x32_bf16 v[144:147], a[128:131], v[16:19], v[144:147]
    v_mfma_f32_16x16x32_bf16 v[148:151], a[128:131], v[20:23], v[148:151]
    v_mfma_f32_16x16x32_bf16 v[152:155], a[128:131], v[24:27], v[152:155]
    v_mfma_f32_16x16x32_bf16 v[156:159], a[128:131], v[28:31], v[156:159]
    v_mfma_f32_16x16x32_bf16 v[160:163], a[132:135], v[16:19], v[160:163]
    v_mfma_f32_16x16x32_bf16 v[164:167], a[132:135], v[20:23], v[164:167]
    v_mfma_f32_16x16x32_bf16 v[168:171], a[132:135], v[24:27], v[168:171]
    v_mfma_f32_16x16x32_bf16 v[172:175], a[132:135], v[28:31], v[172:175]
    v_mfma_f32_16x16x32_bf16 v[176:179], a[136:139], v[16:19], v[176:179]
    v_mfma_f32_16x16x32_bf16 v[180:183], a[136:139], v[20:23], v[180:183]
    v_mfma_f32_16x16x32_bf16 v[184:187], a[136:139], v[24:27], v[184:187]
    v_mfma_f32_16x16x32_bf16 v[188:191], a[136:139], v[28:31], v[188:191]
    v_mfma_f32_16x16x32_bf16 v[192:195], a[140:143], v[16:19], v[192:195]
    v_mfma_f32_16x16x32_bf16 v[196:199], a[140:143], v[20:23], v[196:199]
    v_mfma_f32_16x16x32_bf16 v[200:203], a[140:143], v[24:27], v[200:203]
    v_mfma_f32_16x16x32_bf16 v[204:207], a[140:143], v[28:31], v[204:207]
    s_waitcnt vmcnt(24)
    v_mfma_f32_16x16x32_bf16 v[144:147], a[144:147], v[32:35], v[144:147]
    v_mfma_f32_16x16x32_bf16 v[148:151], a[144:147], v[36:39], v[148:151]
    v_mfma_f32_16x16x32_bf16 v[152:155], a[144:147], v[40:43], v[152:155]
    v_mfma_f32_16x16x32_bf16 v[156:159], a[144:147], v[44:47], v[156:159]
    v_mfma_f32_16x16x32_bf16 v[160:163], a[148:151], v[32:35], v[160:163]
    v_mfma_f32_16x16x32_bf16 v[164:167], a[148:151], v[36:39], v[164:167]
    v_mfma_f32_16x16x32_bf16 v[168:171], a[148:151], v[40:43], v[168:171]
    v_mfma_f32_16x16x32_bf16 v[172:175], a[148:151], v[44:47], v[172:175]
    v_mfma_f32_16x16x32_bf16 v[176:179], a[152:155], v[32:35], v[176:179]
    v_mfma_f32_16x16x32_bf16 v[180:183], a[152:155], v[36:39], v[180:183]
    v_mfma_f32_16x16x32_bf16 v[184:187], a[152:155], v[40:43], v[184:187]
    v_mfma_f32_16x16x32_bf16 v[188:191], a[152:155], v[44:47], v[188:191]
    v_mfma_f32_16x16x32_bf16 v[192:195], a[156:159], v[32:35], v[192:195]
    v_mfma_f32_16x16x32_bf16 v[196:199], a[156:159], v[36:39], v[196:199]
    v_mfma_f32_16x16x32_bf16 v[200:203], a[156:159], v[40:43], v[200:203]
    v_mfma_f32_16x16x32_bf16 v[204:207], a[156:159], v[44:47], v[204:207]
    s_waitcnt vmcnt(20)
    v_mfma_f32_16x16x32_bf16 v[144:147], a[160:163], v[48:51], v[144:147]
    v_mfma_f32_16x16x32_bf16 v[148:151], a[160:163], v[52:55], v[148:151]
    v_mfma_f32_16x16x32_bf16 v[152:155], a[160:163], v[56:59], v[152:155]
    v_mfma_f32_16x16x32_bf16 v[156:159], a[160:163], v[60:63], v[156:159]
    v_mfma_f32_16x16x32_bf16 v[160:163], a[164:167], v[48:51], v[160:163]
    v_mfma_f32_16x16x32_bf16 v[164:167], a[164:167], v[52:55], v[164:167]
    v_mfma_f32_16x16x32_bf16 v[168:171], a[164:167], v[56:59], v[168:171]
    v_mfma_f32_16x16x32_bf16 v[172:175], a[164:167], v[60:63], v[172:175]
    v_mfma_f32_16x16x32_bf16 v[176:179], a[168:171], v[48:51], v[176:179]
    v_mfma_f32_16x16x32_bf16 v[180:183], a[168:171], v[52:55], v[180:183]
    v_mfma_f32_16x16x32_bf16 v[184:187], a[168:171], v[56:59], v[184:187]
    v_mfma_f32_16x16x32_bf16 v[188:191], a[168:171], v[60:63], v[188:191]
    v_mfma_f32_16x16x32_bf16 v[192:195], a[172:175], v[48:51], v[192:195]
    v_mfma_f32_16x16x32_bf16 v[196:199], a[172:175], v[52:55], v[196:199]
    v_mfma_f32_16x16x32_bf16 v[200:203], a[172:175], v[56:59], v[200:203]
    v_mfma_f32_16x16x32_bf16 v[204:207], a[172:175], v[60:63], v[204:207]
    s_waitcnt vmcnt(16)
    v_mfma_f32_16x16x32_bf16 v[144:147], a[176:179], v[64:67], v[144:147]
    v_mfma_f32_16x16x32_bf16 v[148:151], a[176:179], v[68:71], v[148:151]
    v_mfma_f32_16x16x32_bf16 v[152:155], a[176:179], v[72:75], v[152:155]
    v_mfma_f32_16x16x32_bf16 v[156:159], a[176:179], v[76:79], v[156:159]
    v_mfma_f32_16x16x32_bf16 v[160:163], a[180:183], v[64:67], v[160:163]
    v_mfma_f32_16x16x32_bf16 v[164:167], a[180:183], v[68:71], v[164:167]
    v_mfma_f32_16x16x32_bf16 v[168:171], a[180:183], v[72:75], v[168:171]
    v_mfma_f32_16x16x32_bf16 v[172:175], a[180:183], v[76:79], v[172:175]
    v_mfma_f32_16x16x32_bf16 v[176:179], a[184:187], v[64:67], v[176:179]
    v_mfma_f32_16x16x32_bf16 v[180:183], a[184:187], v[68:71], v[180:183]
    v_mfma_f32_16x16x32_bf16 v[184:187], a[184:187], v[72:75], v[184:187]
    v_mfma_f32_16x16x32_bf16 v[188:191], a[184:187], v[76:79], v[188:191]
    v_mfma_f32_16x16x32_bf16 v[192:195], a[188:191], v[64:67], v[192:195]
    v_mfma_f32_16x16x32_bf16 v[196:199], a[188:191], v[68:71], v[196:199]
    v_mfma_f32_16x16x32_bf16 v[200:203], a[188:191], v[72:75], v[200:203]
    v_mfma_f32_16x16x32_bf16 v[204:207], a[188:191], v[76:79], v[204:207]
    s_waitcnt vmcnt(12)
    v_mfma_f32_16x16x32_bf16 v[144:147], a[192:195], v[80:83], v[144:147]
    v_mfma_f32_16x16x32_bf16 v[148:151], a[192:195], v[84:87], v[148:151]
    v_mfma_f32_16x16x32_bf16 v[152:155], a[192:195], v[88:91], v[152:155]
    v_mfma_f32_16x16x32_bf16 v[156:159], a[192:195], v[92:95], v[156:159]
    v_mfma_f32_16x16x32_bf16 v[160:163], a[196:199], v[80:83], v[160:163]
    v_mfma_f32_16x16x32_bf16 v[164:167], a[196:199], v[84:87], v[164:167]
    v_mfma_f32_16x16x32_bf16 v[168:171], a[196:199], v[88:91], v[168:171]
    v_mfma_f32_16x16x32_bf16 v[172:175], a[196:199], v[92:95], v[172:175]
    v_mfma_f32_16x16x32_bf16 v[176:179], a[200:203], v[80:83], v[176:179]
    v_mfma_f32_16x16x32_bf16 v[180:183], a[200:203], v[84:87], v[180:183]
    v_mfma_f32_16x16x32_bf16 v[184:187], a[200:203], v[88:91], v[184:187]
    v_mfma_f32_16x16x32_bf16 v[188:191], a[200:203], v[92:95], v[188:191]
    v_mfma_f32_16x16x32_bf16 v[192:195], a[204:207], v[80:83], v[192:195]
    v_mfma_f32_16x16x32_bf16 v[196:199], a[204:207], v[84:87], v[196:199]
    v_mfma_f32_16x16x32_bf16 v[200:203], a[204:207], v[88:91], v[200:203]
    v_mfma_f32_16x16x32_bf16 v[204:207], a[204:207], v[92:95], v[204:207]
    s_waitcnt vmcnt(8)
    v_mfma_f32_16x16x32_bf16 v[144:147], a[208:211], v[96:99], v[144:147]
    v_mfma_f32_16x16x32_bf16 v[148:151], a[208:211], v[100:103], v[148:151]
    v_mfma_f32_16x16x32_bf16 v[152:155], a[208:211], v[104:107], v[152:155]
    v_mfma_f32_16x16x32_bf16 v[156:159], a[208:211], v[108:111], v[156:159]
    v_mfma_f32_16x16x32_bf16 v[160:163], a[212:215], v[96:99], v[160:163]
    v_mfma_f32_16x16x32_bf16 v[164:167], a[212:215], v[100:103], v[164:167]
    v_mfma_f32_16x16x32_bf16 v[168:171], a[212:215], v[104:107], v[168:171]
    v_mfma_f32_16x16x32_bf16 v[172:175], a[212:215], v[108:111], v[172:175]
    v_mfma_f32_16x16x32_bf16 v[176:179], a[216:219], v[96:99], v[176:179]
    v_mfma_f32_16x16x32_bf16 v[180:183], a[216:219], v[100:103], v[180:183]
    v_mfma_f32_16x16x32_bf16 v[184:187], a[216:219], v[104:107], v[184:187]
    v_mfma_f32_16x16x32_bf16 v[188:191], a[216:219], v[108:111], v[188:191]
    v_mfma_f32_16x16x32_bf16 v[192:195], a[220:223], v[96:99], v[192:195]
    v_mfma_f32_16x16x32_bf16 v[196:199], a[220:223], v[100:103], v[196:199]
    v_mfma_f32_16x16x32_bf16 v[200:203], a[220:223], v[104:107], v[200:203]
    v_mfma_f32_16x16x32_bf16 v[204:207], a[220:223], v[108:111], v[204:207]
    s_waitcnt vmcnt(4)
    v_mfma_f32_16x16x32_bf16 v[144:147], a[224:227], v[112:115], v[144:147]
    v_mfma_f32_16x16x32_bf16 v[148:151], a[224:227], v[116:119], v[148:151]
    v_mfma_f32_16x16x32_bf16 v[152:155], a[224:227], v[120:123], v[152:155]
    v_mfma_f32_16x16x32_bf16 v[156:159], a[224:227], v[124:127], v[156:159]
    v_mfma_f32_16x16x32_bf16 v[160:163], a[228:231], v[112:115], v[160:163]
    v_mfma_f32_16x16x32_bf16 v[164:167], a[228:231], v[116:119], v[164:167]
    v_mfma_f32_16x16x32_bf16 v[168:171], a[228:231], v[120:123], v[168:171]
    v_mfma_f32_16x16x32_bf16 v[172:175], a[228:231], v[124:127], v[172:175]
    v_mfma_f32_16x16x32_bf16 v[176:179], a[232:235], v[112:115], v[176:179]
    v_mfma_f32_16x16x32_bf16 v[180:183], a[232:235], v[116:119], v[180:183]
    v_mfma_f32_16x16x32_bf16 v[184:187], a[232:235], v[120:123], v[184:187]
    v_mfma_f32_16x16x32_bf16 v[188:191], a[232:235], v[124:127], v[188:191]
    v_mfma_f32_16x16x32_bf16 v[192:195], a[236:239], v[112:115], v[192:195]
    v_mfma_f32_16x16x32_bf16 v[196:199], a[236:239], v[116:119], v[196:199]
    v_mfma_f32_16x16x32_bf16 v[200:203], a[236:239], v[120:123], v[200:203]
    v_mfma_f32_16x16x32_bf16 v[204:207], a[236:239], v[124:127], v[204:207]
    s_waitcnt vmcnt(0)
    v_mfma_f32_16x16x32_bf16 v[144:147], a[240:243], v[128:131], v[144:147]
    v_mfma_f32_16x16x32_bf16 v[148:151], a[240:243], v[132:135], v[148:151]
    v_mfma_f32_16x16x32_bf16 v[152:155], a[240:243], v[136:139], v[152:155]
    v_mfma_f32_16x16x32_bf16 v[156:159], a[240:243], v[140:143], v[156:159]
    v_mfma_f32_16x16x32_bf16 v[160:163], a[244:247], v[128:131], v[160:163]
    v_mfma_f32_16x16x32_bf16 v[164:167], a[244:247], v[132:135], v[164:167]
    v_mfma_f32_16x16x32_bf16 v[168:171], a[244:247], v[136:139], v[168:171]
    v_mfma_f32_16x16x32_bf16 v[172:175], a[244:247], v[140:143], v[172:175]
    v_mfma_f32_16x16x32_bf16 v[176:179], a[248:251], v[128:131], v[176:179]
    v_mfma_f32_16x16x32_bf16 v[180:183], a[248:251], v[132:135], v[180:183]
    v_mfma_f32_16x16x32_bf16 v[184:187], a[248:251], v[136:139], v[184:187]
    v_mfma_f32_16x16x32_bf16 v[188:191], a[248:251], v[140:143], v[188:191]
    v_mfma_f32_16x16x32_bf16 v[192:195], a[252:255], v[128:131], v[192:195]
    v_mfma_f32_16x16x32_bf16 v[196:199], a[252:255], v[132:135], v[196:199]
    v_mfma_f32_16x16x32_bf16 v[200:203], a[252:255], v[136:139], v[200:203]
    v_mfma_f32_16x16x32_bf16 v[204:207], a[252:255], v[140:143], v[204:207]
    s_add_u32 s32, s6, 0x2716000
    s_addc_u32 s33, s7, 0
    s_and_b32 s33, s33, 0xffff
    s_mov_b32 s34, 0x1000000
    s_mov_b32 s35, 0x20000
    s_lshl_b32 s27, s30, 7
    s_lshl_b32 s28, s31, 19
    s_add_u32 s27, s27, s28
    v_lshrrev_b32 v10, 2, v8
    v_lshlrev_b32 v10, 3, v10
    v_and_b32 v11, 3, v8
    v_add_u32 v10, v10, v11
    v_mul_u32_u24 v10, 0x2000, v10
    v_lshl_add_u32 v10, v9, 4, v10
    s_add_u32 s28, s27, 0
    v_cvt_pk_bf16_f32 v16, v144, v145
    v_cvt_pk_bf16_f32 v17, v146, v147
    v_cvt_pk_bf16_f32 v18, v160, v161
    v_cvt_pk_bf16_f32 v19, v162, v163
    buffer_store_dwordx4 v[16:19], v10, s[32:35], s28 offen offset:0 sc1
    v_cvt_pk_bf16_f32 v20, v176, v177
    v_cvt_pk_bf16_f32 v21, v178, v179
    v_cvt_pk_bf16_f32 v22, v192, v193
    v_cvt_pk_bf16_f32 v23, v194, v195
    buffer_store_dwordx4 v[20:23], v10, s[32:35], s28 offen offset:64 sc1
    s_nop 0
    s_add_u32 s28, s27, 0x8000
    v_cvt_pk_bf16_f32 v24, v148, v149
    v_cvt_pk_bf16_f32 v25, v150, v151
    v_cvt_pk_bf16_f32 v26, v164, v165
    v_cvt_pk_bf16_f32 v27, v166, v167
    buffer_store_dwordx4 v[24:27], v10, s[32:35], s28 offen offset:0 sc1
    v_cvt_pk_bf16_f32 v28, v180, v181
    v_cvt_pk_bf16_f32 v29, v182, v183
    v_cvt_pk_bf16_f32 v30, v196, v197
    v_cvt_pk_bf16_f32 v31, v198, v199
    buffer_store_dwordx4 v[28:31], v10, s[32:35], s28 offen offset:64 sc1
    s_nop 0
    s_add_u32 s28, s27, 0x40000
    v_cvt_pk_bf16_f32 v32, v152, v153
    v_cvt_pk_bf16_f32 v33, v154, v155
    v_cvt_pk_bf16_f32 v34, v168, v169
    v_cvt_pk_bf16_f32 v35, v170, v171
    buffer_store_dwordx4 v[32:35], v10, s[32:35], s28 offen offset:0 sc1
    v_cvt_pk_bf16_f32 v36, v184, v185
    v_cvt_pk_bf16_f32 v37, v186, v187
    v_cvt_pk_bf16_f32 v38, v200, v201
    v_cvt_pk_bf16_f32 v39, v202, v203
    buffer_store_dwordx4 v[36:39], v10, s[32:35], s28 offen offset:64 sc1
    s_nop 0
    s_add_u32 s28, s27, 0x48000
    v_cvt_pk_bf16_f32 v40, v156, v157
    v_cvt_pk_bf16_f32 v41, v158, v159
    v_cvt_pk_bf16_f32 v42, v172, v173
    v_cvt_pk_bf16_f32 v43, v174, v175
    buffer_store_dwordx4 v[40:43], v10, s[32:35], s28 offen offset:0 sc1
    v_cvt_pk_bf16_f32 v44, v188, v189
    v_cvt_pk_bf16_f32 v45, v190, v191
    v_cvt_pk_bf16_f32 v46, v204, v205
    v_cvt_pk_bf16_f32 v47, v206, v207
    buffer_store_dwordx4 v[44:47], v10, s[32:35], s28 offen offset:64 sc1
    s_branch kv0_sig_58
kv0_v_57:
    buffer_load_dwordx4 v[16:19], v4, s[16:19], s25 offen offset:0
    buffer_load_dwordx4 v[20:23], v4, s[16:19], s25 offen offset:1024
    buffer_load_dwordx4 v[24:27], v5, s[16:19], s25 offen offset:0
    buffer_load_dwordx4 v[28:31], v5, s[16:19], s25 offen offset:1024
    s_add_u32 s25, s25, 0x800
    buffer_load_dwordx4 v[32:35], v4, s[16:19], s25 offen offset:0
    buffer_load_dwordx4 v[36:39], v4, s[16:19], s25 offen offset:1024
    buffer_load_dwordx4 v[40:43], v5, s[16:19], s25 offen offset:0
    buffer_load_dwordx4 v[44:47], v5, s[16:19], s25 offen offset:1024
    s_add_u32 s25, s25, 0x800
    buffer_load_dwordx4 v[48:51], v4, s[16:19], s25 offen offset:0
    buffer_load_dwordx4 v[52:55], v4, s[16:19], s25 offen offset:1024
    buffer_load_dwordx4 v[56:59], v5, s[16:19], s25 offen offset:0
    buffer_load_dwordx4 v[60:63], v5, s[16:19], s25 offen offset:1024
    s_add_u32 s25, s25, 0x800
    buffer_load_dwordx4 v[64:67], v4, s[16:19], s25 offen offset:0
    buffer_load_dwordx4 v[68:71], v4, s[16:19], s25 offen offset:1024
    buffer_load_dwordx4 v[72:75], v5, s[16:19], s25 offen offset:0
    buffer_load_dwordx4 v[76:79], v5, s[16:19], s25 offen offset:1024
    s_add_u32 s25, s25, 0x800
    buffer_load_dwordx4 v[80:83], v4, s[16:19], s25 offen offset:0
    buffer_load_dwordx4 v[84:87], v4, s[16:19], s25 offen offset:1024
    buffer_load_dwordx4 v[88:91], v5, s[16:19], s25 offen offset:0
    buffer_load_dwordx4 v[92:95], v5, s[16:19], s25 offen offset:1024
    s_add_u32 s25, s25, 0x800
    buffer_load_dwordx4 v[96:99], v4, s[16:19], s25 offen offset:0
    buffer_load_dwordx4 v[100:103], v4, s[16:19], s25 offen offset:1024
    buffer_load_dwordx4 v[104:107], v5, s[16:19], s25 offen offset:0
    buffer_load_dwordx4 v[108:111], v5, s[16:19], s25 offen offset:1024
    s_add_u32 s25, s25, 0x800
    buffer_load_dwordx4 v[112:115], v4, s[16:19], s25 offen offset:0
    buffer_load_dwordx4 v[116:119], v4, s[16:19], s25 offen offset:1024
    buffer_load_dwordx4 v[120:123], v5, s[16:19], s25 offen offset:0
    buffer_load_dwordx4 v[124:127], v5, s[16:19], s25 offen offset:1024
    s_add_u32 s25, s25, 0x800
    buffer_load_dwordx4 v[128:131], v4, s[16:19], s25 offen offset:0
    buffer_load_dwordx4 v[132:135], v4, s[16:19], s25 offen offset:1024
    buffer_load_dwordx4 v[136:139], v5, s[16:19], s25 offen offset:0
    buffer_load_dwordx4 v[140:143], v5, s[16:19], s25 offen offset:1024
    s_add_u32 s25, s25, 0x800
    s_waitcnt vmcnt(28)
    v_mfma_f32_16x16x32_bf16 v[144:147], v[16:19], a[0:3], 0
    v_mfma_f32_16x16x32_bf16 v[148:151], v[20:23], a[0:3], 0
    v_mfma_f32_16x16x32_bf16 v[152:155], v[24:27], a[0:3], 0
    v_mfma_f32_16x16x32_bf16 v[156:159], v[28:31], a[0:3], 0
    v_mfma_f32_16x16x32_bf16 v[160:163], v[16:19], a[4:7], 0
    v_mfma_f32_16x16x32_bf16 v[164:167], v[20:23], a[4:7], 0
    v_mfma_f32_16x16x32_bf16 v[168:171], v[24:27], a[4:7], 0
    v_mfma_f32_16x16x32_bf16 v[172:175], v[28:31], a[4:7], 0
    v_mfma_f32_16x16x32_bf16 v[176:179], v[16:19], a[8:11], 0
    v_mfma_f32_16x16x32_bf16 v[180:183], v[20:23], a[8:11], 0
    v_mfma_f32_16x16x32_bf16 v[184:187], v[24:27], a[8:11], 0
    v_mfma_f32_16x16x32_bf16 v[188:191], v[28:31], a[8:11], 0
    v_mfma_f32_16x16x32_bf16 v[192:195], v[16:19], a[12:15], 0
    v_mfma_f32_16x16x32_bf16 v[196:199], v[20:23], a[12:15], 0
    v_mfma_f32_16x16x32_bf16 v[200:203], v[24:27], a[12:15], 0
    v_mfma_f32_16x16x32_bf16 v[204:207], v[28:31], a[12:15], 0
    buffer_load_dwordx4 v[16:19], v4, s[16:19], s25 offen offset:0
    buffer_load_dwordx4 v[20:23], v4, s[16:19], s25 offen offset:1024
    buffer_load_dwordx4 v[24:27], v5, s[16:19], s25 offen offset:0
    buffer_load_dwordx4 v[28:31], v5, s[16:19], s25 offen offset:1024
    s_add_u32 s25, s25, 0x800
    s_waitcnt vmcnt(28)
    v_mfma_f32_16x16x32_bf16 v[144:147], v[32:35], a[16:19], v[144:147]
    v_mfma_f32_16x16x32_bf16 v[148:151], v[36:39], a[16:19], v[148:151]
    v_mfma_f32_16x16x32_bf16 v[152:155], v[40:43], a[16:19], v[152:155]
    v_mfma_f32_16x16x32_bf16 v[156:159], v[44:47], a[16:19], v[156:159]
    v_mfma_f32_16x16x32_bf16 v[160:163], v[32:35], a[20:23], v[160:163]
    v_mfma_f32_16x16x32_bf16 v[164:167], v[36:39], a[20:23], v[164:167]
    v_mfma_f32_16x16x32_bf16 v[168:171], v[40:43], a[20:23], v[168:171]
    v_mfma_f32_16x16x32_bf16 v[172:175], v[44:47], a[20:23], v[172:175]
    v_mfma_f32_16x16x32_bf16 v[176:179], v[32:35], a[24:27], v[176:179]
    v_mfma_f32_16x16x32_bf16 v[180:183], v[36:39], a[24:27], v[180:183]
    v_mfma_f32_16x16x32_bf16 v[184:187], v[40:43], a[24:27], v[184:187]
    v_mfma_f32_16x16x32_bf16 v[188:191], v[44:47], a[24:27], v[188:191]
    v_mfma_f32_16x16x32_bf16 v[192:195], v[32:35], a[28:31], v[192:195]
    v_mfma_f32_16x16x32_bf16 v[196:199], v[36:39], a[28:31], v[196:199]
    v_mfma_f32_16x16x32_bf16 v[200:203], v[40:43], a[28:31], v[200:203]
    v_mfma_f32_16x16x32_bf16 v[204:207], v[44:47], a[28:31], v[204:207]
    buffer_load_dwordx4 v[32:35], v4, s[16:19], s25 offen offset:0
    buffer_load_dwordx4 v[36:39], v4, s[16:19], s25 offen offset:1024
    buffer_load_dwordx4 v[40:43], v5, s[16:19], s25 offen offset:0
    buffer_load_dwordx4 v[44:47], v5, s[16:19], s25 offen offset:1024
    s_add_u32 s25, s25, 0x800
    s_waitcnt vmcnt(28)
    v_mfma_f32_16x16x32_bf16 v[144:147], v[48:51], a[32:35], v[144:147]
    v_mfma_f32_16x16x32_bf16 v[148:151], v[52:55], a[32:35], v[148:151]
    v_mfma_f32_16x16x32_bf16 v[152:155], v[56:59], a[32:35], v[152:155]
    v_mfma_f32_16x16x32_bf16 v[156:159], v[60:63], a[32:35], v[156:159]
    v_mfma_f32_16x16x32_bf16 v[160:163], v[48:51], a[36:39], v[160:163]
    v_mfma_f32_16x16x32_bf16 v[164:167], v[52:55], a[36:39], v[164:167]
    v_mfma_f32_16x16x32_bf16 v[168:171], v[56:59], a[36:39], v[168:171]
    v_mfma_f32_16x16x32_bf16 v[172:175], v[60:63], a[36:39], v[172:175]
    v_mfma_f32_16x16x32_bf16 v[176:179], v[48:51], a[40:43], v[176:179]
    v_mfma_f32_16x16x32_bf16 v[180:183], v[52:55], a[40:43], v[180:183]
    v_mfma_f32_16x16x32_bf16 v[184:187], v[56:59], a[40:43], v[184:187]
    v_mfma_f32_16x16x32_bf16 v[188:191], v[60:63], a[40:43], v[188:191]
    v_mfma_f32_16x16x32_bf16 v[192:195], v[48:51], a[44:47], v[192:195]
    v_mfma_f32_16x16x32_bf16 v[196:199], v[52:55], a[44:47], v[196:199]
    v_mfma_f32_16x16x32_bf16 v[200:203], v[56:59], a[44:47], v[200:203]
    v_mfma_f32_16x16x32_bf16 v[204:207], v[60:63], a[44:47], v[204:207]
    buffer_load_dwordx4 v[48:51], v4, s[16:19], s25 offen offset:0
    buffer_load_dwordx4 v[52:55], v4, s[16:19], s25 offen offset:1024
    buffer_load_dwordx4 v[56:59], v5, s[16:19], s25 offen offset:0
    buffer_load_dwordx4 v[60:63], v5, s[16:19], s25 offen offset:1024
    s_add_u32 s25, s25, 0x800
    s_waitcnt vmcnt(28)
    v_mfma_f32_16x16x32_bf16 v[144:147], v[64:67], a[48:51], v[144:147]
    v_mfma_f32_16x16x32_bf16 v[148:151], v[68:71], a[48:51], v[148:151]
    v_mfma_f32_16x16x32_bf16 v[152:155], v[72:75], a[48:51], v[152:155]
    v_mfma_f32_16x16x32_bf16 v[156:159], v[76:79], a[48:51], v[156:159]
    v_mfma_f32_16x16x32_bf16 v[160:163], v[64:67], a[52:55], v[160:163]
    v_mfma_f32_16x16x32_bf16 v[164:167], v[68:71], a[52:55], v[164:167]
    v_mfma_f32_16x16x32_bf16 v[168:171], v[72:75], a[52:55], v[168:171]
    v_mfma_f32_16x16x32_bf16 v[172:175], v[76:79], a[52:55], v[172:175]
    v_mfma_f32_16x16x32_bf16 v[176:179], v[64:67], a[56:59], v[176:179]
    v_mfma_f32_16x16x32_bf16 v[180:183], v[68:71], a[56:59], v[180:183]
    v_mfma_f32_16x16x32_bf16 v[184:187], v[72:75], a[56:59], v[184:187]
    v_mfma_f32_16x16x32_bf16 v[188:191], v[76:79], a[56:59], v[188:191]
    v_mfma_f32_16x16x32_bf16 v[192:195], v[64:67], a[60:63], v[192:195]
    v_mfma_f32_16x16x32_bf16 v[196:199], v[68:71], a[60:63], v[196:199]
    v_mfma_f32_16x16x32_bf16 v[200:203], v[72:75], a[60:63], v[200:203]
    v_mfma_f32_16x16x32_bf16 v[204:207], v[76:79], a[60:63], v[204:207]
    buffer_load_dwordx4 v[64:67], v4, s[16:19], s25 offen offset:0
    buffer_load_dwordx4 v[68:71], v4, s[16:19], s25 offen offset:1024
    buffer_load_dwordx4 v[72:75], v5, s[16:19], s25 offen offset:0
    buffer_load_dwordx4 v[76:79], v5, s[16:19], s25 offen offset:1024
    s_add_u32 s25, s25, 0x800
    s_waitcnt vmcnt(28)
    v_mfma_f32_16x16x32_bf16 v[144:147], v[80:83], a[64:67], v[144:147]
    v_mfma_f32_16x16x32_bf16 v[148:151], v[84:87], a[64:67], v[148:151]
    v_mfma_f32_16x16x32_bf16 v[152:155], v[88:91], a[64:67], v[152:155]
    v_mfma_f32_16x16x32_bf16 v[156:159], v[92:95], a[64:67], v[156:159]
    v_mfma_f32_16x16x32_bf16 v[160:163], v[80:83], a[68:71], v[160:163]
    v_mfma_f32_16x16x32_bf16 v[164:167], v[84:87], a[68:71], v[164:167]
    v_mfma_f32_16x16x32_bf16 v[168:171], v[88:91], a[68:71], v[168:171]
    v_mfma_f32_16x16x32_bf16 v[172:175], v[92:95], a[68:71], v[172:175]
    v_mfma_f32_16x16x32_bf16 v[176:179], v[80:83], a[72:75], v[176:179]
    v_mfma_f32_16x16x32_bf16 v[180:183], v[84:87], a[72:75], v[180:183]
    v_mfma_f32_16x16x32_bf16 v[184:187], v[88:91], a[72:75], v[184:187]
    v_mfma_f32_16x16x32_bf16 v[188:191], v[92:95], a[72:75], v[188:191]
    v_mfma_f32_16x16x32_bf16 v[192:195], v[80:83], a[76:79], v[192:195]
    v_mfma_f32_16x16x32_bf16 v[196:199], v[84:87], a[76:79], v[196:199]
    v_mfma_f32_16x16x32_bf16 v[200:203], v[88:91], a[76:79], v[200:203]
    v_mfma_f32_16x16x32_bf16 v[204:207], v[92:95], a[76:79], v[204:207]
    buffer_load_dwordx4 v[80:83], v4, s[16:19], s25 offen offset:0
    buffer_load_dwordx4 v[84:87], v4, s[16:19], s25 offen offset:1024
    buffer_load_dwordx4 v[88:91], v5, s[16:19], s25 offen offset:0
    buffer_load_dwordx4 v[92:95], v5, s[16:19], s25 offen offset:1024
    s_add_u32 s25, s25, 0x800
    s_waitcnt vmcnt(28)
    v_mfma_f32_16x16x32_bf16 v[144:147], v[96:99], a[80:83], v[144:147]
    v_mfma_f32_16x16x32_bf16 v[148:151], v[100:103], a[80:83], v[148:151]
    v_mfma_f32_16x16x32_bf16 v[152:155], v[104:107], a[80:83], v[152:155]
    v_mfma_f32_16x16x32_bf16 v[156:159], v[108:111], a[80:83], v[156:159]
    v_mfma_f32_16x16x32_bf16 v[160:163], v[96:99], a[84:87], v[160:163]
    v_mfma_f32_16x16x32_bf16 v[164:167], v[100:103], a[84:87], v[164:167]
    v_mfma_f32_16x16x32_bf16 v[168:171], v[104:107], a[84:87], v[168:171]
    v_mfma_f32_16x16x32_bf16 v[172:175], v[108:111], a[84:87], v[172:175]
    v_mfma_f32_16x16x32_bf16 v[176:179], v[96:99], a[88:91], v[176:179]
    v_mfma_f32_16x16x32_bf16 v[180:183], v[100:103], a[88:91], v[180:183]
    v_mfma_f32_16x16x32_bf16 v[184:187], v[104:107], a[88:91], v[184:187]
    v_mfma_f32_16x16x32_bf16 v[188:191], v[108:111], a[88:91], v[188:191]
    v_mfma_f32_16x16x32_bf16 v[192:195], v[96:99], a[92:95], v[192:195]
    v_mfma_f32_16x16x32_bf16 v[196:199], v[100:103], a[92:95], v[196:199]
    v_mfma_f32_16x16x32_bf16 v[200:203], v[104:107], a[92:95], v[200:203]
    v_mfma_f32_16x16x32_bf16 v[204:207], v[108:111], a[92:95], v[204:207]
    buffer_load_dwordx4 v[96:99], v4, s[16:19], s25 offen offset:0
    buffer_load_dwordx4 v[100:103], v4, s[16:19], s25 offen offset:1024
    buffer_load_dwordx4 v[104:107], v5, s[16:19], s25 offen offset:0
    buffer_load_dwordx4 v[108:111], v5, s[16:19], s25 offen offset:1024
    s_add_u32 s25, s25, 0x800
    s_waitcnt vmcnt(28)
    v_mfma_f32_16x16x32_bf16 v[144:147], v[112:115], a[96:99], v[144:147]
    v_mfma_f32_16x16x32_bf16 v[148:151], v[116:119], a[96:99], v[148:151]
    v_mfma_f32_16x16x32_bf16 v[152:155], v[120:123], a[96:99], v[152:155]
    v_mfma_f32_16x16x32_bf16 v[156:159], v[124:127], a[96:99], v[156:159]
    v_mfma_f32_16x16x32_bf16 v[160:163], v[112:115], a[100:103], v[160:163]
    v_mfma_f32_16x16x32_bf16 v[164:167], v[116:119], a[100:103], v[164:167]
    v_mfma_f32_16x16x32_bf16 v[168:171], v[120:123], a[100:103], v[168:171]
    v_mfma_f32_16x16x32_bf16 v[172:175], v[124:127], a[100:103], v[172:175]
    v_mfma_f32_16x16x32_bf16 v[176:179], v[112:115], a[104:107], v[176:179]
    v_mfma_f32_16x16x32_bf16 v[180:183], v[116:119], a[104:107], v[180:183]
    v_mfma_f32_16x16x32_bf16 v[184:187], v[120:123], a[104:107], v[184:187]
    v_mfma_f32_16x16x32_bf16 v[188:191], v[124:127], a[104:107], v[188:191]
    v_mfma_f32_16x16x32_bf16 v[192:195], v[112:115], a[108:111], v[192:195]
    v_mfma_f32_16x16x32_bf16 v[196:199], v[116:119], a[108:111], v[196:199]
    v_mfma_f32_16x16x32_bf16 v[200:203], v[120:123], a[108:111], v[200:203]
    v_mfma_f32_16x16x32_bf16 v[204:207], v[124:127], a[108:111], v[204:207]
    buffer_load_dwordx4 v[112:115], v4, s[16:19], s25 offen offset:0
    buffer_load_dwordx4 v[116:119], v4, s[16:19], s25 offen offset:1024
    buffer_load_dwordx4 v[120:123], v5, s[16:19], s25 offen offset:0
    buffer_load_dwordx4 v[124:127], v5, s[16:19], s25 offen offset:1024
    s_add_u32 s25, s25, 0x800
    s_waitcnt vmcnt(28)
    v_mfma_f32_16x16x32_bf16 v[144:147], v[128:131], a[112:115], v[144:147]
    v_mfma_f32_16x16x32_bf16 v[148:151], v[132:135], a[112:115], v[148:151]
    v_mfma_f32_16x16x32_bf16 v[152:155], v[136:139], a[112:115], v[152:155]
    v_mfma_f32_16x16x32_bf16 v[156:159], v[140:143], a[112:115], v[156:159]
    v_mfma_f32_16x16x32_bf16 v[160:163], v[128:131], a[116:119], v[160:163]
    v_mfma_f32_16x16x32_bf16 v[164:167], v[132:135], a[116:119], v[164:167]
    v_mfma_f32_16x16x32_bf16 v[168:171], v[136:139], a[116:119], v[168:171]
    v_mfma_f32_16x16x32_bf16 v[172:175], v[140:143], a[116:119], v[172:175]
    v_mfma_f32_16x16x32_bf16 v[176:179], v[128:131], a[120:123], v[176:179]
    v_mfma_f32_16x16x32_bf16 v[180:183], v[132:135], a[120:123], v[180:183]
    v_mfma_f32_16x16x32_bf16 v[184:187], v[136:139], a[120:123], v[184:187]
    v_mfma_f32_16x16x32_bf16 v[188:191], v[140:143], a[120:123], v[188:191]
    v_mfma_f32_16x16x32_bf16 v[192:195], v[128:131], a[124:127], v[192:195]
    v_mfma_f32_16x16x32_bf16 v[196:199], v[132:135], a[124:127], v[196:199]
    v_mfma_f32_16x16x32_bf16 v[200:203], v[136:139], a[124:127], v[200:203]
    v_mfma_f32_16x16x32_bf16 v[204:207], v[140:143], a[124:127], v[204:207]
    buffer_load_dwordx4 v[128:131], v4, s[16:19], s25 offen offset:0
    buffer_load_dwordx4 v[132:135], v4, s[16:19], s25 offen offset:1024
    buffer_load_dwordx4 v[136:139], v5, s[16:19], s25 offen offset:0
    buffer_load_dwordx4 v[140:143], v5, s[16:19], s25 offen offset:1024
    s_add_u32 s25, s25, 0x800
    s_waitcnt vmcnt(28)
    v_mfma_f32_16x16x32_bf16 v[144:147], v[16:19], a[128:131], v[144:147]
    v_mfma_f32_16x16x32_bf16 v[148:151], v[20:23], a[128:131], v[148:151]
    v_mfma_f32_16x16x32_bf16 v[152:155], v[24:27], a[128:131], v[152:155]
    v_mfma_f32_16x16x32_bf16 v[156:159], v[28:31], a[128:131], v[156:159]
    v_mfma_f32_16x16x32_bf16 v[160:163], v[16:19], a[132:135], v[160:163]
    v_mfma_f32_16x16x32_bf16 v[164:167], v[20:23], a[132:135], v[164:167]
    v_mfma_f32_16x16x32_bf16 v[168:171], v[24:27], a[132:135], v[168:171]
    v_mfma_f32_16x16x32_bf16 v[172:175], v[28:31], a[132:135], v[172:175]
    v_mfma_f32_16x16x32_bf16 v[176:179], v[16:19], a[136:139], v[176:179]
    v_mfma_f32_16x16x32_bf16 v[180:183], v[20:23], a[136:139], v[180:183]
    v_mfma_f32_16x16x32_bf16 v[184:187], v[24:27], a[136:139], v[184:187]
    v_mfma_f32_16x16x32_bf16 v[188:191], v[28:31], a[136:139], v[188:191]
    v_mfma_f32_16x16x32_bf16 v[192:195], v[16:19], a[140:143], v[192:195]
    v_mfma_f32_16x16x32_bf16 v[196:199], v[20:23], a[140:143], v[196:199]
    v_mfma_f32_16x16x32_bf16 v[200:203], v[24:27], a[140:143], v[200:203]
    v_mfma_f32_16x16x32_bf16 v[204:207], v[28:31], a[140:143], v[204:207]
    s_waitcnt vmcnt(24)
    v_mfma_f32_16x16x32_bf16 v[144:147], v[32:35], a[144:147], v[144:147]
    v_mfma_f32_16x16x32_bf16 v[148:151], v[36:39], a[144:147], v[148:151]
    v_mfma_f32_16x16x32_bf16 v[152:155], v[40:43], a[144:147], v[152:155]
    v_mfma_f32_16x16x32_bf16 v[156:159], v[44:47], a[144:147], v[156:159]
    v_mfma_f32_16x16x32_bf16 v[160:163], v[32:35], a[148:151], v[160:163]
    v_mfma_f32_16x16x32_bf16 v[164:167], v[36:39], a[148:151], v[164:167]
    v_mfma_f32_16x16x32_bf16 v[168:171], v[40:43], a[148:151], v[168:171]
    v_mfma_f32_16x16x32_bf16 v[172:175], v[44:47], a[148:151], v[172:175]
    v_mfma_f32_16x16x32_bf16 v[176:179], v[32:35], a[152:155], v[176:179]
    v_mfma_f32_16x16x32_bf16 v[180:183], v[36:39], a[152:155], v[180:183]
    v_mfma_f32_16x16x32_bf16 v[184:187], v[40:43], a[152:155], v[184:187]
    v_mfma_f32_16x16x32_bf16 v[188:191], v[44:47], a[152:155], v[188:191]
    v_mfma_f32_16x16x32_bf16 v[192:195], v[32:35], a[156:159], v[192:195]
    v_mfma_f32_16x16x32_bf16 v[196:199], v[36:39], a[156:159], v[196:199]
    v_mfma_f32_16x16x32_bf16 v[200:203], v[40:43], a[156:159], v[200:203]
    v_mfma_f32_16x16x32_bf16 v[204:207], v[44:47], a[156:159], v[204:207]
    s_waitcnt vmcnt(20)
    v_mfma_f32_16x16x32_bf16 v[144:147], v[48:51], a[160:163], v[144:147]
    v_mfma_f32_16x16x32_bf16 v[148:151], v[52:55], a[160:163], v[148:151]
    v_mfma_f32_16x16x32_bf16 v[152:155], v[56:59], a[160:163], v[152:155]
    v_mfma_f32_16x16x32_bf16 v[156:159], v[60:63], a[160:163], v[156:159]
    v_mfma_f32_16x16x32_bf16 v[160:163], v[48:51], a[164:167], v[160:163]
    v_mfma_f32_16x16x32_bf16 v[164:167], v[52:55], a[164:167], v[164:167]
    v_mfma_f32_16x16x32_bf16 v[168:171], v[56:59], a[164:167], v[168:171]
    v_mfma_f32_16x16x32_bf16 v[172:175], v[60:63], a[164:167], v[172:175]
    v_mfma_f32_16x16x32_bf16 v[176:179], v[48:51], a[168:171], v[176:179]
    v_mfma_f32_16x16x32_bf16 v[180:183], v[52:55], a[168:171], v[180:183]
    v_mfma_f32_16x16x32_bf16 v[184:187], v[56:59], a[168:171], v[184:187]
    v_mfma_f32_16x16x32_bf16 v[188:191], v[60:63], a[168:171], v[188:191]
    v_mfma_f32_16x16x32_bf16 v[192:195], v[48:51], a[172:175], v[192:195]
    v_mfma_f32_16x16x32_bf16 v[196:199], v[52:55], a[172:175], v[196:199]
    v_mfma_f32_16x16x32_bf16 v[200:203], v[56:59], a[172:175], v[200:203]
    v_mfma_f32_16x16x32_bf16 v[204:207], v[60:63], a[172:175], v[204:207]
    s_waitcnt vmcnt(16)
    v_mfma_f32_16x16x32_bf16 v[144:147], v[64:67], a[176:179], v[144:147]
    v_mfma_f32_16x16x32_bf16 v[148:151], v[68:71], a[176:179], v[148:151]
    v_mfma_f32_16x16x32_bf16 v[152:155], v[72:75], a[176:179], v[152:155]
    v_mfma_f32_16x16x32_bf16 v[156:159], v[76:79], a[176:179], v[156:159]
    v_mfma_f32_16x16x32_bf16 v[160:163], v[64:67], a[180:183], v[160:163]
    v_mfma_f32_16x16x32_bf16 v[164:167], v[68:71], a[180:183], v[164:167]
    v_mfma_f32_16x16x32_bf16 v[168:171], v[72:75], a[180:183], v[168:171]
    v_mfma_f32_16x16x32_bf16 v[172:175], v[76:79], a[180:183], v[172:175]
    v_mfma_f32_16x16x32_bf16 v[176:179], v[64:67], a[184:187], v[176:179]
    v_mfma_f32_16x16x32_bf16 v[180:183], v[68:71], a[184:187], v[180:183]
    v_mfma_f32_16x16x32_bf16 v[184:187], v[72:75], a[184:187], v[184:187]
    v_mfma_f32_16x16x32_bf16 v[188:191], v[76:79], a[184:187], v[188:191]
    v_mfma_f32_16x16x32_bf16 v[192:195], v[64:67], a[188:191], v[192:195]
    v_mfma_f32_16x16x32_bf16 v[196:199], v[68:71], a[188:191], v[196:199]
    v_mfma_f32_16x16x32_bf16 v[200:203], v[72:75], a[188:191], v[200:203]
    v_mfma_f32_16x16x32_bf16 v[204:207], v[76:79], a[188:191], v[204:207]
    s_waitcnt vmcnt(12)
    v_mfma_f32_16x16x32_bf16 v[144:147], v[80:83], a[192:195], v[144:147]
    v_mfma_f32_16x16x32_bf16 v[148:151], v[84:87], a[192:195], v[148:151]
    v_mfma_f32_16x16x32_bf16 v[152:155], v[88:91], a[192:195], v[152:155]
    v_mfma_f32_16x16x32_bf16 v[156:159], v[92:95], a[192:195], v[156:159]
    v_mfma_f32_16x16x32_bf16 v[160:163], v[80:83], a[196:199], v[160:163]
    v_mfma_f32_16x16x32_bf16 v[164:167], v[84:87], a[196:199], v[164:167]
    v_mfma_f32_16x16x32_bf16 v[168:171], v[88:91], a[196:199], v[168:171]
    v_mfma_f32_16x16x32_bf16 v[172:175], v[92:95], a[196:199], v[172:175]
    v_mfma_f32_16x16x32_bf16 v[176:179], v[80:83], a[200:203], v[176:179]
    v_mfma_f32_16x16x32_bf16 v[180:183], v[84:87], a[200:203], v[180:183]
    v_mfma_f32_16x16x32_bf16 v[184:187], v[88:91], a[200:203], v[184:187]
    v_mfma_f32_16x16x32_bf16 v[188:191], v[92:95], a[200:203], v[188:191]
    v_mfma_f32_16x16x32_bf16 v[192:195], v[80:83], a[204:207], v[192:195]
    v_mfma_f32_16x16x32_bf16 v[196:199], v[84:87], a[204:207], v[196:199]
    v_mfma_f32_16x16x32_bf16 v[200:203], v[88:91], a[204:207], v[200:203]
    v_mfma_f32_16x16x32_bf16 v[204:207], v[92:95], a[204:207], v[204:207]
    s_waitcnt vmcnt(8)
    v_mfma_f32_16x16x32_bf16 v[144:147], v[96:99], a[208:211], v[144:147]
    v_mfma_f32_16x16x32_bf16 v[148:151], v[100:103], a[208:211], v[148:151]
    v_mfma_f32_16x16x32_bf16 v[152:155], v[104:107], a[208:211], v[152:155]
    v_mfma_f32_16x16x32_bf16 v[156:159], v[108:111], a[208:211], v[156:159]
    v_mfma_f32_16x16x32_bf16 v[160:163], v[96:99], a[212:215], v[160:163]
    v_mfma_f32_16x16x32_bf16 v[164:167], v[100:103], a[212:215], v[164:167]
    v_mfma_f32_16x16x32_bf16 v[168:171], v[104:107], a[212:215], v[168:171]
    v_mfma_f32_16x16x32_bf16 v[172:175], v[108:111], a[212:215], v[172:175]
    v_mfma_f32_16x16x32_bf16 v[176:179], v[96:99], a[216:219], v[176:179]
    v_mfma_f32_16x16x32_bf16 v[180:183], v[100:103], a[216:219], v[180:183]
    v_mfma_f32_16x16x32_bf16 v[184:187], v[104:107], a[216:219], v[184:187]
    v_mfma_f32_16x16x32_bf16 v[188:191], v[108:111], a[216:219], v[188:191]
    v_mfma_f32_16x16x32_bf16 v[192:195], v[96:99], a[220:223], v[192:195]
    v_mfma_f32_16x16x32_bf16 v[196:199], v[100:103], a[220:223], v[196:199]
    v_mfma_f32_16x16x32_bf16 v[200:203], v[104:107], a[220:223], v[200:203]
    v_mfma_f32_16x16x32_bf16 v[204:207], v[108:111], a[220:223], v[204:207]
    s_waitcnt vmcnt(4)
    v_mfma_f32_16x16x32_bf16 v[144:147], v[112:115], a[224:227], v[144:147]
    v_mfma_f32_16x16x32_bf16 v[148:151], v[116:119], a[224:227], v[148:151]
    v_mfma_f32_16x16x32_bf16 v[152:155], v[120:123], a[224:227], v[152:155]
    v_mfma_f32_16x16x32_bf16 v[156:159], v[124:127], a[224:227], v[156:159]
    v_mfma_f32_16x16x32_bf16 v[160:163], v[112:115], a[228:231], v[160:163]
    v_mfma_f32_16x16x32_bf16 v[164:167], v[116:119], a[228:231], v[164:167]
    v_mfma_f32_16x16x32_bf16 v[168:171], v[120:123], a[228:231], v[168:171]
    v_mfma_f32_16x16x32_bf16 v[172:175], v[124:127], a[228:231], v[172:175]
    v_mfma_f32_16x16x32_bf16 v[176:179], v[112:115], a[232:235], v[176:179]
    v_mfma_f32_16x16x32_bf16 v[180:183], v[116:119], a[232:235], v[180:183]
    v_mfma_f32_16x16x32_bf16 v[184:187], v[120:123], a[232:235], v[184:187]
    v_mfma_f32_16x16x32_bf16 v[188:191], v[124:127], a[232:235], v[188:191]
    v_mfma_f32_16x16x32_bf16 v[192:195], v[112:115], a[236:239], v[192:195]
    v_mfma_f32_16x16x32_bf16 v[196:199], v[116:119], a[236:239], v[196:199]
    v_mfma_f32_16x16x32_bf16 v[200:203], v[120:123], a[236:239], v[200:203]
    v_mfma_f32_16x16x32_bf16 v[204:207], v[124:127], a[236:239], v[204:207]
    s_waitcnt vmcnt(0)
    v_mfma_f32_16x16x32_bf16 v[144:147], v[128:131], a[240:243], v[144:147]
    v_mfma_f32_16x16x32_bf16 v[148:151], v[132:135], a[240:243], v[148:151]
    v_mfma_f32_16x16x32_bf16 v[152:155], v[136:139], a[240:243], v[152:155]
    v_mfma_f32_16x16x32_bf16 v[156:159], v[140:143], a[240:243], v[156:159]
    v_mfma_f32_16x16x32_bf16 v[160:163], v[128:131], a[244:247], v[160:163]
    v_mfma_f32_16x16x32_bf16 v[164:167], v[132:135], a[244:247], v[164:167]
    v_mfma_f32_16x16x32_bf16 v[168:171], v[136:139], a[244:247], v[168:171]
    v_mfma_f32_16x16x32_bf16 v[172:175], v[140:143], a[244:247], v[172:175]
    v_mfma_f32_16x16x32_bf16 v[176:179], v[128:131], a[248:251], v[176:179]
    v_mfma_f32_16x16x32_bf16 v[180:183], v[132:135], a[248:251], v[180:183]
    v_mfma_f32_16x16x32_bf16 v[184:187], v[136:139], a[248:251], v[184:187]
    v_mfma_f32_16x16x32_bf16 v[188:191], v[140:143], a[248:251], v[188:191]
    v_mfma_f32_16x16x32_bf16 v[192:195], v[128:131], a[252:255], v[192:195]
    v_mfma_f32_16x16x32_bf16 v[196:199], v[132:135], a[252:255], v[196:199]
    v_mfma_f32_16x16x32_bf16 v[200:203], v[136:139], a[252:255], v[200:203]
    v_mfma_f32_16x16x32_bf16 v[204:207], v[140:143], a[252:255], v[204:207]
    s_add_u32 s32, s6, 0x3716000
    s_addc_u32 s33, s7, 0
    s_and_b32 s33, s33, 0xffff
    s_mov_b32 s34, 0x1000000
    s_mov_b32 s35, 0x20000
    s_and_b32 s27, s30, 63
    s_lshl_b32 s27, s27, 18
    s_lshl_b32 s28, s31, 7
    s_add_u32 s27, s27, s28
    v_lshrrev_b32 v10, 2, v8
    v_lshlrev_b32 v10, 3, v10
    v_and_b32 v11, 3, v8
    v_add_u32 v10, v10, v11
    v_mul_u32_u24 v10, 0x1000, v10
    v_lshl_add_u32 v10, v9, 4, v10
    s_add_u32 s28, s27, 0
    v_cvt_pk_bf16_f32 v16, v144, v145
    v_cvt_pk_bf16_f32 v17, v146, v147
    v_cvt_pk_bf16_f32 v18, v148, v149
    v_cvt_pk_bf16_f32 v19, v150, v151
    buffer_store_dwordx4 v[16:19], v10, s[32:35], s28 offen offset:0 sc1
    v_cvt_pk_bf16_f32 v20, v152, v153
    v_cvt_pk_bf16_f32 v21, v154, v155
    v_cvt_pk_bf16_f32 v22, v156, v157
    v_cvt_pk_bf16_f32 v23, v158, v159
    buffer_store_dwordx4 v[20:23], v10, s[32:35], s28 offen offset:64 sc1
    s_nop 0
    s_add_u32 s28, s27, 0x4000
    v_cvt_pk_bf16_f32 v24, v160, v161
    v_cvt_pk_bf16_f32 v25, v162, v163
    v_cvt_pk_bf16_f32 v26, v164, v165
    v_cvt_pk_bf16_f32 v27, v166, v167
    buffer_store_dwordx4 v[24:27], v10, s[32:35], s28 offen offset:0 sc1
    v_cvt_pk_bf16_f32 v28, v168, v169
    v_cvt_pk_bf16_f32 v29, v170, v171
    v_cvt_pk_bf16_f32 v30, v172, v173
    v_cvt_pk_bf16_f32 v31, v174, v175
    buffer_store_dwordx4 v[28:31], v10, s[32:35], s28 offen offset:64 sc1
    s_nop 0
    s_add_u32 s28, s27, 0x20000
    v_cvt_pk_bf16_f32 v32, v176, v177
    v_cvt_pk_bf16_f32 v33, v178, v179
    v_cvt_pk_bf16_f32 v34, v180, v181
    v_cvt_pk_bf16_f32 v35, v182, v183
    buffer_store_dwordx4 v[32:35], v10, s[32:35], s28 offen offset:0 sc1
    v_cvt_pk_bf16_f32 v36, v184, v185
    v_cvt_pk_bf16_f32 v37, v186, v187
    v_cvt_pk_bf16_f32 v38, v188, v189
    v_cvt_pk_bf16_f32 v39, v190, v191
    buffer_store_dwordx4 v[36:39], v10, s[32:35], s28 offen offset:64 sc1
    s_nop 0
    s_add_u32 s28, s27, 0x24000
    v_cvt_pk_bf16_f32 v40, v192, v193
    v_cvt_pk_bf16_f32 v41, v194, v195
    v_cvt_pk_bf16_f32 v42, v196, v197
    v_cvt_pk_bf16_f32 v43, v198, v199
    buffer_store_dwordx4 v[40:43], v10, s[32:35], s28 offen offset:0 sc1
    v_cvt_pk_bf16_f32 v44, v200, v201
    v_cvt_pk_bf16_f32 v45, v202, v203
    v_cvt_pk_bf16_f32 v46, v204, v205
    v_cvt_pk_bf16_f32 v47, v206, v207
    buffer_store_dwordx4 v[44:47], v10, s[32:35], s28 offen offset:64 sc1
kv0_sig_58:
    s_mov_b32 s22, 32
    s_waitcnt vmcnt(0)
    s_barrier
    s_cmp_lg_u32 s3, 0
    s_cbranch_scc1 w_loop
    s_lshl_b32 s90, s22, 8
    s_add_u32 s90, s90, 0
    s_mov_b64 exec, 1
    v_mov_b32 v250, 0
    v_mov_b32 v251, 1
    buffer_atomic_add v251, v250, s[8:11], s90 offen
    s_mov_b64 exec, -1
    s_branch w_loop
w_a_28:
    s_sub_u32 s24, s5, 0x90
    s_lshl_b32 s24, s24, 2
    s_branch w_wp_24
w_wp2_27:
    s_sub_u32 s24, s5, 0x1e0
    s_lshl_b32 s24, s24, 2
w_wp_24:
    s_load_dwordx4 s[44:47], s[0:1], 16
    s_load_dwordx4 s[48:51], s[0:1], 32
    s_load_dwordx2 s[52:53], s[0:1], 64
    s_load_dwordx2 s[54:55], s[0:1], 0x50
    s_add_u32 s24, s24, s3
    s_waitcnt lgkmcnt(0)
    s_mov_b32 s26, s46
    s_mov_b32 s27, s47
    s_mov_b32 s28, 0x2000
    s_mov_b32 s29, 16
    s_mov_b32 s30, 0x796000
    s_mov_b32 s31, 0
    s_mov_b32 s32, 0
    s_mov_b32 s33, 0x400000
    s_mov_b32 s22, 0xa0
    s_mov_b32 s23, 5
    s_cmp_ge_u32 s24, 0x200
    s_cselect_b32 s26, s48, s26
    s_cselect_b32 s27, s49, s27
    s_cselect_b32 s28, 0x2000, s28
    s_cselect_b32 s29, 16, s29
    s_cselect_b32 s30, 0xb96000, s30
    s_cselect_b32 s31, 0x200, s31
    s_cselect_b32 s32, 0, s32
    s_cselect_b32 s33, 0x400000, s33
    s_cselect_b32 s22, 0xb0, s22
    s_cselect_b32 s23, 5, s23
    s_cmp_ge_u32 s24, 0x400
    s_cselect_b32 s26, s44, s26
    s_cselect_b32 s27, s45, s27
    s_cselect_b32 s28, 0x2000, s28
    s_cselect_b32 s29, 16, s29
    s_cselect_b32 s30, 0x396000, s30
    s_cselect_b32 s31, 0x400, s31
    s_cselect_b32 s32, 0, s32
    s_cselect_b32 s33, 0x400000, s33
    s_cselect_b32 s22, 0x90, s22
    s_cselect_b32 s23, 5, s23
    s_cmp_ge_u32 s24, 0x600
    s_cselect_b32 s26, s50, s26
    s_cselect_b32 s27, s51, s27
    s_cselect_b32 s28, 0x400, s28
    s_cselect_b32 s29, 0x80, s29
    s_cselect_b32 s30, 0xf96000, s30
    s_cselect_b32 s31, 0x600, s31
    s_cselect_b32 s32, 1, s32
    s_cselect_b32 s33, 0x400000, s33
    s_cselect_b32 s22, 0xd0, s22
    s_cselect_b32 s23, 31, s23
    s_cmp_ge_u32 s24, 0x800
    s_cselect_b32 s26, s52, s26
    s_cselect_b32 s27, s53, s27
    s_cselect_b32 s28, 0xe00, s28
    s_cselect_b32 s29, 16, s29
    s_cselect_b32 s30, 0x1396000, s30
    s_cselect_b32 s31, 0x800, s31
    s_cselect_b32 s32, 0, s32
    s_cselect_b32 s33, 0x1c0000, s33
    s_cselect_b32 s22, 0xd1, s22
    s_cselect_b32 s23, 31, s23
    s_cmp_ge_u32 s24, 0x8e0
    s_cselect_b32 s26, s54, s26
    s_cselect_b32 s27, s55, s27
    s_cselect_b32 s28, 0x400, s28
    s_cselect_b32 s29, 56, s29
    s_cselect_b32 s30, 0x1556000, s30
    s_cselect_b32 s31, 0x8e0, s31
    s_cselect_b32 s32, 1, s32
    s_cselect_b32 s33, 0x1c0000, s33
    s_cselect_b32 s22, 0xd2, s22
    s_cselect_b32 s23, 31, s23
    s_sub_u32 s24, s24, s31
    s_lshr_b32 s23, s24, s23
    s_add_u32 s22, s22, s23
    s_lshr_b32 s34, s24, 4
    s_and_b32 s35, s24, 15
    s_and_b32 s36, s24, 3
    s_lshr_b32 s37, s24, 2
    s_cmp_eq_u32 s32, 1
    s_cselect_b32 s34, s36, s34
    s_cselect_b32 s35, s37, s35
    s_mov_b32 s40, s26
    s_and_b32 s41, s27, 0xffff
    s_mov_b32 s42, s33
    s_mov_b32 s43, 0x20000
    s_add_u32 s44, s6, 0x396000
    s_addc_u32 s45, s7, 0
    s_and_b32 s45, s45, 0xffff
    s_mov_b32 s46, 0x1380000
    s_mov_b32 s47, 0x20000
    s_add_u32 s8, s6, 0x3000
    s_addc_u32 s9, s7, 0
    s_and_b32 s9, s9, 0xffff
    s_mov_b32 s10, 0x10000
    s_mov_b32 s11, 0x20000
    s_sub_u32 s30, s30, 0x396000
    s_mul_i32 s38, s35, s28
    s_lshl_b32 s38, s38, 5
    s_lshl_b32 s39, s34, 8
    s_add_u32 s38, s38, s39
    v_lshrrev_b32 v3, 4, v0
    v_and_b32 v4, 15, v0
    v_mul_lo_u32 v5, v3, s28
    v_lshl_add_u32 v5, v4, 4, v5
    s_lshl_b32 s39, s28, 2
    buffer_load_dwordx4 v[16:19], v5, s[40:43], s38 offen
    s_add_u32 s38, s38, s39
    buffer_load_dwordx4 v[20:23], v5, s[40:43], s38 offen
    s_add_u32 s38, s38, s39
    buffer_load_dwordx4 v[24:27], v5, s[40:43], s38 offen
    s_add_u32 s38, s38, s39
    buffer_load_dwordx4 v[28:31], v5, s[40:43], s38 offen
    s_add_u32 s38, s38, s39
    buffer_load_dwordx4 v[32:35], v5, s[40:43], s38 offen
    s_add_u32 s38, s38, s39
    buffer_load_dwordx4 v[36:39], v5, s[40:43], s38 offen
    s_add_u32 s38, s38, s39
    buffer_load_dwordx4 v[40:43], v5, s[40:43], s38 offen
    s_add_u32 s38, s38, s39
    buffer_load_dwordx4 v[44:47], v5, s[40:43], s38 offen
    s_mul_i32 s39, s3, 0x2200
    v_mul_u32_u24 v6, 0x110, v3
    v_lshl_add_u32 v6, v4, 4, v6
    v_add_u32 v6, s39, v6
    v_bfe_u32 v7, v0, 2, 2
    v_lshl_add_u32 v7, v3, 3, v7
    v_mul_u32_u24 v7, 0x110, v7
    v_and_b32 v8, 3, v0
    v_lshl_add_u32 v7, v8, 4, v7
    v_add_u32 v7, s39, v7
    v_lshlrev_b32 v9, 4, v0
    s_mul_i32 s39, s34, s29
    s_lshl_b32 s39, s39, 2
    s_add_u32 s39, s39, s35
    s_lshl_b32 s39, s39, 11
    s_add_u32 s39, s39, s30
    s_lshl_b32 s38, s29, 11
    s_waitcnt vmcnt(7)
    ds_write_b128 v6, v[16:19] offset:0
    s_waitcnt vmcnt(6)
    ds_write_b128 v6, v[20:23] offset:1088
    s_waitcnt vmcnt(5)
    ds_write_b128 v6, v[24:27] offset:2176
    s_waitcnt vmcnt(4)
    ds_write_b128 v6, v[28:31] offset:3264
    s_waitcnt vmcnt(3)
    ds_write_b128 v6, v[32:35] offset:4352
    s_waitcnt vmcnt(2)
    ds_write_b128 v6, v[36:39] offset:5440
    s_waitcnt vmcnt(1)
    ds_write_b128 v6, v[40:43] offset:6528
    s_waitcnt vmcnt(0)
    ds_write_b128 v6, v[44:47] offset:7616
    s_waitcnt lgkmcnt(0)
    ds_read_b64_tr_b16 v[16:17], v7 offset:0
    ds_read_b64_tr_b16 v[18:19], v7 offset:1088
    ds_read_b64_tr_b16 v[20:21], v7 offset:8
    ds_read_b64_tr_b16 v[22:23], v7 offset:1096
    ds_read_b64_tr_b16 v[24:25], v7 offset:64
    ds_read_b64_tr_b16 v[26:27], v7 offset:1152
    ds_read_b64_tr_b16 v[28:29], v7 offset:72
    ds_read_b64_tr_b16 v[30:31], v7 offset:1160
    ds_read_b64_tr_b16 v[32:33], v7 offset:128
    ds_read_b64_tr_b16 v[34:35], v7 offset:1216
    ds_read_b64_tr_b16 v[36:37], v7 offset:136
    ds_read_b64_tr_b16 v[38:39], v7 offset:1224
    ds_read_b64_tr_b16 v[40:41], v7 offset:192
    ds_read_b64_tr_b16 v[42:43], v7 offset:1280
    ds_read_b64_tr_b16 v[44:45], v7 offset:200
    ds_read_b64_tr_b16 v[46:47], v7 offset:1288
    s_waitcnt lgkmcnt(14)
    buffer_store_dwordx4 v[16:19], v9, s[44:47], s39 offen offset:0 sc1
    s_waitcnt lgkmcnt(12)
    buffer_store_dwordx4 v[20:23], v9, s[44:47], s39 offen offset:1024 sc1
    s_nop 0
    s_add_u32 s39, s39, s38
    s_waitcnt lgkmcnt(10)
    buffer_store_dwordx4 v[24:27], v9, s[44:47], s39 offen offset:0 sc1
    s_waitcnt lgkmcnt(8)
    buffer_store_dwordx4 v[28:31], v9, s[44:47], s39 offen offset:1024 sc1
    s_nop 0
    s_add_u32 s39, s39, s38
    s_waitcnt lgkmcnt(6)
    buffer_store_dwordx4 v[32:35], v9, s[44:47], s39 offen offset:0 sc1
    s_waitcnt lgkmcnt(4)
    buffer_store_dwordx4 v[36:39], v9, s[44:47], s39 offen offset:1024 sc1
    s_nop 0
    s_add_u32 s39, s39, s38
    s_waitcnt lgkmcnt(2)
    buffer_store_dwordx4 v[40:43], v9, s[44:47], s39 offen offset:0 sc1
    s_waitcnt lgkmcnt(0)
    buffer_store_dwordx4 v[44:47], v9, s[44:47], s39 offen offset:1024 sc1
    s_nop 0
    s_add_u32 s39, s39, s38
    s_waitcnt vmcnt(0)
    s_barrier
    s_cmp_lg_u32 s3, 0
    s_cbranch_scc1 w_loop
    s_lshl_b32 s90, s22, 8
    s_add_u32 s90, s90, 0
    s_mov_b64 exec, 1
    v_mov_b32 v250, 0
    v_mov_b32 v251, 1
    buffer_atomic_add v251, v250, s[8:11], s90 offen
    s_mov_b64 exec, -1
    s_branch w_loop
w_b_29:
    s_sub_u32 s21, s5, 0x180
w_ln1_25:
    s_add_u32 s8, s6, 0x3000
    s_addc_u32 s9, s7, 0
    s_and_b32 s9, s9, 0xffff
    s_mov_b32 s10, 0x10000
    s_mov_b32 s11, 0x20000
    s_load_dwordx2 s[4:5], s[0:1], 0
    s_lshl_b32 s30, s21, 4
    s_lshl_b32 s22, s3, 2
    s_add_u32 s30, s30, s22
    s_lshr_b32 s22, s21, 4
    s_add_u32 s22, s22, 0xc0
    s_waitcnt lgkmcnt(0)
    s_mov_b32 s12, s4
    s_mov_b32 s13, s5
    s_and_b32 s13, s13, 0xffff
    s_mov_b32 s14, 0x200000
    s_mov_b32 s15, 0x20000
    s_mov_b32 s16, s6
    s_mov_b32 s17, s7
    s_and_b32 s17, s17, 0xffff
    s_mov_b32 s18, 0x3000
    s_mov_b32 s19, 0x20000
    s_add_u32 s24, s6, 0x196000
    s_addc_u32 s25, s7, 0
    s_and_b32 s25, s25, 0xffff
    s_mov_b32 s26, 0x200000
    s_mov_b32 s27, 0x20000
    s_lshl_b32 s31, s30, 10
    v_lshlrev_b32 v3, 4, v0
    buffer_load_dwordx4 v[40:43], v3, s[12:15], s31 offen offset:0
    buffer_load_dwordx4 v[44:47], v3, s[12:15], s31 offen offset:1024
    buffer_load_dwordx4 v[48:51], v3, s[12:15], s31 offen offset:2048
    buffer_load_dwordx4 v[52:55], v3, s[12:15], s31 offen offset:3072
    s_cmp_lg_u32 s3, 0
    s_cbranch_scc1 dwd_60
    v_mov_b32 v250, 0xc0
dw_59:
    buffer_load_dword v251, v250, s[96:99], 0 offen sc1
    s_waitcnt vmcnt(0)
    v_readfirstlane_b32 s91, v251
    s_cmp_ge_u32 s91, 24
    s_cbranch_scc1 dwd_60
    s_sleep 4
    s_add_u32 s92, s92, 1
    s_cmp_gt_u32 s92, 0x1e8480
    s_cbranch_scc1 main_kernel_exit_w
    s_branch dw_59
dwd_60:
    s_waitcnt vmcnt(0)
    s_barrier
    v_lshlrev_b32 v3, 5, v0
    s_mov_b32 s33, 0x800
    buffer_load_dwordx4 v[24:27], v3, s[16:19], 0 offen
    buffer_load_dwordx4 v[28:31], v3, s[16:19], 0 offen offset:16
    buffer_load_dwordx4 v[32:35], v3, s[16:19], s33 offen
    buffer_load_dwordx4 v[36:39], v3, s[16:19], s33 offen offset:16
    v_lshrrev_b32 v3, 2, v0
    v_lshlrev_b32 v3, 11, v3
    v_and_b32 v1, 3, v0
    v_lshl_add_u32 v3, v1, 8, v3
    s_waitcnt vmcnt(0)
    v_add_f32 v32, 1.0, v32
    v_cvt_pk_bf16_f32 v32, v32, v32
    v_lshlrev_b32 v32, 16, v32
    v_add_f32 v33, 1.0, v33
    v_cvt_pk_bf16_f32 v33, v33, v33
    v_lshlrev_b32 v33, 16, v33
    v_add_f32 v34, 1.0, v34
    v_cvt_pk_bf16_f32 v34, v34, v34
    v_lshlrev_b32 v34, 16, v34
    v_add_f32 v35, 1.0, v35
    v_cvt_pk_bf16_f32 v35, v35, v35
    v_lshlrev_b32 v35, 16, v35
    v_add_f32 v36, 1.0, v36
    v_cvt_pk_bf16_f32 v36, v36, v36
    v_lshlrev_b32 v36, 16, v36
    v_add_f32 v37, 1.0, v37
    v_cvt_pk_bf16_f32 v37, v37, v37
    v_lshlrev_b32 v37, 16, v37
    v_add_f32 v38, 1.0, v38
    v_cvt_pk_bf16_f32 v38, v38, v38
    v_lshlrev_b32 v38, 16, v38
    v_add_f32 v39, 1.0, v39
    v_cvt_pk_bf16_f32 v39, v39, v39
    v_lshlrev_b32 v39, 16, v39
    s_lshr_b32 s31, s30, 5
    s_lshl_b32 s31, s31, 15
    s_bfe_u32 s32, s30, 0x10002
    s_lshl_b32 s32, s32, 10
    s_add_u32 s31, s31, s32
    s_bfe_u32 s32, s30, 0x20003
    s_lshl_b32 s32, s32, 6
    s_add_u32 s31, s31, s32
    v_lshlrev_b32 v8, 16, v40
    v_and_b32 v9, 0xffff0000, v40
    v_lshlrev_b32 v10, 16, v41
    v_and_b32 v11, 0xffff0000, v41
    v_lshlrev_b32 v12, 16, v42
    v_and_b32 v13, 0xffff0000, v42
    v_lshlrev_b32 v14, 16, v43
    v_and_b32 v15, 0xffff0000, v43
    v_add_f32 v16, v8, v9
    v_add_f32 v16, v16, v10
    v_add_f32 v16, v16, v11
    v_add_f32 v16, v16, v12
    v_add_f32 v16, v16, v13
    v_add_f32 v16, v16, v14
    v_add_f32 v16, v16, v15
    s_nop 1
    v_add_f32_dpp v16, v16, v16 quad_perm:[1,0,3,2] row_mask:0xf bank_mask:0xf
    s_nop 1
    v_add_f32_dpp v16, v16, v16 quad_perm:[2,3,0,1] row_mask:0xf bank_mask:0xf
    s_nop 1
    v_add_f32_dpp v16, v16, v16 row_half_mirror row_mask:0xf bank_mask:0xf
    s_nop 1
    v_add_f32_dpp v16, v16, v16 row_mirror row_mask:0xf bank_mask:0xf
    v_mov_b32 v17, v16
    s_nop 1
    v_permlane16_swap_b32 v16, v17
    v_add_f32 v16, v16, v17
    v_mov_b32 v17, v16
    s_nop 1
    v_permlane32_swap_b32 v16, v17
    v_add_f32 v16, v16, v17
    v_mul_f32 v16, 0x3b000000, v16
    v_sub_f32 v18, v8, v16
    v_mul_f32 v17, v18, v18
    v_sub_f32 v18, v9, v16
    v_fmac_f32 v17, v18, v18
    v_sub_f32 v18, v10, v16
    v_fmac_f32 v17, v18, v18
    v_sub_f32 v18, v11, v16
    v_fmac_f32 v17, v18, v18
    v_sub_f32 v18, v12, v16
    v_fmac_f32 v17, v18, v18
    v_sub_f32 v18, v13, v16
    v_fmac_f32 v17, v18, v18
    v_sub_f32 v18, v14, v16
    v_fmac_f32 v17, v18, v18
    v_sub_f32 v18, v15, v16
    v_fmac_f32 v17, v18, v18
    s_nop 1
    v_add_f32_dpp v17, v17, v17 quad_perm:[1,0,3,2] row_mask:0xf bank_mask:0xf
    s_nop 1
    v_add_f32_dpp v17, v17, v17 quad_perm:[2,3,0,1] row_mask:0xf bank_mask:0xf
    s_nop 1
    v_add_f32_dpp v17, v17, v17 row_half_mirror row_mask:0xf bank_mask:0xf
    s_nop 1
    v_add_f32_dpp v17, v17, v17 row_mirror row_mask:0xf bank_mask:0xf
    v_mov_b32 v18, v17
    s_nop 1
    v_permlane16_swap_b32 v17, v18
    v_add_f32 v17, v17, v18
    v_mov_b32 v18, v17
    s_nop 1
    v_permlane32_swap_b32 v17, v18
    v_add_f32 v17, v17, v18
    v_mul_f32 v17, 0x3b000000, v17
    v_cvt_pk_bf16_f32 v16, v16, v16
    v_lshlrev_b32 v16, 16, v16
    v_cvt_pk_bf16_f32 v17, v17, v17
    v_lshlrev_b32 v17, 16, v17
    v_add_f32 v17, 0x3727c5ac, v17
    v_cvt_pk_bf16_f32 v17, v17, v17
    v_lshlrev_b32 v17, 16, v17
    v_sqrt_f32 v17, v17
    s_nop 0
    v_cvt_pk_bf16_f32 v17, v17, v17
    v_lshlrev_b32 v17, 16, v17
    v_rcp_f32 v17, v17
    v_sub_f32 v8, v8, v16
    v_cvt_pk_bf16_f32 v8, v8, v8
    v_lshlrev_b32 v8, 16, v8
    v_mul_f32 v8, v8, v17
    v_cvt_pk_bf16_f32 v8, v8, v8
    v_lshlrev_b32 v8, 16, v8
    v_sub_f32 v9, v9, v16
    v_cvt_pk_bf16_f32 v9, v9, v9
    v_lshlrev_b32 v9, 16, v9
    v_mul_f32 v9, v9, v17
    v_cvt_pk_bf16_f32 v9, v9, v9
    v_lshlrev_b32 v9, 16, v9
    v_sub_f32 v10, v10, v16
    v_cvt_pk_bf16_f32 v10, v10, v10
    v_lshlrev_b32 v10, 16, v10
    v_mul_f32 v10, v10, v17
    v_cvt_pk_bf16_f32 v10, v10, v10
    v_lshlrev_b32 v10, 16, v10
    v_sub_f32 v11, v11, v16
    v_cvt_pk_bf16_f32 v11, v11, v11
    v_lshlrev_b32 v11, 16, v11
    v_mul_f32 v11, v11, v17
    v_cvt_pk_bf16_f32 v11, v11, v11
    v_lshlrev_b32 v11, 16, v11
    v_sub_f32 v12, v12, v16
    v_cvt_pk_bf16_f32 v12, v12, v12
    v_lshlrev_b32 v12, 16, v12
    v_mul_f32 v12, v12, v17
    v_cvt_pk_bf16_f32 v12, v12, v12
    v_lshlrev_b32 v12, 16, v12
    v_sub_f32 v13, v13, v16
    v_cvt_pk_bf16_f32 v13, v13, v13
    v_lshlrev_b32 v13, 16, v13
    v_mul_f32 v13, v13, v17
    v_cvt_pk_bf16_f32 v13, v13, v13
    v_lshlrev_b32 v13, 16, v13
    v_sub_f32 v14, v14, v16
    v_cvt_pk_bf16_f32 v14, v14, v14
    v_lshlrev_b32 v14, 16, v14
    v_mul_f32 v14, v14, v17
    v_cvt_pk_bf16_f32 v14, v14, v14
    v_lshlrev_b32 v14, 16, v14
    v_sub_f32 v15, v15, v16
    v_cvt_pk_bf16_f32 v15, v15, v15
    v_lshlrev_b32 v15, 16, v15
    v_mul_f32 v15, v15, v17
    v_cvt_pk_bf16_f32 v15, v15, v15
    v_lshlrev_b32 v15, 16, v15
    v_mul_f32 v8, v8, v32
    v_cvt_pk_bf16_f32 v8, v8, v8
    v_lshlrev_b32 v8, 16, v8
    v_add_f32 v8, v8, v24
    v_mul_f32 v9, v9, v33
    v_cvt_pk_bf16_f32 v9, v9, v9
    v_lshlrev_b32 v9, 16, v9
    v_add_f32 v9, v9, v25
    v_mul_f32 v10, v10, v34
    v_cvt_pk_bf16_f32 v10, v10, v10
    v_lshlrev_b32 v10, 16, v10
    v_add_f32 v10, v10, v26
    v_mul_f32 v11, v11, v35
    v_cvt_pk_bf16_f32 v11, v11, v11
    v_lshlrev_b32 v11, 16, v11
    v_add_f32 v11, v11, v27
    v_mul_f32 v12, v12, v36
    v_cvt_pk_bf16_f32 v12, v12, v12
    v_lshlrev_b32 v12, 16, v12
    v_add_f32 v12, v12, v28
    v_mul_f32 v13, v13, v37
    v_cvt_pk_bf16_f32 v13, v13, v13
    v_lshlrev_b32 v13, 16, v13
    v_add_f32 v13, v13, v29
    v_mul_f32 v14, v14, v38
    v_cvt_pk_bf16_f32 v14, v14, v14
    v_lshlrev_b32 v14, 16, v14
    v_add_f32 v14, v14, v30
    v_mul_f32 v15, v15, v39
    v_cvt_pk_bf16_f32 v15, v15, v15
    v_lshlrev_b32 v15, 16, v15
    v_add_f32 v15, v15, v31
    v_cvt_pk_bf16_f32 v56, v8, v9
    v_cvt_pk_bf16_f32 v57, v10, v11
    v_cvt_pk_bf16_f32 v58, v12, v13
    v_cvt_pk_bf16_f32 v59, v14, v15
    buffer_store_dwordx4 v[56:59], v3, s[24:27], s31 offen offset:0 sc1
    v_lshlrev_b32 v8, 16, v44
    v_and_b32 v9, 0xffff0000, v44
    v_lshlrev_b32 v10, 16, v45
    v_and_b32 v11, 0xffff0000, v45
    v_lshlrev_b32 v12, 16, v46
    v_and_b32 v13, 0xffff0000, v46
    v_lshlrev_b32 v14, 16, v47
    v_and_b32 v15, 0xffff0000, v47
    v_add_f32 v16, v8, v9
    v_add_f32 v16, v16, v10
    v_add_f32 v16, v16, v11
    v_add_f32 v16, v16, v12
    v_add_f32 v16, v16, v13
    v_add_f32 v16, v16, v14
    v_add_f32 v16, v16, v15
    s_nop 1
    v_add_f32_dpp v16, v16, v16 quad_perm:[1,0,3,2] row_mask:0xf bank_mask:0xf
    s_nop 1
    v_add_f32_dpp v16, v16, v16 quad_perm:[2,3,0,1] row_mask:0xf bank_mask:0xf
    s_nop 1
    v_add_f32_dpp v16, v16, v16 row_half_mirror row_mask:0xf bank_mask:0xf
    s_nop 1
    v_add_f32_dpp v16, v16, v16 row_mirror row_mask:0xf bank_mask:0xf
    v_mov_b32 v17, v16
    s_nop 1
    v_permlane16_swap_b32 v16, v17
    v_add_f32 v16, v16, v17
    v_mov_b32 v17, v16
    s_nop 1
    v_permlane32_swap_b32 v16, v17
    v_add_f32 v16, v16, v17
    v_mul_f32 v16, 0x3b000000, v16
    v_sub_f32 v18, v8, v16
    v_mul_f32 v17, v18, v18
    v_sub_f32 v18, v9, v16
    v_fmac_f32 v17, v18, v18
    v_sub_f32 v18, v10, v16
    v_fmac_f32 v17, v18, v18
    v_sub_f32 v18, v11, v16
    v_fmac_f32 v17, v18, v18
    v_sub_f32 v18, v12, v16
    v_fmac_f32 v17, v18, v18
    v_sub_f32 v18, v13, v16
    v_fmac_f32 v17, v18, v18
    v_sub_f32 v18, v14, v16
    v_fmac_f32 v17, v18, v18
    v_sub_f32 v18, v15, v16
    v_fmac_f32 v17, v18, v18
    s_nop 1
    v_add_f32_dpp v17, v17, v17 quad_perm:[1,0,3,2] row_mask:0xf bank_mask:0xf
    s_nop 1
    v_add_f32_dpp v17, v17, v17 quad_perm:[2,3,0,1] row_mask:0xf bank_mask:0xf
    s_nop 1
    v_add_f32_dpp v17, v17, v17 row_half_mirror row_mask:0xf bank_mask:0xf
    s_nop 1
    v_add_f32_dpp v17, v17, v17 row_mirror row_mask:0xf bank_mask:0xf
    v_mov_b32 v18, v17
    s_nop 1
    v_permlane16_swap_b32 v17, v18
    v_add_f32 v17, v17, v18
    v_mov_b32 v18, v17
    s_nop 1
    v_permlane32_swap_b32 v17, v18
    v_add_f32 v17, v17, v18
    v_mul_f32 v17, 0x3b000000, v17
    v_cvt_pk_bf16_f32 v16, v16, v16
    v_lshlrev_b32 v16, 16, v16
    v_cvt_pk_bf16_f32 v17, v17, v17
    v_lshlrev_b32 v17, 16, v17
    v_add_f32 v17, 0x3727c5ac, v17
    v_cvt_pk_bf16_f32 v17, v17, v17
    v_lshlrev_b32 v17, 16, v17
    v_sqrt_f32 v17, v17
    s_nop 0
    v_cvt_pk_bf16_f32 v17, v17, v17
    v_lshlrev_b32 v17, 16, v17
    v_rcp_f32 v17, v17
    v_sub_f32 v8, v8, v16
    v_cvt_pk_bf16_f32 v8, v8, v8
    v_lshlrev_b32 v8, 16, v8
    v_mul_f32 v8, v8, v17
    v_cvt_pk_bf16_f32 v8, v8, v8
    v_lshlrev_b32 v8, 16, v8
    v_sub_f32 v9, v9, v16
    v_cvt_pk_bf16_f32 v9, v9, v9
    v_lshlrev_b32 v9, 16, v9
    v_mul_f32 v9, v9, v17
    v_cvt_pk_bf16_f32 v9, v9, v9
    v_lshlrev_b32 v9, 16, v9
    v_sub_f32 v10, v10, v16
    v_cvt_pk_bf16_f32 v10, v10, v10
    v_lshlrev_b32 v10, 16, v10
    v_mul_f32 v10, v10, v17
    v_cvt_pk_bf16_f32 v10, v10, v10
    v_lshlrev_b32 v10, 16, v10
    v_sub_f32 v11, v11, v16
    v_cvt_pk_bf16_f32 v11, v11, v11
    v_lshlrev_b32 v11, 16, v11
    v_mul_f32 v11, v11, v17
    v_cvt_pk_bf16_f32 v11, v11, v11
    v_lshlrev_b32 v11, 16, v11
    v_sub_f32 v12, v12, v16
    v_cvt_pk_bf16_f32 v12, v12, v12
    v_lshlrev_b32 v12, 16, v12
    v_mul_f32 v12, v12, v17
    v_cvt_pk_bf16_f32 v12, v12, v12
    v_lshlrev_b32 v12, 16, v12
    v_sub_f32 v13, v13, v16
    v_cvt_pk_bf16_f32 v13, v13, v13
    v_lshlrev_b32 v13, 16, v13
    v_mul_f32 v13, v13, v17
    v_cvt_pk_bf16_f32 v13, v13, v13
    v_lshlrev_b32 v13, 16, v13
    v_sub_f32 v14, v14, v16
    v_cvt_pk_bf16_f32 v14, v14, v14
    v_lshlrev_b32 v14, 16, v14
    v_mul_f32 v14, v14, v17
    v_cvt_pk_bf16_f32 v14, v14, v14
    v_lshlrev_b32 v14, 16, v14
    v_sub_f32 v15, v15, v16
    v_cvt_pk_bf16_f32 v15, v15, v15
    v_lshlrev_b32 v15, 16, v15
    v_mul_f32 v15, v15, v17
    v_cvt_pk_bf16_f32 v15, v15, v15
    v_lshlrev_b32 v15, 16, v15
    v_mul_f32 v8, v8, v32
    v_cvt_pk_bf16_f32 v8, v8, v8
    v_lshlrev_b32 v8, 16, v8
    v_add_f32 v8, v8, v24
    v_mul_f32 v9, v9, v33
    v_cvt_pk_bf16_f32 v9, v9, v9
    v_lshlrev_b32 v9, 16, v9
    v_add_f32 v9, v9, v25
    v_mul_f32 v10, v10, v34
    v_cvt_pk_bf16_f32 v10, v10, v10
    v_lshlrev_b32 v10, 16, v10
    v_add_f32 v10, v10, v26
    v_mul_f32 v11, v11, v35
    v_cvt_pk_bf16_f32 v11, v11, v11
    v_lshlrev_b32 v11, 16, v11
    v_add_f32 v11, v11, v27
    v_mul_f32 v12, v12, v36
    v_cvt_pk_bf16_f32 v12, v12, v12
    v_lshlrev_b32 v12, 16, v12
    v_add_f32 v12, v12, v28
    v_mul_f32 v13, v13, v37
    v_cvt_pk_bf16_f32 v13, v13, v13
    v_lshlrev_b32 v13, 16, v13
    v_add_f32 v13, v13, v29
    v_mul_f32 v14, v14, v38
    v_cvt_pk_bf16_f32 v14, v14, v14
    v_lshlrev_b32 v14, 16, v14
    v_add_f32 v14, v14, v30
    v_mul_f32 v15, v15, v39
    v_cvt_pk_bf16_f32 v15, v15, v15
    v_lshlrev_b32 v15, 16, v15
    v_add_f32 v15, v15, v31
    v_cvt_pk_bf16_f32 v60, v8, v9
    v_cvt_pk_bf16_f32 v61, v10, v11
    v_cvt_pk_bf16_f32 v62, v12, v13
    v_cvt_pk_bf16_f32 v63, v14, v15
    buffer_store_dwordx4 v[60:63], v3, s[24:27], s31 offen offset:16 sc1
    v_lshlrev_b32 v8, 16, v48
    v_and_b32 v9, 0xffff0000, v48
    v_lshlrev_b32 v10, 16, v49
    v_and_b32 v11, 0xffff0000, v49
    v_lshlrev_b32 v12, 16, v50
    v_and_b32 v13, 0xffff0000, v50
    v_lshlrev_b32 v14, 16, v51
    v_and_b32 v15, 0xffff0000, v51
    v_add_f32 v16, v8, v9
    v_add_f32 v16, v16, v10
    v_add_f32 v16, v16, v11
    v_add_f32 v16, v16, v12
    v_add_f32 v16, v16, v13
    v_add_f32 v16, v16, v14
    v_add_f32 v16, v16, v15
    s_nop 1
    v_add_f32_dpp v16, v16, v16 quad_perm:[1,0,3,2] row_mask:0xf bank_mask:0xf
    s_nop 1
    v_add_f32_dpp v16, v16, v16 quad_perm:[2,3,0,1] row_mask:0xf bank_mask:0xf
    s_nop 1
    v_add_f32_dpp v16, v16, v16 row_half_mirror row_mask:0xf bank_mask:0xf
    s_nop 1
    v_add_f32_dpp v16, v16, v16 row_mirror row_mask:0xf bank_mask:0xf
    v_mov_b32 v17, v16
    s_nop 1
    v_permlane16_swap_b32 v16, v17
    v_add_f32 v16, v16, v17
    v_mov_b32 v17, v16
    s_nop 1
    v_permlane32_swap_b32 v16, v17
    v_add_f32 v16, v16, v17
    v_mul_f32 v16, 0x3b000000, v16
    v_sub_f32 v18, v8, v16
    v_mul_f32 v17, v18, v18
    v_sub_f32 v18, v9, v16
    v_fmac_f32 v17, v18, v18
    v_sub_f32 v18, v10, v16
    v_fmac_f32 v17, v18, v18
    v_sub_f32 v18, v11, v16
    v_fmac_f32 v17, v18, v18
    v_sub_f32 v18, v12, v16
    v_fmac_f32 v17, v18, v18
    v_sub_f32 v18, v13, v16
    v_fmac_f32 v17, v18, v18
    v_sub_f32 v18, v14, v16
    v_fmac_f32 v17, v18, v18
    v_sub_f32 v18, v15, v16
    v_fmac_f32 v17, v18, v18
    s_nop 1
    v_add_f32_dpp v17, v17, v17 quad_perm:[1,0,3,2] row_mask:0xf bank_mask:0xf
    s_nop 1
    v_add_f32_dpp v17, v17, v17 quad_perm:[2,3,0,1] row_mask:0xf bank_mask:0xf
    s_nop 1
    v_add_f32_dpp v17, v17, v17 row_half_mirror row_mask:0xf bank_mask:0xf
    s_nop 1
    v_add_f32_dpp v17, v17, v17 row_mirror row_mask:0xf bank_mask:0xf
    v_mov_b32 v18, v17
    s_nop 1
    v_permlane16_swap_b32 v17, v18
    v_add_f32 v17, v17, v18
    v_mov_b32 v18, v17
    s_nop 1
    v_permlane32_swap_b32 v17, v18
    v_add_f32 v17, v17, v18
    v_mul_f32 v17, 0x3b000000, v17
    v_cvt_pk_bf16_f32 v16, v16, v16
    v_lshlrev_b32 v16, 16, v16
    v_cvt_pk_bf16_f32 v17, v17, v17
    v_lshlrev_b32 v17, 16, v17
    v_add_f32 v17, 0x3727c5ac, v17
    v_cvt_pk_bf16_f32 v17, v17, v17
    v_lshlrev_b32 v17, 16, v17
    v_sqrt_f32 v17, v17
    s_nop 0
    v_cvt_pk_bf16_f32 v17, v17, v17
    v_lshlrev_b32 v17, 16, v17
    v_rcp_f32 v17, v17
    v_sub_f32 v8, v8, v16
    v_cvt_pk_bf16_f32 v8, v8, v8
    v_lshlrev_b32 v8, 16, v8
    v_mul_f32 v8, v8, v17
    v_cvt_pk_bf16_f32 v8, v8, v8
    v_lshlrev_b32 v8, 16, v8
    v_sub_f32 v9, v9, v16
    v_cvt_pk_bf16_f32 v9, v9, v9
    v_lshlrev_b32 v9, 16, v9
    v_mul_f32 v9, v9, v17
    v_cvt_pk_bf16_f32 v9, v9, v9
    v_lshlrev_b32 v9, 16, v9
    v_sub_f32 v10, v10, v16
    v_cvt_pk_bf16_f32 v10, v10, v10
    v_lshlrev_b32 v10, 16, v10
    v_mul_f32 v10, v10, v17
    v_cvt_pk_bf16_f32 v10, v10, v10
    v_lshlrev_b32 v10, 16, v10
    v_sub_f32 v11, v11, v16
    v_cvt_pk_bf16_f32 v11, v11, v11
    v_lshlrev_b32 v11, 16, v11
    v_mul_f32 v11, v11, v17
    v_cvt_pk_bf16_f32 v11, v11, v11
    v_lshlrev_b32 v11, 16, v11
    v_sub_f32 v12, v12, v16
    v_cvt_pk_bf16_f32 v12, v12, v12
    v_lshlrev_b32 v12, 16, v12
    v_mul_f32 v12, v12, v17
    v_cvt_pk_bf16_f32 v12, v12, v12
    v_lshlrev_b32 v12, 16, v12
    v_sub_f32 v13, v13, v16
    v_cvt_pk_bf16_f32 v13, v13, v13
    v_lshlrev_b32 v13, 16, v13
    v_mul_f32 v13, v13, v17
    v_cvt_pk_bf16_f32 v13, v13, v13
    v_lshlrev_b32 v13, 16, v13
    v_sub_f32 v14, v14, v16
    v_cvt_pk_bf16_f32 v14, v14, v14
    v_lshlrev_b32 v14, 16, v14
    v_mul_f32 v14, v14, v17
    v_cvt_pk_bf16_f32 v14, v14, v14
    v_lshlrev_b32 v14, 16, v14
    v_sub_f32 v15, v15, v16
    v_cvt_pk_bf16_f32 v15, v15, v15
    v_lshlrev_b32 v15, 16, v15
    v_mul_f32 v15, v15, v17
    v_cvt_pk_bf16_f32 v15, v15, v15
    v_lshlrev_b32 v15, 16, v15
    v_mul_f32 v8, v8, v32
    v_cvt_pk_bf16_f32 v8, v8, v8
    v_lshlrev_b32 v8, 16, v8
    v_add_f32 v8, v8, v24
    v_mul_f32 v9, v9, v33
    v_cvt_pk_bf16_f32 v9, v9, v9
    v_lshlrev_b32 v9, 16, v9
    v_add_f32 v9, v9, v25
    v_mul_f32 v10, v10, v34
    v_cvt_pk_bf16_f32 v10, v10, v10
    v_lshlrev_b32 v10, 16, v10
    v_add_f32 v10, v10, v26
    v_mul_f32 v11, v11, v35
    v_cvt_pk_bf16_f32 v11, v11, v11
    v_lshlrev_b32 v11, 16, v11
    v_add_f32 v11, v11, v27
    v_mul_f32 v12, v12, v36
    v_cvt_pk_bf16_f32 v12, v12, v12
    v_lshlrev_b32 v12, 16, v12
    v_add_f32 v12, v12, v28
    v_mul_f32 v13, v13, v37
    v_cvt_pk_bf16_f32 v13, v13, v13
    v_lshlrev_b32 v13, 16, v13
    v_add_f32 v13, v13, v29
    v_mul_f32 v14, v14, v38
    v_cvt_pk_bf16_f32 v14, v14, v14
    v_lshlrev_b32 v14, 16, v14
    v_add_f32 v14, v14, v30
    v_mul_f32 v15, v15, v39
    v_cvt_pk_bf16_f32 v15, v15, v15
    v_lshlrev_b32 v15, 16, v15
    v_add_f32 v15, v15, v31
    v_cvt_pk_bf16_f32 v64, v8, v9
    v_cvt_pk_bf16_f32 v65, v10, v11
    v_cvt_pk_bf16_f32 v66, v12, v13
    v_cvt_pk_bf16_f32 v67, v14, v15
    buffer_store_dwordx4 v[64:67], v3, s[24:27], s31 offen offset:32 sc1
    v_lshlrev_b32 v8, 16, v52
    v_and_b32 v9, 0xffff0000, v52
    v_lshlrev_b32 v10, 16, v53
    v_and_b32 v11, 0xffff0000, v53
    v_lshlrev_b32 v12, 16, v54
    v_and_b32 v13, 0xffff0000, v54
    v_lshlrev_b32 v14, 16, v55
    v_and_b32 v15, 0xffff0000, v55
    v_add_f32 v16, v8, v9
    v_add_f32 v16, v16, v10
    v_add_f32 v16, v16, v11
    v_add_f32 v16, v16, v12
    v_add_f32 v16, v16, v13
    v_add_f32 v16, v16, v14
    v_add_f32 v16, v16, v15
    s_nop 1
    v_add_f32_dpp v16, v16, v16 quad_perm:[1,0,3,2] row_mask:0xf bank_mask:0xf
    s_nop 1
    v_add_f32_dpp v16, v16, v16 quad_perm:[2,3,0,1] row_mask:0xf bank_mask:0xf
    s_nop 1
    v_add_f32_dpp v16, v16, v16 row_half_mirror row_mask:0xf bank_mask:0xf
    s_nop 1
    v_add_f32_dpp v16, v16, v16 row_mirror row_mask:0xf bank_mask:0xf
    v_mov_b32 v17, v16
    s_nop 1
    v_permlane16_swap_b32 v16, v17
    v_add_f32 v16, v16, v17
    v_mov_b32 v17, v16
    s_nop 1
    v_permlane32_swap_b32 v16, v17
    v_add_f32 v16, v16, v17
    v_mul_f32 v16, 0x3b000000, v16
    v_sub_f32 v18, v8, v16
    v_mul_f32 v17, v18, v18
    v_sub_f32 v18, v9, v16
    v_fmac_f32 v17, v18, v18
    v_sub_f32 v18, v10, v16
    v_fmac_f32 v17, v18, v18
    v_sub_f32 v18, v11, v16
    v_fmac_f32 v17, v18, v18
    v_sub_f32 v18, v12, v16
    v_fmac_f32 v17, v18, v18
    v_sub_f32 v18, v13, v16
    v_fmac_f32 v17, v18, v18
    v_sub_f32 v18, v14, v16
    v_fmac_f32 v17, v18, v18
    v_sub_f32 v18, v15, v16
    v_fmac_f32 v17, v18, v18
    s_nop 1
    v_add_f32_dpp v17, v17, v17 quad_perm:[1,0,3,2] row_mask:0xf bank_mask:0xf
    s_nop 1
    v_add_f32_dpp v17, v17, v17 quad_perm:[2,3,0,1] row_mask:0xf bank_mask:0xf
    s_nop 1
    v_add_f32_dpp v17, v17, v17 row_half_mirror row_mask:0xf bank_mask:0xf
    s_nop 1
    v_add_f32_dpp v17, v17, v17 row_mirror row_mask:0xf bank_mask:0xf
    v_mov_b32 v18, v17
    s_nop 1
    v_permlane16_swap_b32 v17, v18
    v_add_f32 v17, v17, v18
    v_mov_b32 v18, v17
    s_nop 1
    v_permlane32_swap_b32 v17, v18
    v_add_f32 v17, v17, v18
    v_mul_f32 v17, 0x3b000000, v17
    v_cvt_pk_bf16_f32 v16, v16, v16
    v_lshlrev_b32 v16, 16, v16
    v_cvt_pk_bf16_f32 v17, v17, v17
    v_lshlrev_b32 v17, 16, v17
    v_add_f32 v17, 0x3727c5ac, v17
    v_cvt_pk_bf16_f32 v17, v17, v17
    v_lshlrev_b32 v17, 16, v17
    v_sqrt_f32 v17, v17
    s_nop 0
    v_cvt_pk_bf16_f32 v17, v17, v17
    v_lshlrev_b32 v17, 16, v17
    v_rcp_f32 v17, v17
    v_sub_f32 v8, v8, v16
    v_cvt_pk_bf16_f32 v8, v8, v8
    v_lshlrev_b32 v8, 16, v8
    v_mul_f32 v8, v8, v17
    v_cvt_pk_bf16_f32 v8, v8, v8
    v_lshlrev_b32 v8, 16, v8
    v_sub_f32 v9, v9, v16
    v_cvt_pk_bf16_f32 v9, v9, v9
    v_lshlrev_b32 v9, 16, v9
    v_mul_f32 v9, v9, v17
    v_cvt_pk_bf16_f32 v9, v9, v9
    v_lshlrev_b32 v9, 16, v9
    v_sub_f32 v10, v10, v16
    v_cvt_pk_bf16_f32 v10, v10, v10
    v_lshlrev_b32 v10, 16, v10
    v_mul_f32 v10, v10, v17
    v_cvt_pk_bf16_f32 v10, v10, v10
    v_lshlrev_b32 v10, 16, v10
    v_sub_f32 v11, v11, v16
    v_cvt_pk_bf16_f32 v11, v11, v11
    v_lshlrev_b32 v11, 16, v11
    v_mul_f32 v11, v11, v17
    v_cvt_pk_bf16_f32 v11, v11, v11
    v_lshlrev_b32 v11, 16, v11
    v_sub_f32 v12, v12, v16
    v_cvt_pk_bf16_f32 v12, v12, v12
    v_lshlrev_b32 v12, 16, v12
    v_mul_f32 v12, v12, v17
    v_cvt_pk_bf16_f32 v12, v12, v12
    v_lshlrev_b32 v12, 16, v12
    v_sub_f32 v13, v13, v16
    v_cvt_pk_bf16_f32 v13, v13, v13
    v_lshlrev_b32 v13, 16, v13
    v_mul_f32 v13, v13, v17
    v_cvt_pk_bf16_f32 v13, v13, v13
    v_lshlrev_b32 v13, 16, v13
    v_sub_f32 v14, v14, v16
    v_cvt_pk_bf16_f32 v14, v14, v14
    v_lshlrev_b32 v14, 16, v14
    v_mul_f32 v14, v14, v17
    v_cvt_pk_bf16_f32 v14, v14, v14
    v_lshlrev_b32 v14, 16, v14
    v_sub_f32 v15, v15, v16
    v_cvt_pk_bf16_f32 v15, v15, v15
    v_lshlrev_b32 v15, 16, v15
    v_mul_f32 v15, v15, v17
    v_cvt_pk_bf16_f32 v15, v15, v15
    v_lshlrev_b32 v15, 16, v15
    v_mul_f32 v8, v8, v32
    v_cvt_pk_bf16_f32 v8, v8, v8
    v_lshlrev_b32 v8, 16, v8
    v_add_f32 v8, v8, v24
    v_mul_f32 v9, v9, v33
    v_cvt_pk_bf16_f32 v9, v9, v9
    v_lshlrev_b32 v9, 16, v9
    v_add_f32 v9, v9, v25
    v_mul_f32 v10, v10, v34
    v_cvt_pk_bf16_f32 v10, v10, v10
    v_lshlrev_b32 v10, 16, v10
    v_add_f32 v10, v10, v26
    v_mul_f32 v11, v11, v35
    v_cvt_pk_bf16_f32 v11, v11, v11
    v_lshlrev_b32 v11, 16, v11
    v_add_f32 v11, v11, v27
    v_mul_f32 v12, v12, v36
    v_cvt_pk_bf16_f32 v12, v12, v12
    v_lshlrev_b32 v12, 16, v12
    v_add_f32 v12, v12, v28
    v_mul_f32 v13, v13, v37
    v_cvt_pk_bf16_f32 v13, v13, v13
    v_lshlrev_b32 v13, 16, v13
    v_add_f32 v13, v13, v29
    v_mul_f32 v14, v14, v38
    v_cvt_pk_bf16_f32 v14, v14, v14
    v_lshlrev_b32 v14, 16, v14
    v_add_f32 v14, v14, v30
    v_mul_f32 v15, v15, v39
    v_cvt_pk_bf16_f32 v15, v15, v15
    v_lshlrev_b32 v15, 16, v15
    v_add_f32 v15, v15, v31
    v_cvt_pk_bf16_f32 v68, v8, v9
    v_cvt_pk_bf16_f32 v69, v10, v11
    v_cvt_pk_bf16_f32 v70, v12, v13
    v_cvt_pk_bf16_f32 v71, v14, v15
    buffer_store_dwordx4 v[68:71], v3, s[24:27], s31 offen offset:48 sc1
    s_waitcnt vmcnt(0)
    s_barrier
    s_cmp_lg_u32 s3, 0
    s_cbranch_scc1 w_loop
    s_lshl_b32 s90, s22, 8
    s_add_u32 s90, s90, 0
    s_mov_b64 exec, 1
    v_mov_b32 v250, 0
    v_mov_b32 v251, 1
    buffer_atomic_add v251, v250, s[8:11], s90 offen
    s_mov_b64 exec, -1
    s_branch w_loop
w_c_30:
    s_sub_u32 s5, s5, 0x1e0
    s_lshr_b32 s21, s5, 5
    s_and_b32 s20, s5, 31
    s_add_u32 s20, s20, 16
    s_add_u32 s22, s21, 32
    s_branch w_qkv_23
w_q_21:
    s_sub_u32 s5, s5, 0x450
    s_lshr_b32 s21, s5, 4
    s_and_b32 s20, s5, 15
    s_add_u32 s22, s21, 48
w_qkv_23:
    s_lshr_b32 s10, s3, 1
    s_and_b32 s11, s3, 1
    s_lshl_b32 s30, s20, 1
    s_add_u32 s30, s30, s10
    s_lshl_b32 s31, s21, 1
    s_add_u32 s31, s31, s11
    s_add_u32 s8, s6, 0x3000
    s_addc_u32 s9, s7, 0
    s_and_b32 s9, s9, 0xffff
    s_mov_b32 s10, 0x10000
    s_mov_b32 s11, 0x20000
    s_cmp_lg_u32 s3, 0
    s_cbranch_scc1 wcd_62
    s_lshl_b32 s90, s20, 8
    s_add_u32 s90, s90, 0x9000
    v_mov_b32 v250, 0
wc_61:
    buffer_load_dword v251, v250, s[8:11], s90 offen sc1
    s_waitcnt vmcnt(0)
    v_readfirstlane_b32 s91, v251
    s_cmp_ge_u32 s91, 8
    s_cbranch_scc1 wcd_62
    s_sleep 2
    s_add_u32 s92, s92, 1
    s_cmp_gt_u32 s92, 0x1e8480
    s_cbranch_scc1 main_kernel_exit_w
    s_branch wc_61
wcd_62:
    s_waitcnt vmcnt(0)
    s_barrier
    s_cmp_lg_u32 s3, 0
    s_cbranch_scc1 wcd_64
    s_lshl_b32 s90, s21, 8
    s_add_u32 s90, s90, 0xc000
    v_mov_b32 v250, 0
wc_63:
    buffer_load_dword v251, v250, s[8:11], s90 offen sc1
    s_waitcnt vmcnt(0)
    v_readfirstlane_b32 s91, v251
    s_cmp_ge_u32 s91, 16
    s_cbranch_scc1 wcd_64
    s_sleep 2
    s_add_u32 s92, s92, 1
    s_cmp_gt_u32 s92, 0x1e8480
    s_cbranch_scc1 main_kernel_exit_w
    s_branch wc_63
wcd_64:
    s_waitcnt vmcnt(0)
    s_barrier
    s_add_u32 s12, s6, 0x396000
    s_addc_u32 s13, s7, 0
    s_and_b32 s13, s13, 0xffff
    s_mov_b32 s14, 0xc00000
    s_mov_b32 s15, 0x20000
    s_add_u32 s16, s6, 0x196000
    s_addc_u32 s17, s7, 0
    s_and_b32 s17, s17, 0xffff
    s_mov_b32 s18, 0x200000
    s_mov_b32 s19, 0x20000
    s_lshl_b32 s24, s30, 17
    s_lshl_b32 s25, s31, 17
    v_lshlrev_b32 v2, 4, v0
    v_and_b32 v8, 15, v0
    v_lshrrev_b32 v9, 4, v0
    v_add_u32 v4, 0, v2
    v_add_u32 v5, 0x8000, v2
    v_add_u32 v6, 0x10000, v2
    v_add_u32 v7, 0x18000, v2
    s_cmp_ge_u32 s30, 64
    s_cbranch_scc1 qkv_v_65
    buffer_load_dwordx4 v[16:19], v4, s[12:15], s24 offen offset:0
    buffer_load_dwordx4 v[20:23], v4, s[12:15], s24 offen offset:1024
    buffer_load_dwordx4 v[24:27], v5, s[12:15], s24 offen offset:0
    buffer_load_dwordx4 v[28:31], v5, s[12:15], s24 offen offset:1024
    buffer_load_dwordx4 v[32:35], v6, s[12:15], s24 offen offset:0
    buffer_load_dwordx4 v[36:39], v6, s[12:15], s24 offen offset:1024
    buffer_load_dwordx4 v[40:43], v7, s[12:15], s24 offen offset:0
    buffer_load_dwordx4 v[44:47], v7, s[12:15], s24 offen offset:1024
    buffer_load_dwordx4 v[48:51], v4, s[16:19], s25 offen offset:0
    buffer_load_dwordx4 v[52:55], v4, s[16:19], s25 offen offset:1024
    buffer_load_dwordx4 v[56:59], v5, s[16:19], s25 offen offset:0
    buffer_load_dwordx4 v[60:63], v5, s[16:19], s25 offen offset:1024
    buffer_load_dwordx4 v[64:67], v6, s[16:19], s25 offen offset:0
    buffer_load_dwordx4 v[68:71], v6, s[16:19], s25 offen offset:1024
    buffer_load_dwordx4 v[72:75], v7, s[16:19], s25 offen offset:0
    buffer_load_dwordx4 v[76:79], v7, s[16:19], s25 offen offset:1024
    s_add_u32 s24, s24, 0x800
    s_add_u32 s25, s25, 0x800
    buffer_load_dwordx4 v[80:83], v4, s[12:15], s24 offen offset:0
    buffer_load_dwordx4 v[84:87], v4, s[12:15], s24 offen offset:1024
    buffer_load_dwordx4 v[88:91], v5, s[12:15], s24 offen offset:0
    buffer_load_dwordx4 v[92:95], v5, s[12:15], s24 offen offset:1024
    buffer_load_dwordx4 v[96:99], v6, s[12:15], s24 offen offset:0
    buffer_load_dwordx4 v[100:103], v6, s[12:15], s24 offen offset:1024
    buffer_load_dwordx4 v[104:107], v7, s[12:15], s24 offen offset:0
    buffer_load_dwordx4 v[108:111], v7, s[12:15], s24 offen offset:1024
    buffer_load_dwordx4 v[112:115], v4, s[16:19], s25 offen offset:0
    buffer_load_dwordx4 v[116:119], v4, s[16:19], s25 offen offset:1024
    buffer_load_dwordx4 v[120:123], v5, s[16:19], s25 offen offset:0
    buffer_load_dwordx4 v[124:127], v5, s[16:19], s25 offen offset:1024
    buffer_load_dwordx4 v[128:131], v6, s[16:19], s25 offen offset:0
    buffer_load_dwordx4 v[132:135], v6, s[16:19], s25 offen offset:1024
    buffer_load_dwordx4 v[136:139], v7, s[16:19], s25 offen offset:0
    buffer_load_dwordx4 v[140:143], v7, s[16:19], s25 offen offset:1024
    s_add_u32 s24, s24, 0x800
    s_add_u32 s25, s25, 0x800
    s_waitcnt vmcnt(16)
    v_mfma_f32_16x16x32_bf16 a[0:3], v[16:19], v[48:51], 0
    v_mfma_f32_16x16x32_bf16 a[4:7], v[16:19], v[52:55], 0
    v_mfma_f32_16x16x32_bf16 a[8:11], v[16:19], v[56:59], 0
    v_mfma_f32_16x16x32_bf16 a[12:15], v[16:19], v[60:63], 0
    v_mfma_f32_16x16x32_bf16 a[16:19], v[16:19], v[64:67], 0
    v_mfma_f32_16x16x32_bf16 a[20:23], v[16:19], v[68:71], 0
    v_mfma_f32_16x16x32_bf16 a[24:27], v[16:19], v[72:75], 0
    v_mfma_f32_16x16x32_bf16 a[28:31], v[16:19], v[76:79], 0
    v_mfma_f32_16x16x32_bf16 a[32:35], v[20:23], v[48:51], 0
    v_mfma_f32_16x16x32_bf16 a[36:39], v[20:23], v[52:55], 0
    v_mfma_f32_16x16x32_bf16 a[40:43], v[20:23], v[56:59], 0
    v_mfma_f32_16x16x32_bf16 a[44:47], v[20:23], v[60:63], 0
    v_mfma_f32_16x16x32_bf16 a[48:51], v[20:23], v[64:67], 0
    v_mfma_f32_16x16x32_bf16 a[52:55], v[20:23], v[68:71], 0
    v_mfma_f32_16x16x32_bf16 a[56:59], v[20:23], v[72:75], 0
    v_mfma_f32_16x16x32_bf16 a[60:63], v[20:23], v[76:79], 0
    v_mfma_f32_16x16x32_bf16 a[64:67], v[24:27], v[48:51], 0
    v_mfma_f32_16x16x32_bf16 a[68:71], v[24:27], v[52:55], 0
    v_mfma_f32_16x16x32_bf16 a[72:75], v[24:27], v[56:59], 0
    v_mfma_f32_16x16x32_bf16 a[76:79], v[24:27], v[60:63], 0
    v_mfma_f32_16x16x32_bf16 a[80:83], v[24:27], v[64:67], 0
    v_mfma_f32_16x16x32_bf16 a[84:87], v[24:27], v[68:71], 0
    v_mfma_f32_16x16x32_bf16 a[88:91], v[24:27], v[72:75], 0
    v_mfma_f32_16x16x32_bf16 a[92:95], v[24:27], v[76:79], 0
    v_mfma_f32_16x16x32_bf16 a[96:99], v[28:31], v[48:51], 0
    v_mfma_f32_16x16x32_bf16 a[100:103], v[28:31], v[52:55], 0
    v_mfma_f32_16x16x32_bf16 a[104:107], v[28:31], v[56:59], 0
    v_mfma_f32_16x16x32_bf16 a[108:111], v[28:31], v[60:63], 0
    v_mfma_f32_16x16x32_bf16 a[112:115], v[28:31], v[64:67], 0
    v_mfma_f32_16x16x32_bf16 a[116:119], v[28:31], v[68:71], 0
    v_mfma_f32_16x16x32_bf16 a[120:123], v[28:31], v[72:75], 0
    v_mfma_f32_16x16x32_bf16 a[124:127], v[28:31], v[76:79], 0
    v_mfma_f32_16x16x32_bf16 a[128:131], v[32:35], v[48:51], 0
    v_mfma_f32_16x16x32_bf16 a[132:135], v[32:35], v[52:55], 0
    v_mfma_f32_16x16x32_bf16 a[136:139], v[32:35], v[56:59], 0
    v_mfma_f32_16x16x32_bf16 a[140:143], v[32:35], v[60:63], 0
    v_mfma_f32_16x16x32_bf16 a[144:147], v[32:35], v[64:67], 0
    v_mfma_f32_16x16x32_bf16 a[148:151], v[32:35], v[68:71], 0
    v_mfma_f32_16x16x32_bf16 a[152:155], v[32:35], v[72:75], 0
    v_mfma_f32_16x16x32_bf16 a[156:159], v[32:35], v[76:79], 0
    v_mfma_f32_16x16x32_bf16 a[160:163], v[36:39], v[48:51], 0
    v_mfma_f32_16x16x32_bf16 a[164:167], v[36:39], v[52:55], 0
    v_mfma_f32_16x16x32_bf16 a[168:171], v[36:39], v[56:59], 0
    v_mfma_f32_16x16x32_bf16 a[172:175], v[36:39], v[60:63], 0
    v_mfma_f32_16x16x32_bf16 a[176:179], v[36:39], v[64:67], 0
    v_mfma_f32_16x16x32_bf16 a[180:183], v[36:39], v[68:71], 0
    v_mfma_f32_16x16x32_bf16 a[184:187], v[36:39], v[72:75], 0
    v_mfma_f32_16x16x32_bf16 a[188:191], v[36:39], v[76:79], 0
    v_mfma_f32_16x16x32_bf16 a[192:195], v[40:43], v[48:51], 0
    v_mfma_f32_16x16x32_bf16 a[196:199], v[40:43], v[52:55], 0
    v_mfma_f32_16x16x32_bf16 a[200:203], v[40:43], v[56:59], 0
    v_mfma_f32_16x16x32_bf16 a[204:207], v[40:43], v[60:63], 0
    v_mfma_f32_16x16x32_bf16 a[208:211], v[40:43], v[64:67], 0
    v_mfma_f32_16x16x32_bf16 a[212:215], v[40:43], v[68:71], 0
    v_mfma_f32_16x16x32_bf16 a[216:219], v[40:43], v[72:75], 0
    v_mfma_f32_16x16x32_bf16 a[220:223], v[40:43], v[76:79], 0
    v_mfma_f32_16x16x32_bf16 a[224:227], v[44:47], v[48:51], 0
    v_mfma_f32_16x16x32_bf16 a[228:231], v[44:47], v[52:55], 0
    v_mfma_f32_16x16x32_bf16 a[232:235], v[44:47], v[56:59], 0
    v_mfma_f32_16x16x32_bf16 a[236:239], v[44:47], v[60:63], 0
    v_mfma_f32_16x16x32_bf16 a[240:243], v[44:47], v[64:67], 0
    v_mfma_f32_16x16x32_bf16 a[244:247], v[44:47], v[68:71], 0
    v_mfma_f32_16x16x32_bf16 a[248:251], v[44:47], v[72:75], 0
    v_mfma_f32_16x16x32_bf16 a[252:255], v[44:47], v[76:79], 0
    buffer_load_dwordx4 v[16:19], v4, s[12:15], s24 offen offset:0
    buffer_load_dwordx4 v[20:23], v4, s[12:15], s24 offen offset:1024
    buffer_load_dwordx4 v[24:27], v5, s[12:15], s24 offen offset:0
    buffer_load_dwordx4 v[28:31], v5, s[12:15], s24 offen offset:1024
    buffer_load_dwordx4 v[32:35], v6, s[12:15], s24 offen offset:0
    buffer_load_dwordx4 v[36:39], v6, s[12:15], s24 offen offset:1024
    buffer_load_dwordx4 v[40:43], v7, s[12:15], s24 offen offset:0
    buffer_load_dwordx4 v[44:47], v7, s[12:15], s24 offen offset:1024
    buffer_load_dwordx4 v[48:51], v4, s[16:19], s25 offen offset:0
    buffer_load_dwordx4 v[52:55], v4, s[16:19], s25 offen offset:1024
    buffer_load_dwordx4 v[56:59], v5, s[16:19], s25 offen offset:0
    buffer_load_dwordx4 v[60:63], v5, s[16:19], s25 offen offset:1024
    buffer_load_dwordx4 v[64:67], v6, s[16:19], s25 offen offset:0
    buffer_load_dwordx4 v[68:71], v6, s[16:19], s25 offen offset:1024
    buffer_load_dwordx4 v[72:75], v7, s[16:19], s25 offen offset:0
    buffer_load_dwordx4 v[76:79], v7, s[16:19], s25 offen offset:1024
    s_add_u32 s24, s24, 0x800
    s_add_u32 s25, s25, 0x800
    s_waitcnt vmcnt(16)
    v_mfma_f32_16x16x32_bf16 a[0:3], v[80:83], v[112:115], a[0:3]
    v_mfma_f32_16x16x32_bf16 a[4:7], v[80:83], v[116:119], a[4:7]
    v_mfma_f32_16x16x32_bf16 a[8:11], v[80:83], v[120:123], a[8:11]
    v_mfma_f32_16x16x32_bf16 a[12:15], v[80:83], v[124:127], a[12:15]
    v_mfma_f32_16x16x32_bf16 a[16:19], v[80:83], v[128:131], a[16:19]
    v_mfma_f32_16x16x32_bf16 a[20:23], v[80:83], v[132:135], a[20:23]
    v_mfma_f32_16x16x32_bf16 a[24:27], v[80:83], v[136:139], a[24:27]
    v_mfma_f32_16x16x32_bf16 a[28:31], v[80:83], v[140:143], a[28:31]
    v_mfma_f32_16x16x32_bf16 a[32:35], v[84:87], v[112:115], a[32:35]
    v_mfma_f32_16x16x32_bf16 a[36:39], v[84:87], v[116:119], a[36:39]
    v_mfma_f32_16x16x32_bf16 a[40:43], v[84:87], v[120:123], a[40:43]
    v_mfma_f32_16x16x32_bf16 a[44:47], v[84:87], v[124:127], a[44:47]
    v_mfma_f32_16x16x32_bf16 a[48:51], v[84:87], v[128:131], a[48:51]
    v_mfma_f32_16x16x32_bf16 a[52:55], v[84:87], v[132:135], a[52:55]
    v_mfma_f32_16x16x32_bf16 a[56:59], v[84:87], v[136:139], a[56:59]
    v_mfma_f32_16x16x32_bf16 a[60:63], v[84:87], v[140:143], a[60:63]
    v_mfma_f32_16x16x32_bf16 a[64:67], v[88:91], v[112:115], a[64:67]
    v_mfma_f32_16x16x32_bf16 a[68:71], v[88:91], v[116:119], a[68:71]
    v_mfma_f32_16x16x32_bf16 a[72:75], v[88:91], v[120:123], a[72:75]
    v_mfma_f32_16x16x32_bf16 a[76:79], v[88:91], v[124:127], a[76:79]
    v_mfma_f32_16x16x32_bf16 a[80:83], v[88:91], v[128:131], a[80:83]
    v_mfma_f32_16x16x32_bf16 a[84:87], v[88:91], v[132:135], a[84:87]
    v_mfma_f32_16x16x32_bf16 a[88:91], v[88:91], v[136:139], a[88:91]
    v_mfma_f32_16x16x32_bf16 a[92:95], v[88:91], v[140:143], a[92:95]
    v_mfma_f32_16x16x32_bf16 a[96:99], v[92:95], v[112:115], a[96:99]
    v_mfma_f32_16x16x32_bf16 a[100:103], v[92:95], v[116:119], a[100:103]
    v_mfma_f32_16x16x32_bf16 a[104:107], v[92:95], v[120:123], a[104:107]
    v_mfma_f32_16x16x32_bf16 a[108:111], v[92:95], v[124:127], a[108:111]
    v_mfma_f32_16x16x32_bf16 a[112:115], v[92:95], v[128:131], a[112:115]
    v_mfma_f32_16x16x32_bf16 a[116:119], v[92:95], v[132:135], a[116:119]
    v_mfma_f32_16x16x32_bf16 a[120:123], v[92:95], v[136:139], a[120:123]
    v_mfma_f32_16x16x32_bf16 a[124:127], v[92:95], v[140:143], a[124:127]
    v_mfma_f32_16x16x32_bf16 a[128:131], v[96:99], v[112:115], a[128:131]
    v_mfma_f32_16x16x32_bf16 a[132:135], v[96:99], v[116:119], a[132:135]
    v_mfma_f32_16x16x32_bf16 a[136:139], v[96:99], v[120:123], a[136:139]
    v_mfma_f32_16x16x32_bf16 a[140:143], v[96:99], v[124:127], a[140:143]
    v_mfma_f32_16x16x32_bf16 a[144:147], v[96:99], v[128:131], a[144:147]
    v_mfma_f32_16x16x32_bf16 a[148:151], v[96:99], v[132:135], a[148:151]
    v_mfma_f32_16x16x32_bf16 a[152:155], v[96:99], v[136:139], a[152:155]
    v_mfma_f32_16x16x32_bf16 a[156:159], v[96:99], v[140:143], a[156:159]
    v_mfma_f32_16x16x32_bf16 a[160:163], v[100:103], v[112:115], a[160:163]
    v_mfma_f32_16x16x32_bf16 a[164:167], v[100:103], v[116:119], a[164:167]
    v_mfma_f32_16x16x32_bf16 a[168:171], v[100:103], v[120:123], a[168:171]
    v_mfma_f32_16x16x32_bf16 a[172:175], v[100:103], v[124:127], a[172:175]
    v_mfma_f32_16x16x32_bf16 a[176:179], v[100:103], v[128:131], a[176:179]
    v_mfma_f32_16x16x32_bf16 a[180:183], v[100:103], v[132:135], a[180:183]
    v_mfma_f32_16x16x32_bf16 a[184:187], v[100:103], v[136:139], a[184:187]
    v_mfma_f32_16x16x32_bf16 a[188:191], v[100:103], v[140:143], a[188:191]
    v_mfma_f32_16x16x32_bf16 a[192:195], v[104:107], v[112:115], a[192:195]
    v_mfma_f32_16x16x32_bf16 a[196:199], v[104:107], v[116:119], a[196:199]
    v_mfma_f32_16x16x32_bf16 a[200:203], v[104:107], v[120:123], a[200:203]
    v_mfma_f32_16x16x32_bf16 a[204:207], v[104:107], v[124:127], a[204:207]
    v_mfma_f32_16x16x32_bf16 a[208:211], v[104:107], v[128:131], a[208:211]
    v_mfma_f32_16x16x32_bf16 a[212:215], v[104:107], v[132:135], a[212:215]
    v_mfma_f32_16x16x32_bf16 a[216:219], v[104:107], v[136:139], a[216:219]
    v_mfma_f32_16x16x32_bf16 a[220:223], v[104:107], v[140:143], a[220:223]
    v_mfma_f32_16x16x32_bf16 a[224:227], v[108:111], v[112:115], a[224:227]
    v_mfma_f32_16x16x32_bf16 a[228:231], v[108:111], v[116:119], a[228:231]
    v_mfma_f32_16x16x32_bf16 a[232:235], v[108:111], v[120:123], a[232:235]
    v_mfma_f32_16x16x32_bf16 a[236:239], v[108:111], v[124:127], a[236:239]
    v_mfma_f32_16x16x32_bf16 a[240:243], v[108:111], v[128:131], a[240:243]
    v_mfma_f32_16x16x32_bf16 a[244:247], v[108:111], v[132:135], a[244:247]
    v_mfma_f32_16x16x32_bf16 a[248:251], v[108:111], v[136:139], a[248:251]
    v_mfma_f32_16x16x32_bf16 a[252:255], v[108:111], v[140:143], a[252:255]
    buffer_load_dwordx4 v[80:83], v4, s[12:15], s24 offen offset:0
    buffer_load_dwordx4 v[84:87], v4, s[12:15], s24 offen offset:1024
    buffer_load_dwordx4 v[88:91], v5, s[12:15], s24 offen offset:0
    buffer_load_dwordx4 v[92:95], v5, s[12:15], s24 offen offset:1024
    buffer_load_dwordx4 v[96:99], v6, s[12:15], s24 offen offset:0
    buffer_load_dwordx4 v[100:103], v6, s[12:15], s24 offen offset:1024
    buffer_load_dwordx4 v[104:107], v7, s[12:15], s24 offen offset:0
    buffer_load_dwordx4 v[108:111], v7, s[12:15], s24 offen offset:1024
    buffer_load_dwordx4 v[112:115], v4, s[16:19], s25 offen offset:0
    buffer_load_dwordx4 v[116:119], v4, s[16:19], s25 offen offset:1024
    buffer_load_dwordx4 v[120:123], v5, s[16:19], s25 offen offset:0
    buffer_load_dwordx4 v[124:127], v5, s[16:19], s25 offen offset:1024
    buffer_load_dwordx4 v[128:131], v6, s[16:19], s25 offen offset:0
    buffer_load_dwordx4 v[132:135], v6, s[16:19], s25 offen offset:1024
    buffer_load_dwordx4 v[136:139], v7, s[16:19], s25 offen offset:0
    buffer_load_dwordx4 v[140:143], v7, s[16:19], s25 offen offset:1024
    s_add_u32 s24, s24, 0x800
    s_add_u32 s25, s25, 0x800
    s_waitcnt vmcnt(16)
    v_mfma_f32_16x16x32_bf16 a[0:3], v[16:19], v[48:51], a[0:3]
    v_mfma_f32_16x16x32_bf16 a[4:7], v[16:19], v[52:55], a[4:7]
    v_mfma_f32_16x16x32_bf16 a[8:11], v[16:19], v[56:59], a[8:11]
    v_mfma_f32_16x16x32_bf16 a[12:15], v[16:19], v[60:63], a[12:15]
    v_mfma_f32_16x16x32_bf16 a[16:19], v[16:19], v[64:67], a[16:19]
    v_mfma_f32_16x16x32_bf16 a[20:23], v[16:19], v[68:71], a[20:23]
    v_mfma_f32_16x16x32_bf16 a[24:27], v[16:19], v[72:75], a[24:27]
    v_mfma_f32_16x16x32_bf16 a[28:31], v[16:19], v[76:79], a[28:31]
    v_mfma_f32_16x16x32_bf16 a[32:35], v[20:23], v[48:51], a[32:35]
    v_mfma_f32_16x16x32_bf16 a[36:39], v[20:23], v[52:55], a[36:39]
    v_mfma_f32_16x16x32_bf16 a[40:43], v[20:23], v[56:59], a[40:43]
    v_mfma_f32_16x16x32_bf16 a[44:47], v[20:23], v[60:63], a[44:47]
    v_mfma_f32_16x16x32_bf16 a[48:51], v[20:23], v[64:67], a[48:51]
    v_mfma_f32_16x16x32_bf16 a[52:55], v[20:23], v[68:71], a[52:55]
    v_mfma_f32_16x16x32_bf16 a[56:59], v[20:23], v[72:75], a[56:59]
    v_mfma_f32_16x16x32_bf16 a[60:63], v[20:23], v[76:79], a[60:63]
    v_mfma_f32_16x16x32_bf16 a[64:67], v[24:27], v[48:51], a[64:67]
    v_mfma_f32_16x16x32_bf16 a[68:71], v[24:27], v[52:55], a[68:71]
    v_mfma_f32_16x16x32_bf16 a[72:75], v[24:27], v[56:59], a[72:75]
    v_mfma_f32_16x16x32_bf16 a[76:79], v[24:27], v[60:63], a[76:79]
    v_mfma_f32_16x16x32_bf16 a[80:83], v[24:27], v[64:67], a[80:83]
    v_mfma_f32_16x16x32_bf16 a[84:87], v[24:27], v[68:71], a[84:87]
    v_mfma_f32_16x16x32_bf16 a[88:91], v[24:27], v[72:75], a[88:91]
    v_mfma_f32_16x16x32_bf16 a[92:95], v[24:27], v[76:79], a[92:95]
    v_mfma_f32_16x16x32_bf16 a[96:99], v[28:31], v[48:51], a[96:99]
    v_mfma_f32_16x16x32_bf16 a[100:103], v[28:31], v[52:55], a[100:103]
    v_mfma_f32_16x16x32_bf16 a[104:107], v[28:31], v[56:59], a[104:107]
    v_mfma_f32_16x16x32_bf16 a[108:111], v[28:31], v[60:63], a[108:111]
    v_mfma_f32_16x16x32_bf16 a[112:115], v[28:31], v[64:67], a[112:115]
    v_mfma_f32_16x16x32_bf16 a[116:119], v[28:31], v[68:71], a[116:119]
    v_mfma_f32_16x16x32_bf16 a[120:123], v[28:31], v[72:75], a[120:123]
    v_mfma_f32_16x16x32_bf16 a[124:127], v[28:31], v[76:79], a[124:127]
    v_mfma_f32_16x16x32_bf16 a[128:131], v[32:35], v[48:51], a[128:131]
    v_mfma_f32_16x16x32_bf16 a[132:135], v[32:35], v[52:55], a[132:135]
    v_mfma_f32_16x16x32_bf16 a[136:139], v[32:35], v[56:59], a[136:139]
    v_mfma_f32_16x16x32_bf16 a[140:143], v[32:35], v[60:63], a[140:143]
    v_mfma_f32_16x16x32_bf16 a[144:147], v[32:35], v[64:67], a[144:147]
    v_mfma_f32_16x16x32_bf16 a[148:151], v[32:35], v[68:71], a[148:151]
    v_mfma_f32_16x16x32_bf16 a[152:155], v[32:35], v[72:75], a[152:155]
    v_mfma_f32_16x16x32_bf16 a[156:159], v[32:35], v[76:79], a[156:159]
    v_mfma_f32_16x16x32_bf16 a[160:163], v[36:39], v[48:51], a[160:163]
    v_mfma_f32_16x16x32_bf16 a[164:167], v[36:39], v[52:55], a[164:167]
    v_mfma_f32_16x16x32_bf16 a[168:171], v[36:39], v[56:59], a[168:171]
    v_mfma_f32_16x16x32_bf16 a[172:175], v[36:39], v[60:63], a[172:175]
    v_mfma_f32_16x16x32_bf16 a[176:179], v[36:39], v[64:67], a[176:179]
    v_mfma_f32_16x16x32_bf16 a[180:183], v[36:39], v[68:71], a[180:183]
    v_mfma_f32_16x16x32_bf16 a[184:187], v[36:39], v[72:75], a[184:187]
    v_mfma_f32_16x16x32_bf16 a[188:191], v[36:39], v[76:79], a[188:191]
    v_mfma_f32_16x16x32_bf16 a[192:195], v[40:43], v[48:51], a[192:195]
    v_mfma_f32_16x16x32_bf16 a[196:199], v[40:43], v[52:55], a[196:199]
    v_mfma_f32_16x16x32_bf16 a[200:203], v[40:43], v[56:59], a[200:203]
    v_mfma_f32_16x16x32_bf16 a[204:207], v[40:43], v[60:63], a[204:207]
    v_mfma_f32_16x16x32_bf16 a[208:211], v[40:43], v[64:67], a[208:211]
    v_mfma_f32_16x16x32_bf16 a[212:215], v[40:43], v[68:71], a[212:215]
    v_mfma_f32_16x16x32_bf16 a[216:219], v[40:43], v[72:75], a[216:219]
    v_mfma_f32_16x16x32_bf16 a[220:223], v[40:43], v[76:79], a[220:223]
    v_mfma_f32_16x16x32_bf16 a[224:227], v[44:47], v[48:51], a[224:227]
    v_mfma_f32_16x16x32_bf16 a[228:231], v[44:47], v[52:55], a[228:231]
    v_mfma_f32_16x16x32_bf16 a[232:235], v[44:47], v[56:59], a[232:235]
    v_mfma_f32_16x16x32_bf16 a[236:239], v[44:47], v[60:63], a[236:239]
    v_mfma_f32_16x16x32_bf16 a[240:243], v[44:47], v[64:67], a[240:243]
    v_mfma_f32_16x16x32_bf16 a[244:247], v[44:47], v[68:71], a[244:247]
    v_mfma_f32_16x16x32_bf16 a[248:251], v[44:47], v[72:75], a[248:251]
    v_mfma_f32_16x16x32_bf16 a[252:255], v[44:47], v[76:79], a[252:255]
    buffer_load_dwordx4 v[16:19], v4, s[12:15], s24 offen offset:0
    buffer_load_dwordx4 v[20:23], v4, s[12:15], s24 offen offset:1024
    buffer_load_dwordx4 v[24:27], v5, s[12:15], s24 offen offset:0
    buffer_load_dwordx4 v[28:31], v5, s[12:15], s24 offen offset:1024
    buffer_load_dwordx4 v[32:35], v6, s[12:15], s24 offen offset:0
    buffer_load_dwordx4 v[36:39], v6, s[12:15], s24 offen offset:1024
    buffer_load_dwordx4 v[40:43], v7, s[12:15], s24 offen offset:0
    buffer_load_dwordx4 v[44:47], v7, s[12:15], s24 offen offset:1024
    buffer_load_dwordx4 v[48:51], v4, s[16:19], s25 offen offset:0
    buffer_load_dwordx4 v[52:55], v4, s[16:19], s25 offen offset:1024
    buffer_load_dwordx4 v[56:59], v5, s[16:19], s25 offen offset:0
    buffer_load_dwordx4 v[60:63], v5, s[16:19], s25 offen offset:1024
    buffer_load_dwordx4 v[64:67], v6, s[16:19], s25 offen offset:0
    buffer_load_dwordx4 v[68:71], v6, s[16:19], s25 offen offset:1024
    buffer_load_dwordx4 v[72:75], v7, s[16:19], s25 offen offset:0
    buffer_load_dwordx4 v[76:79], v7, s[16:19], s25 offen offset:1024
    s_add_u32 s24, s24, 0x800
    s_add_u32 s25, s25, 0x800
    s_waitcnt vmcnt(16)
    v_mfma_f32_16x16x32_bf16 a[0:3], v[80:83], v[112:115], a[0:3]
    v_mfma_f32_16x16x32_bf16 a[4:7], v[80:83], v[116:119], a[4:7]
    v_mfma_f32_16x16x32_bf16 a[8:11], v[80:83], v[120:123], a[8:11]
    v_mfma_f32_16x16x32_bf16 a[12:15], v[80:83], v[124:127], a[12:15]
    v_mfma_f32_16x16x32_bf16 a[16:19], v[80:83], v[128:131], a[16:19]
    v_mfma_f32_16x16x32_bf16 a[20:23], v[80:83], v[132:135], a[20:23]
    v_mfma_f32_16x16x32_bf16 a[24:27], v[80:83], v[136:139], a[24:27]
    v_mfma_f32_16x16x32_bf16 a[28:31], v[80:83], v[140:143], a[28:31]
    v_mfma_f32_16x16x32_bf16 a[32:35], v[84:87], v[112:115], a[32:35]
    v_mfma_f32_16x16x32_bf16 a[36:39], v[84:87], v[116:119], a[36:39]
    v_mfma_f32_16x16x32_bf16 a[40:43], v[84:87], v[120:123], a[40:43]
    v_mfma_f32_16x16x32_bf16 a[44:47], v[84:87], v[124:127], a[44:47]
    v_mfma_f32_16x16x32_bf16 a[48:51], v[84:87], v[128:131], a[48:51]
    v_mfma_f32_16x16x32_bf16 a[52:55], v[84:87], v[132:135], a[52:55]
    v_mfma_f32_16x16x32_bf16 a[56:59], v[84:87], v[136:139], a[56:59]
    v_mfma_f32_16x16x32_bf16 a[60:63], v[84:87], v[140:143], a[60:63]
    v_mfma_f32_16x16x32_bf16 a[64:67], v[88:91], v[112:115], a[64:67]
    v_mfma_f32_16x16x32_bf16 a[68:71], v[88:91], v[116:119], a[68:71]
    v_mfma_f32_16x16x32_bf16 a[72:75], v[88:91], v[120:123], a[72:75]
    v_mfma_f32_16x16x32_bf16 a[76:79], v[88:91], v[124:127], a[76:79]
    v_mfma_f32_16x16x32_bf16 a[80:83], v[88:91], v[128:131], a[80:83]
    v_mfma_f32_16x16x32_bf16 a[84:87], v[88:91], v[132:135], a[84:87]
    v_mfma_f32_16x16x32_bf16 a[88:91], v[88:91], v[136:139], a[88:91]
    v_mfma_f32_16x16x32_bf16 a[92:95], v[88:91], v[140:143], a[92:95]
    v_mfma_f32_16x16x32_bf16 a[96:99], v[92:95], v[112:115], a[96:99]
    v_mfma_f32_16x16x32_bf16 a[100:103], v[92:95], v[116:119], a[100:103]
    v_mfma_f32_16x16x32_bf16 a[104:107], v[92:95], v[120:123], a[104:107]
    v_mfma_f32_16x16x32_bf16 a[108:111], v[92:95], v[124:127], a[108:111]
    v_mfma_f32_16x16x32_bf16 a[112:115], v[92:95], v[128:131], a[112:115]
    v_mfma_f32_16x16x32_bf16 a[116:119], v[92:95], v[132:135], a[116:119]
    v_mfma_f32_16x16x32_bf16 a[120:123], v[92:95], v[136:139], a[120:123]
    v_mfma_f32_16x16x32_bf16 a[124:127], v[92:95], v[140:143], a[124:127]
    v_mfma_f32_16x16x32_bf16 a[128:131], v[96:99], v[112:115], a[128:131]
    v_mfma_f32_16x16x32_bf16 a[132:135], v[96:99], v[116:119], a[132:135]
    v_mfma_f32_16x16x32_bf16 a[136:139], v[96:99], v[120:123], a[136:139]
    v_mfma_f32_16x16x32_bf16 a[140:143], v[96:99], v[124:127], a[140:143]
    v_mfma_f32_16x16x32_bf16 a[144:147], v[96:99], v[128:131], a[144:147]
    v_mfma_f32_16x16x32_bf16 a[148:151], v[96:99], v[132:135], a[148:151]
    v_mfma_f32_16x16x32_bf16 a[152:155], v[96:99], v[136:139], a[152:155]
    v_mfma_f32_16x16x32_bf16 a[156:159], v[96:99], v[140:143], a[156:159]
    v_mfma_f32_16x16x32_bf16 a[160:163], v[100:103], v[112:115], a[160:163]
    v_mfma_f32_16x16x32_bf16 a[164:167], v[100:103], v[116:119], a[164:167]
    v_mfma_f32_16x16x32_bf16 a[168:171], v[100:103], v[120:123], a[168:171]
    v_mfma_f32_16x16x32_bf16 a[172:175], v[100:103], v[124:127], a[172:175]
    v_mfma_f32_16x16x32_bf16 a[176:179], v[100:103], v[128:131], a[176:179]
    v_mfma_f32_16x16x32_bf16 a[180:183], v[100:103], v[132:135], a[180:183]
    v_mfma_f32_16x16x32_bf16 a[184:187], v[100:103], v[136:139], a[184:187]
    v_mfma_f32_16x16x32_bf16 a[188:191], v[100:103], v[140:143], a[188:191]
    v_mfma_f32_16x16x32_bf16 a[192:195], v[104:107], v[112:115], a[192:195]
    v_mfma_f32_16x16x32_bf16 a[196:199], v[104:107], v[116:119], a[196:199]
    v_mfma_f32_16x16x32_bf16 a[200:203], v[104:107], v[120:123], a[200:203]
    v_mfma_f32_16x16x32_bf16 a[204:207], v[104:107], v[124:127], a[204:207]
    v_mfma_f32_16x16x32_bf16 a[208:211], v[104:107], v[128:131], a[208:211]
    v_mfma_f32_16x16x32_bf16 a[212:215], v[104:107], v[132:135], a[212:215]
    v_mfma_f32_16x16x32_bf16 a[216:219], v[104:107], v[136:139], a[216:219]
    v_mfma_f32_16x16x32_bf16 a[220:223], v[104:107], v[140:143], a[220:223]
    v_mfma_f32_16x16x32_bf16 a[224:227], v[108:111], v[112:115], a[224:227]
    v_mfma_f32_16x16x32_bf16 a[228:231], v[108:111], v[116:119], a[228:231]
    v_mfma_f32_16x16x32_bf16 a[232:235], v[108:111], v[120:123], a[232:235]
    v_mfma_f32_16x16x32_bf16 a[236:239], v[108:111], v[124:127], a[236:239]
    v_mfma_f32_16x16x32_bf16 a[240:243], v[108:111], v[128:131], a[240:243]
    v_mfma_f32_16x16x32_bf16 a[244:247], v[108:111], v[132:135], a[244:247]
    v_mfma_f32_16x16x32_bf16 a[248:251], v[108:111], v[136:139], a[248:251]
    v_mfma_f32_16x16x32_bf16 a[252:255], v[108:111], v[140:143], a[252:255]
    buffer_load_dwordx4 v[80:83], v4, s[12:15], s24 offen offset:0
    buffer_load_dwordx4 v[84:87], v4, s[12:15], s24 offen offset:1024
    buffer_load_dwordx4 v[88:91], v5, s[12:15], s24 offen offset:0
    buffer_load_dwordx4 v[92:95], v5, s[12:15], s24 offen offset:1024
    buffer_load_dwordx4 v[96:99], v6, s[12:15], s24 offen offset:0
    buffer_load_dwordx4 v[100:103], v6, s[12:15], s24 offen offset:1024
    buffer_load_dwordx4 v[104:107], v7, s[12:15], s24 offen offset:0
    buffer_load_dwordx4 v[108:111], v7, s[12:15], s24 offen offset:1024
    buffer_load_dwordx4 v[112:115], v4, s[16:19], s25 offen offset:0
    buffer_load_dwordx4 v[116:119], v4, s[16:19], s25 offen offset:1024
    buffer_load_dwordx4 v[120:123], v5, s[16:19], s25 offen offset:0
    buffer_load_dwordx4 v[124:127], v5, s[16:19], s25 offen offset:1024
    buffer_load_dwordx4 v[128:131], v6, s[16:19], s25 offen offset:0
    buffer_load_dwordx4 v[132:135], v6, s[16:19], s25 offen offset:1024
    buffer_load_dwordx4 v[136:139], v7, s[16:19], s25 offen offset:0
    buffer_load_dwordx4 v[140:143], v7, s[16:19], s25 offen offset:1024
    s_add_u32 s24, s24, 0x800
    s_add_u32 s25, s25, 0x800
    s_waitcnt vmcnt(16)
    v_mfma_f32_16x16x32_bf16 a[0:3], v[16:19], v[48:51], a[0:3]
    v_mfma_f32_16x16x32_bf16 a[4:7], v[16:19], v[52:55], a[4:7]
    v_mfma_f32_16x16x32_bf16 a[8:11], v[16:19], v[56:59], a[8:11]
    v_mfma_f32_16x16x32_bf16 a[12:15], v[16:19], v[60:63], a[12:15]
    v_mfma_f32_16x16x32_bf16 a[16:19], v[16:19], v[64:67], a[16:19]
    v_mfma_f32_16x16x32_bf16 a[20:23], v[16:19], v[68:71], a[20:23]
    v_mfma_f32_16x16x32_bf16 a[24:27], v[16:19], v[72:75], a[24:27]
    v_mfma_f32_16x16x32_bf16 a[28:31], v[16:19], v[76:79], a[28:31]
    v_mfma_f32_16x16x32_bf16 a[32:35], v[20:23], v[48:51], a[32:35]
    v_mfma_f32_16x16x32_bf16 a[36:39], v[20:23], v[52:55], a[36:39]
    v_mfma_f32_16x16x32_bf16 a[40:43], v[20:23], v[56:59], a[40:43]
    v_mfma_f32_16x16x32_bf16 a[44:47], v[20:23], v[60:63], a[44:47]
    v_mfma_f32_16x16x32_bf16 a[48:51], v[20:23], v[64:67], a[48:51]
    v_mfma_f32_16x16x32_bf16 a[52:55], v[20:23], v[68:71], a[52:55]
    v_mfma_f32_16x16x32_bf16 a[56:59], v[20:23], v[72:75], a[56:59]
    v_mfma_f32_16x16x32_bf16 a[60:63], v[20:23], v[76:79], a[60:63]
    v_mfma_f32_16x16x32_bf16 a[64:67], v[24:27], v[48:51], a[64:67]
    v_mfma_f32_16x16x32_bf16 a[68:71], v[24:27], v[52:55], a[68:71]
    v_mfma_f32_16x16x32_bf16 a[72:75], v[24:27], v[56:59], a[72:75]
    v_mfma_f32_16x16x32_bf16 a[76:79], v[24:27], v[60:63], a[76:79]
    v_mfma_f32_16x16x32_bf16 a[80:83], v[24:27], v[64:67], a[80:83]
    v_mfma_f32_16x16x32_bf16 a[84:87], v[24:27], v[68:71], a[84:87]
    v_mfma_f32_16x16x32_bf16 a[88:91], v[24:27], v[72:75], a[88:91]
    v_mfma_f32_16x16x32_bf16 a[92:95], v[24:27], v[76:79], a[92:95]
    v_mfma_f32_16x16x32_bf16 a[96:99], v[28:31], v[48:51], a[96:99]
    v_mfma_f32_16x16x32_bf16 a[100:103], v[28:31], v[52:55], a[100:103]
    v_mfma_f32_16x16x32_bf16 a[104:107], v[28:31], v[56:59], a[104:107]
    v_mfma_f32_16x16x32_bf16 a[108:111], v[28:31], v[60:63], a[108:111]
    v_mfma_f32_16x16x32_bf16 a[112:115], v[28:31], v[64:67], a[112:115]
    v_mfma_f32_16x16x32_bf16 a[116:119], v[28:31], v[68:71], a[116:119]
    v_mfma_f32_16x16x32_bf16 a[120:123], v[28:31], v[72:75], a[120:123]
    v_mfma_f32_16x16x32_bf16 a[124:127], v[28:31], v[76:79], a[124:127]
    v_mfma_f32_16x16x32_bf16 a[128:131], v[32:35], v[48:51], a[128:131]
    v_mfma_f32_16x16x32_bf16 a[132:135], v[32:35], v[52:55], a[132:135]
    v_mfma_f32_16x16x32_bf16 a[136:139], v[32:35], v[56:59], a[136:139]
    v_mfma_f32_16x16x32_bf16 a[140:143], v[32:35], v[60:63], a[140:143]
    v_mfma_f32_16x16x32_bf16 a[144:147], v[32:35], v[64:67], a[144:147]
    v_mfma_f32_16x16x32_bf16 a[148:151], v[32:35], v[68:71], a[148:151]
    v_mfma_f32_16x16x32_bf16 a[152:155], v[32:35], v[72:75], a[152:155]
    v_mfma_f32_16x16x32_bf16 a[156:159], v[32:35], v[76:79], a[156:159]
    v_mfma_f32_16x16x32_bf16 a[160:163], v[36:39], v[48:51], a[160:163]
    v_mfma_f32_16x16x32_bf16 a[164:167], v[36:39], v[52:55], a[164:167]
    v_mfma_f32_16x16x32_bf16 a[168:171], v[36:39], v[56:59], a[168:171]
    v_mfma_f32_16x16x32_bf16 a[172:175], v[36:39], v[60:63], a[172:175]
    v_mfma_f32_16x16x32_bf16 a[176:179], v[36:39], v[64:67], a[176:179]
    v_mfma_f32_16x16x32_bf16 a[180:183], v[36:39], v[68:71], a[180:183]
    v_mfma_f32_16x16x32_bf16 a[184:187], v[36:39], v[72:75], a[184:187]
    v_mfma_f32_16x16x32_bf16 a[188:191], v[36:39], v[76:79], a[188:191]
    v_mfma_f32_16x16x32_bf16 a[192:195], v[40:43], v[48:51], a[192:195]
    v_mfma_f32_16x16x32_bf16 a[196:199], v[40:43], v[52:55], a[196:199]
    v_mfma_f32_16x16x32_bf16 a[200:203], v[40:43], v[56:59], a[200:203]
    v_mfma_f32_16x16x32_bf16 a[204:207], v[40:43], v[60:63], a[204:207]
    v_mfma_f32_16x16x32_bf16 a[208:211], v[40:43], v[64:67], a[208:211]
    v_mfma_f32_16x16x32_bf16 a[212:215], v[40:43], v[68:71], a[212:215]
    v_mfma_f32_16x16x32_bf16 a[216:219], v[40:43], v[72:75], a[216:219]
    v_mfma_f32_16x16x32_bf16 a[220:223], v[40:43], v[76:79], a[220:223]
    v_mfma_f32_16x16x32_bf16 a[224:227], v[44:47], v[48:51], a[224:227]
    v_mfma_f32_16x16x32_bf16 a[228:231], v[44:47], v[52:55], a[228:231]
    v_mfma_f32_16x16x32_bf16 a[232:235], v[44:47], v[56:59], a[232:235]
    v_mfma_f32_16x16x32_bf16 a[236:239], v[44:47], v[60:63], a[236:239]
    v_mfma_f32_16x16x32_bf16 a[240:243], v[44:47], v[64:67], a[240:243]
    v_mfma_f32_16x16x32_bf16 a[244:247], v[44:47], v[68:71], a[244:247]
    v_mfma_f32_16x16x32_bf16 a[248:251], v[44:47], v[72:75], a[248:251]
    v_mfma_f32_16x16x32_bf16 a[252:255], v[44:47], v[76:79], a[252:255]
    buffer_load_dwordx4 v[16:19], v4, s[12:15], s24 offen offset:0
    buffer_load_dwordx4 v[20:23], v4, s[12:15], s24 offen offset:1024
    buffer_load_dwordx4 v[24:27], v5, s[12:15], s24 offen offset:0
    buffer_load_dwordx4 v[28:31], v5, s[12:15], s24 offen offset:1024
    buffer_load_dwordx4 v[32:35], v6, s[12:15], s24 offen offset:0
    buffer_load_dwordx4 v[36:39], v6, s[12:15], s24 offen offset:1024
    buffer_load_dwordx4 v[40:43], v7, s[12:15], s24 offen offset:0
    buffer_load_dwordx4 v[44:47], v7, s[12:15], s24 offen offset:1024
    buffer_load_dwordx4 v[48:51], v4, s[16:19], s25 offen offset:0
    buffer_load_dwordx4 v[52:55], v4, s[16:19], s25 offen offset:1024
    buffer_load_dwordx4 v[56:59], v5, s[16:19], s25 offen offset:0
    buffer_load_dwordx4 v[60:63], v5, s[16:19], s25 offen offset:1024
    buffer_load_dwordx4 v[64:67], v6, s[16:19], s25 offen offset:0
    buffer_load_dwordx4 v[68:71], v6, s[16:19], s25 offen offset:1024
    buffer_load_dwordx4 v[72:75], v7, s[16:19], s25 offen offset:0
    buffer_load_dwordx4 v[76:79], v7, s[16:19], s25 offen offset:1024
    s_add_u32 s24, s24, 0x800
    s_add_u32 s25, s25, 0x800
    s_waitcnt vmcnt(16)
    v_mfma_f32_16x16x32_bf16 a[0:3], v[80:83], v[112:115], a[0:3]
    v_mfma_f32_16x16x32_bf16 a[4:7], v[80:83], v[116:119], a[4:7]
    v_mfma_f32_16x16x32_bf16 a[8:11], v[80:83], v[120:123], a[8:11]
    v_mfma_f32_16x16x32_bf16 a[12:15], v[80:83], v[124:127], a[12:15]
    v_mfma_f32_16x16x32_bf16 a[16:19], v[80:83], v[128:131], a[16:19]
    v_mfma_f32_16x16x32_bf16 a[20:23], v[80:83], v[132:135], a[20:23]
    v_mfma_f32_16x16x32_bf16 a[24:27], v[80:83], v[136:139], a[24:27]
    v_mfma_f32_16x16x32_bf16 a[28:31], v[80:83], v[140:143], a[28:31]
    v_mfma_f32_16x16x32_bf16 a[32:35], v[84:87], v[112:115], a[32:35]
    v_mfma_f32_16x16x32_bf16 a[36:39], v[84:87], v[116:119], a[36:39]
    v_mfma_f32_16x16x32_bf16 a[40:43], v[84:87], v[120:123], a[40:43]
    v_mfma_f32_16x16x32_bf16 a[44:47], v[84:87], v[124:127], a[44:47]
    v_mfma_f32_16x16x32_bf16 a[48:51], v[84:87], v[128:131], a[48:51]
    v_mfma_f32_16x16x32_bf16 a[52:55], v[84:87], v[132:135], a[52:55]
    v_mfma_f32_16x16x32_bf16 a[56:59], v[84:87], v[136:139], a[56:59]
    v_mfma_f32_16x16x32_bf16 a[60:63], v[84:87], v[140:143], a[60:63]
    v_mfma_f32_16x16x32_bf16 a[64:67], v[88:91], v[112:115], a[64:67]
    v_mfma_f32_16x16x32_bf16 a[68:71], v[88:91], v[116:119], a[68:71]
    v_mfma_f32_16x16x32_bf16 a[72:75], v[88:91], v[120:123], a[72:75]
    v_mfma_f32_16x16x32_bf16 a[76:79], v[88:91], v[124:127], a[76:79]
    v_mfma_f32_16x16x32_bf16 a[80:83], v[88:91], v[128:131], a[80:83]
    v_mfma_f32_16x16x32_bf16 a[84:87], v[88:91], v[132:135], a[84:87]
    v_mfma_f32_16x16x32_bf16 a[88:91], v[88:91], v[136:139], a[88:91]
    v_mfma_f32_16x16x32_bf16 a[92:95], v[88:91], v[140:143], a[92:95]
    v_mfma_f32_16x16x32_bf16 a[96:99], v[92:95], v[112:115], a[96:99]
    v_mfma_f32_16x16x32_bf16 a[100:103], v[92:95], v[116:119], a[100:103]
    v_mfma_f32_16x16x32_bf16 a[104:107], v[92:95], v[120:123], a[104:107]
    v_mfma_f32_16x16x32_bf16 a[108:111], v[92:95], v[124:127], a[108:111]
    v_mfma_f32_16x16x32_bf16 a[112:115], v[92:95], v[128:131], a[112:115]
    v_mfma_f32_16x16x32_bf16 a[116:119], v[92:95], v[132:135], a[116:119]
    v_mfma_f32_16x16x32_bf16 a[120:123], v[92:95], v[136:139], a[120:123]
    v_mfma_f32_16x16x32_bf16 a[124:127], v[92:95], v[140:143], a[124:127]
    v_mfma_f32_16x16x32_bf16 a[128:131], v[96:99], v[112:115], a[128:131]
    v_mfma_f32_16x16x32_bf16 a[132:135], v[96:99], v[116:119], a[132:135]
    v_mfma_f32_16x16x32_bf16 a[136:139], v[96:99], v[120:123], a[136:139]
    v_mfma_f32_16x16x32_bf16 a[140:143], v[96:99], v[124:127], a[140:143]
    v_mfma_f32_16x16x32_bf16 a[144:147], v[96:99], v[128:131], a[144:147]
    v_mfma_f32_16x16x32_bf16 a[148:151], v[96:99], v[132:135], a[148:151]
    v_mfma_f32_16x16x32_bf16 a[152:155], v[96:99], v[136:139], a[152:155]
    v_mfma_f32_16x16x32_bf16 a[156:159], v[96:99], v[140:143], a[156:159]
    v_mfma_f32_16x16x32_bf16 a[160:163], v[100:103], v[112:115], a[160:163]
    v_mfma_f32_16x16x32_bf16 a[164:167], v[100:103], v[116:119], a[164:167]
    v_mfma_f32_16x16x32_bf16 a[168:171], v[100:103], v[120:123], a[168:171]
    v_mfma_f32_16x16x32_bf16 a[172:175], v[100:103], v[124:127], a[172:175]
    v_mfma_f32_16x16x32_bf16 a[176:179], v[100:103], v[128:131], a[176:179]
    v_mfma_f32_16x16x32_bf16 a[180:183], v[100:103], v[132:135], a[180:183]
    v_mfma_f32_16x16x32_bf16 a[184:187], v[100:103], v[136:139], a[184:187]
    v_mfma_f32_16x16x32_bf16 a[188:191], v[100:103], v[140:143], a[188:191]
    v_mfma_f32_16x16x32_bf16 a[192:195], v[104:107], v[112:115], a[192:195]
    v_mfma_f32_16x16x32_bf16 a[196:199], v[104:107], v[116:119], a[196:199]
    v_mfma_f32_16x16x32_bf16 a[200:203], v[104:107], v[120:123], a[200:203]
    v_mfma_f32_16x16x32_bf16 a[204:207], v[104:107], v[124:127], a[204:207]
    v_mfma_f32_16x16x32_bf16 a[208:211], v[104:107], v[128:131], a[208:211]
    v_mfma_f32_16x16x32_bf16 a[212:215], v[104:107], v[132:135], a[212:215]
    v_mfma_f32_16x16x32_bf16 a[216:219], v[104:107], v[136:139], a[216:219]
    v_mfma_f32_16x16x32_bf16 a[220:223], v[104:107], v[140:143], a[220:223]
    v_mfma_f32_16x16x32_bf16 a[224:227], v[108:111], v[112:115], a[224:227]
    v_mfma_f32_16x16x32_bf16 a[228:231], v[108:111], v[116:119], a[228:231]
    v_mfma_f32_16x16x32_bf16 a[232:235], v[108:111], v[120:123], a[232:235]
    v_mfma_f32_16x16x32_bf16 a[236:239], v[108:111], v[124:127], a[236:239]
    v_mfma_f32_16x16x32_bf16 a[240:243], v[108:111], v[128:131], a[240:243]
    v_mfma_f32_16x16x32_bf16 a[244:247], v[108:111], v[132:135], a[244:247]
    v_mfma_f32_16x16x32_bf16 a[248:251], v[108:111], v[136:139], a[248:251]
    v_mfma_f32_16x16x32_bf16 a[252:255], v[108:111], v[140:143], a[252:255]
    buffer_load_dwordx4 v[80:83], v4, s[12:15], s24 offen offset:0
    buffer_load_dwordx4 v[84:87], v4, s[12:15], s24 offen offset:1024
    buffer_load_dwordx4 v[88:91], v5, s[12:15], s24 offen offset:0
    buffer_load_dwordx4 v[92:95], v5, s[12:15], s24 offen offset:1024
    buffer_load_dwordx4 v[96:99], v6, s[12:15], s24 offen offset:0
    buffer_load_dwordx4 v[100:103], v6, s[12:15], s24 offen offset:1024
    buffer_load_dwordx4 v[104:107], v7, s[12:15], s24 offen offset:0
    buffer_load_dwordx4 v[108:111], v7, s[12:15], s24 offen offset:1024
    buffer_load_dwordx4 v[112:115], v4, s[16:19], s25 offen offset:0
    buffer_load_dwordx4 v[116:119], v4, s[16:19], s25 offen offset:1024
    buffer_load_dwordx4 v[120:123], v5, s[16:19], s25 offen offset:0
    buffer_load_dwordx4 v[124:127], v5, s[16:19], s25 offen offset:1024
    buffer_load_dwordx4 v[128:131], v6, s[16:19], s25 offen offset:0
    buffer_load_dwordx4 v[132:135], v6, s[16:19], s25 offen offset:1024
    buffer_load_dwordx4 v[136:139], v7, s[16:19], s25 offen offset:0
    buffer_load_dwordx4 v[140:143], v7, s[16:19], s25 offen offset:1024
    s_add_u32 s24, s24, 0x800
    s_add_u32 s25, s25, 0x800
    s_waitcnt vmcnt(16)
    v_mfma_f32_16x16x32_bf16 a[0:3], v[16:19], v[48:51], a[0:3]
    v_mfma_f32_16x16x32_bf16 a[4:7], v[16:19], v[52:55], a[4:7]
    v_mfma_f32_16x16x32_bf16 a[8:11], v[16:19], v[56:59], a[8:11]
    v_mfma_f32_16x16x32_bf16 a[12:15], v[16:19], v[60:63], a[12:15]
    v_mfma_f32_16x16x32_bf16 a[16:19], v[16:19], v[64:67], a[16:19]
    v_mfma_f32_16x16x32_bf16 a[20:23], v[16:19], v[68:71], a[20:23]
    v_mfma_f32_16x16x32_bf16 a[24:27], v[16:19], v[72:75], a[24:27]
    v_mfma_f32_16x16x32_bf16 a[28:31], v[16:19], v[76:79], a[28:31]
    v_mfma_f32_16x16x32_bf16 a[32:35], v[20:23], v[48:51], a[32:35]
    v_mfma_f32_16x16x32_bf16 a[36:39], v[20:23], v[52:55], a[36:39]
    v_mfma_f32_16x16x32_bf16 a[40:43], v[20:23], v[56:59], a[40:43]
    v_mfma_f32_16x16x32_bf16 a[44:47], v[20:23], v[60:63], a[44:47]
    v_mfma_f32_16x16x32_bf16 a[48:51], v[20:23], v[64:67], a[48:51]
    v_mfma_f32_16x16x32_bf16 a[52:55], v[20:23], v[68:71], a[52:55]
    v_mfma_f32_16x16x32_bf16 a[56:59], v[20:23], v[72:75], a[56:59]
    v_mfma_f32_16x16x32_bf16 a[60:63], v[20:23], v[76:79], a[60:63]
    v_mfma_f32_16x16x32_bf16 a[64:67], v[24:27], v[48:51], a[64:67]
    v_mfma_f32_16x16x32_bf16 a[68:71], v[24:27], v[52:55], a[68:71]
    v_mfma_f32_16x16x32_bf16 a[72:75], v[24:27], v[56:59], a[72:75]
    v_mfma_f32_16x16x32_bf16 a[76:79], v[24:27], v[60:63], a[76:79]
    v_mfma_f32_16x16x32_bf16 a[80:83], v[24:27], v[64:67], a[80:83]
    v_mfma_f32_16x16x32_bf16 a[84:87], v[24:27], v[68:71], a[84:87]
    v_mfma_f32_16x16x32_bf16 a[88:91], v[24:27], v[72:75], a[88:91]
    v_mfma_f32_16x16x32_bf16 a[92:95], v[24:27], v[76:79], a[92:95]
    v_mfma_f32_16x16x32_bf16 a[96:99], v[28:31], v[48:51], a[96:99]
    v_mfma_f32_16x16x32_bf16 a[100:103], v[28:31], v[52:55], a[100:103]
    v_mfma_f32_16x16x32_bf16 a[104:107], v[28:31], v[56:59], a[104:107]
    v_mfma_f32_16x16x32_bf16 a[108:111], v[28:31], v[60:63], a[108:111]
    v_mfma_f32_16x16x32_bf16 a[112:115], v[28:31], v[64:67], a[112:115]
    v_mfma_f32_16x16x32_bf16 a[116:119], v[28:31], v[68:71], a[116:119]
    v_mfma_f32_16x16x32_bf16 a[120:123], v[28:31], v[72:75], a[120:123]
    v_mfma_f32_16x16x32_bf16 a[124:127], v[28:31], v[76:79], a[124:127]
    v_mfma_f32_16x16x32_bf16 a[128:131], v[32:35], v[48:51], a[128:131]
    v_mfma_f32_16x16x32_bf16 a[132:135], v[32:35], v[52:55], a[132:135]
    v_mfma_f32_16x16x32_bf16 a[136:139], v[32:35], v[56:59], a[136:139]
    v_mfma_f32_16x16x32_bf16 a[140:143], v[32:35], v[60:63], a[140:143]
    v_mfma_f32_16x16x32_bf16 a[144:147], v[32:35], v[64:67], a[144:147]
    v_mfma_f32_16x16x32_bf16 a[148:151], v[32:35], v[68:71], a[148:151]
    v_mfma_f32_16x16x32_bf16 a[152:155], v[32:35], v[72:75], a[152:155]
    v_mfma_f32_16x16x32_bf16 a[156:159], v[32:35], v[76:79], a[156:159]
    v_mfma_f32_16x16x32_bf16 a[160:163], v[36:39], v[48:51], a[160:163]
    v_mfma_f32_16x16x32_bf16 a[164:167], v[36:39], v[52:55], a[164:167]
    v_mfma_f32_16x16x32_bf16 a[168:171], v[36:39], v[56:59], a[168:171]
    v_mfma_f32_16x16x32_bf16 a[172:175], v[36:39], v[60:63], a[172:175]
    v_mfma_f32_16x16x32_bf16 a[176:179], v[36:39], v[64:67], a[176:179]
    v_mfma_f32_16x16x32_bf16 a[180:183], v[36:39], v[68:71], a[180:183]
    v_mfma_f32_16x16x32_bf16 a[184:187], v[36:39], v[72:75], a[184:187]
    v_mfma_f32_16x16x32_bf16 a[188:191], v[36:39], v[76:79], a[188:191]
    v_mfma_f32_16x16x32_bf16 a[192:195], v[40:43], v[48:51], a[192:195]
    v_mfma_f32_16x16x32_bf16 a[196:199], v[40:43], v[52:55], a[196:199]
    v_mfma_f32_16x16x32_bf16 a[200:203], v[40:43], v[56:59], a[200:203]
    v_mfma_f32_16x16x32_bf16 a[204:207], v[40:43], v[60:63], a[204:207]
    v_mfma_f32_16x16x32_bf16 a[208:211], v[40:43], v[64:67], a[208:211]
    v_mfma_f32_16x16x32_bf16 a[212:215], v[40:43], v[68:71], a[212:215]
    v_mfma_f32_16x16x32_bf16 a[216:219], v[40:43], v[72:75], a[216:219]
    v_mfma_f32_16x16x32_bf16 a[220:223], v[40:43], v[76:79], a[220:223]
    v_mfma_f32_16x16x32_bf16 a[224:227], v[44:47], v[48:51], a[224:227]
    v_mfma_f32_16x16x32_bf16 a[228:231], v[44:47], v[52:55], a[228:231]
    v_mfma_f32_16x16x32_bf16 a[232:235], v[44:47], v[56:59], a[232:235]
    v_mfma_f32_16x16x32_bf16 a[236:239], v[44:47], v[60:63], a[236:239]
    v_mfma_f32_16x16x32_bf16 a[240:243], v[44:47], v[64:67], a[240:243]
    v_mfma_f32_16x16x32_bf16 a[244:247], v[44:47], v[68:71], a[244:247]
    v_mfma_f32_16x16x32_bf16 a[248:251], v[44:47], v[72:75], a[248:251]
    v_mfma_f32_16x16x32_bf16 a[252:255], v[44:47], v[76:79], a[252:255]
    buffer_load_dwordx4 v[16:19], v4, s[12:15], s24 offen offset:0
    buffer_load_dwordx4 v[20:23], v4, s[12:15], s24 offen offset:1024
    buffer_load_dwordx4 v[24:27], v5, s[12:15], s24 offen offset:0
    buffer_load_dwordx4 v[28:31], v5, s[12:15], s24 offen offset:1024
    buffer_load_dwordx4 v[32:35], v6, s[12:15], s24 offen offset:0
    buffer_load_dwordx4 v[36:39], v6, s[12:15], s24 offen offset:1024
    buffer_load_dwordx4 v[40:43], v7, s[12:15], s24 offen offset:0
    buffer_load_dwordx4 v[44:47], v7, s[12:15], s24 offen offset:1024
    buffer_load_dwordx4 v[48:51], v4, s[16:19], s25 offen offset:0
    buffer_load_dwordx4 v[52:55], v4, s[16:19], s25 offen offset:1024
    buffer_load_dwordx4 v[56:59], v5, s[16:19], s25 offen offset:0
    buffer_load_dwordx4 v[60:63], v5, s[16:19], s25 offen offset:1024
    buffer_load_dwordx4 v[64:67], v6, s[16:19], s25 offen offset:0
    buffer_load_dwordx4 v[68:71], v6, s[16:19], s25 offen offset:1024
    buffer_load_dwordx4 v[72:75], v7, s[16:19], s25 offen offset:0
    buffer_load_dwordx4 v[76:79], v7, s[16:19], s25 offen offset:1024
    s_add_u32 s24, s24, 0x800
    s_add_u32 s25, s25, 0x800
    s_waitcnt vmcnt(16)
    v_mfma_f32_16x16x32_bf16 a[0:3], v[80:83], v[112:115], a[0:3]
    v_mfma_f32_16x16x32_bf16 a[4:7], v[80:83], v[116:119], a[4:7]
    v_mfma_f32_16x16x32_bf16 a[8:11], v[80:83], v[120:123], a[8:11]
    v_mfma_f32_16x16x32_bf16 a[12:15], v[80:83], v[124:127], a[12:15]
    v_mfma_f32_16x16x32_bf16 a[16:19], v[80:83], v[128:131], a[16:19]
    v_mfma_f32_16x16x32_bf16 a[20:23], v[80:83], v[132:135], a[20:23]
    v_mfma_f32_16x16x32_bf16 a[24:27], v[80:83], v[136:139], a[24:27]
    v_mfma_f32_16x16x32_bf16 a[28:31], v[80:83], v[140:143], a[28:31]
    v_mfma_f32_16x16x32_bf16 a[32:35], v[84:87], v[112:115], a[32:35]
    v_mfma_f32_16x16x32_bf16 a[36:39], v[84:87], v[116:119], a[36:39]
    v_mfma_f32_16x16x32_bf16 a[40:43], v[84:87], v[120:123], a[40:43]
    v_mfma_f32_16x16x32_bf16 a[44:47], v[84:87], v[124:127], a[44:47]
    v_mfma_f32_16x16x32_bf16 a[48:51], v[84:87], v[128:131], a[48:51]
    v_mfma_f32_16x16x32_bf16 a[52:55], v[84:87], v[132:135], a[52:55]
    v_mfma_f32_16x16x32_bf16 a[56:59], v[84:87], v[136:139], a[56:59]
    v_mfma_f32_16x16x32_bf16 a[60:63], v[84:87], v[140:143], a[60:63]
    v_mfma_f32_16x16x32_bf16 a[64:67], v[88:91], v[112:115], a[64:67]
    v_mfma_f32_16x16x32_bf16 a[68:71], v[88:91], v[116:119], a[68:71]
    v_mfma_f32_16x16x32_bf16 a[72:75], v[88:91], v[120:123], a[72:75]
    v_mfma_f32_16x16x32_bf16 a[76:79], v[88:91], v[124:127], a[76:79]
    v_mfma_f32_16x16x32_bf16 a[80:83], v[88:91], v[128:131], a[80:83]
    v_mfma_f32_16x16x32_bf16 a[84:87], v[88:91], v[132:135], a[84:87]
    v_mfma_f32_16x16x32_bf16 a[88:91], v[88:91], v[136:139], a[88:91]
    v_mfma_f32_16x16x32_bf16 a[92:95], v[88:91], v[140:143], a[92:95]
    v_mfma_f32_16x16x32_bf16 a[96:99], v[92:95], v[112:115], a[96:99]
    v_mfma_f32_16x16x32_bf16 a[100:103], v[92:95], v[116:119], a[100:103]
    v_mfma_f32_16x16x32_bf16 a[104:107], v[92:95], v[120:123], a[104:107]
    v_mfma_f32_16x16x32_bf16 a[108:111], v[92:95], v[124:127], a[108:111]
    v_mfma_f32_16x16x32_bf16 a[112:115], v[92:95], v[128:131], a[112:115]
    v_mfma_f32_16x16x32_bf16 a[116:119], v[92:95], v[132:135], a[116:119]
    v_mfma_f32_16x16x32_bf16 a[120:123], v[92:95], v[136:139], a[120:123]
    v_mfma_f32_16x16x32_bf16 a[124:127], v[92:95], v[140:143], a[124:127]
    v_mfma_f32_16x16x32_bf16 a[128:131], v[96:99], v[112:115], a[128:131]
    v_mfma_f32_16x16x32_bf16 a[132:135], v[96:99], v[116:119], a[132:135]
    v_mfma_f32_16x16x32_bf16 a[136:139], v[96:99], v[120:123], a[136:139]
    v_mfma_f32_16x16x32_bf16 a[140:143], v[96:99], v[124:127], a[140:143]
    v_mfma_f32_16x16x32_bf16 a[144:147], v[96:99], v[128:131], a[144:147]
    v_mfma_f32_16x16x32_bf16 a[148:151], v[96:99], v[132:135], a[148:151]
    v_mfma_f32_16x16x32_bf16 a[152:155], v[96:99], v[136:139], a[152:155]
    v_mfma_f32_16x16x32_bf16 a[156:159], v[96:99], v[140:143], a[156:159]
    v_mfma_f32_16x16x32_bf16 a[160:163], v[100:103], v[112:115], a[160:163]
    v_mfma_f32_16x16x32_bf16 a[164:167], v[100:103], v[116:119], a[164:167]
    v_mfma_f32_16x16x32_bf16 a[168:171], v[100:103], v[120:123], a[168:171]
    v_mfma_f32_16x16x32_bf16 a[172:175], v[100:103], v[124:127], a[172:175]
    v_mfma_f32_16x16x32_bf16 a[176:179], v[100:103], v[128:131], a[176:179]
    v_mfma_f32_16x16x32_bf16 a[180:183], v[100:103], v[132:135], a[180:183]
    v_mfma_f32_16x16x32_bf16 a[184:187], v[100:103], v[136:139], a[184:187]
    v_mfma_f32_16x16x32_bf16 a[188:191], v[100:103], v[140:143], a[188:191]
    v_mfma_f32_16x16x32_bf16 a[192:195], v[104:107], v[112:115], a[192:195]
    v_mfma_f32_16x16x32_bf16 a[196:199], v[104:107], v[116:119], a[196:199]
    v_mfma_f32_16x16x32_bf16 a[200:203], v[104:107], v[120:123], a[200:203]
    v_mfma_f32_16x16x32_bf16 a[204:207], v[104:107], v[124:127], a[204:207]
    v_mfma_f32_16x16x32_bf16 a[208:211], v[104:107], v[128:131], a[208:211]
    v_mfma_f32_16x16x32_bf16 a[212:215], v[104:107], v[132:135], a[212:215]
    v_mfma_f32_16x16x32_bf16 a[216:219], v[104:107], v[136:139], a[216:219]
    v_mfma_f32_16x16x32_bf16 a[220:223], v[104:107], v[140:143], a[220:223]
    v_mfma_f32_16x16x32_bf16 a[224:227], v[108:111], v[112:115], a[224:227]
    v_mfma_f32_16x16x32_bf16 a[228:231], v[108:111], v[116:119], a[228:231]
    v_mfma_f32_16x16x32_bf16 a[232:235], v[108:111], v[120:123], a[232:235]
    v_mfma_f32_16x16x32_bf16 a[236:239], v[108:111], v[124:127], a[236:239]
    v_mfma_f32_16x16x32_bf16 a[240:243], v[108:111], v[128:131], a[240:243]
    v_mfma_f32_16x16x32_bf16 a[244:247], v[108:111], v[132:135], a[244:247]
    v_mfma_f32_16x16x32_bf16 a[248:251], v[108:111], v[136:139], a[248:251]
    v_mfma_f32_16x16x32_bf16 a[252:255], v[108:111], v[140:143], a[252:255]
    buffer_load_dwordx4 v[80:83], v4, s[12:15], s24 offen offset:0
    buffer_load_dwordx4 v[84:87], v4, s[12:15], s24 offen offset:1024
    buffer_load_dwordx4 v[88:91], v5, s[12:15], s24 offen offset:0
    buffer_load_dwordx4 v[92:95], v5, s[12:15], s24 offen offset:1024
    buffer_load_dwordx4 v[96:99], v6, s[12:15], s24 offen offset:0
    buffer_load_dwordx4 v[100:103], v6, s[12:15], s24 offen offset:1024
    buffer_load_dwordx4 v[104:107], v7, s[12:15], s24 offen offset:0
    buffer_load_dwordx4 v[108:111], v7, s[12:15], s24 offen offset:1024
    buffer_load_dwordx4 v[112:115], v4, s[16:19], s25 offen offset:0
    buffer_load_dwordx4 v[116:119], v4, s[16:19], s25 offen offset:1024
    buffer_load_dwordx4 v[120:123], v5, s[16:19], s25 offen offset:0
    buffer_load_dwordx4 v[124:127], v5, s[16:19], s25 offen offset:1024
    buffer_load_dwordx4 v[128:131], v6, s[16:19], s25 offen offset:0
    buffer_load_dwordx4 v[132:135], v6, s[16:19], s25 offen offset:1024
    buffer_load_dwordx4 v[136:139], v7, s[16:19], s25 offen offset:0
    buffer_load_dwordx4 v[140:143], v7, s[16:19], s25 offen offset:1024
    s_add_u32 s24, s24, 0x800
    s_add_u32 s25, s25, 0x800
    s_waitcnt vmcnt(16)
    v_mfma_f32_16x16x32_bf16 a[0:3], v[16:19], v[48:51], a[0:3]
    v_mfma_f32_16x16x32_bf16 a[4:7], v[16:19], v[52:55], a[4:7]
    v_mfma_f32_16x16x32_bf16 a[8:11], v[16:19], v[56:59], a[8:11]
    v_mfma_f32_16x16x32_bf16 a[12:15], v[16:19], v[60:63], a[12:15]
    v_mfma_f32_16x16x32_bf16 a[16:19], v[16:19], v[64:67], a[16:19]
    v_mfma_f32_16x16x32_bf16 a[20:23], v[16:19], v[68:71], a[20:23]
    v_mfma_f32_16x16x32_bf16 a[24:27], v[16:19], v[72:75], a[24:27]
    v_mfma_f32_16x16x32_bf16 a[28:31], v[16:19], v[76:79], a[28:31]
    v_mfma_f32_16x16x32_bf16 a[32:35], v[20:23], v[48:51], a[32:35]
    v_mfma_f32_16x16x32_bf16 a[36:39], v[20:23], v[52:55], a[36:39]
    v_mfma_f32_16x16x32_bf16 a[40:43], v[20:23], v[56:59], a[40:43]
    v_mfma_f32_16x16x32_bf16 a[44:47], v[20:23], v[60:63], a[44:47]
    v_mfma_f32_16x16x32_bf16 a[48:51], v[20:23], v[64:67], a[48:51]
    v_mfma_f32_16x16x32_bf16 a[52:55], v[20:23], v[68:71], a[52:55]
    v_mfma_f32_16x16x32_bf16 a[56:59], v[20:23], v[72:75], a[56:59]
    v_mfma_f32_16x16x32_bf16 a[60:63], v[20:23], v[76:79], a[60:63]
    v_mfma_f32_16x16x32_bf16 a[64:67], v[24:27], v[48:51], a[64:67]
    v_mfma_f32_16x16x32_bf16 a[68:71], v[24:27], v[52:55], a[68:71]
    v_mfma_f32_16x16x32_bf16 a[72:75], v[24:27], v[56:59], a[72:75]
    v_mfma_f32_16x16x32_bf16 a[76:79], v[24:27], v[60:63], a[76:79]
    v_mfma_f32_16x16x32_bf16 a[80:83], v[24:27], v[64:67], a[80:83]
    v_mfma_f32_16x16x32_bf16 a[84:87], v[24:27], v[68:71], a[84:87]
    v_mfma_f32_16x16x32_bf16 a[88:91], v[24:27], v[72:75], a[88:91]
    v_mfma_f32_16x16x32_bf16 a[92:95], v[24:27], v[76:79], a[92:95]
    v_mfma_f32_16x16x32_bf16 a[96:99], v[28:31], v[48:51], a[96:99]
    v_mfma_f32_16x16x32_bf16 a[100:103], v[28:31], v[52:55], a[100:103]
    v_mfma_f32_16x16x32_bf16 a[104:107], v[28:31], v[56:59], a[104:107]
    v_mfma_f32_16x16x32_bf16 a[108:111], v[28:31], v[60:63], a[108:111]
    v_mfma_f32_16x16x32_bf16 a[112:115], v[28:31], v[64:67], a[112:115]
    v_mfma_f32_16x16x32_bf16 a[116:119], v[28:31], v[68:71], a[116:119]
    v_mfma_f32_16x16x32_bf16 a[120:123], v[28:31], v[72:75], a[120:123]
    v_mfma_f32_16x16x32_bf16 a[124:127], v[28:31], v[76:79], a[124:127]
    v_mfma_f32_16x16x32_bf16 a[128:131], v[32:35], v[48:51], a[128:131]
    v_mfma_f32_16x16x32_bf16 a[132:135], v[32:35], v[52:55], a[132:135]
    v_mfma_f32_16x16x32_bf16 a[136:139], v[32:35], v[56:59], a[136:139]
    v_mfma_f32_16x16x32_bf16 a[140:143], v[32:35], v[60:63], a[140:143]
    v_mfma_f32_16x16x32_bf16 a[144:147], v[32:35], v[64:67], a[144:147]
    v_mfma_f32_16x16x32_bf16 a[148:151], v[32:35], v[68:71], a[148:151]
    v_mfma_f32_16x16x32_bf16 a[152:155], v[32:35], v[72:75], a[152:155]
    v_mfma_f32_16x16x32_bf16 a[156:159], v[32:35], v[76:79], a[156:159]
    v_mfma_f32_16x16x32_bf16 a[160:163], v[36:39], v[48:51], a[160:163]
    v_mfma_f32_16x16x32_bf16 a[164:167], v[36:39], v[52:55], a[164:167]
    v_mfma_f32_16x16x32_bf16 a[168:171], v[36:39], v[56:59], a[168:171]
    v_mfma_f32_16x16x32_bf16 a[172:175], v[36:39], v[60:63], a[172:175]
    v_mfma_f32_16x16x32_bf16 a[176:179], v[36:39], v[64:67], a[176:179]
    v_mfma_f32_16x16x32_bf16 a[180:183], v[36:39], v[68:71], a[180:183]
    v_mfma_f32_16x16x32_bf16 a[184:187], v[36:39], v[72:75], a[184:187]
    v_mfma_f32_16x16x32_bf16 a[188:191], v[36:39], v[76:79], a[188:191]
    v_mfma_f32_16x16x32_bf16 a[192:195], v[40:43], v[48:51], a[192:195]
    v_mfma_f32_16x16x32_bf16 a[196:199], v[40:43], v[52:55], a[196:199]
    v_mfma_f32_16x16x32_bf16 a[200:203], v[40:43], v[56:59], a[200:203]
    v_mfma_f32_16x16x32_bf16 a[204:207], v[40:43], v[60:63], a[204:207]
    v_mfma_f32_16x16x32_bf16 a[208:211], v[40:43], v[64:67], a[208:211]
    v_mfma_f32_16x16x32_bf16 a[212:215], v[40:43], v[68:71], a[212:215]
    v_mfma_f32_16x16x32_bf16 a[216:219], v[40:43], v[72:75], a[216:219]
    v_mfma_f32_16x16x32_bf16 a[220:223], v[40:43], v[76:79], a[220:223]
    v_mfma_f32_16x16x32_bf16 a[224:227], v[44:47], v[48:51], a[224:227]
    v_mfma_f32_16x16x32_bf16 a[228:231], v[44:47], v[52:55], a[228:231]
    v_mfma_f32_16x16x32_bf16 a[232:235], v[44:47], v[56:59], a[232:235]
    v_mfma_f32_16x16x32_bf16 a[236:239], v[44:47], v[60:63], a[236:239]
    v_mfma_f32_16x16x32_bf16 a[240:243], v[44:47], v[64:67], a[240:243]
    v_mfma_f32_16x16x32_bf16 a[244:247], v[44:47], v[68:71], a[244:247]
    v_mfma_f32_16x16x32_bf16 a[248:251], v[44:47], v[72:75], a[248:251]
    v_mfma_f32_16x16x32_bf16 a[252:255], v[44:47], v[76:79], a[252:255]
    buffer_load_dwordx4 v[16:19], v4, s[12:15], s24 offen offset:0
    buffer_load_dwordx4 v[20:23], v4, s[12:15], s24 offen offset:1024
    buffer_load_dwordx4 v[24:27], v5, s[12:15], s24 offen offset:0
    buffer_load_dwordx4 v[28:31], v5, s[12:15], s24 offen offset:1024
    buffer_load_dwordx4 v[32:35], v6, s[12:15], s24 offen offset:0
    buffer_load_dwordx4 v[36:39], v6, s[12:15], s24 offen offset:1024
    buffer_load_dwordx4 v[40:43], v7, s[12:15], s24 offen offset:0
    buffer_load_dwordx4 v[44:47], v7, s[12:15], s24 offen offset:1024
    buffer_load_dwordx4 v[48:51], v4, s[16:19], s25 offen offset:0
    buffer_load_dwordx4 v[52:55], v4, s[16:19], s25 offen offset:1024
    buffer_load_dwordx4 v[56:59], v5, s[16:19], s25 offen offset:0
    buffer_load_dwordx4 v[60:63], v5, s[16:19], s25 offen offset:1024
    buffer_load_dwordx4 v[64:67], v6, s[16:19], s25 offen offset:0
    buffer_load_dwordx4 v[68:71], v6, s[16:19], s25 offen offset:1024
    buffer_load_dwordx4 v[72:75], v7, s[16:19], s25 offen offset:0
    buffer_load_dwordx4 v[76:79], v7, s[16:19], s25 offen offset:1024
    s_add_u32 s24, s24, 0x800
    s_add_u32 s25, s25, 0x800
    s_waitcnt vmcnt(16)
    v_mfma_f32_16x16x32_bf16 a[0:3], v[80:83], v[112:115], a[0:3]
    v_mfma_f32_16x16x32_bf16 a[4:7], v[80:83], v[116:119], a[4:7]
    v_mfma_f32_16x16x32_bf16 a[8:11], v[80:83], v[120:123], a[8:11]
    v_mfma_f32_16x16x32_bf16 a[12:15], v[80:83], v[124:127], a[12:15]
    v_mfma_f32_16x16x32_bf16 a[16:19], v[80:83], v[128:131], a[16:19]
    v_mfma_f32_16x16x32_bf16 a[20:23], v[80:83], v[132:135], a[20:23]
    v_mfma_f32_16x16x32_bf16 a[24:27], v[80:83], v[136:139], a[24:27]
    v_mfma_f32_16x16x32_bf16 a[28:31], v[80:83], v[140:143], a[28:31]
    v_mfma_f32_16x16x32_bf16 a[32:35], v[84:87], v[112:115], a[32:35]
    v_mfma_f32_16x16x32_bf16 a[36:39], v[84:87], v[116:119], a[36:39]
    v_mfma_f32_16x16x32_bf16 a[40:43], v[84:87], v[120:123], a[40:43]
    v_mfma_f32_16x16x32_bf16 a[44:47], v[84:87], v[124:127], a[44:47]
    v_mfma_f32_16x16x32_bf16 a[48:51], v[84:87], v[128:131], a[48:51]
    v_mfma_f32_16x16x32_bf16 a[52:55], v[84:87], v[132:135], a[52:55]
    v_mfma_f32_16x16x32_bf16 a[56:59], v[84:87], v[136:139], a[56:59]
    v_mfma_f32_16x16x32_bf16 a[60:63], v[84:87], v[140:143], a[60:63]
    v_mfma_f32_16x16x32_bf16 a[64:67], v[88:91], v[112:115], a[64:67]
    v_mfma_f32_16x16x32_bf16 a[68:71], v[88:91], v[116:119], a[68:71]
    v_mfma_f32_16x16x32_bf16 a[72:75], v[88:91], v[120:123], a[72:75]
    v_mfma_f32_16x16x32_bf16 a[76:79], v[88:91], v[124:127], a[76:79]
    v_mfma_f32_16x16x32_bf16 a[80:83], v[88:91], v[128:131], a[80:83]
    v_mfma_f32_16x16x32_bf16 a[84:87], v[88:91], v[132:135], a[84:87]
    v_mfma_f32_16x16x32_bf16 a[88:91], v[88:91], v[136:139], a[88:91]
    v_mfma_f32_16x16x32_bf16 a[92:95], v[88:91], v[140:143], a[92:95]
    v_mfma_f32_16x16x32_bf16 a[96:99], v[92:95], v[112:115], a[96:99]
    v_mfma_f32_16x16x32_bf16 a[100:103], v[92:95], v[116:119], a[100:103]
    v_mfma_f32_16x16x32_bf16 a[104:107], v[92:95], v[120:123], a[104:107]
    v_mfma_f32_16x16x32_bf16 a[108:111], v[92:95], v[124:127], a[108:111]
    v_mfma_f32_16x16x32_bf16 a[112:115], v[92:95], v[128:131], a[112:115]
    v_mfma_f32_16x16x32_bf16 a[116:119], v[92:95], v[132:135], a[116:119]
    v_mfma_f32_16x16x32_bf16 a[120:123], v[92:95], v[136:139], a[120:123]
    v_mfma_f32_16x16x32_bf16 a[124:127], v[92:95], v[140:143], a[124:127]
    v_mfma_f32_16x16x32_bf16 a[128:131], v[96:99], v[112:115], a[128:131]
    v_mfma_f32_16x16x32_bf16 a[132:135], v[96:99], v[116:119], a[132:135]
    v_mfma_f32_16x16x32_bf16 a[136:139], v[96:99], v[120:123], a[136:139]
    v_mfma_f32_16x16x32_bf16 a[140:143], v[96:99], v[124:127], a[140:143]
    v_mfma_f32_16x16x32_bf16 a[144:147], v[96:99], v[128:131], a[144:147]
    v_mfma_f32_16x16x32_bf16 a[148:151], v[96:99], v[132:135], a[148:151]
    v_mfma_f32_16x16x32_bf16 a[152:155], v[96:99], v[136:139], a[152:155]
    v_mfma_f32_16x16x32_bf16 a[156:159], v[96:99], v[140:143], a[156:159]
    v_mfma_f32_16x16x32_bf16 a[160:163], v[100:103], v[112:115], a[160:163]
    v_mfma_f32_16x16x32_bf16 a[164:167], v[100:103], v[116:119], a[164:167]
    v_mfma_f32_16x16x32_bf16 a[168:171], v[100:103], v[120:123], a[168:171]
    v_mfma_f32_16x16x32_bf16 a[172:175], v[100:103], v[124:127], a[172:175]
    v_mfma_f32_16x16x32_bf16 a[176:179], v[100:103], v[128:131], a[176:179]
    v_mfma_f32_16x16x32_bf16 a[180:183], v[100:103], v[132:135], a[180:183]
    v_mfma_f32_16x16x32_bf16 a[184:187], v[100:103], v[136:139], a[184:187]
    v_mfma_f32_16x16x32_bf16 a[188:191], v[100:103], v[140:143], a[188:191]
    v_mfma_f32_16x16x32_bf16 a[192:195], v[104:107], v[112:115], a[192:195]
    v_mfma_f32_16x16x32_bf16 a[196:199], v[104:107], v[116:119], a[196:199]
    v_mfma_f32_16x16x32_bf16 a[200:203], v[104:107], v[120:123], a[200:203]
    v_mfma_f32_16x16x32_bf16 a[204:207], v[104:107], v[124:127], a[204:207]
    v_mfma_f32_16x16x32_bf16 a[208:211], v[104:107], v[128:131], a[208:211]
    v_mfma_f32_16x16x32_bf16 a[212:215], v[104:107], v[132:135], a[212:215]
    v_mfma_f32_16x16x32_bf16 a[216:219], v[104:107], v[136:139], a[216:219]
    v_mfma_f32_16x16x32_bf16 a[220:223], v[104:107], v[140:143], a[220:223]
    v_mfma_f32_16x16x32_bf16 a[224:227], v[108:111], v[112:115], a[224:227]
    v_mfma_f32_16x16x32_bf16 a[228:231], v[108:111], v[116:119], a[228:231]
    v_mfma_f32_16x16x32_bf16 a[232:235], v[108:111], v[120:123], a[232:235]
    v_mfma_f32_16x16x32_bf16 a[236:239], v[108:111], v[124:127], a[236:239]
    v_mfma_f32_16x16x32_bf16 a[240:243], v[108:111], v[128:131], a[240:243]
    v_mfma_f32_16x16x32_bf16 a[244:247], v[108:111], v[132:135], a[244:247]
    v_mfma_f32_16x16x32_bf16 a[248:251], v[108:111], v[136:139], a[248:251]
    v_mfma_f32_16x16x32_bf16 a[252:255], v[108:111], v[140:143], a[252:255]
    buffer_load_dwordx4 v[80:83], v4, s[12:15], s24 offen offset:0
    buffer_load_dwordx4 v[84:87], v4, s[12:15], s24 offen offset:1024
    buffer_load_dwordx4 v[88:91], v5, s[12:15], s24 offen offset:0
    buffer_load_dwordx4 v[92:95], v5, s[12:15], s24 offen offset:1024
    buffer_load_dwordx4 v[96:99], v6, s[12:15], s24 offen offset:0
    buffer_load_dwordx4 v[100:103], v6, s[12:15], s24 offen offset:1024
    buffer_load_dwordx4 v[104:107], v7, s[12:15], s24 offen offset:0
    buffer_load_dwordx4 v[108:111], v7, s[12:15], s24 offen offset:1024
    buffer_load_dwordx4 v[112:115], v4, s[16:19], s25 offen offset:0
    buffer_load_dwordx4 v[116:119], v4, s[16:19], s25 offen offset:1024
    buffer_load_dwordx4 v[120:123], v5, s[16:19], s25 offen offset:0
    buffer_load_dwordx4 v[124:127], v5, s[16:19], s25 offen offset:1024
    buffer_load_dwordx4 v[128:131], v6, s[16:19], s25 offen offset:0
    buffer_load_dwordx4 v[132:135], v6, s[16:19], s25 offen offset:1024
    buffer_load_dwordx4 v[136:139], v7, s[16:19], s25 offen offset:0
    buffer_load_dwordx4 v[140:143], v7, s[16:19], s25 offen offset:1024
    s_add_u32 s24, s24, 0x800
    s_add_u32 s25, s25, 0x800
    s_waitcnt vmcnt(16)
    v_mfma_f32_16x16x32_bf16 a[0:3], v[16:19], v[48:51], a[0:3]
    v_mfma_f32_16x16x32_bf16 a[4:7], v[16:19], v[52:55], a[4:7]
    v_mfma_f32_16x16x32_bf16 a[8:11], v[16:19], v[56:59], a[8:11]
    v_mfma_f32_16x16x32_bf16 a[12:15], v[16:19], v[60:63], a[12:15]
    v_mfma_f32_16x16x32_bf16 a[16:19], v[16:19], v[64:67], a[16:19]
    v_mfma_f32_16x16x32_bf16 a[20:23], v[16:19], v[68:71], a[20:23]
    v_mfma_f32_16x16x32_bf16 a[24:27], v[16:19], v[72:75], a[24:27]
    v_mfma_f32_16x16x32_bf16 a[28:31], v[16:19], v[76:79], a[28:31]
    v_mfma_f32_16x16x32_bf16 a[32:35], v[20:23], v[48:51], a[32:35]
    v_mfma_f32_16x16x32_bf16 a[36:39], v[20:23], v[52:55], a[36:39]
    v_mfma_f32_16x16x32_bf16 a[40:43], v[20:23], v[56:59], a[40:43]
    v_mfma_f32_16x16x32_bf16 a[44:47], v[20:23], v[60:63], a[44:47]
    v_mfma_f32_16x16x32_bf16 a[48:51], v[20:23], v[64:67], a[48:51]
    v_mfma_f32_16x16x32_bf16 a[52:55], v[20:23], v[68:71], a[52:55]
    v_mfma_f32_16x16x32_bf16 a[56:59], v[20:23], v[72:75], a[56:59]
    v_mfma_f32_16x16x32_bf16 a[60:63], v[20:23], v[76:79], a[60:63]
    v_mfma_f32_16x16x32_bf16 a[64:67], v[24:27], v[48:51], a[64:67]
    v_mfma_f32_16x16x32_bf16 a[68:71], v[24:27], v[52:55], a[68:71]
    v_mfma_f32_16x16x32_bf16 a[72:75], v[24:27], v[56:59], a[72:75]
    v_mfma_f32_16x16x32_bf16 a[76:79], v[24:27], v[60:63], a[76:79]
    v_mfma_f32_16x16x32_bf16 a[80:83], v[24:27], v[64:67], a[80:83]
    v_mfma_f32_16x16x32_bf16 a[84:87], v[24:27], v[68:71], a[84:87]
    v_mfma_f32_16x16x32_bf16 a[88:91], v[24:27], v[72:75], a[88:91]
    v_mfma_f32_16x16x32_bf16 a[92:95], v[24:27], v[76:79], a[92:95]
    v_mfma_f32_16x16x32_bf16 a[96:99], v[28:31], v[48:51], a[96:99]
    v_mfma_f32_16x16x32_bf16 a[100:103], v[28:31], v[52:55], a[100:103]
    v_mfma_f32_16x16x32_bf16 a[104:107], v[28:31], v[56:59], a[104:107]
    v_mfma_f32_16x16x32_bf16 a[108:111], v[28:31], v[60:63], a[108:111]
    v_mfma_f32_16x16x32_bf16 a[112:115], v[28:31], v[64:67], a[112:115]
    v_mfma_f32_16x16x32_bf16 a[116:119], v[28:31], v[68:71], a[116:119]
    v_mfma_f32_16x16x32_bf16 a[120:123], v[28:31], v[72:75], a[120:123]
    v_mfma_f32_16x16x32_bf16 a[124:127], v[28:31], v[76:79], a[124:127]
    v_mfma_f32_16x16x32_bf16 a[128:131], v[32:35], v[48:51], a[128:131]
    v_mfma_f32_16x16x32_bf16 a[132:135], v[32:35], v[52:55], a[132:135]
    v_mfma_f32_16x16x32_bf16 a[136:139], v[32:35], v[56:59], a[136:139]
    v_mfma_f32_16x16x32_bf16 a[140:143], v[32:35], v[60:63], a[140:143]
    v_mfma_f32_16x16x32_bf16 a[144:147], v[32:35], v[64:67], a[144:147]
    v_mfma_f32_16x16x32_bf16 a[148:151], v[32:35], v[68:71], a[148:151]
    v_mfma_f32_16x16x32_bf16 a[152:155], v[32:35], v[72:75], a[152:155]
    v_mfma_f32_16x16x32_bf16 a[156:159], v[32:35], v[76:79], a[156:159]
    v_mfma_f32_16x16x32_bf16 a[160:163], v[36:39], v[48:51], a[160:163]
    v_mfma_f32_16x16x32_bf16 a[164:167], v[36:39], v[52:55], a[164:167]
    v_mfma_f32_16x16x32_bf16 a[168:171], v[36:39], v[56:59], a[168:171]
    v_mfma_f32_16x16x32_bf16 a[172:175], v[36:39], v[60:63], a[172:175]
    v_mfma_f32_16x16x32_bf16 a[176:179], v[36:39], v[64:67], a[176:179]
    v_mfma_f32_16x16x32_bf16 a[180:183], v[36:39], v[68:71], a[180:183]
    v_mfma_f32_16x16x32_bf16 a[184:187], v[36:39], v[72:75], a[184:187]
    v_mfma_f32_16x16x32_bf16 a[188:191], v[36:39], v[76:79], a[188:191]
    v_mfma_f32_16x16x32_bf16 a[192:195], v[40:43], v[48:51], a[192:195]
    v_mfma_f32_16x16x32_bf16 a[196:199], v[40:43], v[52:55], a[196:199]
    v_mfma_f32_16x16x32_bf16 a[200:203], v[40:43], v[56:59], a[200:203]
    v_mfma_f32_16x16x32_bf16 a[204:207], v[40:43], v[60:63], a[204:207]
    v_mfma_f32_16x16x32_bf16 a[208:211], v[40:43], v[64:67], a[208:211]
    v_mfma_f32_16x16x32_bf16 a[212:215], v[40:43], v[68:71], a[212:215]
    v_mfma_f32_16x16x32_bf16 a[216:219], v[40:43], v[72:75], a[216:219]
    v_mfma_f32_16x16x32_bf16 a[220:223], v[40:43], v[76:79], a[220:223]
    v_mfma_f32_16x16x32_bf16 a[224:227], v[44:47], v[48:51], a[224:227]
    v_mfma_f32_16x16x32_bf16 a[228:231], v[44:47], v[52:55], a[228:231]
    v_mfma_f32_16x16x32_bf16 a[232:235], v[44:47], v[56:59], a[232:235]
    v_mfma_f32_16x16x32_bf16 a[236:239], v[44:47], v[60:63], a[236:239]
    v_mfma_f32_16x16x32_bf16 a[240:243], v[44:47], v[64:67], a[240:243]
    v_mfma_f32_16x16x32_bf16 a[244:247], v[44:47], v[68:71], a[244:247]
    v_mfma_f32_16x16x32_bf16 a[248:251], v[44:47], v[72:75], a[248:251]
    v_mfma_f32_16x16x32_bf16 a[252:255], v[44:47], v[76:79], a[252:255]
    buffer_load_dwordx4 v[16:19], v4, s[12:15], s24 offen offset:0
    buffer_load_dwordx4 v[20:23], v4, s[12:15], s24 offen offset:1024
    buffer_load_dwordx4 v[24:27], v5, s[12:15], s24 offen offset:0
    buffer_load_dwordx4 v[28:31], v5, s[12:15], s24 offen offset:1024
    buffer_load_dwordx4 v[32:35], v6, s[12:15], s24 offen offset:0
    buffer_load_dwordx4 v[36:39], v6, s[12:15], s24 offen offset:1024
    buffer_load_dwordx4 v[40:43], v7, s[12:15], s24 offen offset:0
    buffer_load_dwordx4 v[44:47], v7, s[12:15], s24 offen offset:1024
    buffer_load_dwordx4 v[48:51], v4, s[16:19], s25 offen offset:0
    buffer_load_dwordx4 v[52:55], v4, s[16:19], s25 offen offset:1024
    buffer_load_dwordx4 v[56:59], v5, s[16:19], s25 offen offset:0
    buffer_load_dwordx4 v[60:63], v5, s[16:19], s25 offen offset:1024
    buffer_load_dwordx4 v[64:67], v6, s[16:19], s25 offen offset:0
    buffer_load_dwordx4 v[68:71], v6, s[16:19], s25 offen offset:1024
    buffer_load_dwordx4 v[72:75], v7, s[16:19], s25 offen offset:0
    buffer_load_dwordx4 v[76:79], v7, s[16:19], s25 offen offset:1024
    s_add_u32 s24, s24, 0x800
    s_add_u32 s25, s25, 0x800
    s_waitcnt vmcnt(16)
    v_mfma_f32_16x16x32_bf16 a[0:3], v[80:83], v[112:115], a[0:3]
    v_mfma_f32_16x16x32_bf16 a[4:7], v[80:83], v[116:119], a[4:7]
    v_mfma_f32_16x16x32_bf16 a[8:11], v[80:83], v[120:123], a[8:11]
    v_mfma_f32_16x16x32_bf16 a[12:15], v[80:83], v[124:127], a[12:15]
    v_mfma_f32_16x16x32_bf16 a[16:19], v[80:83], v[128:131], a[16:19]
    v_mfma_f32_16x16x32_bf16 a[20:23], v[80:83], v[132:135], a[20:23]
    v_mfma_f32_16x16x32_bf16 a[24:27], v[80:83], v[136:139], a[24:27]
    v_mfma_f32_16x16x32_bf16 a[28:31], v[80:83], v[140:143], a[28:31]
    v_mfma_f32_16x16x32_bf16 a[32:35], v[84:87], v[112:115], a[32:35]
    v_mfma_f32_16x16x32_bf16 a[36:39], v[84:87], v[116:119], a[36:39]
    v_mfma_f32_16x16x32_bf16 a[40:43], v[84:87], v[120:123], a[40:43]
    v_mfma_f32_16x16x32_bf16 a[44:47], v[84:87], v[124:127], a[44:47]
    v_mfma_f32_16x16x32_bf16 a[48:51], v[84:87], v[128:131], a[48:51]
    v_mfma_f32_16x16x32_bf16 a[52:55], v[84:87], v[132:135], a[52:55]
    v_mfma_f32_16x16x32_bf16 a[56:59], v[84:87], v[136:139], a[56:59]
    v_mfma_f32_16x16x32_bf16 a[60:63], v[84:87], v[140:143], a[60:63]
    v_mfma_f32_16x16x32_bf16 a[64:67], v[88:91], v[112:115], a[64:67]
    v_mfma_f32_16x16x32_bf16 a[68:71], v[88:91], v[116:119], a[68:71]
    v_mfma_f32_16x16x32_bf16 a[72:75], v[88:91], v[120:123], a[72:75]
    v_mfma_f32_16x16x32_bf16 a[76:79], v[88:91], v[124:127], a[76:79]
    v_mfma_f32_16x16x32_bf16 a[80:83], v[88:91], v[128:131], a[80:83]
    v_mfma_f32_16x16x32_bf16 a[84:87], v[88:91], v[132:135], a[84:87]
    v_mfma_f32_16x16x32_bf16 a[88:91], v[88:91], v[136:139], a[88:91]
    v_mfma_f32_16x16x32_bf16 a[92:95], v[88:91], v[140:143], a[92:95]
    v_mfma_f32_16x16x32_bf16 a[96:99], v[92:95], v[112:115], a[96:99]
    v_mfma_f32_16x16x32_bf16 a[100:103], v[92:95], v[116:119], a[100:103]
    v_mfma_f32_16x16x32_bf16 a[104:107], v[92:95], v[120:123], a[104:107]
    v_mfma_f32_16x16x32_bf16 a[108:111], v[92:95], v[124:127], a[108:111]
    v_mfma_f32_16x16x32_bf16 a[112:115], v[92:95], v[128:131], a[112:115]
    v_mfma_f32_16x16x32_bf16 a[116:119], v[92:95], v[132:135], a[116:119]
    v_mfma_f32_16x16x32_bf16 a[120:123], v[92:95], v[136:139], a[120:123]
    v_mfma_f32_16x16x32_bf16 a[124:127], v[92:95], v[140:143], a[124:127]
    v_mfma_f32_16x16x32_bf16 a[128:131], v[96:99], v[112:115], a[128:131]
    v_mfma_f32_16x16x32_bf16 a[132:135], v[96:99], v[116:119], a[132:135]
    v_mfma_f32_16x16x32_bf16 a[136:139], v[96:99], v[120:123], a[136:139]
    v_mfma_f32_16x16x32_bf16 a[140:143], v[96:99], v[124:127], a[140:143]
    v_mfma_f32_16x16x32_bf16 a[144:147], v[96:99], v[128:131], a[144:147]
    v_mfma_f32_16x16x32_bf16 a[148:151], v[96:99], v[132:135], a[148:151]
    v_mfma_f32_16x16x32_bf16 a[152:155], v[96:99], v[136:139], a[152:155]
    v_mfma_f32_16x16x32_bf16 a[156:159], v[96:99], v[140:143], a[156:159]
    v_mfma_f32_16x16x32_bf16 a[160:163], v[100:103], v[112:115], a[160:163]
    v_mfma_f32_16x16x32_bf16 a[164:167], v[100:103], v[116:119], a[164:167]
    v_mfma_f32_16x16x32_bf16 a[168:171], v[100:103], v[120:123], a[168:171]
    v_mfma_f32_16x16x32_bf16 a[172:175], v[100:103], v[124:127], a[172:175]
    v_mfma_f32_16x16x32_bf16 a[176:179], v[100:103], v[128:131], a[176:179]
    v_mfma_f32_16x16x32_bf16 a[180:183], v[100:103], v[132:135], a[180:183]
    v_mfma_f32_16x16x32_bf16 a[184:187], v[100:103], v[136:139], a[184:187]
    v_mfma_f32_16x16x32_bf16 a[188:191], v[100:103], v[140:143], a[188:191]
    v_mfma_f32_16x16x32_bf16 a[192:195], v[104:107], v[112:115], a[192:195]
    v_mfma_f32_16x16x32_bf16 a[196:199], v[104:107], v[116:119], a[196:199]
    v_mfma_f32_16x16x32_bf16 a[200:203], v[104:107], v[120:123], a[200:203]
    v_mfma_f32_16x16x32_bf16 a[204:207], v[104:107], v[124:127], a[204:207]
    v_mfma_f32_16x16x32_bf16 a[208:211], v[104:107], v[128:131], a[208:211]
    v_mfma_f32_16x16x32_bf16 a[212:215], v[104:107], v[132:135], a[212:215]
    v_mfma_f32_16x16x32_bf16 a[216:219], v[104:107], v[136:139], a[216:219]
    v_mfma_f32_16x16x32_bf16 a[220:223], v[104:107], v[140:143], a[220:223]
    v_mfma_f32_16x16x32_bf16 a[224:227], v[108:111], v[112:115], a[224:227]
    v_mfma_f32_16x16x32_bf16 a[228:231], v[108:111], v[116:119], a[228:231]
    v_mfma_f32_16x16x32_bf16 a[232:235], v[108:111], v[120:123], a[232:235]
    v_mfma_f32_16x16x32_bf16 a[236:239], v[108:111], v[124:127], a[236:239]
    v_mfma_f32_16x16x32_bf16 a[240:243], v[108:111], v[128:131], a[240:243]
    v_mfma_f32_16x16x32_bf16 a[244:247], v[108:111], v[132:135], a[244:247]
    v_mfma_f32_16x16x32_bf16 a[248:251], v[108:111], v[136:139], a[248:251]
    v_mfma_f32_16x16x32_bf16 a[252:255], v[108:111], v[140:143], a[252:255]
    buffer_load_dwordx4 v[80:83], v4, s[12:15], s24 offen offset:0
    buffer_load_dwordx4 v[84:87], v4, s[12:15], s24 offen offset:1024
    buffer_load_dwordx4 v[88:91], v5, s[12:15], s24 offen offset:0
    buffer_load_dwordx4 v[92:95], v5, s[12:15], s24 offen offset:1024
    buffer_load_dwordx4 v[96:99], v6, s[12:15], s24 offen offset:0
    buffer_load_dwordx4 v[100:103], v6, s[12:15], s24 offen offset:1024
    buffer_load_dwordx4 v[104:107], v7, s[12:15], s24 offen offset:0
    buffer_load_dwordx4 v[108:111], v7, s[12:15], s24 offen offset:1024
    buffer_load_dwordx4 v[112:115], v4, s[16:19], s25 offen offset:0
    buffer_load_dwordx4 v[116:119], v4, s[16:19], s25 offen offset:1024
    buffer_load_dwordx4 v[120:123], v5, s[16:19], s25 offen offset:0
    buffer_load_dwordx4 v[124:127], v5, s[16:19], s25 offen offset:1024
    buffer_load_dwordx4 v[128:131], v6, s[16:19], s25 offen offset:0
    buffer_load_dwordx4 v[132:135], v6, s[16:19], s25 offen offset:1024
    buffer_load_dwordx4 v[136:139], v7, s[16:19], s25 offen offset:0
    buffer_load_dwordx4 v[140:143], v7, s[16:19], s25 offen offset:1024
    s_add_u32 s24, s24, 0x800
    s_add_u32 s25, s25, 0x800
    s_waitcnt vmcnt(16)
    v_mfma_f32_16x16x32_bf16 a[0:3], v[16:19], v[48:51], a[0:3]
    v_mfma_f32_16x16x32_bf16 a[4:7], v[16:19], v[52:55], a[4:7]
    v_mfma_f32_16x16x32_bf16 a[8:11], v[16:19], v[56:59], a[8:11]
    v_mfma_f32_16x16x32_bf16 a[12:15], v[16:19], v[60:63], a[12:15]
    v_mfma_f32_16x16x32_bf16 a[16:19], v[16:19], v[64:67], a[16:19]
    v_mfma_f32_16x16x32_bf16 a[20:23], v[16:19], v[68:71], a[20:23]
    v_mfma_f32_16x16x32_bf16 a[24:27], v[16:19], v[72:75], a[24:27]
    v_mfma_f32_16x16x32_bf16 a[28:31], v[16:19], v[76:79], a[28:31]
    v_mfma_f32_16x16x32_bf16 a[32:35], v[20:23], v[48:51], a[32:35]
    v_mfma_f32_16x16x32_bf16 a[36:39], v[20:23], v[52:55], a[36:39]
    v_mfma_f32_16x16x32_bf16 a[40:43], v[20:23], v[56:59], a[40:43]
    v_mfma_f32_16x16x32_bf16 a[44:47], v[20:23], v[60:63], a[44:47]
    v_mfma_f32_16x16x32_bf16 a[48:51], v[20:23], v[64:67], a[48:51]
    v_mfma_f32_16x16x32_bf16 a[52:55], v[20:23], v[68:71], a[52:55]
    v_mfma_f32_16x16x32_bf16 a[56:59], v[20:23], v[72:75], a[56:59]
    v_mfma_f32_16x16x32_bf16 a[60:63], v[20:23], v[76:79], a[60:63]
    v_mfma_f32_16x16x32_bf16 a[64:67], v[24:27], v[48:51], a[64:67]
    v_mfma_f32_16x16x32_bf16 a[68:71], v[24:27], v[52:55], a[68:71]
    v_mfma_f32_16x16x32_bf16 a[72:75], v[24:27], v[56:59], a[72:75]
    v_mfma_f32_16x16x32_bf16 a[76:79], v[24:27], v[60:63], a[76:79]
    v_mfma_f32_16x16x32_bf16 a[80:83], v[24:27], v[64:67], a[80:83]
    v_mfma_f32_16x16x32_bf16 a[84:87], v[24:27], v[68:71], a[84:87]
    v_mfma_f32_16x16x32_bf16 a[88:91], v[24:27], v[72:75], a[88:91]
    v_mfma_f32_16x16x32_bf16 a[92:95], v[24:27], v[76:79], a[92:95]
    v_mfma_f32_16x16x32_bf16 a[96:99], v[28:31], v[48:51], a[96:99]
    v_mfma_f32_16x16x32_bf16 a[100:103], v[28:31], v[52:55], a[100:103]
    v_mfma_f32_16x16x32_bf16 a[104:107], v[28:31], v[56:59], a[104:107]
    v_mfma_f32_16x16x32_bf16 a[108:111], v[28:31], v[60:63], a[108:111]
    v_mfma_f32_16x16x32_bf16 a[112:115], v[28:31], v[64:67], a[112:115]
    v_mfma_f32_16x16x32_bf16 a[116:119], v[28:31], v[68:71], a[116:119]
    v_mfma_f32_16x16x32_bf16 a[120:123], v[28:31], v[72:75], a[120:123]
    v_mfma_f32_16x16x32_bf16 a[124:127], v[28:31], v[76:79], a[124:127]
    v_mfma_f32_16x16x32_bf16 a[128:131], v[32:35], v[48:51], a[128:131]
    v_mfma_f32_16x16x32_bf16 a[132:135], v[32:35], v[52:55], a[132:135]
    v_mfma_f32_16x16x32_bf16 a[136:139], v[32:35], v[56:59], a[136:139]
    v_mfma_f32_16x16x32_bf16 a[140:143], v[32:35], v[60:63], a[140:143]
    v_mfma_f32_16x16x32_bf16 a[144:147], v[32:35], v[64:67], a[144:147]
    v_mfma_f32_16x16x32_bf16 a[148:151], v[32:35], v[68:71], a[148:151]
    v_mfma_f32_16x16x32_bf16 a[152:155], v[32:35], v[72:75], a[152:155]
    v_mfma_f32_16x16x32_bf16 a[156:159], v[32:35], v[76:79], a[156:159]
    v_mfma_f32_16x16x32_bf16 a[160:163], v[36:39], v[48:51], a[160:163]
    v_mfma_f32_16x16x32_bf16 a[164:167], v[36:39], v[52:55], a[164:167]
    v_mfma_f32_16x16x32_bf16 a[168:171], v[36:39], v[56:59], a[168:171]
    v_mfma_f32_16x16x32_bf16 a[172:175], v[36:39], v[60:63], a[172:175]
    v_mfma_f32_16x16x32_bf16 a[176:179], v[36:39], v[64:67], a[176:179]
    v_mfma_f32_16x16x32_bf16 a[180:183], v[36:39], v[68:71], a[180:183]
    v_mfma_f32_16x16x32_bf16 a[184:187], v[36:39], v[72:75], a[184:187]
    v_mfma_f32_16x16x32_bf16 a[188:191], v[36:39], v[76:79], a[188:191]
    v_mfma_f32_16x16x32_bf16 a[192:195], v[40:43], v[48:51], a[192:195]
    v_mfma_f32_16x16x32_bf16 a[196:199], v[40:43], v[52:55], a[196:199]
    v_mfma_f32_16x16x32_bf16 a[200:203], v[40:43], v[56:59], a[200:203]
    v_mfma_f32_16x16x32_bf16 a[204:207], v[40:43], v[60:63], a[204:207]
    v_mfma_f32_16x16x32_bf16 a[208:211], v[40:43], v[64:67], a[208:211]
    v_mfma_f32_16x16x32_bf16 a[212:215], v[40:43], v[68:71], a[212:215]
    v_mfma_f32_16x16x32_bf16 a[216:219], v[40:43], v[72:75], a[216:219]
    v_mfma_f32_16x16x32_bf16 a[220:223], v[40:43], v[76:79], a[220:223]
    v_mfma_f32_16x16x32_bf16 a[224:227], v[44:47], v[48:51], a[224:227]
    v_mfma_f32_16x16x32_bf16 a[228:231], v[44:47], v[52:55], a[228:231]
    v_mfma_f32_16x16x32_bf16 a[232:235], v[44:47], v[56:59], a[232:235]
    v_mfma_f32_16x16x32_bf16 a[236:239], v[44:47], v[60:63], a[236:239]
    v_mfma_f32_16x16x32_bf16 a[240:243], v[44:47], v[64:67], a[240:243]
    v_mfma_f32_16x16x32_bf16 a[244:247], v[44:47], v[68:71], a[244:247]
    v_mfma_f32_16x16x32_bf16 a[248:251], v[44:47], v[72:75], a[248:251]
    v_mfma_f32_16x16x32_bf16 a[252:255], v[44:47], v[76:79], a[252:255]
    buffer_load_dwordx4 v[16:19], v4, s[12:15], s24 offen offset:0
    buffer_load_dwordx4 v[20:23], v4, s[12:15], s24 offen offset:1024
    buffer_load_dwordx4 v[24:27], v5, s[12:15], s24 offen offset:0
    buffer_load_dwordx4 v[28:31], v5, s[12:15], s24 offen offset:1024
    buffer_load_dwordx4 v[32:35], v6, s[12:15], s24 offen offset:0
    buffer_load_dwordx4 v[36:39], v6, s[12:15], s24 offen offset:1024
    buffer_load_dwordx4 v[40:43], v7, s[12:15], s24 offen offset:0
    buffer_load_dwordx4 v[44:47], v7, s[12:15], s24 offen offset:1024
    buffer_load_dwordx4 v[48:51], v4, s[16:19], s25 offen offset:0
    buffer_load_dwordx4 v[52:55], v4, s[16:19], s25 offen offset:1024
    buffer_load_dwordx4 v[56:59], v5, s[16:19], s25 offen offset:0
    buffer_load_dwordx4 v[60:63], v5, s[16:19], s25 offen offset:1024
    buffer_load_dwordx4 v[64:67], v6, s[16:19], s25 offen offset:0
    buffer_load_dwordx4 v[68:71], v6, s[16:19], s25 offen offset:1024
    buffer_load_dwordx4 v[72:75], v7, s[16:19], s25 offen offset:0
    buffer_load_dwordx4 v[76:79], v7, s[16:19], s25 offen offset:1024
    s_add_u32 s24, s24, 0x800
    s_add_u32 s25, s25, 0x800
    s_waitcnt vmcnt(16)
    v_mfma_f32_16x16x32_bf16 a[0:3], v[80:83], v[112:115], a[0:3]
    v_mfma_f32_16x16x32_bf16 a[4:7], v[80:83], v[116:119], a[4:7]
    v_mfma_f32_16x16x32_bf16 a[8:11], v[80:83], v[120:123], a[8:11]
    v_mfma_f32_16x16x32_bf16 a[12:15], v[80:83], v[124:127], a[12:15]
    v_mfma_f32_16x16x32_bf16 a[16:19], v[80:83], v[128:131], a[16:19]
    v_mfma_f32_16x16x32_bf16 a[20:23], v[80:83], v[132:135], a[20:23]
    v_mfma_f32_16x16x32_bf16 a[24:27], v[80:83], v[136:139], a[24:27]
    v_mfma_f32_16x16x32_bf16 a[28:31], v[80:83], v[140:143], a[28:31]
    v_mfma_f32_16x16x32_bf16 a[32:35], v[84:87], v[112:115], a[32:35]
    v_mfma_f32_16x16x32_bf16 a[36:39], v[84:87], v[116:119], a[36:39]
    v_mfma_f32_16x16x32_bf16 a[40:43], v[84:87], v[120:123], a[40:43]
    v_mfma_f32_16x16x32_bf16 a[44:47], v[84:87], v[124:127], a[44:47]
    v_mfma_f32_16x16x32_bf16 a[48:51], v[84:87], v[128:131], a[48:51]
    v_mfma_f32_16x16x32_bf16 a[52:55], v[84:87], v[132:135], a[52:55]
    v_mfma_f32_16x16x32_bf16 a[56:59], v[84:87], v[136:139], a[56:59]
    v_mfma_f32_16x16x32_bf16 a[60:63], v[84:87], v[140:143], a[60:63]
    v_mfma_f32_16x16x32_bf16 a[64:67], v[88:91], v[112:115], a[64:67]
    v_mfma_f32_16x16x32_bf16 a[68:71], v[88:91], v[116:119], a[68:71]
    v_mfma_f32_16x16x32_bf16 a[72:75], v[88:91], v[120:123], a[72:75]
    v_mfma_f32_16x16x32_bf16 a[76:79], v[88:91], v[124:127], a[76:79]
    v_mfma_f32_16x16x32_bf16 a[80:83], v[88:91], v[128:131], a[80:83]
    v_mfma_f32_16x16x32_bf16 a[84:87], v[88:91], v[132:135], a[84:87]
    v_mfma_f32_16x16x32_bf16 a[88:91], v[88:91], v[136:139], a[88:91]
    v_mfma_f32_16x16x32_bf16 a[92:95], v[88:91], v[140:143], a[92:95]
    v_mfma_f32_16x16x32_bf16 a[96:99], v[92:95], v[112:115], a[96:99]
    v_mfma_f32_16x16x32_bf16 a[100:103], v[92:95], v[116:119], a[100:103]
    v_mfma_f32_16x16x32_bf16 a[104:107], v[92:95], v[120:123], a[104:107]
    v_mfma_f32_16x16x32_bf16 a[108:111], v[92:95], v[124:127], a[108:111]
    v_mfma_f32_16x16x32_bf16 a[112:115], v[92:95], v[128:131], a[112:115]
    v_mfma_f32_16x16x32_bf16 a[116:119], v[92:95], v[132:135], a[116:119]
    v_mfma_f32_16x16x32_bf16 a[120:123], v[92:95], v[136:139], a[120:123]
    v_mfma_f32_16x16x32_bf16 a[124:127], v[92:95], v[140:143], a[124:127]
    v_mfma_f32_16x16x32_bf16 a[128:131], v[96:99], v[112:115], a[128:131]
    v_mfma_f32_16x16x32_bf16 a[132:135], v[96:99], v[116:119], a[132:135]
    v_mfma_f32_16x16x32_bf16 a[136:139], v[96:99], v[120:123], a[136:139]
    v_mfma_f32_16x16x32_bf16 a[140:143], v[96:99], v[124:127], a[140:143]
    v_mfma_f32_16x16x32_bf16 a[144:147], v[96:99], v[128:131], a[144:147]
    v_mfma_f32_16x16x32_bf16 a[148:151], v[96:99], v[132:135], a[148:151]
    v_mfma_f32_16x16x32_bf16 a[152:155], v[96:99], v[136:139], a[152:155]
    v_mfma_f32_16x16x32_bf16 a[156:159], v[96:99], v[140:143], a[156:159]
    v_mfma_f32_16x16x32_bf16 a[160:163], v[100:103], v[112:115], a[160:163]
    v_mfma_f32_16x16x32_bf16 a[164:167], v[100:103], v[116:119], a[164:167]
    v_mfma_f32_16x16x32_bf16 a[168:171], v[100:103], v[120:123], a[168:171]
    v_mfma_f32_16x16x32_bf16 a[172:175], v[100:103], v[124:127], a[172:175]
    v_mfma_f32_16x16x32_bf16 a[176:179], v[100:103], v[128:131], a[176:179]
    v_mfma_f32_16x16x32_bf16 a[180:183], v[100:103], v[132:135], a[180:183]
    v_mfma_f32_16x16x32_bf16 a[184:187], v[100:103], v[136:139], a[184:187]
    v_mfma_f32_16x16x32_bf16 a[188:191], v[100:103], v[140:143], a[188:191]
    v_mfma_f32_16x16x32_bf16 a[192:195], v[104:107], v[112:115], a[192:195]
    v_mfma_f32_16x16x32_bf16 a[196:199], v[104:107], v[116:119], a[196:199]
    v_mfma_f32_16x16x32_bf16 a[200:203], v[104:107], v[120:123], a[200:203]
    v_mfma_f32_16x16x32_bf16 a[204:207], v[104:107], v[124:127], a[204:207]
    v_mfma_f32_16x16x32_bf16 a[208:211], v[104:107], v[128:131], a[208:211]
    v_mfma_f32_16x16x32_bf16 a[212:215], v[104:107], v[132:135], a[212:215]
    v_mfma_f32_16x16x32_bf16 a[216:219], v[104:107], v[136:139], a[216:219]
    v_mfma_f32_16x16x32_bf16 a[220:223], v[104:107], v[140:143], a[220:223]
    v_mfma_f32_16x16x32_bf16 a[224:227], v[108:111], v[112:115], a[224:227]
    v_mfma_f32_16x16x32_bf16 a[228:231], v[108:111], v[116:119], a[228:231]
    v_mfma_f32_16x16x32_bf16 a[232:235], v[108:111], v[120:123], a[232:235]
    v_mfma_f32_16x16x32_bf16 a[236:239], v[108:111], v[124:127], a[236:239]
    v_mfma_f32_16x16x32_bf16 a[240:243], v[108:111], v[128:131], a[240:243]
    v_mfma_f32_16x16x32_bf16 a[244:247], v[108:111], v[132:135], a[244:247]
    v_mfma_f32_16x16x32_bf16 a[248:251], v[108:111], v[136:139], a[248:251]
    v_mfma_f32_16x16x32_bf16 a[252:255], v[108:111], v[140:143], a[252:255]
    buffer_load_dwordx4 v[80:83], v4, s[12:15], s24 offen offset:0
    buffer_load_dwordx4 v[84:87], v4, s[12:15], s24 offen offset:1024
    buffer_load_dwordx4 v[88:91], v5, s[12:15], s24 offen offset:0
    buffer_load_dwordx4 v[92:95], v5, s[12:15], s24 offen offset:1024
    buffer_load_dwordx4 v[96:99], v6, s[12:15], s24 offen offset:0
    buffer_load_dwordx4 v[100:103], v6, s[12:15], s24 offen offset:1024
    buffer_load_dwordx4 v[104:107], v7, s[12:15], s24 offen offset:0
    buffer_load_dwordx4 v[108:111], v7, s[12:15], s24 offen offset:1024
    buffer_load_dwordx4 v[112:115], v4, s[16:19], s25 offen offset:0
    buffer_load_dwordx4 v[116:119], v4, s[16:19], s25 offen offset:1024
    buffer_load_dwordx4 v[120:123], v5, s[16:19], s25 offen offset:0
    buffer_load_dwordx4 v[124:127], v5, s[16:19], s25 offen offset:1024
    buffer_load_dwordx4 v[128:131], v6, s[16:19], s25 offen offset:0
    buffer_load_dwordx4 v[132:135], v6, s[16:19], s25 offen offset:1024
    buffer_load_dwordx4 v[136:139], v7, s[16:19], s25 offen offset:0
    buffer_load_dwordx4 v[140:143], v7, s[16:19], s25 offen offset:1024
    s_add_u32 s24, s24, 0x800
    s_add_u32 s25, s25, 0x800
    s_waitcnt vmcnt(16)
    v_mfma_f32_16x16x32_bf16 a[0:3], v[16:19], v[48:51], a[0:3]
    v_mfma_f32_16x16x32_bf16 a[4:7], v[16:19], v[52:55], a[4:7]
    v_mfma_f32_16x16x32_bf16 a[8:11], v[16:19], v[56:59], a[8:11]
    v_mfma_f32_16x16x32_bf16 a[12:15], v[16:19], v[60:63], a[12:15]
    v_mfma_f32_16x16x32_bf16 a[16:19], v[16:19], v[64:67], a[16:19]
    v_mfma_f32_16x16x32_bf16 a[20:23], v[16:19], v[68:71], a[20:23]
    v_mfma_f32_16x16x32_bf16 a[24:27], v[16:19], v[72:75], a[24:27]
    v_mfma_f32_16x16x32_bf16 a[28:31], v[16:19], v[76:79], a[28:31]
    v_mfma_f32_16x16x32_bf16 a[32:35], v[20:23], v[48:51], a[32:35]
    v_mfma_f32_16x16x32_bf16 a[36:39], v[20:23], v[52:55], a[36:39]
    v_mfma_f32_16x16x32_bf16 a[40:43], v[20:23], v[56:59], a[40:43]
    v_mfma_f32_16x16x32_bf16 a[44:47], v[20:23], v[60:63], a[44:47]
    v_mfma_f32_16x16x32_bf16 a[48:51], v[20:23], v[64:67], a[48:51]
    v_mfma_f32_16x16x32_bf16 a[52:55], v[20:23], v[68:71], a[52:55]
    v_mfma_f32_16x16x32_bf16 a[56:59], v[20:23], v[72:75], a[56:59]
    v_mfma_f32_16x16x32_bf16 a[60:63], v[20:23], v[76:79], a[60:63]
    v_mfma_f32_16x16x32_bf16 a[64:67], v[24:27], v[48:51], a[64:67]
    v_mfma_f32_16x16x32_bf16 a[68:71], v[24:27], v[52:55], a[68:71]
    v_mfma_f32_16x16x32_bf16 a[72:75], v[24:27], v[56:59], a[72:75]
    v_mfma_f32_16x16x32_bf16 a[76:79], v[24:27], v[60:63], a[76:79]
    v_mfma_f32_16x16x32_bf16 a[80:83], v[24:27], v[64:67], a[80:83]
    v_mfma_f32_16x16x32_bf16 a[84:87], v[24:27], v[68:71], a[84:87]
    v_mfma_f32_16x16x32_bf16 a[88:91], v[24:27], v[72:75], a[88:91]
    v_mfma_f32_16x16x32_bf16 a[92:95], v[24:27], v[76:79], a[92:95]
    v_mfma_f32_16x16x32_bf16 a[96:99], v[28:31], v[48:51], a[96:99]
    v_mfma_f32_16x16x32_bf16 a[100:103], v[28:31], v[52:55], a[100:103]
    v_mfma_f32_16x16x32_bf16 a[104:107], v[28:31], v[56:59], a[104:107]
    v_mfma_f32_16x16x32_bf16 a[108:111], v[28:31], v[60:63], a[108:111]
    v_mfma_f32_16x16x32_bf16 a[112:115], v[28:31], v[64:67], a[112:115]
    v_mfma_f32_16x16x32_bf16 a[116:119], v[28:31], v[68:71], a[116:119]
    v_mfma_f32_16x16x32_bf16 a[120:123], v[28:31], v[72:75], a[120:123]
    v_mfma_f32_16x16x32_bf16 a[124:127], v[28:31], v[76:79], a[124:127]
    v_mfma_f32_16x16x32_bf16 a[128:131], v[32:35], v[48:51], a[128:131]
    v_mfma_f32_16x16x32_bf16 a[132:135], v[32:35], v[52:55], a[132:135]
    v_mfma_f32_16x16x32_bf16 a[136:139], v[32:35], v[56:59], a[136:139]
    v_mfma_f32_16x16x32_bf16 a[140:143], v[32:35], v[60:63], a[140:143]
    v_mfma_f32_16x16x32_bf16 a[144:147], v[32:35], v[64:67], a[144:147]
    v_mfma_f32_16x16x32_bf16 a[148:151], v[32:35], v[68:71], a[148:151]
    v_mfma_f32_16x16x32_bf16 a[152:155], v[32:35], v[72:75], a[152:155]
    v_mfma_f32_16x16x32_bf16 a[156:159], v[32:35], v[76:79], a[156:159]
    v_mfma_f32_16x16x32_bf16 a[160:163], v[36:39], v[48:51], a[160:163]
    v_mfma_f32_16x16x32_bf16 a[164:167], v[36:39], v[52:55], a[164:167]
    v_mfma_f32_16x16x32_bf16 a[168:171], v[36:39], v[56:59], a[168:171]
    v_mfma_f32_16x16x32_bf16 a[172:175], v[36:39], v[60:63], a[172:175]
    v_mfma_f32_16x16x32_bf16 a[176:179], v[36:39], v[64:67], a[176:179]
    v_mfma_f32_16x16x32_bf16 a[180:183], v[36:39], v[68:71], a[180:183]
    v_mfma_f32_16x16x32_bf16 a[184:187], v[36:39], v[72:75], a[184:187]
    v_mfma_f32_16x16x32_bf16 a[188:191], v[36:39], v[76:79], a[188:191]
    v_mfma_f32_16x16x32_bf16 a[192:195], v[40:43], v[48:51], a[192:195]
    v_mfma_f32_16x16x32_bf16 a[196:199], v[40:43], v[52:55], a[196:199]
    v_mfma_f32_16x16x32_bf16 a[200:203], v[40:43], v[56:59], a[200:203]
    v_mfma_f32_16x16x32_bf16 a[204:207], v[40:43], v[60:63], a[204:207]
    v_mfma_f32_16x16x32_bf16 a[208:211], v[40:43], v[64:67], a[208:211]
    v_mfma_f32_16x16x32_bf16 a[212:215], v[40:43], v[68:71], a[212:215]
    v_mfma_f32_16x16x32_bf16 a[216:219], v[40:43], v[72:75], a[216:219]
    v_mfma_f32_16x16x32_bf16 a[220:223], v[40:43], v[76:79], a[220:223]
    v_mfma_f32_16x16x32_bf16 a[224:227], v[44:47], v[48:51], a[224:227]
    v_mfma_f32_16x16x32_bf16 a[228:231], v[44:47], v[52:55], a[228:231]
    v_mfma_f32_16x16x32_bf16 a[232:235], v[44:47], v[56:59], a[232:235]
    v_mfma_f32_16x16x32_bf16 a[236:239], v[44:47], v[60:63], a[236:239]
    v_mfma_f32_16x16x32_bf16 a[240:243], v[44:47], v[64:67], a[240:243]
    v_mfma_f32_16x16x32_bf16 a[244:247], v[44:47], v[68:71], a[244:247]
    v_mfma_f32_16x16x32_bf16 a[248:251], v[44:47], v[72:75], a[248:251]
    v_mfma_f32_16x16x32_bf16 a[252:255], v[44:47], v[76:79], a[252:255]
    s_waitcnt vmcnt(0)
    v_mfma_f32_16x16x32_bf16 a[0:3], v[80:83], v[112:115], a[0:3]
    v_mfma_f32_16x16x32_bf16 a[4:7], v[80:83], v[116:119], a[4:7]
    v_mfma_f32_16x16x32_bf16 a[8:11], v[80:83], v[120:123], a[8:11]
    v_mfma_f32_16x16x32_bf16 a[12:15], v[80:83], v[124:127], a[12:15]
    v_mfma_f32_16x16x32_bf16 a[16:19], v[80:83], v[128:131], a[16:19]
    v_mfma_f32_16x16x32_bf16 a[20:23], v[80:83], v[132:135], a[20:23]
    v_mfma_f32_16x16x32_bf16 a[24:27], v[80:83], v[136:139], a[24:27]
    v_mfma_f32_16x16x32_bf16 a[28:31], v[80:83], v[140:143], a[28:31]
    v_mfma_f32_16x16x32_bf16 a[32:35], v[84:87], v[112:115], a[32:35]
    v_mfma_f32_16x16x32_bf16 a[36:39], v[84:87], v[116:119], a[36:39]
    v_mfma_f32_16x16x32_bf16 a[40:43], v[84:87], v[120:123], a[40:43]
    v_mfma_f32_16x16x32_bf16 a[44:47], v[84:87], v[124:127], a[44:47]
    v_mfma_f32_16x16x32_bf16 a[48:51], v[84:87], v[128:131], a[48:51]
    v_mfma_f32_16x16x32_bf16 a[52:55], v[84:87], v[132:135], a[52:55]
    v_mfma_f32_16x16x32_bf16 a[56:59], v[84:87], v[136:139], a[56:59]
    v_mfma_f32_16x16x32_bf16 a[60:63], v[84:87], v[140:143], a[60:63]
    v_mfma_f32_16x16x32_bf16 a[64:67], v[88:91], v[112:115], a[64:67]
    v_mfma_f32_16x16x32_bf16 a[68:71], v[88:91], v[116:119], a[68:71]
    v_mfma_f32_16x16x32_bf16 a[72:75], v[88:91], v[120:123], a[72:75]
    v_mfma_f32_16x16x32_bf16 a[76:79], v[88:91], v[124:127], a[76:79]
    v_mfma_f32_16x16x32_bf16 a[80:83], v[88:91], v[128:131], a[80:83]
    v_mfma_f32_16x16x32_bf16 a[84:87], v[88:91], v[132:135], a[84:87]
    v_mfma_f32_16x16x32_bf16 a[88:91], v[88:91], v[136:139], a[88:91]
    v_mfma_f32_16x16x32_bf16 a[92:95], v[88:91], v[140:143], a[92:95]
    v_mfma_f32_16x16x32_bf16 a[96:99], v[92:95], v[112:115], a[96:99]
    v_mfma_f32_16x16x32_bf16 a[100:103], v[92:95], v[116:119], a[100:103]
    v_mfma_f32_16x16x32_bf16 a[104:107], v[92:95], v[120:123], a[104:107]
    v_mfma_f32_16x16x32_bf16 a[108:111], v[92:95], v[124:127], a[108:111]
    v_mfma_f32_16x16x32_bf16 a[112:115], v[92:95], v[128:131], a[112:115]
    v_mfma_f32_16x16x32_bf16 a[116:119], v[92:95], v[132:135], a[116:119]
    v_mfma_f32_16x16x32_bf16 a[120:123], v[92:95], v[136:139], a[120:123]
    v_mfma_f32_16x16x32_bf16 a[124:127], v[92:95], v[140:143], a[124:127]
    v_mfma_f32_16x16x32_bf16 a[128:131], v[96:99], v[112:115], a[128:131]
    v_mfma_f32_16x16x32_bf16 a[132:135], v[96:99], v[116:119], a[132:135]
    v_mfma_f32_16x16x32_bf16 a[136:139], v[96:99], v[120:123], a[136:139]
    v_mfma_f32_16x16x32_bf16 a[140:143], v[96:99], v[124:127], a[140:143]
    v_mfma_f32_16x16x32_bf16 a[144:147], v[96:99], v[128:131], a[144:147]
    v_mfma_f32_16x16x32_bf16 a[148:151], v[96:99], v[132:135], a[148:151]
    v_mfma_f32_16x16x32_bf16 a[152:155], v[96:99], v[136:139], a[152:155]
    v_mfma_f32_16x16x32_bf16 a[156:159], v[96:99], v[140:143], a[156:159]
    v_mfma_f32_16x16x32_bf16 a[160:163], v[100:103], v[112:115], a[160:163]
    v_mfma_f32_16x16x32_bf16 a[164:167], v[100:103], v[116:119], a[164:167]
    v_mfma_f32_16x16x32_bf16 a[168:171], v[100:103], v[120:123], a[168:171]
    v_mfma_f32_16x16x32_bf16 a[172:175], v[100:103], v[124:127], a[172:175]
    v_mfma_f32_16x16x32_bf16 a[176:179], v[100:103], v[128:131], a[176:179]
    v_mfma_f32_16x16x32_bf16 a[180:183], v[100:103], v[132:135], a[180:183]
    v_mfma_f32_16x16x32_bf16 a[184:187], v[100:103], v[136:139], a[184:187]
    v_mfma_f32_16x16x32_bf16 a[188:191], v[100:103], v[140:143], a[188:191]
    v_mfma_f32_16x16x32_bf16 a[192:195], v[104:107], v[112:115], a[192:195]
    v_mfma_f32_16x16x32_bf16 a[196:199], v[104:107], v[116:119], a[196:199]
    v_mfma_f32_16x16x32_bf16 a[200:203], v[104:107], v[120:123], a[200:203]
    v_mfma_f32_16x16x32_bf16 a[204:207], v[104:107], v[124:127], a[204:207]
    v_mfma_f32_16x16x32_bf16 a[208:211], v[104:107], v[128:131], a[208:211]
    v_mfma_f32_16x16x32_bf16 a[212:215], v[104:107], v[132:135], a[212:215]
    v_mfma_f32_16x16x32_bf16 a[216:219], v[104:107], v[136:139], a[216:219]
    v_mfma_f32_16x16x32_bf16 a[220:223], v[104:107], v[140:143], a[220:223]
    v_mfma_f32_16x16x32_bf16 a[224:227], v[108:111], v[112:115], a[224:227]
    v_mfma_f32_16x16x32_bf16 a[228:231], v[108:111], v[116:119], a[228:231]
    v_mfma_f32_16x16x32_bf16 a[232:235], v[108:111], v[120:123], a[232:235]
    v_mfma_f32_16x16x32_bf16 a[236:239], v[108:111], v[124:127], a[236:239]
    v_mfma_f32_16x16x32_bf16 a[240:243], v[108:111], v[128:131], a[240:243]
    v_mfma_f32_16x16x32_bf16 a[244:247], v[108:111], v[132:135], a[244:247]
    v_mfma_f32_16x16x32_bf16 a[248:251], v[108:111], v[136:139], a[248:251]
    v_mfma_f32_16x16x32_bf16 a[252:255], v[108:111], v[140:143], a[252:255]
    s_add_u32 s32, s6, 0x1716000
    s_addc_u32 s33, s7, 0
    s_and_b32 s33, s33, 0xffff
    s_mov_b32 s34, 0x2000000
    s_mov_b32 s35, 0x20000
    s_lshr_b32 s27, s30, 5
    s_lshl_b32 s27, s27, 24
    s_and_b32 s28, s30, 31
    s_lshl_b32 s28, s28, 8
    s_add_u32 s27, s27, s28
    s_lshl_b32 s28, s31, 20
    s_add_u32 s27, s27, s28
    v_lshrrev_b32 v10, 2, v8
    v_lshlrev_b32 v10, 3, v10
    v_and_b32 v11, 3, v8
    v_add_u32 v10, v10, v11
    v_mul_u32_u24 v10, 0x2000, v10
    v_lshl_add_u32 v10, v9, 4, v10
    s_add_u32 s28, s27, 0
    v_accvgpr_read_b32 v16, a0
    v_accvgpr_read_b32 v17, a1
    v_accvgpr_read_b32 v18, a2
    v_accvgpr_read_b32 v19, a3
    v_accvgpr_read_b32 v20, a32
    v_accvgpr_read_b32 v21, a33
    v_accvgpr_read_b32 v22, a34
    v_accvgpr_read_b32 v23, a35
    v_cvt_pk_bf16_f32 v24, v16, v17
    v_cvt_pk_bf16_f32 v25, v18, v19
    v_cvt_pk_bf16_f32 v26, v20, v21
    v_cvt_pk_bf16_f32 v27, v22, v23
    buffer_store_dwordx4 v[24:27], v10, s[32:35], s28 offen offset:0 sc1
    v_accvgpr_read_b32 v28, a64
    v_accvgpr_read_b32 v29, a65
    v_accvgpr_read_b32 v30, a66
    v_accvgpr_read_b32 v31, a67
    v_accvgpr_read_b32 v32, a96
    v_accvgpr_read_b32 v33, a97
    v_accvgpr_read_b32 v34, a98
    v_accvgpr_read_b32 v35, a99
    v_cvt_pk_bf16_f32 v36, v28, v29
    v_cvt_pk_bf16_f32 v37, v30, v31
    v_cvt_pk_bf16_f32 v38, v32, v33
    v_cvt_pk_bf16_f32 v39, v34, v35
    buffer_store_dwordx4 v[36:39], v10, s[32:35], s28 offen offset:64 sc1
    v_accvgpr_read_b32 v40, a128
    v_accvgpr_read_b32 v41, a129
    v_accvgpr_read_b32 v42, a130
    v_accvgpr_read_b32 v43, a131
    v_accvgpr_read_b32 v44, a160
    v_accvgpr_read_b32 v45, a161
    v_accvgpr_read_b32 v46, a162
    v_accvgpr_read_b32 v47, a163
    v_cvt_pk_bf16_f32 v48, v40, v41
    v_cvt_pk_bf16_f32 v49, v42, v43
    v_cvt_pk_bf16_f32 v50, v44, v45
    v_cvt_pk_bf16_f32 v51, v46, v47
    buffer_store_dwordx4 v[48:51], v10, s[32:35], s28 offen offset:128 sc1
    v_accvgpr_read_b32 v52, a192
    v_accvgpr_read_b32 v53, a193
    v_accvgpr_read_b32 v54, a194
    v_accvgpr_read_b32 v55, a195
    v_accvgpr_read_b32 v56, a224
    v_accvgpr_read_b32 v57, a225
    v_accvgpr_read_b32 v58, a226
    v_accvgpr_read_b32 v59, a227
    v_cvt_pk_bf16_f32 v60, v52, v53
    v_cvt_pk_bf16_f32 v61, v54, v55
    v_cvt_pk_bf16_f32 v62, v56, v57
    v_cvt_pk_bf16_f32 v63, v58, v59
    buffer_store_dwordx4 v[60:63], v10, s[32:35], s28 offen offset:192 sc1
    s_nop 0
    s_add_u32 s28, s27, 0x8000
    v_accvgpr_read_b32 v64, a4
    v_accvgpr_read_b32 v65, a5
    v_accvgpr_read_b32 v66, a6
    v_accvgpr_read_b32 v67, a7
    v_accvgpr_read_b32 v68, a36
    v_accvgpr_read_b32 v69, a37
    v_accvgpr_read_b32 v70, a38
    v_accvgpr_read_b32 v71, a39
    v_cvt_pk_bf16_f32 v72, v64, v65
    v_cvt_pk_bf16_f32 v73, v66, v67
    v_cvt_pk_bf16_f32 v74, v68, v69
    v_cvt_pk_bf16_f32 v75, v70, v71
    buffer_store_dwordx4 v[72:75], v10, s[32:35], s28 offen offset:0 sc1
    v_accvgpr_read_b32 v76, a68
    v_accvgpr_read_b32 v77, a69
    v_accvgpr_read_b32 v78, a70
    v_accvgpr_read_b32 v79, a71
    v_accvgpr_read_b32 v80, a100
    v_accvgpr_read_b32 v81, a101
    v_accvgpr_read_b32 v82, a102
    v_accvgpr_read_b32 v83, a103
    v_cvt_pk_bf16_f32 v84, v76, v77
    v_cvt_pk_bf16_f32 v85, v78, v79
    v_cvt_pk_bf16_f32 v86, v80, v81
    v_cvt_pk_bf16_f32 v87, v82, v83
    buffer_store_dwordx4 v[84:87], v10, s[32:35], s28 offen offset:64 sc1
    v_accvgpr_read_b32 v88, a132
    v_accvgpr_read_b32 v89, a133
    v_accvgpr_read_b32 v90, a134
    v_accvgpr_read_b32 v91, a135
    v_accvgpr_read_b32 v92, a164
    v_accvgpr_read_b32 v93, a165
    v_accvgpr_read_b32 v94, a166
    v_accvgpr_read_b32 v95, a167
    v_cvt_pk_bf16_f32 v96, v88, v89
    v_cvt_pk_bf16_f32 v97, v90, v91
    v_cvt_pk_bf16_f32 v98, v92, v93
    v_cvt_pk_bf16_f32 v99, v94, v95
    buffer_store_dwordx4 v[96:99], v10, s[32:35], s28 offen offset:128 sc1
    v_accvgpr_read_b32 v100, a196
    v_accvgpr_read_b32 v101, a197
    v_accvgpr_read_b32 v102, a198
    v_accvgpr_read_b32 v103, a199
    v_accvgpr_read_b32 v104, a228
    v_accvgpr_read_b32 v105, a229
    v_accvgpr_read_b32 v106, a230
    v_accvgpr_read_b32 v107, a231
    v_cvt_pk_bf16_f32 v108, v100, v101
    v_cvt_pk_bf16_f32 v109, v102, v103
    v_cvt_pk_bf16_f32 v110, v104, v105
    v_cvt_pk_bf16_f32 v111, v106, v107
    buffer_store_dwordx4 v[108:111], v10, s[32:35], s28 offen offset:192 sc1
    s_nop 0
    s_add_u32 s28, s27, 0x40000
    v_accvgpr_read_b32 v16, a8
    v_accvgpr_read_b32 v17, a9
    v_accvgpr_read_b32 v18, a10
    v_accvgpr_read_b32 v19, a11
    v_accvgpr_read_b32 v20, a40
    v_accvgpr_read_b32 v21, a41
    v_accvgpr_read_b32 v22, a42
    v_accvgpr_read_b32 v23, a43
    v_cvt_pk_bf16_f32 v24, v16, v17
    v_cvt_pk_bf16_f32 v25, v18, v19
    v_cvt_pk_bf16_f32 v26, v20, v21
    v_cvt_pk_bf16_f32 v27, v22, v23
    buffer_store_dwordx4 v[24:27], v10, s[32:35], s28 offen offset:0 sc1
    v_accvgpr_read_b32 v28, a72
    v_accvgpr_read_b32 v29, a73
    v_accvgpr_read_b32 v30, a74
    v_accvgpr_read_b32 v31, a75
    v_accvgpr_read_b32 v32, a104
    v_accvgpr_read_b32 v33, a105
    v_accvgpr_read_b32 v34, a106
    v_accvgpr_read_b32 v35, a107
    v_cvt_pk_bf16_f32 v36, v28, v29
    v_cvt_pk_bf16_f32 v37, v30, v31
    v_cvt_pk_bf16_f32 v38, v32, v33
    v_cvt_pk_bf16_f32 v39, v34, v35
    buffer_store_dwordx4 v[36:39], v10, s[32:35], s28 offen offset:64 sc1
    v_accvgpr_read_b32 v40, a136
    v_accvgpr_read_b32 v41, a137
    v_accvgpr_read_b32 v42, a138
    v_accvgpr_read_b32 v43, a139
    v_accvgpr_read_b32 v44, a168
    v_accvgpr_read_b32 v45, a169
    v_accvgpr_read_b32 v46, a170
    v_accvgpr_read_b32 v47, a171
    v_cvt_pk_bf16_f32 v48, v40, v41
    v_cvt_pk_bf16_f32 v49, v42, v43
    v_cvt_pk_bf16_f32 v50, v44, v45
    v_cvt_pk_bf16_f32 v51, v46, v47
    buffer_store_dwordx4 v[48:51], v10, s[32:35], s28 offen offset:128 sc1
    v_accvgpr_read_b32 v52, a200
    v_accvgpr_read_b32 v53, a201
    v_accvgpr_read_b32 v54, a202
    v_accvgpr_read_b32 v55, a203
    v_accvgpr_read_b32 v56, a232
    v_accvgpr_read_b32 v57, a233
    v_accvgpr_read_b32 v58, a234
    v_accvgpr_read_b32 v59, a235
    v_cvt_pk_bf16_f32 v60, v52, v53
    v_cvt_pk_bf16_f32 v61, v54, v55
    v_cvt_pk_bf16_f32 v62, v56, v57
    v_cvt_pk_bf16_f32 v63, v58, v59
    buffer_store_dwordx4 v[60:63], v10, s[32:35], s28 offen offset:192 sc1
    s_nop 0
    s_add_u32 s28, s27, 0x48000
    v_accvgpr_read_b32 v64, a12
    v_accvgpr_read_b32 v65, a13
    v_accvgpr_read_b32 v66, a14
    v_accvgpr_read_b32 v67, a15
    v_accvgpr_read_b32 v68, a44
    v_accvgpr_read_b32 v69, a45
    v_accvgpr_read_b32 v70, a46
    v_accvgpr_read_b32 v71, a47
    v_cvt_pk_bf16_f32 v72, v64, v65
    v_cvt_pk_bf16_f32 v73, v66, v67
    v_cvt_pk_bf16_f32 v74, v68, v69
    v_cvt_pk_bf16_f32 v75, v70, v71
    buffer_store_dwordx4 v[72:75], v10, s[32:35], s28 offen offset:0 sc1
    v_accvgpr_read_b32 v76, a76
    v_accvgpr_read_b32 v77, a77
    v_accvgpr_read_b32 v78, a78
    v_accvgpr_read_b32 v79, a79
    v_accvgpr_read_b32 v80, a108
    v_accvgpr_read_b32 v81, a109
    v_accvgpr_read_b32 v82, a110
    v_accvgpr_read_b32 v83, a111
    v_cvt_pk_bf16_f32 v84, v76, v77
    v_cvt_pk_bf16_f32 v85, v78, v79
    v_cvt_pk_bf16_f32 v86, v80, v81
    v_cvt_pk_bf16_f32 v87, v82, v83
    buffer_store_dwordx4 v[84:87], v10, s[32:35], s28 offen offset:64 sc1
    v_accvgpr_read_b32 v88, a140
    v_accvgpr_read_b32 v89, a141
    v_accvgpr_read_b32 v90, a142
    v_accvgpr_read_b32 v91, a143
    v_accvgpr_read_b32 v92, a172
    v_accvgpr_read_b32 v93, a173
    v_accvgpr_read_b32 v94, a174
    v_accvgpr_read_b32 v95, a175
    v_cvt_pk_bf16_f32 v96, v88, v89
    v_cvt_pk_bf16_f32 v97, v90, v91
    v_cvt_pk_bf16_f32 v98, v92, v93
    v_cvt_pk_bf16_f32 v99, v94, v95
    buffer_store_dwordx4 v[96:99], v10, s[32:35], s28 offen offset:128 sc1
    v_accvgpr_read_b32 v100, a204
    v_accvgpr_read_b32 v101, a205
    v_accvgpr_read_b32 v102, a206
    v_accvgpr_read_b32 v103, a207
    v_accvgpr_read_b32 v104, a236
    v_accvgpr_read_b32 v105, a237
    v_accvgpr_read_b32 v106, a238
    v_accvgpr_read_b32 v107, a239
    v_cvt_pk_bf16_f32 v108, v100, v101
    v_cvt_pk_bf16_f32 v109, v102, v103
    v_cvt_pk_bf16_f32 v110, v104, v105
    v_cvt_pk_bf16_f32 v111, v106, v107
    buffer_store_dwordx4 v[108:111], v10, s[32:35], s28 offen offset:192 sc1
    s_nop 0
    s_add_u32 s28, s27, 0x80000
    v_accvgpr_read_b32 v16, a16
    v_accvgpr_read_b32 v17, a17
    v_accvgpr_read_b32 v18, a18
    v_accvgpr_read_b32 v19, a19
    v_accvgpr_read_b32 v20, a48
    v_accvgpr_read_b32 v21, a49
    v_accvgpr_read_b32 v22, a50
    v_accvgpr_read_b32 v23, a51
    v_cvt_pk_bf16_f32 v24, v16, v17
    v_cvt_pk_bf16_f32 v25, v18, v19
    v_cvt_pk_bf16_f32 v26, v20, v21
    v_cvt_pk_bf16_f32 v27, v22, v23
    buffer_store_dwordx4 v[24:27], v10, s[32:35], s28 offen offset:0 sc1
    v_accvgpr_read_b32 v28, a80
    v_accvgpr_read_b32 v29, a81
    v_accvgpr_read_b32 v30, a82
    v_accvgpr_read_b32 v31, a83
    v_accvgpr_read_b32 v32, a112
    v_accvgpr_read_b32 v33, a113
    v_accvgpr_read_b32 v34, a114
    v_accvgpr_read_b32 v35, a115
    v_cvt_pk_bf16_f32 v36, v28, v29
    v_cvt_pk_bf16_f32 v37, v30, v31
    v_cvt_pk_bf16_f32 v38, v32, v33
    v_cvt_pk_bf16_f32 v39, v34, v35
    buffer_store_dwordx4 v[36:39], v10, s[32:35], s28 offen offset:64 sc1
    v_accvgpr_read_b32 v40, a144
    v_accvgpr_read_b32 v41, a145
    v_accvgpr_read_b32 v42, a146
    v_accvgpr_read_b32 v43, a147
    v_accvgpr_read_b32 v44, a176
    v_accvgpr_read_b32 v45, a177
    v_accvgpr_read_b32 v46, a178
    v_accvgpr_read_b32 v47, a179
    v_cvt_pk_bf16_f32 v48, v40, v41
    v_cvt_pk_bf16_f32 v49, v42, v43
    v_cvt_pk_bf16_f32 v50, v44, v45
    v_cvt_pk_bf16_f32 v51, v46, v47
    buffer_store_dwordx4 v[48:51], v10, s[32:35], s28 offen offset:128 sc1
    v_accvgpr_read_b32 v52, a208
    v_accvgpr_read_b32 v53, a209
    v_accvgpr_read_b32 v54, a210
    v_accvgpr_read_b32 v55, a211
    v_accvgpr_read_b32 v56, a240
    v_accvgpr_read_b32 v57, a241
    v_accvgpr_read_b32 v58, a242
    v_accvgpr_read_b32 v59, a243
    v_cvt_pk_bf16_f32 v60, v52, v53
    v_cvt_pk_bf16_f32 v61, v54, v55
    v_cvt_pk_bf16_f32 v62, v56, v57
    v_cvt_pk_bf16_f32 v63, v58, v59
    buffer_store_dwordx4 v[60:63], v10, s[32:35], s28 offen offset:192 sc1
    s_nop 0
    s_add_u32 s28, s27, 0x88000
    v_accvgpr_read_b32 v64, a20
    v_accvgpr_read_b32 v65, a21
    v_accvgpr_read_b32 v66, a22
    v_accvgpr_read_b32 v67, a23
    v_accvgpr_read_b32 v68, a52
    v_accvgpr_read_b32 v69, a53
    v_accvgpr_read_b32 v70, a54
    v_accvgpr_read_b32 v71, a55
    v_cvt_pk_bf16_f32 v72, v64, v65
    v_cvt_pk_bf16_f32 v73, v66, v67
    v_cvt_pk_bf16_f32 v74, v68, v69
    v_cvt_pk_bf16_f32 v75, v70, v71
    buffer_store_dwordx4 v[72:75], v10, s[32:35], s28 offen offset:0 sc1
    v_accvgpr_read_b32 v76, a84
    v_accvgpr_read_b32 v77, a85
    v_accvgpr_read_b32 v78, a86
    v_accvgpr_read_b32 v79, a87
    v_accvgpr_read_b32 v80, a116
    v_accvgpr_read_b32 v81, a117
    v_accvgpr_read_b32 v82, a118
    v_accvgpr_read_b32 v83, a119
    v_cvt_pk_bf16_f32 v84, v76, v77
    v_cvt_pk_bf16_f32 v85, v78, v79
    v_cvt_pk_bf16_f32 v86, v80, v81
    v_cvt_pk_bf16_f32 v87, v82, v83
    buffer_store_dwordx4 v[84:87], v10, s[32:35], s28 offen offset:64 sc1
    v_accvgpr_read_b32 v88, a148
    v_accvgpr_read_b32 v89, a149
    v_accvgpr_read_b32 v90, a150
    v_accvgpr_read_b32 v91, a151
    v_accvgpr_read_b32 v92, a180
    v_accvgpr_read_b32 v93, a181
    v_accvgpr_read_b32 v94, a182
    v_accvgpr_read_b32 v95, a183
    v_cvt_pk_bf16_f32 v96, v88, v89
    v_cvt_pk_bf16_f32 v97, v90, v91
    v_cvt_pk_bf16_f32 v98, v92, v93
    v_cvt_pk_bf16_f32 v99, v94, v95
    buffer_store_dwordx4 v[96:99], v10, s[32:35], s28 offen offset:128 sc1
    v_accvgpr_read_b32 v100, a212
    v_accvgpr_read_b32 v101, a213
    v_accvgpr_read_b32 v102, a214
    v_accvgpr_read_b32 v103, a215
    v_accvgpr_read_b32 v104, a244
    v_accvgpr_read_b32 v105, a245
    v_accvgpr_read_b32 v106, a246
    v_accvgpr_read_b32 v107, a247
    v_cvt_pk_bf16_f32 v108, v100, v101
    v_cvt_pk_bf16_f32 v109, v102, v103
    v_cvt_pk_bf16_f32 v110, v104, v105
    v_cvt_pk_bf16_f32 v111, v106, v107
    buffer_store_dwordx4 v[108:111], v10, s[32:35], s28 offen offset:192 sc1
    s_nop 0
    s_add_u32 s28, s27, 0xc0000
    v_accvgpr_read_b32 v16, a24
    v_accvgpr_read_b32 v17, a25
    v_accvgpr_read_b32 v18, a26
    v_accvgpr_read_b32 v19, a27
    v_accvgpr_read_b32 v20, a56
    v_accvgpr_read_b32 v21, a57
    v_accvgpr_read_b32 v22, a58
    v_accvgpr_read_b32 v23, a59
    v_cvt_pk_bf16_f32 v24, v16, v17
    v_cvt_pk_bf16_f32 v25, v18, v19
    v_cvt_pk_bf16_f32 v26, v20, v21
    v_cvt_pk_bf16_f32 v27, v22, v23
    buffer_store_dwordx4 v[24:27], v10, s[32:35], s28 offen offset:0 sc1
    v_accvgpr_read_b32 v28, a88
    v_accvgpr_read_b32 v29, a89
    v_accvgpr_read_b32 v30, a90
    v_accvgpr_read_b32 v31, a91
    v_accvgpr_read_b32 v32, a120
    v_accvgpr_read_b32 v33, a121
    v_accvgpr_read_b32 v34, a122
    v_accvgpr_read_b32 v35, a123
    v_cvt_pk_bf16_f32 v36, v28, v29
    v_cvt_pk_bf16_f32 v37, v30, v31
    v_cvt_pk_bf16_f32 v38, v32, v33
    v_cvt_pk_bf16_f32 v39, v34, v35
    buffer_store_dwordx4 v[36:39], v10, s[32:35], s28 offen offset:64 sc1
    v_accvgpr_read_b32 v40, a152
    v_accvgpr_read_b32 v41, a153
    v_accvgpr_read_b32 v42, a154
    v_accvgpr_read_b32 v43, a155
    v_accvgpr_read_b32 v44, a184
    v_accvgpr_read_b32 v45, a185
    v_accvgpr_read_b32 v46, a186
    v_accvgpr_read_b32 v47, a187
    v_cvt_pk_bf16_f32 v48, v40, v41
    v_cvt_pk_bf16_f32 v49, v42, v43
    v_cvt_pk_bf16_f32 v50, v44, v45
    v_cvt_pk_bf16_f32 v51, v46, v47
    buffer_store_dwordx4 v[48:51], v10, s[32:35], s28 offen offset:128 sc1
    v_accvgpr_read_b32 v52, a216
    v_accvgpr_read_b32 v53, a217
    v_accvgpr_read_b32 v54, a218
    v_accvgpr_read_b32 v55, a219
    v_accvgpr_read_b32 v56, a248
    v_accvgpr_read_b32 v57, a249
    v_accvgpr_read_b32 v58, a250
    v_accvgpr_read_b32 v59, a251
    v_cvt_pk_bf16_f32 v60, v52, v53
    v_cvt_pk_bf16_f32 v61, v54, v55
    v_cvt_pk_bf16_f32 v62, v56, v57
    v_cvt_pk_bf16_f32 v63, v58, v59
    buffer_store_dwordx4 v[60:63], v10, s[32:35], s28 offen offset:192 sc1
    s_nop 0
    s_add_u32 s28, s27, 0xc8000
    v_accvgpr_read_b32 v64, a28
    v_accvgpr_read_b32 v65, a29
    v_accvgpr_read_b32 v66, a30
    v_accvgpr_read_b32 v67, a31
    v_accvgpr_read_b32 v68, a60
    v_accvgpr_read_b32 v69, a61
    v_accvgpr_read_b32 v70, a62
    v_accvgpr_read_b32 v71, a63
    v_cvt_pk_bf16_f32 v72, v64, v65
    v_cvt_pk_bf16_f32 v73, v66, v67
    v_cvt_pk_bf16_f32 v74, v68, v69
    v_cvt_pk_bf16_f32 v75, v70, v71
    buffer_store_dwordx4 v[72:75], v10, s[32:35], s28 offen offset:0 sc1
    v_accvgpr_read_b32 v76, a92
    v_accvgpr_read_b32 v77, a93
    v_accvgpr_read_b32 v78, a94
    v_accvgpr_read_b32 v79, a95
    v_accvgpr_read_b32 v80, a124
    v_accvgpr_read_b32 v81, a125
    v_accvgpr_read_b32 v82, a126
    v_accvgpr_read_b32 v83, a127
    v_cvt_pk_bf16_f32 v84, v76, v77
    v_cvt_pk_bf16_f32 v85, v78, v79
    v_cvt_pk_bf16_f32 v86, v80, v81
    v_cvt_pk_bf16_f32 v87, v82, v83
    buffer_store_dwordx4 v[84:87], v10, s[32:35], s28 offen offset:64 sc1
    v_accvgpr_read_b32 v88, a156
    v_accvgpr_read_b32 v89, a157
    v_accvgpr_read_b32 v90, a158
    v_accvgpr_read_b32 v91, a159
    v_accvgpr_read_b32 v92, a188
    v_accvgpr_read_b32 v93, a189
    v_accvgpr_read_b32 v94, a190
    v_accvgpr_read_b32 v95, a191
    v_cvt_pk_bf16_f32 v96, v88, v89
    v_cvt_pk_bf16_f32 v97, v90, v91
    v_cvt_pk_bf16_f32 v98, v92, v93
    v_cvt_pk_bf16_f32 v99, v94, v95
    buffer_store_dwordx4 v[96:99], v10, s[32:35], s28 offen offset:128 sc1
    v_accvgpr_read_b32 v100, a220
    v_accvgpr_read_b32 v101, a221
    v_accvgpr_read_b32 v102, a222
    v_accvgpr_read_b32 v103, a223
    v_accvgpr_read_b32 v104, a252
    v_accvgpr_read_b32 v105, a253
    v_accvgpr_read_b32 v106, a254
    v_accvgpr_read_b32 v107, a255
    v_cvt_pk_bf16_f32 v108, v100, v101
    v_cvt_pk_bf16_f32 v109, v102, v103
    v_cvt_pk_bf16_f32 v110, v104, v105
    v_cvt_pk_bf16_f32 v111, v106, v107
    buffer_store_dwordx4 v[108:111], v10, s[32:35], s28 offen offset:192 sc1
    s_branch qkv_sig_66
qkv_v_65:
    buffer_load_dwordx4 v[16:19], v4, s[12:15], s24 offen offset:0
    buffer_load_dwordx4 v[20:23], v4, s[12:15], s24 offen offset:1024
    buffer_load_dwordx4 v[24:27], v5, s[12:15], s24 offen offset:0
    buffer_load_dwordx4 v[28:31], v5, s[12:15], s24 offen offset:1024
    buffer_load_dwordx4 v[32:35], v6, s[12:15], s24 offen offset:0
    buffer_load_dwordx4 v[36:39], v6, s[12:15], s24 offen offset:1024
    buffer_load_dwordx4 v[40:43], v7, s[12:15], s24 offen offset:0
    buffer_load_dwordx4 v[44:47], v7, s[12:15], s24 offen offset:1024
    buffer_load_dwordx4 v[48:51], v4, s[16:19], s25 offen offset:0
    buffer_load_dwordx4 v[52:55], v4, s[16:19], s25 offen offset:1024
    buffer_load_dwordx4 v[56:59], v5, s[16:19], s25 offen offset:0
    buffer_load_dwordx4 v[60:63], v5, s[16:19], s25 offen offset:1024
    buffer_load_dwordx4 v[64:67], v6, s[16:19], s25 offen offset:0
    buffer_load_dwordx4 v[68:71], v6, s[16:19], s25 offen offset:1024
    buffer_load_dwordx4 v[72:75], v7, s[16:19], s25 offen offset:0
    buffer_load_dwordx4 v[76:79], v7, s[16:19], s25 offen offset:1024
    s_add_u32 s24, s24, 0x800
    s_add_u32 s25, s25, 0x800
    buffer_load_dwordx4 v[80:83], v4, s[12:15], s24 offen offset:0
    buffer_load_dwordx4 v[84:87], v4, s[12:15], s24 offen offset:1024
    buffer_load_dwordx4 v[88:91], v5, s[12:15], s24 offen offset:0
    buffer_load_dwordx4 v[92:95], v5, s[12:15], s24 offen offset:1024
    buffer_load_dwordx4 v[96:99], v6, s[12:15], s24 offen offset:0
    buffer_load_dwordx4 v[100:103], v6, s[12:15], s24 offen offset:1024
    buffer_load_dwordx4 v[104:107], v7, s[12:15], s24 offen offset:0
    buffer_load_dwordx4 v[108:111], v7, s[12:15], s24 offen offset:1024
    buffer_load_dwordx4 v[112:115], v4, s[16:19], s25 offen offset:0
    buffer_load_dwordx4 v[116:119], v4, s[16:19], s25 offen offset:1024
    buffer_load_dwordx4 v[120:123], v5, s[16:19], s25 offen offset:0
    buffer_load_dwordx4 v[124:127], v5, s[16:19], s25 offen offset:1024
    buffer_load_dwordx4 v[128:131], v6, s[16:19], s25 offen offset:0
    buffer_load_dwordx4 v[132:135], v6, s[16:19], s25 offen offset:1024
    buffer_load_dwordx4 v[136:139], v7, s[16:19], s25 offen offset:0
    buffer_load_dwordx4 v[140:143], v7, s[16:19], s25 offen offset:1024
    s_add_u32 s24, s24, 0x800
    s_add_u32 s25, s25, 0x800
    s_waitcnt vmcnt(16)
    v_mfma_f32_16x16x32_bf16 a[0:3], v[48:51], v[16:19], 0
    v_mfma_f32_16x16x32_bf16 a[4:7], v[52:55], v[16:19], 0
    v_mfma_f32_16x16x32_bf16 a[8:11], v[56:59], v[16:19], 0
    v_mfma_f32_16x16x32_bf16 a[12:15], v[60:63], v[16:19], 0
    v_mfma_f32_16x16x32_bf16 a[16:19], v[64:67], v[16:19], 0
    v_mfma_f32_16x16x32_bf16 a[20:23], v[68:71], v[16:19], 0
    v_mfma_f32_16x16x32_bf16 a[24:27], v[72:75], v[16:19], 0
    v_mfma_f32_16x16x32_bf16 a[28:31], v[76:79], v[16:19], 0
    v_mfma_f32_16x16x32_bf16 a[32:35], v[48:51], v[20:23], 0
    v_mfma_f32_16x16x32_bf16 a[36:39], v[52:55], v[20:23], 0
    v_mfma_f32_16x16x32_bf16 a[40:43], v[56:59], v[20:23], 0
    v_mfma_f32_16x16x32_bf16 a[44:47], v[60:63], v[20:23], 0
    v_mfma_f32_16x16x32_bf16 a[48:51], v[64:67], v[20:23], 0
    v_mfma_f32_16x16x32_bf16 a[52:55], v[68:71], v[20:23], 0
    v_mfma_f32_16x16x32_bf16 a[56:59], v[72:75], v[20:23], 0
    v_mfma_f32_16x16x32_bf16 a[60:63], v[76:79], v[20:23], 0
    v_mfma_f32_16x16x32_bf16 a[64:67], v[48:51], v[24:27], 0
    v_mfma_f32_16x16x32_bf16 a[68:71], v[52:55], v[24:27], 0
    v_mfma_f32_16x16x32_bf16 a[72:75], v[56:59], v[24:27], 0
    v_mfma_f32_16x16x32_bf16 a[76:79], v[60:63], v[24:27], 0
    v_mfma_f32_16x16x32_bf16 a[80:83], v[64:67], v[24:27], 0
    v_mfma_f32_16x16x32_bf16 a[84:87], v[68:71], v[24:27], 0
    v_mfma_f32_16x16x32_bf16 a[88:91], v[72:75], v[24:27], 0
    v_mfma_f32_16x16x32_bf16 a[92:95], v[76:79], v[24:27], 0
    v_mfma_f32_16x16x32_bf16 a[96:99], v[48:51], v[28:31], 0
    v_mfma_f32_16x16x32_bf16 a[100:103], v[52:55], v[28:31], 0
    v_mfma_f32_16x16x32_bf16 a[104:107], v[56:59], v[28:31], 0
    v_mfma_f32_16x16x32_bf16 a[108:111], v[60:63], v[28:31], 0
    v_mfma_f32_16x16x32_bf16 a[112:115], v[64:67], v[28:31], 0
    v_mfma_f32_16x16x32_bf16 a[116:119], v[68:71], v[28:31], 0
    v_mfma_f32_16x16x32_bf16 a[120:123], v[72:75], v[28:31], 0
    v_mfma_f32_16x16x32_bf16 a[124:127], v[76:79], v[28:31], 0
    v_mfma_f32_16x16x32_bf16 a[128:131], v[48:51], v[32:35], 0
    v_mfma_f32_16x16x32_bf16 a[132:135], v[52:55], v[32:35], 0
    v_mfma_f32_16x16x32_bf16 a[136:139], v[56:59], v[32:35], 0
    v_mfma_f32_16x16x32_bf16 a[140:143], v[60:63], v[32:35], 0
    v_mfma_f32_16x16x32_bf16 a[144:147], v[64:67], v[32:35], 0
    v_mfma_f32_16x16x32_bf16 a[148:151], v[68:71], v[32:35], 0
    v_mfma_f32_16x16x32_bf16 a[152:155], v[72:75], v[32:35], 0
    v_mfma_f32_16x16x32_bf16 a[156:159], v[76:79], v[32:35], 0
    v_mfma_f32_16x16x32_bf16 a[160:163], v[48:51], v[36:39], 0
    v_mfma_f32_16x16x32_bf16 a[164:167], v[52:55], v[36:39], 0
    v_mfma_f32_16x16x32_bf16 a[168:171], v[56:59], v[36:39], 0
    v_mfma_f32_16x16x32_bf16 a[172:175], v[60:63], v[36:39], 0
    v_mfma_f32_16x16x32_bf16 a[176:179], v[64:67], v[36:39], 0
    v_mfma_f32_16x16x32_bf16 a[180:183], v[68:71], v[36:39], 0
    v_mfma_f32_16x16x32_bf16 a[184:187], v[72:75], v[36:39], 0
    v_mfma_f32_16x16x32_bf16 a[188:191], v[76:79], v[36:39], 0
    v_mfma_f32_16x16x32_bf16 a[192:195], v[48:51], v[40:43], 0
    v_mfma_f32_16x16x32_bf16 a[196:199], v[52:55], v[40:43], 0
    v_mfma_f32_16x16x32_bf16 a[200:203], v[56:59], v[40:43], 0
    v_mfma_f32_16x16x32_bf16 a[204:207], v[60:63], v[40:43], 0
    v_mfma_f32_16x16x32_bf16 a[208:211], v[64:67], v[40:43], 0
    v_mfma_f32_16x16x32_bf16 a[212:215], v[68:71], v[40:43], 0
    v_mfma_f32_16x16x32_bf16 a[216:219], v[72:75], v[40:43], 0
    v_mfma_f32_16x16x32_bf16 a[220:223], v[76:79], v[40:43], 0
    v_mfma_f32_16x16x32_bf16 a[224:227], v[48:51], v[44:47], 0
    v_mfma_f32_16x16x32_bf16 a[228:231], v[52:55], v[44:47], 0
    v_mfma_f32_16x16x32_bf16 a[232:235], v[56:59], v[44:47], 0
    v_mfma_f32_16x16x32_bf16 a[236:239], v[60:63], v[44:47], 0
    v_mfma_f32_16x16x32_bf16 a[240:243], v[64:67], v[44:47], 0
    v_mfma_f32_16x16x32_bf16 a[244:247], v[68:71], v[44:47], 0
    v_mfma_f32_16x16x32_bf16 a[248:251], v[72:75], v[44:47], 0
    v_mfma_f32_16x16x32_bf16 a[252:255], v[76:79], v[44:47], 0
    buffer_load_dwordx4 v[16:19], v4, s[12:15], s24 offen offset:0
    buffer_load_dwordx4 v[20:23], v4, s[12:15], s24 offen offset:1024
    buffer_load_dwordx4 v[24:27], v5, s[12:15], s24 offen offset:0
    buffer_load_dwordx4 v[28:31], v5, s[12:15], s24 offen offset:1024
    buffer_load_dwordx4 v[32:35], v6, s[12:15], s24 offen offset:0
    buffer_load_dwordx4 v[36:39], v6, s[12:15], s24 offen offset:1024
    buffer_load_dwordx4 v[40:43], v7, s[12:15], s24 offen offset:0
    buffer_load_dwordx4 v[44:47], v7, s[12:15], s24 offen offset:1024
    buffer_load_dwordx4 v[48:51], v4, s[16:19], s25 offen offset:0
    buffer_load_dwordx4 v[52:55], v4, s[16:19], s25 offen offset:1024
    buffer_load_dwordx4 v[56:59], v5, s[16:19], s25 offen offset:0
    buffer_load_dwordx4 v[60:63], v5, s[16:19], s25 offen offset:1024
    buffer_load_dwordx4 v[64:67], v6, s[16:19], s25 offen offset:0
    buffer_load_dwordx4 v[68:71], v6, s[16:19], s25 offen offset:1024
    buffer_load_dwordx4 v[72:75], v7, s[16:19], s25 offen offset:0
    buffer_load_dwordx4 v[76:79], v7, s[16:19], s25 offen offset:1024
    s_add_u32 s24, s24, 0x800
    s_add_u32 s25, s25, 0x800
    s_waitcnt vmcnt(16)
    v_mfma_f32_16x16x32_bf16 a[0:3], v[112:115], v[80:83], a[0:3]
    v_mfma_f32_16x16x32_bf16 a[4:7], v[116:119], v[80:83], a[4:7]
    v_mfma_f32_16x16x32_bf16 a[8:11], v[120:123], v[80:83], a[8:11]
    v_mfma_f32_16x16x32_bf16 a[12:15], v[124:127], v[80:83], a[12:15]
    v_mfma_f32_16x16x32_bf16 a[16:19], v[128:131], v[80:83], a[16:19]
    v_mfma_f32_16x16x32_bf16 a[20:23], v[132:135], v[80:83], a[20:23]
    v_mfma_f32_16x16x32_bf16 a[24:27], v[136:139], v[80:83], a[24:27]
    v_mfma_f32_16x16x32_bf16 a[28:31], v[140:143], v[80:83], a[28:31]
    v_mfma_f32_16x16x32_bf16 a[32:35], v[112:115], v[84:87], a[32:35]
    v_mfma_f32_16x16x32_bf16 a[36:39], v[116:119], v[84:87], a[36:39]
    v_mfma_f32_16x16x32_bf16 a[40:43], v[120:123], v[84:87], a[40:43]
    v_mfma_f32_16x16x32_bf16 a[44:47], v[124:127], v[84:87], a[44:47]
    v_mfma_f32_16x16x32_bf16 a[48:51], v[128:131], v[84:87], a[48:51]
    v_mfma_f32_16x16x32_bf16 a[52:55], v[132:135], v[84:87], a[52:55]
    v_mfma_f32_16x16x32_bf16 a[56:59], v[136:139], v[84:87], a[56:59]
    v_mfma_f32_16x16x32_bf16 a[60:63], v[140:143], v[84:87], a[60:63]
    v_mfma_f32_16x16x32_bf16 a[64:67], v[112:115], v[88:91], a[64:67]
    v_mfma_f32_16x16x32_bf16 a[68:71], v[116:119], v[88:91], a[68:71]
    v_mfma_f32_16x16x32_bf16 a[72:75], v[120:123], v[88:91], a[72:75]
    v_mfma_f32_16x16x32_bf16 a[76:79], v[124:127], v[88:91], a[76:79]
    v_mfma_f32_16x16x32_bf16 a[80:83], v[128:131], v[88:91], a[80:83]
    v_mfma_f32_16x16x32_bf16 a[84:87], v[132:135], v[88:91], a[84:87]
    v_mfma_f32_16x16x32_bf16 a[88:91], v[136:139], v[88:91], a[88:91]
    v_mfma_f32_16x16x32_bf16 a[92:95], v[140:143], v[88:91], a[92:95]
    v_mfma_f32_16x16x32_bf16 a[96:99], v[112:115], v[92:95], a[96:99]
    v_mfma_f32_16x16x32_bf16 a[100:103], v[116:119], v[92:95], a[100:103]
    v_mfma_f32_16x16x32_bf16 a[104:107], v[120:123], v[92:95], a[104:107]
    v_mfma_f32_16x16x32_bf16 a[108:111], v[124:127], v[92:95], a[108:111]
    v_mfma_f32_16x16x32_bf16 a[112:115], v[128:131], v[92:95], a[112:115]
    v_mfma_f32_16x16x32_bf16 a[116:119], v[132:135], v[92:95], a[116:119]
    v_mfma_f32_16x16x32_bf16 a[120:123], v[136:139], v[92:95], a[120:123]
    v_mfma_f32_16x16x32_bf16 a[124:127], v[140:143], v[92:95], a[124:127]
    v_mfma_f32_16x16x32_bf16 a[128:131], v[112:115], v[96:99], a[128:131]
    v_mfma_f32_16x16x32_bf16 a[132:135], v[116:119], v[96:99], a[132:135]
    v_mfma_f32_16x16x32_bf16 a[136:139], v[120:123], v[96:99], a[136:139]
    v_mfma_f32_16x16x32_bf16 a[140:143], v[124:127], v[96:99], a[140:143]
    v_mfma_f32_16x16x32_bf16 a[144:147], v[128:131], v[96:99], a[144:147]
    v_mfma_f32_16x16x32_bf16 a[148:151], v[132:135], v[96:99], a[148:151]
    v_mfma_f32_16x16x32_bf16 a[152:155], v[136:139], v[96:99], a[152:155]
    v_mfma_f32_16x16x32_bf16 a[156:159], v[140:143], v[96:99], a[156:159]
    v_mfma_f32_16x16x32_bf16 a[160:163], v[112:115], v[100:103], a[160:163]
    v_mfma_f32_16x16x32_bf16 a[164:167], v[116:119], v[100:103], a[164:167]
    v_mfma_f32_16x16x32_bf16 a[168:171], v[120:123], v[100:103], a[168:171]
    v_mfma_f32_16x16x32_bf16 a[172:175], v[124:127], v[100:103], a[172:175]
    v_mfma_f32_16x16x32_bf16 a[176:179], v[128:131], v[100:103], a[176:179]
    v_mfma_f32_16x16x32_bf16 a[180:183], v[132:135], v[100:103], a[180:183]
    v_mfma_f32_16x16x32_bf16 a[184:187], v[136:139], v[100:103], a[184:187]
    v_mfma_f32_16x16x32_bf16 a[188:191], v[140:143], v[100:103], a[188:191]
    v_mfma_f32_16x16x32_bf16 a[192:195], v[112:115], v[104:107], a[192:195]
    v_mfma_f32_16x16x32_bf16 a[196:199], v[116:119], v[104:107], a[196:199]
    v_mfma_f32_16x16x32_bf16 a[200:203], v[120:123], v[104:107], a[200:203]
    v_mfma_f32_16x16x32_bf16 a[204:207], v[124:127], v[104:107], a[204:207]
    v_mfma_f32_16x16x32_bf16 a[208:211], v[128:131], v[104:107], a[208:211]
    v_mfma_f32_16x16x32_bf16 a[212:215], v[132:135], v[104:107], a[212:215]
    v_mfma_f32_16x16x32_bf16 a[216:219], v[136:139], v[104:107], a[216:219]
    v_mfma_f32_16x16x32_bf16 a[220:223], v[140:143], v[104:107], a[220:223]
    v_mfma_f32_16x16x32_bf16 a[224:227], v[112:115], v[108:111], a[224:227]
    v_mfma_f32_16x16x32_bf16 a[228:231], v[116:119], v[108:111], a[228:231]
    v_mfma_f32_16x16x32_bf16 a[232:235], v[120:123], v[108:111], a[232:235]
    v_mfma_f32_16x16x32_bf16 a[236:239], v[124:127], v[108:111], a[236:239]
    v_mfma_f32_16x16x32_bf16 a[240:243], v[128:131], v[108:111], a[240:243]
    v_mfma_f32_16x16x32_bf16 a[244:247], v[132:135], v[108:111], a[244:247]
    v_mfma_f32_16x16x32_bf16 a[248:251], v[136:139], v[108:111], a[248:251]
    v_mfma_f32_16x16x32_bf16 a[252:255], v[140:143], v[108:111], a[252:255]
    buffer_load_dwordx4 v[80:83], v4, s[12:15], s24 offen offset:0
    buffer_load_dwordx4 v[84:87], v4, s[12:15], s24 offen offset:1024
    buffer_load_dwordx4 v[88:91], v5, s[12:15], s24 offen offset:0
    buffer_load_dwordx4 v[92:95], v5, s[12:15], s24 offen offset:1024
    buffer_load_dwordx4 v[96:99], v6, s[12:15], s24 offen offset:0
    buffer_load_dwordx4 v[100:103], v6, s[12:15], s24 offen offset:1024
    buffer_load_dwordx4 v[104:107], v7, s[12:15], s24 offen offset:0
    buffer_load_dwordx4 v[108:111], v7, s[12:15], s24 offen offset:1024
    buffer_load_dwordx4 v[112:115], v4, s[16:19], s25 offen offset:0
    buffer_load_dwordx4 v[116:119], v4, s[16:19], s25 offen offset:1024
    buffer_load_dwordx4 v[120:123], v5, s[16:19], s25 offen offset:0
    buffer_load_dwordx4 v[124:127], v5, s[16:19], s25 offen offset:1024
    buffer_load_dwordx4 v[128:131], v6, s[16:19], s25 offen offset:0
    buffer_load_dwordx4 v[132:135], v6, s[16:19], s25 offen offset:1024
    buffer_load_dwordx4 v[136:139], v7, s[16:19], s25 offen offset:0
    buffer_load_dwordx4 v[140:143], v7, s[16:19], s25 offen offset:1024
    s_add_u32 s24, s24, 0x800
    s_add_u32 s25, s25, 0x800
    s_waitcnt vmcnt(16)
    v_mfma_f32_16x16x32_bf16 a[0:3], v[48:51], v[16:19], a[0:3]
    v_mfma_f32_16x16x32_bf16 a[4:7], v[52:55], v[16:19], a[4:7]
    v_mfma_f32_16x16x32_bf16 a[8:11], v[56:59], v[16:19], a[8:11]
    v_mfma_f32_16x16x32_bf16 a[12:15], v[60:63], v[16:19], a[12:15]
    v_mfma_f32_16x16x32_bf16 a[16:19], v[64:67], v[16:19], a[16:19]
    v_mfma_f32_16x16x32_bf16 a[20:23], v[68:71], v[16:19], a[20:23]
    v_mfma_f32_16x16x32_bf16 a[24:27], v[72:75], v[16:19], a[24:27]
    v_mfma_f32_16x16x32_bf16 a[28:31], v[76:79], v[16:19], a[28:31]
    v_mfma_f32_16x16x32_bf16 a[32:35], v[48:51], v[20:23], a[32:35]
    v_mfma_f32_16x16x32_bf16 a[36:39], v[52:55], v[20:23], a[36:39]
    v_mfma_f32_16x16x32_bf16 a[40:43], v[56:59], v[20:23], a[40:43]
    v_mfma_f32_16x16x32_bf16 a[44:47], v[60:63], v[20:23], a[44:47]
    v_mfma_f32_16x16x32_bf16 a[48:51], v[64:67], v[20:23], a[48:51]
    v_mfma_f32_16x16x32_bf16 a[52:55], v[68:71], v[20:23], a[52:55]
    v_mfma_f32_16x16x32_bf16 a[56:59], v[72:75], v[20:23], a[56:59]
    v_mfma_f32_16x16x32_bf16 a[60:63], v[76:79], v[20:23], a[60:63]
    v_mfma_f32_16x16x32_bf16 a[64:67], v[48:51], v[24:27], a[64:67]
    v_mfma_f32_16x16x32_bf16 a[68:71], v[52:55], v[24:27], a[68:71]
    v_mfma_f32_16x16x32_bf16 a[72:75], v[56:59], v[24:27], a[72:75]
    v_mfma_f32_16x16x32_bf16 a[76:79], v[60:63], v[24:27], a[76:79]
    v_mfma_f32_16x16x32_bf16 a[80:83], v[64:67], v[24:27], a[80:83]
    v_mfma_f32_16x16x32_bf16 a[84:87], v[68:71], v[24:27], a[84:87]
    v_mfma_f32_16x16x32_bf16 a[88:91], v[72:75], v[24:27], a[88:91]
    v_mfma_f32_16x16x32_bf16 a[92:95], v[76:79], v[24:27], a[92:95]
    v_mfma_f32_16x16x32_bf16 a[96:99], v[48:51], v[28:31], a[96:99]
    v_mfma_f32_16x16x32_bf16 a[100:103], v[52:55], v[28:31], a[100:103]
    v_mfma_f32_16x16x32_bf16 a[104:107], v[56:59], v[28:31], a[104:107]
    v_mfma_f32_16x16x32_bf16 a[108:111], v[60:63], v[28:31], a[108:111]
    v_mfma_f32_16x16x32_bf16 a[112:115], v[64:67], v[28:31], a[112:115]
    v_mfma_f32_16x16x32_bf16 a[116:119], v[68:71], v[28:31], a[116:119]
    v_mfma_f32_16x16x32_bf16 a[120:123], v[72:75], v[28:31], a[120:123]
    v_mfma_f32_16x16x32_bf16 a[124:127], v[76:79], v[28:31], a[124:127]
    v_mfma_f32_16x16x32_bf16 a[128:131], v[48:51], v[32:35], a[128:131]
    v_mfma_f32_16x16x32_bf16 a[132:135], v[52:55], v[32:35], a[132:135]
    v_mfma_f32_16x16x32_bf16 a[136:139], v[56:59], v[32:35], a[136:139]
    v_mfma_f32_16x16x32_bf16 a[140:143], v[60:63], v[32:35], a[140:143]
    v_mfma_f32_16x16x32_bf16 a[144:147], v[64:67], v[32:35], a[144:147]
    v_mfma_f32_16x16x32_bf16 a[148:151], v[68:71], v[32:35], a[148:151]
    v_mfma_f32_16x16x32_bf16 a[152:155], v[72:75], v[32:35], a[152:155]
    v_mfma_f32_16x16x32_bf16 a[156:159], v[76:79], v[32:35], a[156:159]
    v_mfma_f32_16x16x32_bf16 a[160:163], v[48:51], v[36:39], a[160:163]
    v_mfma_f32_16x16x32_bf16 a[164:167], v[52:55], v[36:39], a[164:167]
    v_mfma_f32_16x16x32_bf16 a[168:171], v[56:59], v[36:39], a[168:171]
    v_mfma_f32_16x16x32_bf16 a[172:175], v[60:63], v[36:39], a[172:175]
    v_mfma_f32_16x16x32_bf16 a[176:179], v[64:67], v[36:39], a[176:179]
    v_mfma_f32_16x16x32_bf16 a[180:183], v[68:71], v[36:39], a[180:183]
    v_mfma_f32_16x16x32_bf16 a[184:187], v[72:75], v[36:39], a[184:187]
    v_mfma_f32_16x16x32_bf16 a[188:191], v[76:79], v[36:39], a[188:191]
    v_mfma_f32_16x16x32_bf16 a[192:195], v[48:51], v[40:43], a[192:195]
    v_mfma_f32_16x16x32_bf16 a[196:199], v[52:55], v[40:43], a[196:199]
    v_mfma_f32_16x16x32_bf16 a[200:203], v[56:59], v[40:43], a[200:203]
    v_mfma_f32_16x16x32_bf16 a[204:207], v[60:63], v[40:43], a[204:207]
    v_mfma_f32_16x16x32_bf16 a[208:211], v[64:67], v[40:43], a[208:211]
    v_mfma_f32_16x16x32_bf16 a[212:215], v[68:71], v[40:43], a[212:215]
    v_mfma_f32_16x16x32_bf16 a[216:219], v[72:75], v[40:43], a[216:219]
    v_mfma_f32_16x16x32_bf16 a[220:223], v[76:79], v[40:43], a[220:223]
    v_mfma_f32_16x16x32_bf16 a[224:227], v[48:51], v[44:47], a[224:227]
    v_mfma_f32_16x16x32_bf16 a[228:231], v[52:55], v[44:47], a[228:231]
    v_mfma_f32_16x16x32_bf16 a[232:235], v[56:59], v[44:47], a[232:235]
    v_mfma_f32_16x16x32_bf16 a[236:239], v[60:63], v[44:47], a[236:239]
    v_mfma_f32_16x16x32_bf16 a[240:243], v[64:67], v[44:47], a[240:243]
    v_mfma_f32_16x16x32_bf16 a[244:247], v[68:71], v[44:47], a[244:247]
    v_mfma_f32_16x16x32_bf16 a[248:251], v[72:75], v[44:47], a[248:251]
    v_mfma_f32_16x16x32_bf16 a[252:255], v[76:79], v[44:47], a[252:255]
    buffer_load_dwordx4 v[16:19], v4, s[12:15], s24 offen offset:0
    buffer_load_dwordx4 v[20:23], v4, s[12:15], s24 offen offset:1024
    buffer_load_dwordx4 v[24:27], v5, s[12:15], s24 offen offset:0
    buffer_load_dwordx4 v[28:31], v5, s[12:15], s24 offen offset:1024
    buffer_load_dwordx4 v[32:35], v6, s[12:15], s24 offen offset:0
    buffer_load_dwordx4 v[36:39], v6, s[12:15], s24 offen offset:1024
    buffer_load_dwordx4 v[40:43], v7, s[12:15], s24 offen offset:0
    buffer_load_dwordx4 v[44:47], v7, s[12:15], s24 offen offset:1024
    buffer_load_dwordx4 v[48:51], v4, s[16:19], s25 offen offset:0
    buffer_load_dwordx4 v[52:55], v4, s[16:19], s25 offen offset:1024
    buffer_load_dwordx4 v[56:59], v5, s[16:19], s25 offen offset:0
    buffer_load_dwordx4 v[60:63], v5, s[16:19], s25 offen offset:1024
    buffer_load_dwordx4 v[64:67], v6, s[16:19], s25 offen offset:0
    buffer_load_dwordx4 v[68:71], v6, s[16:19], s25 offen offset:1024
    buffer_load_dwordx4 v[72:75], v7, s[16:19], s25 offen offset:0
    buffer_load_dwordx4 v[76:79], v7, s[16:19], s25 offen offset:1024
    s_add_u32 s24, s24, 0x800
    s_add_u32 s25, s25, 0x800
    s_waitcnt vmcnt(16)
    v_mfma_f32_16x16x32_bf16 a[0:3], v[112:115], v[80:83], a[0:3]
    v_mfma_f32_16x16x32_bf16 a[4:7], v[116:119], v[80:83], a[4:7]
    v_mfma_f32_16x16x32_bf16 a[8:11], v[120:123], v[80:83], a[8:11]
    v_mfma_f32_16x16x32_bf16 a[12:15], v[124:127], v[80:83], a[12:15]
    v_mfma_f32_16x16x32_bf16 a[16:19], v[128:131], v[80:83], a[16:19]
    v_mfma_f32_16x16x32_bf16 a[20:23], v[132:135], v[80:83], a[20:23]
    v_mfma_f32_16x16x32_bf16 a[24:27], v[136:139], v[80:83], a[24:27]
    v_mfma_f32_16x16x32_bf16 a[28:31], v[140:143], v[80:83], a[28:31]
    v_mfma_f32_16x16x32_bf16 a[32:35], v[112:115], v[84:87], a[32:35]
    v_mfma_f32_16x16x32_bf16 a[36:39], v[116:119], v[84:87], a[36:39]
    v_mfma_f32_16x16x32_bf16 a[40:43], v[120:123], v[84:87], a[40:43]
    v_mfma_f32_16x16x32_bf16 a[44:47], v[124:127], v[84:87], a[44:47]
    v_mfma_f32_16x16x32_bf16 a[48:51], v[128:131], v[84:87], a[48:51]
    v_mfma_f32_16x16x32_bf16 a[52:55], v[132:135], v[84:87], a[52:55]
    v_mfma_f32_16x16x32_bf16 a[56:59], v[136:139], v[84:87], a[56:59]
    v_mfma_f32_16x16x32_bf16 a[60:63], v[140:143], v[84:87], a[60:63]
    v_mfma_f32_16x16x32_bf16 a[64:67], v[112:115], v[88:91], a[64:67]
    v_mfma_f32_16x16x32_bf16 a[68:71], v[116:119], v[88:91], a[68:71]
    v_mfma_f32_16x16x32_bf16 a[72:75], v[120:123], v[88:91], a[72:75]
    v_mfma_f32_16x16x32_bf16 a[76:79], v[124:127], v[88:91], a[76:79]
    v_mfma_f32_16x16x32_bf16 a[80:83], v[128:131], v[88:91], a[80:83]
    v_mfma_f32_16x16x32_bf16 a[84:87], v[132:135], v[88:91], a[84:87]
    v_mfma_f32_16x16x32_bf16 a[88:91], v[136:139], v[88:91], a[88:91]
    v_mfma_f32_16x16x32_bf16 a[92:95], v[140:143], v[88:91], a[92:95]
    v_mfma_f32_16x16x32_bf16 a[96:99], v[112:115], v[92:95], a[96:99]
    v_mfma_f32_16x16x32_bf16 a[100:103], v[116:119], v[92:95], a[100:103]
    v_mfma_f32_16x16x32_bf16 a[104:107], v[120:123], v[92:95], a[104:107]
    v_mfma_f32_16x16x32_bf16 a[108:111], v[124:127], v[92:95], a[108:111]
    v_mfma_f32_16x16x32_bf16 a[112:115], v[128:131], v[92:95], a[112:115]
    v_mfma_f32_16x16x32_bf16 a[116:119], v[132:135], v[92:95], a[116:119]
    v_mfma_f32_16x16x32_bf16 a[120:123], v[136:139], v[92:95], a[120:123]
    v_mfma_f32_16x16x32_bf16 a[124:127], v[140:143], v[92:95], a[124:127]
    v_mfma_f32_16x16x32_bf16 a[128:131], v[112:115], v[96:99], a[128:131]
    v_mfma_f32_16x16x32_bf16 a[132:135], v[116:119], v[96:99], a[132:135]
    v_mfma_f32_16x16x32_bf16 a[136:139], v[120:123], v[96:99], a[136:139]
    v_mfma_f32_16x16x32_bf16 a[140:143], v[124:127], v[96:99], a[140:143]
    v_mfma_f32_16x16x32_bf16 a[144:147], v[128:131], v[96:99], a[144:147]
    v_mfma_f32_16x16x32_bf16 a[148:151], v[132:135], v[96:99], a[148:151]
    v_mfma_f32_16x16x32_bf16 a[152:155], v[136:139], v[96:99], a[152:155]
    v_mfma_f32_16x16x32_bf16 a[156:159], v[140:143], v[96:99], a[156:159]
    v_mfma_f32_16x16x32_bf16 a[160:163], v[112:115], v[100:103], a[160:163]
    v_mfma_f32_16x16x32_bf16 a[164:167], v[116:119], v[100:103], a[164:167]
    v_mfma_f32_16x16x32_bf16 a[168:171], v[120:123], v[100:103], a[168:171]
    v_mfma_f32_16x16x32_bf16 a[172:175], v[124:127], v[100:103], a[172:175]
    v_mfma_f32_16x16x32_bf16 a[176:179], v[128:131], v[100:103], a[176:179]
    v_mfma_f32_16x16x32_bf16 a[180:183], v[132:135], v[100:103], a[180:183]
    v_mfma_f32_16x16x32_bf16 a[184:187], v[136:139], v[100:103], a[184:187]
    v_mfma_f32_16x16x32_bf16 a[188:191], v[140:143], v[100:103], a[188:191]
    v_mfma_f32_16x16x32_bf16 a[192:195], v[112:115], v[104:107], a[192:195]
    v_mfma_f32_16x16x32_bf16 a[196:199], v[116:119], v[104:107], a[196:199]
    v_mfma_f32_16x16x32_bf16 a[200:203], v[120:123], v[104:107], a[200:203]
    v_mfma_f32_16x16x32_bf16 a[204:207], v[124:127], v[104:107], a[204:207]
    v_mfma_f32_16x16x32_bf16 a[208:211], v[128:131], v[104:107], a[208:211]
    v_mfma_f32_16x16x32_bf16 a[212:215], v[132:135], v[104:107], a[212:215]
    v_mfma_f32_16x16x32_bf16 a[216:219], v[136:139], v[104:107], a[216:219]
    v_mfma_f32_16x16x32_bf16 a[220:223], v[140:143], v[104:107], a[220:223]
    v_mfma_f32_16x16x32_bf16 a[224:227], v[112:115], v[108:111], a[224:227]
    v_mfma_f32_16x16x32_bf16 a[228:231], v[116:119], v[108:111], a[228:231]
    v_mfma_f32_16x16x32_bf16 a[232:235], v[120:123], v[108:111], a[232:235]
    v_mfma_f32_16x16x32_bf16 a[236:239], v[124:127], v[108:111], a[236:239]
    v_mfma_f32_16x16x32_bf16 a[240:243], v[128:131], v[108:111], a[240:243]
    v_mfma_f32_16x16x32_bf16 a[244:247], v[132:135], v[108:111], a[244:247]
    v_mfma_f32_16x16x32_bf16 a[248:251], v[136:139], v[108:111], a[248:251]
    v_mfma_f32_16x16x32_bf16 a[252:255], v[140:143], v[108:111], a[252:255]
    buffer_load_dwordx4 v[80:83], v4, s[12:15], s24 offen offset:0
    buffer_load_dwordx4 v[84:87], v4, s[12:15], s24 offen offset:1024
    buffer_load_dwordx4 v[88:91], v5, s[12:15], s24 offen offset:0
    buffer_load_dwordx4 v[92:95], v5, s[12:15], s24 offen offset:1024
    buffer_load_dwordx4 v[96:99], v6, s[12:15], s24 offen offset:0
    buffer_load_dwordx4 v[100:103], v6, s[12:15], s24 offen offset:1024
    buffer_load_dwordx4 v[104:107], v7, s[12:15], s24 offen offset:0
    buffer_load_dwordx4 v[108:111], v7, s[12:15], s24 offen offset:1024
    buffer_load_dwordx4 v[112:115], v4, s[16:19], s25 offen offset:0
    buffer_load_dwordx4 v[116:119], v4, s[16:19], s25 offen offset:1024
    buffer_load_dwordx4 v[120:123], v5, s[16:19], s25 offen offset:0
    buffer_load_dwordx4 v[124:127], v5, s[16:19], s25 offen offset:1024
    buffer_load_dwordx4 v[128:131], v6, s[16:19], s25 offen offset:0
    buffer_load_dwordx4 v[132:135], v6, s[16:19], s25 offen offset:1024
    buffer_load_dwordx4 v[136:139], v7, s[16:19], s25 offen offset:0
    buffer_load_dwordx4 v[140:143], v7, s[16:19], s25 offen offset:1024
    s_add_u32 s24, s24, 0x800
    s_add_u32 s25, s25, 0x800
    s_waitcnt vmcnt(16)
    v_mfma_f32_16x16x32_bf16 a[0:3], v[48:51], v[16:19], a[0:3]
    v_mfma_f32_16x16x32_bf16 a[4:7], v[52:55], v[16:19], a[4:7]
    v_mfma_f32_16x16x32_bf16 a[8:11], v[56:59], v[16:19], a[8:11]
    v_mfma_f32_16x16x32_bf16 a[12:15], v[60:63], v[16:19], a[12:15]
    v_mfma_f32_16x16x32_bf16 a[16:19], v[64:67], v[16:19], a[16:19]
    v_mfma_f32_16x16x32_bf16 a[20:23], v[68:71], v[16:19], a[20:23]
    v_mfma_f32_16x16x32_bf16 a[24:27], v[72:75], v[16:19], a[24:27]
    v_mfma_f32_16x16x32_bf16 a[28:31], v[76:79], v[16:19], a[28:31]
    v_mfma_f32_16x16x32_bf16 a[32:35], v[48:51], v[20:23], a[32:35]
    v_mfma_f32_16x16x32_bf16 a[36:39], v[52:55], v[20:23], a[36:39]
    v_mfma_f32_16x16x32_bf16 a[40:43], v[56:59], v[20:23], a[40:43]
    v_mfma_f32_16x16x32_bf16 a[44:47], v[60:63], v[20:23], a[44:47]
    v_mfma_f32_16x16x32_bf16 a[48:51], v[64:67], v[20:23], a[48:51]
    v_mfma_f32_16x16x32_bf16 a[52:55], v[68:71], v[20:23], a[52:55]
    v_mfma_f32_16x16x32_bf16 a[56:59], v[72:75], v[20:23], a[56:59]
    v_mfma_f32_16x16x32_bf16 a[60:63], v[76:79], v[20:23], a[60:63]
    v_mfma_f32_16x16x32_bf16 a[64:67], v[48:51], v[24:27], a[64:67]
    v_mfma_f32_16x16x32_bf16 a[68:71], v[52:55], v[24:27], a[68:71]
    v_mfma_f32_16x16x32_bf16 a[72:75], v[56:59], v[24:27], a[72:75]
    v_mfma_f32_16x16x32_bf16 a[76:79], v[60:63], v[24:27], a[76:79]
    v_mfma_f32_16x16x32_bf16 a[80:83], v[64:67], v[24:27], a[80:83]
    v_mfma_f32_16x16x32_bf16 a[84:87], v[68:71], v[24:27], a[84:87]
    v_mfma_f32_16x16x32_bf16 a[88:91], v[72:75], v[24:27], a[88:91]
    v_mfma_f32_16x16x32_bf16 a[92:95], v[76:79], v[24:27], a[92:95]
    v_mfma_f32_16x16x32_bf16 a[96:99], v[48:51], v[28:31], a[96:99]
    v_mfma_f32_16x16x32_bf16 a[100:103], v[52:55], v[28:31], a[100:103]
    v_mfma_f32_16x16x32_bf16 a[104:107], v[56:59], v[28:31], a[104:107]
    v_mfma_f32_16x16x32_bf16 a[108:111], v[60:63], v[28:31], a[108:111]
    v_mfma_f32_16x16x32_bf16 a[112:115], v[64:67], v[28:31], a[112:115]
    v_mfma_f32_16x16x32_bf16 a[116:119], v[68:71], v[28:31], a[116:119]
    v_mfma_f32_16x16x32_bf16 a[120:123], v[72:75], v[28:31], a[120:123]
    v_mfma_f32_16x16x32_bf16 a[124:127], v[76:79], v[28:31], a[124:127]
    v_mfma_f32_16x16x32_bf16 a[128:131], v[48:51], v[32:35], a[128:131]
    v_mfma_f32_16x16x32_bf16 a[132:135], v[52:55], v[32:35], a[132:135]
    v_mfma_f32_16x16x32_bf16 a[136:139], v[56:59], v[32:35], a[136:139]
    v_mfma_f32_16x16x32_bf16 a[140:143], v[60:63], v[32:35], a[140:143]
    v_mfma_f32_16x16x32_bf16 a[144:147], v[64:67], v[32:35], a[144:147]
    v_mfma_f32_16x16x32_bf16 a[148:151], v[68:71], v[32:35], a[148:151]
    v_mfma_f32_16x16x32_bf16 a[152:155], v[72:75], v[32:35], a[152:155]
    v_mfma_f32_16x16x32_bf16 a[156:159], v[76:79], v[32:35], a[156:159]
    v_mfma_f32_16x16x32_bf16 a[160:163], v[48:51], v[36:39], a[160:163]
    v_mfma_f32_16x16x32_bf16 a[164:167], v[52:55], v[36:39], a[164:167]
    v_mfma_f32_16x16x32_bf16 a[168:171], v[56:59], v[36:39], a[168:171]
    v_mfma_f32_16x16x32_bf16 a[172:175], v[60:63], v[36:39], a[172:175]
    v_mfma_f32_16x16x32_bf16 a[176:179], v[64:67], v[36:39], a[176:179]
    v_mfma_f32_16x16x32_bf16 a[180:183], v[68:71], v[36:39], a[180:183]
    v_mfma_f32_16x16x32_bf16 a[184:187], v[72:75], v[36:39], a[184:187]
    v_mfma_f32_16x16x32_bf16 a[188:191], v[76:79], v[36:39], a[188:191]
    v_mfma_f32_16x16x32_bf16 a[192:195], v[48:51], v[40:43], a[192:195]
    v_mfma_f32_16x16x32_bf16 a[196:199], v[52:55], v[40:43], a[196:199]
    v_mfma_f32_16x16x32_bf16 a[200:203], v[56:59], v[40:43], a[200:203]
    v_mfma_f32_16x16x32_bf16 a[204:207], v[60:63], v[40:43], a[204:207]
    v_mfma_f32_16x16x32_bf16 a[208:211], v[64:67], v[40:43], a[208:211]
    v_mfma_f32_16x16x32_bf16 a[212:215], v[68:71], v[40:43], a[212:215]
    v_mfma_f32_16x16x32_bf16 a[216:219], v[72:75], v[40:43], a[216:219]
    v_mfma_f32_16x16x32_bf16 a[220:223], v[76:79], v[40:43], a[220:223]
    v_mfma_f32_16x16x32_bf16 a[224:227], v[48:51], v[44:47], a[224:227]
    v_mfma_f32_16x16x32_bf16 a[228:231], v[52:55], v[44:47], a[228:231]
    v_mfma_f32_16x16x32_bf16 a[232:235], v[56:59], v[44:47], a[232:235]
    v_mfma_f32_16x16x32_bf16 a[236:239], v[60:63], v[44:47], a[236:239]
    v_mfma_f32_16x16x32_bf16 a[240:243], v[64:67], v[44:47], a[240:243]
    v_mfma_f32_16x16x32_bf16 a[244:247], v[68:71], v[44:47], a[244:247]
    v_mfma_f32_16x16x32_bf16 a[248:251], v[72:75], v[44:47], a[248:251]
    v_mfma_f32_16x16x32_bf16 a[252:255], v[76:79], v[44:47], a[252:255]
    buffer_load_dwordx4 v[16:19], v4, s[12:15], s24 offen offset:0
    buffer_load_dwordx4 v[20:23], v4, s[12:15], s24 offen offset:1024
    buffer_load_dwordx4 v[24:27], v5, s[12:15], s24 offen offset:0
    buffer_load_dwordx4 v[28:31], v5, s[12:15], s24 offen offset:1024
    buffer_load_dwordx4 v[32:35], v6, s[12:15], s24 offen offset:0
    buffer_load_dwordx4 v[36:39], v6, s[12:15], s24 offen offset:1024
    buffer_load_dwordx4 v[40:43], v7, s[12:15], s24 offen offset:0
    buffer_load_dwordx4 v[44:47], v7, s[12:15], s24 offen offset:1024
    buffer_load_dwordx4 v[48:51], v4, s[16:19], s25 offen offset:0
    buffer_load_dwordx4 v[52:55], v4, s[16:19], s25 offen offset:1024
    buffer_load_dwordx4 v[56:59], v5, s[16:19], s25 offen offset:0
    buffer_load_dwordx4 v[60:63], v5, s[16:19], s25 offen offset:1024
    buffer_load_dwordx4 v[64:67], v6, s[16:19], s25 offen offset:0
    buffer_load_dwordx4 v[68:71], v6, s[16:19], s25 offen offset:1024
    buffer_load_dwordx4 v[72:75], v7, s[16:19], s25 offen offset:0
    buffer_load_dwordx4 v[76:79], v7, s[16:19], s25 offen offset:1024
    s_add_u32 s24, s24, 0x800
    s_add_u32 s25, s25, 0x800
    s_waitcnt vmcnt(16)
    v_mfma_f32_16x16x32_bf16 a[0:3], v[112:115], v[80:83], a[0:3]
    v_mfma_f32_16x16x32_bf16 a[4:7], v[116:119], v[80:83], a[4:7]
    v_mfma_f32_16x16x32_bf16 a[8:11], v[120:123], v[80:83], a[8:11]
    v_mfma_f32_16x16x32_bf16 a[12:15], v[124:127], v[80:83], a[12:15]
    v_mfma_f32_16x16x32_bf16 a[16:19], v[128:131], v[80:83], a[16:19]
    v_mfma_f32_16x16x32_bf16 a[20:23], v[132:135], v[80:83], a[20:23]
    v_mfma_f32_16x16x32_bf16 a[24:27], v[136:139], v[80:83], a[24:27]
    v_mfma_f32_16x16x32_bf16 a[28:31], v[140:143], v[80:83], a[28:31]
    v_mfma_f32_16x16x32_bf16 a[32:35], v[112:115], v[84:87], a[32:35]
    v_mfma_f32_16x16x32_bf16 a[36:39], v[116:119], v[84:87], a[36:39]
    v_mfma_f32_16x16x32_bf16 a[40:43], v[120:123], v[84:87], a[40:43]
    v_mfma_f32_16x16x32_bf16 a[44:47], v[124:127], v[84:87], a[44:47]
    v_mfma_f32_16x16x32_bf16 a[48:51], v[128:131], v[84:87], a[48:51]
    v_mfma_f32_16x16x32_bf16 a[52:55], v[132:135], v[84:87], a[52:55]
    v_mfma_f32_16x16x32_bf16 a[56:59], v[136:139], v[84:87], a[56:59]
    v_mfma_f32_16x16x32_bf16 a[60:63], v[140:143], v[84:87], a[60:63]
    v_mfma_f32_16x16x32_bf16 a[64:67], v[112:115], v[88:91], a[64:67]
    v_mfma_f32_16x16x32_bf16 a[68:71], v[116:119], v[88:91], a[68:71]
    v_mfma_f32_16x16x32_bf16 a[72:75], v[120:123], v[88:91], a[72:75]
    v_mfma_f32_16x16x32_bf16 a[76:79], v[124:127], v[88:91], a[76:79]
    v_mfma_f32_16x16x32_bf16 a[80:83], v[128:131], v[88:91], a[80:83]
    v_mfma_f32_16x16x32_bf16 a[84:87], v[132:135], v[88:91], a[84:87]
    v_mfma_f32_16x16x32_bf16 a[88:91], v[136:139], v[88:91], a[88:91]
    v_mfma_f32_16x16x32_bf16 a[92:95], v[140:143], v[88:91], a[92:95]
    v_mfma_f32_16x16x32_bf16 a[96:99], v[112:115], v[92:95], a[96:99]
    v_mfma_f32_16x16x32_bf16 a[100:103], v[116:119], v[92:95], a[100:103]
    v_mfma_f32_16x16x32_bf16 a[104:107], v[120:123], v[92:95], a[104:107]
    v_mfma_f32_16x16x32_bf16 a[108:111], v[124:127], v[92:95], a[108:111]
    v_mfma_f32_16x16x32_bf16 a[112:115], v[128:131], v[92:95], a[112:115]
    v_mfma_f32_16x16x32_bf16 a[116:119], v[132:135], v[92:95], a[116:119]
    v_mfma_f32_16x16x32_bf16 a[120:123], v[136:139], v[92:95], a[120:123]
    v_mfma_f32_16x16x32_bf16 a[124:127], v[140:143], v[92:95], a[124:127]
    v_mfma_f32_16x16x32_bf16 a[128:131], v[112:115], v[96:99], a[128:131]
    v_mfma_f32_16x16x32_bf16 a[132:135], v[116:119], v[96:99], a[132:135]
    v_mfma_f32_16x16x32_bf16 a[136:139], v[120:123], v[96:99], a[136:139]
    v_mfma_f32_16x16x32_bf16 a[140:143], v[124:127], v[96:99], a[140:143]
    v_mfma_f32_16x16x32_bf16 a[144:147], v[128:131], v[96:99], a[144:147]
    v_mfma_f32_16x16x32_bf16 a[148:151], v[132:135], v[96:99], a[148:151]
    v_mfma_f32_16x16x32_bf16 a[152:155], v[136:139], v[96:99], a[152:155]
    v_mfma_f32_16x16x32_bf16 a[156:159], v[140:143], v[96:99], a[156:159]
    v_mfma_f32_16x16x32_bf16 a[160:163], v[112:115], v[100:103], a[160:163]
    v_mfma_f32_16x16x32_bf16 a[164:167], v[116:119], v[100:103], a[164:167]
    v_mfma_f32_16x16x32_bf16 a[168:171], v[120:123], v[100:103], a[168:171]
    v_mfma_f32_16x16x32_bf16 a[172:175], v[124:127], v[100:103], a[172:175]
    v_mfma_f32_16x16x32_bf16 a[176:179], v[128:131], v[100:103], a[176:179]
    v_mfma_f32_16x16x32_bf16 a[180:183], v[132:135], v[100:103], a[180:183]
    v_mfma_f32_16x16x32_bf16 a[184:187], v[136:139], v[100:103], a[184:187]
    v_mfma_f32_16x16x32_bf16 a[188:191], v[140:143], v[100:103], a[188:191]
    v_mfma_f32_16x16x32_bf16 a[192:195], v[112:115], v[104:107], a[192:195]
    v_mfma_f32_16x16x32_bf16 a[196:199], v[116:119], v[104:107], a[196:199]
    v_mfma_f32_16x16x32_bf16 a[200:203], v[120:123], v[104:107], a[200:203]
    v_mfma_f32_16x16x32_bf16 a[204:207], v[124:127], v[104:107], a[204:207]
    v_mfma_f32_16x16x32_bf16 a[208:211], v[128:131], v[104:107], a[208:211]
    v_mfma_f32_16x16x32_bf16 a[212:215], v[132:135], v[104:107], a[212:215]
    v_mfma_f32_16x16x32_bf16 a[216:219], v[136:139], v[104:107], a[216:219]
    v_mfma_f32_16x16x32_bf16 a[220:223], v[140:143], v[104:107], a[220:223]
    v_mfma_f32_16x16x32_bf16 a[224:227], v[112:115], v[108:111], a[224:227]
    v_mfma_f32_16x16x32_bf16 a[228:231], v[116:119], v[108:111], a[228:231]
    v_mfma_f32_16x16x32_bf16 a[232:235], v[120:123], v[108:111], a[232:235]
    v_mfma_f32_16x16x32_bf16 a[236:239], v[124:127], v[108:111], a[236:239]
    v_mfma_f32_16x16x32_bf16 a[240:243], v[128:131], v[108:111], a[240:243]
    v_mfma_f32_16x16x32_bf16 a[244:247], v[132:135], v[108:111], a[244:247]
    v_mfma_f32_16x16x32_bf16 a[248:251], v[136:139], v[108:111], a[248:251]
    v_mfma_f32_16x16x32_bf16 a[252:255], v[140:143], v[108:111], a[252:255]
    buffer_load_dwordx4 v[80:83], v4, s[12:15], s24 offen offset:0
    buffer_load_dwordx4 v[84:87], v4, s[12:15], s24 offen offset:1024
    buffer_load_dwordx4 v[88:91], v5, s[12:15], s24 offen offset:0
    buffer_load_dwordx4 v[92:95], v5, s[12:15], s24 offen offset:1024
    buffer_load_dwordx4 v[96:99], v6, s[12:15], s24 offen offset:0
    buffer_load_dwordx4 v[100:103], v6, s[12:15], s24 offen offset:1024
    buffer_load_dwordx4 v[104:107], v7, s[12:15], s24 offen offset:0
    buffer_load_dwordx4 v[108:111], v7, s[12:15], s24 offen offset:1024
    buffer_load_dwordx4 v[112:115], v4, s[16:19], s25 offen offset:0
    buffer_load_dwordx4 v[116:119], v4, s[16:19], s25 offen offset:1024
    buffer_load_dwordx4 v[120:123], v5, s[16:19], s25 offen offset:0
    buffer_load_dwordx4 v[124:127], v5, s[16:19], s25 offen offset:1024
    buffer_load_dwordx4 v[128:131], v6, s[16:19], s25 offen offset:0
    buffer_load_dwordx4 v[132:135], v6, s[16:19], s25 offen offset:1024
    buffer_load_dwordx4 v[136:139], v7, s[16:19], s25 offen offset:0
    buffer_load_dwordx4 v[140:143], v7, s[16:19], s25 offen offset:1024
    s_add_u32 s24, s24, 0x800
    s_add_u32 s25, s25, 0x800
    s_waitcnt vmcnt(16)
    v_mfma_f32_16x16x32_bf16 a[0:3], v[48:51], v[16:19], a[0:3]
    v_mfma_f32_16x16x32_bf16 a[4:7], v[52:55], v[16:19], a[4:7]
    v_mfma_f32_16x16x32_bf16 a[8:11], v[56:59], v[16:19], a[8:11]
    v_mfma_f32_16x16x32_bf16 a[12:15], v[60:63], v[16:19], a[12:15]
    v_mfma_f32_16x16x32_bf16 a[16:19], v[64:67], v[16:19], a[16:19]
    v_mfma_f32_16x16x32_bf16 a[20:23], v[68:71], v[16:19], a[20:23]
    v_mfma_f32_16x16x32_bf16 a[24:27], v[72:75], v[16:19], a[24:27]
    v_mfma_f32_16x16x32_bf16 a[28:31], v[76:79], v[16:19], a[28:31]
    v_mfma_f32_16x16x32_bf16 a[32:35], v[48:51], v[20:23], a[32:35]
    v_mfma_f32_16x16x32_bf16 a[36:39], v[52:55], v[20:23], a[36:39]
    v_mfma_f32_16x16x32_bf16 a[40:43], v[56:59], v[20:23], a[40:43]
    v_mfma_f32_16x16x32_bf16 a[44:47], v[60:63], v[20:23], a[44:47]
    v_mfma_f32_16x16x32_bf16 a[48:51], v[64:67], v[20:23], a[48:51]
    v_mfma_f32_16x16x32_bf16 a[52:55], v[68:71], v[20:23], a[52:55]
    v_mfma_f32_16x16x32_bf16 a[56:59], v[72:75], v[20:23], a[56:59]
    v_mfma_f32_16x16x32_bf16 a[60:63], v[76:79], v[20:23], a[60:63]
    v_mfma_f32_16x16x32_bf16 a[64:67], v[48:51], v[24:27], a[64:67]
    v_mfma_f32_16x16x32_bf16 a[68:71], v[52:55], v[24:27], a[68:71]
    v_mfma_f32_16x16x32_bf16 a[72:75], v[56:59], v[24:27], a[72:75]
    v_mfma_f32_16x16x32_bf16 a[76:79], v[60:63], v[24:27], a[76:79]
    v_mfma_f32_16x16x32_bf16 a[80:83], v[64:67], v[24:27], a[80:83]
    v_mfma_f32_16x16x32_bf16 a[84:87], v[68:71], v[24:27], a[84:87]
    v_mfma_f32_16x16x32_bf16 a[88:91], v[72:75], v[24:27], a[88:91]
    v_mfma_f32_16x16x32_bf16 a[92:95], v[76:79], v[24:27], a[92:95]
    v_mfma_f32_16x16x32_bf16 a[96:99], v[48:51], v[28:31], a[96:99]
    v_mfma_f32_16x16x32_bf16 a[100:103], v[52:55], v[28:31], a[100:103]
    v_mfma_f32_16x16x32_bf16 a[104:107], v[56:59], v[28:31], a[104:107]
    v_mfma_f32_16x16x32_bf16 a[108:111], v[60:63], v[28:31], a[108:111]
    v_mfma_f32_16x16x32_bf16 a[112:115], v[64:67], v[28:31], a[112:115]
    v_mfma_f32_16x16x32_bf16 a[116:119], v[68:71], v[28:31], a[116:119]
    v_mfma_f32_16x16x32_bf16 a[120:123], v[72:75], v[28:31], a[120:123]
    v_mfma_f32_16x16x32_bf16 a[124:127], v[76:79], v[28:31], a[124:127]
    v_mfma_f32_16x16x32_bf16 a[128:131], v[48:51], v[32:35], a[128:131]
    v_mfma_f32_16x16x32_bf16 a[132:135], v[52:55], v[32:35], a[132:135]
    v_mfma_f32_16x16x32_bf16 a[136:139], v[56:59], v[32:35], a[136:139]
    v_mfma_f32_16x16x32_bf16 a[140:143], v[60:63], v[32:35], a[140:143]
    v_mfma_f32_16x16x32_bf16 a[144:147], v[64:67], v[32:35], a[144:147]
    v_mfma_f32_16x16x32_bf16 a[148:151], v[68:71], v[32:35], a[148:151]
    v_mfma_f32_16x16x32_bf16 a[152:155], v[72:75], v[32:35], a[152:155]
    v_mfma_f32_16x16x32_bf16 a[156:159], v[76:79], v[32:35], a[156:159]
    v_mfma_f32_16x16x32_bf16 a[160:163], v[48:51], v[36:39], a[160:163]
    v_mfma_f32_16x16x32_bf16 a[164:167], v[52:55], v[36:39], a[164:167]
    v_mfma_f32_16x16x32_bf16 a[168:171], v[56:59], v[36:39], a[168:171]
    v_mfma_f32_16x16x32_bf16 a[172:175], v[60:63], v[36:39], a[172:175]
    v_mfma_f32_16x16x32_bf16 a[176:179], v[64:67], v[36:39], a[176:179]
    v_mfma_f32_16x16x32_bf16 a[180:183], v[68:71], v[36:39], a[180:183]
    v_mfma_f32_16x16x32_bf16 a[184:187], v[72:75], v[36:39], a[184:187]
    v_mfma_f32_16x16x32_bf16 a[188:191], v[76:79], v[36:39], a[188:191]
    v_mfma_f32_16x16x32_bf16 a[192:195], v[48:51], v[40:43], a[192:195]
    v_mfma_f32_16x16x32_bf16 a[196:199], v[52:55], v[40:43], a[196:199]
    v_mfma_f32_16x16x32_bf16 a[200:203], v[56:59], v[40:43], a[200:203]
    v_mfma_f32_16x16x32_bf16 a[204:207], v[60:63], v[40:43], a[204:207]
    v_mfma_f32_16x16x32_bf16 a[208:211], v[64:67], v[40:43], a[208:211]
    v_mfma_f32_16x16x32_bf16 a[212:215], v[68:71], v[40:43], a[212:215]
    v_mfma_f32_16x16x32_bf16 a[216:219], v[72:75], v[40:43], a[216:219]
    v_mfma_f32_16x16x32_bf16 a[220:223], v[76:79], v[40:43], a[220:223]
    v_mfma_f32_16x16x32_bf16 a[224:227], v[48:51], v[44:47], a[224:227]
    v_mfma_f32_16x16x32_bf16 a[228:231], v[52:55], v[44:47], a[228:231]
    v_mfma_f32_16x16x32_bf16 a[232:235], v[56:59], v[44:47], a[232:235]
    v_mfma_f32_16x16x32_bf16 a[236:239], v[60:63], v[44:47], a[236:239]
    v_mfma_f32_16x16x32_bf16 a[240:243], v[64:67], v[44:47], a[240:243]
    v_mfma_f32_16x16x32_bf16 a[244:247], v[68:71], v[44:47], a[244:247]
    v_mfma_f32_16x16x32_bf16 a[248:251], v[72:75], v[44:47], a[248:251]
    v_mfma_f32_16x16x32_bf16 a[252:255], v[76:79], v[44:47], a[252:255]
    buffer_load_dwordx4 v[16:19], v4, s[12:15], s24 offen offset:0
    buffer_load_dwordx4 v[20:23], v4, s[12:15], s24 offen offset:1024
    buffer_load_dwordx4 v[24:27], v5, s[12:15], s24 offen offset:0
    buffer_load_dwordx4 v[28:31], v5, s[12:15], s24 offen offset:1024
    buffer_load_dwordx4 v[32:35], v6, s[12:15], s24 offen offset:0
    buffer_load_dwordx4 v[36:39], v6, s[12:15], s24 offen offset:1024
    buffer_load_dwordx4 v[40:43], v7, s[12:15], s24 offen offset:0
    buffer_load_dwordx4 v[44:47], v7, s[12:15], s24 offen offset:1024
    buffer_load_dwordx4 v[48:51], v4, s[16:19], s25 offen offset:0
    buffer_load_dwordx4 v[52:55], v4, s[16:19], s25 offen offset:1024
    buffer_load_dwordx4 v[56:59], v5, s[16:19], s25 offen offset:0
    buffer_load_dwordx4 v[60:63], v5, s[16:19], s25 offen offset:1024
    buffer_load_dwordx4 v[64:67], v6, s[16:19], s25 offen offset:0
    buffer_load_dwordx4 v[68:71], v6, s[16:19], s25 offen offset:1024
    buffer_load_dwordx4 v[72:75], v7, s[16:19], s25 offen offset:0
    buffer_load_dwordx4 v[76:79], v7, s[16:19], s25 offen offset:1024
    s_add_u32 s24, s24, 0x800
    s_add_u32 s25, s25, 0x800
    s_waitcnt vmcnt(16)
    v_mfma_f32_16x16x32_bf16 a[0:3], v[112:115], v[80:83], a[0:3]
    v_mfma_f32_16x16x32_bf16 a[4:7], v[116:119], v[80:83], a[4:7]
    v_mfma_f32_16x16x32_bf16 a[8:11], v[120:123], v[80:83], a[8:11]
    v_mfma_f32_16x16x32_bf16 a[12:15], v[124:127], v[80:83], a[12:15]
    v_mfma_f32_16x16x32_bf16 a[16:19], v[128:131], v[80:83], a[16:19]
    v_mfma_f32_16x16x32_bf16 a[20:23], v[132:135], v[80:83], a[20:23]
    v_mfma_f32_16x16x32_bf16 a[24:27], v[136:139], v[80:83], a[24:27]
    v_mfma_f32_16x16x32_bf16 a[28:31], v[140:143], v[80:83], a[28:31]
    v_mfma_f32_16x16x32_bf16 a[32:35], v[112:115], v[84:87], a[32:35]
    v_mfma_f32_16x16x32_bf16 a[36:39], v[116:119], v[84:87], a[36:39]
    v_mfma_f32_16x16x32_bf16 a[40:43], v[120:123], v[84:87], a[40:43]
    v_mfma_f32_16x16x32_bf16 a[44:47], v[124:127], v[84:87], a[44:47]
    v_mfma_f32_16x16x32_bf16 a[48:51], v[128:131], v[84:87], a[48:51]
    v_mfma_f32_16x16x32_bf16 a[52:55], v[132:135], v[84:87], a[52:55]
    v_mfma_f32_16x16x32_bf16 a[56:59], v[136:139], v[84:87], a[56:59]
    v_mfma_f32_16x16x32_bf16 a[60:63], v[140:143], v[84:87], a[60:63]
    v_mfma_f32_16x16x32_bf16 a[64:67], v[112:115], v[88:91], a[64:67]
    v_mfma_f32_16x16x32_bf16 a[68:71], v[116:119], v[88:91], a[68:71]
    v_mfma_f32_16x16x32_bf16 a[72:75], v[120:123], v[88:91], a[72:75]
    v_mfma_f32_16x16x32_bf16 a[76:79], v[124:127], v[88:91], a[76:79]
    v_mfma_f32_16x16x32_bf16 a[80:83], v[128:131], v[88:91], a[80:83]
    v_mfma_f32_16x16x32_bf16 a[84:87], v[132:135], v[88:91], a[84:87]
    v_mfma_f32_16x16x32_bf16 a[88:91], v[136:139], v[88:91], a[88:91]
    v_mfma_f32_16x16x32_bf16 a[92:95], v[140:143], v[88:91], a[92:95]
    v_mfma_f32_16x16x32_bf16 a[96:99], v[112:115], v[92:95], a[96:99]
    v_mfma_f32_16x16x32_bf16 a[100:103], v[116:119], v[92:95], a[100:103]
    v_mfma_f32_16x16x32_bf16 a[104:107], v[120:123], v[92:95], a[104:107]
    v_mfma_f32_16x16x32_bf16 a[108:111], v[124:127], v[92:95], a[108:111]
    v_mfma_f32_16x16x32_bf16 a[112:115], v[128:131], v[92:95], a[112:115]
    v_mfma_f32_16x16x32_bf16 a[116:119], v[132:135], v[92:95], a[116:119]
    v_mfma_f32_16x16x32_bf16 a[120:123], v[136:139], v[92:95], a[120:123]
    v_mfma_f32_16x16x32_bf16 a[124:127], v[140:143], v[92:95], a[124:127]
    v_mfma_f32_16x16x32_bf16 a[128:131], v[112:115], v[96:99], a[128:131]
    v_mfma_f32_16x16x32_bf16 a[132:135], v[116:119], v[96:99], a[132:135]
    v_mfma_f32_16x16x32_bf16 a[136:139], v[120:123], v[96:99], a[136:139]
    v_mfma_f32_16x16x32_bf16 a[140:143], v[124:127], v[96:99], a[140:143]
    v_mfma_f32_16x16x32_bf16 a[144:147], v[128:131], v[96:99], a[144:147]
    v_mfma_f32_16x16x32_bf16 a[148:151], v[132:135], v[96:99], a[148:151]
    v_mfma_f32_16x16x32_bf16 a[152:155], v[136:139], v[96:99], a[152:155]
    v_mfma_f32_16x16x32_bf16 a[156:159], v[140:143], v[96:99], a[156:159]
    v_mfma_f32_16x16x32_bf16 a[160:163], v[112:115], v[100:103], a[160:163]
    v_mfma_f32_16x16x32_bf16 a[164:167], v[116:119], v[100:103], a[164:167]
    v_mfma_f32_16x16x32_bf16 a[168:171], v[120:123], v[100:103], a[168:171]
    v_mfma_f32_16x16x32_bf16 a[172:175], v[124:127], v[100:103], a[172:175]
    v_mfma_f32_16x16x32_bf16 a[176:179], v[128:131], v[100:103], a[176:179]
    v_mfma_f32_16x16x32_bf16 a[180:183], v[132:135], v[100:103], a[180:183]
    v_mfma_f32_16x16x32_bf16 a[184:187], v[136:139], v[100:103], a[184:187]
    v_mfma_f32_16x16x32_bf16 a[188:191], v[140:143], v[100:103], a[188:191]
    v_mfma_f32_16x16x32_bf16 a[192:195], v[112:115], v[104:107], a[192:195]
    v_mfma_f32_16x16x32_bf16 a[196:199], v[116:119], v[104:107], a[196:199]
    v_mfma_f32_16x16x32_bf16 a[200:203], v[120:123], v[104:107], a[200:203]
    v_mfma_f32_16x16x32_bf16 a[204:207], v[124:127], v[104:107], a[204:207]
    v_mfma_f32_16x16x32_bf16 a[208:211], v[128:131], v[104:107], a[208:211]
    v_mfma_f32_16x16x32_bf16 a[212:215], v[132:135], v[104:107], a[212:215]
    v_mfma_f32_16x16x32_bf16 a[216:219], v[136:139], v[104:107], a[216:219]
    v_mfma_f32_16x16x32_bf16 a[220:223], v[140:143], v[104:107], a[220:223]
    v_mfma_f32_16x16x32_bf16 a[224:227], v[112:115], v[108:111], a[224:227]
    v_mfma_f32_16x16x32_bf16 a[228:231], v[116:119], v[108:111], a[228:231]
    v_mfma_f32_16x16x32_bf16 a[232:235], v[120:123], v[108:111], a[232:235]
    v_mfma_f32_16x16x32_bf16 a[236:239], v[124:127], v[108:111], a[236:239]
    v_mfma_f32_16x16x32_bf16 a[240:243], v[128:131], v[108:111], a[240:243]
    v_mfma_f32_16x16x32_bf16 a[244:247], v[132:135], v[108:111], a[244:247]
    v_mfma_f32_16x16x32_bf16 a[248:251], v[136:139], v[108:111], a[248:251]
    v_mfma_f32_16x16x32_bf16 a[252:255], v[140:143], v[108:111], a[252:255]
    buffer_load_dwordx4 v[80:83], v4, s[12:15], s24 offen offset:0
    buffer_load_dwordx4 v[84:87], v4, s[12:15], s24 offen offset:1024
    buffer_load_dwordx4 v[88:91], v5, s[12:15], s24 offen offset:0
    buffer_load_dwordx4 v[92:95], v5, s[12:15], s24 offen offset:1024
    buffer_load_dwordx4 v[96:99], v6, s[12:15], s24 offen offset:0
    buffer_load_dwordx4 v[100:103], v6, s[12:15], s24 offen offset:1024
    buffer_load_dwordx4 v[104:107], v7, s[12:15], s24 offen offset:0
    buffer_load_dwordx4 v[108:111], v7, s[12:15], s24 offen offset:1024
    buffer_load_dwordx4 v[112:115], v4, s[16:19], s25 offen offset:0
    buffer_load_dwordx4 v[116:119], v4, s[16:19], s25 offen offset:1024
    buffer_load_dwordx4 v[120:123], v5, s[16:19], s25 offen offset:0
    buffer_load_dwordx4 v[124:127], v5, s[16:19], s25 offen offset:1024
    buffer_load_dwordx4 v[128:131], v6, s[16:19], s25 offen offset:0
    buffer_load_dwordx4 v[132:135], v6, s[16:19], s25 offen offset:1024
    buffer_load_dwordx4 v[136:139], v7, s[16:19], s25 offen offset:0
    buffer_load_dwordx4 v[140:143], v7, s[16:19], s25 offen offset:1024
    s_add_u32 s24, s24, 0x800
    s_add_u32 s25, s25, 0x800
    s_waitcnt vmcnt(16)
    v_mfma_f32_16x16x32_bf16 a[0:3], v[48:51], v[16:19], a[0:3]
    v_mfma_f32_16x16x32_bf16 a[4:7], v[52:55], v[16:19], a[4:7]
    v_mfma_f32_16x16x32_bf16 a[8:11], v[56:59], v[16:19], a[8:11]
    v_mfma_f32_16x16x32_bf16 a[12:15], v[60:63], v[16:19], a[12:15]
    v_mfma_f32_16x16x32_bf16 a[16:19], v[64:67], v[16:19], a[16:19]
    v_mfma_f32_16x16x32_bf16 a[20:23], v[68:71], v[16:19], a[20:23]
    v_mfma_f32_16x16x32_bf16 a[24:27], v[72:75], v[16:19], a[24:27]
    v_mfma_f32_16x16x32_bf16 a[28:31], v[76:79], v[16:19], a[28:31]
    v_mfma_f32_16x16x32_bf16 a[32:35], v[48:51], v[20:23], a[32:35]
    v_mfma_f32_16x16x32_bf16 a[36:39], v[52:55], v[20:23], a[36:39]
    v_mfma_f32_16x16x32_bf16 a[40:43], v[56:59], v[20:23], a[40:43]
    v_mfma_f32_16x16x32_bf16 a[44:47], v[60:63], v[20:23], a[44:47]
    v_mfma_f32_16x16x32_bf16 a[48:51], v[64:67], v[20:23], a[48:51]
    v_mfma_f32_16x16x32_bf16 a[52:55], v[68:71], v[20:23], a[52:55]
    v_mfma_f32_16x16x32_bf16 a[56:59], v[72:75], v[20:23], a[56:59]
    v_mfma_f32_16x16x32_bf16 a[60:63], v[76:79], v[20:23], a[60:63]
    v_mfma_f32_16x16x32_bf16 a[64:67], v[48:51], v[24:27], a[64:67]
    v_mfma_f32_16x16x32_bf16 a[68:71], v[52:55], v[24:27], a[68:71]
    v_mfma_f32_16x16x32_bf16 a[72:75], v[56:59], v[24:27], a[72:75]
    v_mfma_f32_16x16x32_bf16 a[76:79], v[60:63], v[24:27], a[76:79]
    v_mfma_f32_16x16x32_bf16 a[80:83], v[64:67], v[24:27], a[80:83]
    v_mfma_f32_16x16x32_bf16 a[84:87], v[68:71], v[24:27], a[84:87]
    v_mfma_f32_16x16x32_bf16 a[88:91], v[72:75], v[24:27], a[88:91]
    v_mfma_f32_16x16x32_bf16 a[92:95], v[76:79], v[24:27], a[92:95]
    v_mfma_f32_16x16x32_bf16 a[96:99], v[48:51], v[28:31], a[96:99]
    v_mfma_f32_16x16x32_bf16 a[100:103], v[52:55], v[28:31], a[100:103]
    v_mfma_f32_16x16x32_bf16 a[104:107], v[56:59], v[28:31], a[104:107]
    v_mfma_f32_16x16x32_bf16 a[108:111], v[60:63], v[28:31], a[108:111]
    v_mfma_f32_16x16x32_bf16 a[112:115], v[64:67], v[28:31], a[112:115]
    v_mfma_f32_16x16x32_bf16 a[116:119], v[68:71], v[28:31], a[116:119]
    v_mfma_f32_16x16x32_bf16 a[120:123], v[72:75], v[28:31], a[120:123]
    v_mfma_f32_16x16x32_bf16 a[124:127], v[76:79], v[28:31], a[124:127]
    v_mfma_f32_16x16x32_bf16 a[128:131], v[48:51], v[32:35], a[128:131]
    v_mfma_f32_16x16x32_bf16 a[132:135], v[52:55], v[32:35], a[132:135]
    v_mfma_f32_16x16x32_bf16 a[136:139], v[56:59], v[32:35], a[136:139]
    v_mfma_f32_16x16x32_bf16 a[140:143], v[60:63], v[32:35], a[140:143]
    v_mfma_f32_16x16x32_bf16 a[144:147], v[64:67], v[32:35], a[144:147]
    v_mfma_f32_16x16x32_bf16 a[148:151], v[68:71], v[32:35], a[148:151]
    v_mfma_f32_16x16x32_bf16 a[152:155], v[72:75], v[32:35], a[152:155]
    v_mfma_f32_16x16x32_bf16 a[156:159], v[76:79], v[32:35], a[156:159]
    v_mfma_f32_16x16x32_bf16 a[160:163], v[48:51], v[36:39], a[160:163]
    v_mfma_f32_16x16x32_bf16 a[164:167], v[52:55], v[36:39], a[164:167]
    v_mfma_f32_16x16x32_bf16 a[168:171], v[56:59], v[36:39], a[168:171]
    v_mfma_f32_16x16x32_bf16 a[172:175], v[60:63], v[36:39], a[172:175]
    v_mfma_f32_16x16x32_bf16 a[176:179], v[64:67], v[36:39], a[176:179]
    v_mfma_f32_16x16x32_bf16 a[180:183], v[68:71], v[36:39], a[180:183]
    v_mfma_f32_16x16x32_bf16 a[184:187], v[72:75], v[36:39], a[184:187]
    v_mfma_f32_16x16x32_bf16 a[188:191], v[76:79], v[36:39], a[188:191]
    v_mfma_f32_16x16x32_bf16 a[192:195], v[48:51], v[40:43], a[192:195]
    v_mfma_f32_16x16x32_bf16 a[196:199], v[52:55], v[40:43], a[196:199]
    v_mfma_f32_16x16x32_bf16 a[200:203], v[56:59], v[40:43], a[200:203]
    v_mfma_f32_16x16x32_bf16 a[204:207], v[60:63], v[40:43], a[204:207]
    v_mfma_f32_16x16x32_bf16 a[208:211], v[64:67], v[40:43], a[208:211]
    v_mfma_f32_16x16x32_bf16 a[212:215], v[68:71], v[40:43], a[212:215]
    v_mfma_f32_16x16x32_bf16 a[216:219], v[72:75], v[40:43], a[216:219]
    v_mfma_f32_16x16x32_bf16 a[220:223], v[76:79], v[40:43], a[220:223]
    v_mfma_f32_16x16x32_bf16 a[224:227], v[48:51], v[44:47], a[224:227]
    v_mfma_f32_16x16x32_bf16 a[228:231], v[52:55], v[44:47], a[228:231]
    v_mfma_f32_16x16x32_bf16 a[232:235], v[56:59], v[44:47], a[232:235]
    v_mfma_f32_16x16x32_bf16 a[236:239], v[60:63], v[44:47], a[236:239]
    v_mfma_f32_16x16x32_bf16 a[240:243], v[64:67], v[44:47], a[240:243]
    v_mfma_f32_16x16x32_bf16 a[244:247], v[68:71], v[44:47], a[244:247]
    v_mfma_f32_16x16x32_bf16 a[248:251], v[72:75], v[44:47], a[248:251]
    v_mfma_f32_16x16x32_bf16 a[252:255], v[76:79], v[44:47], a[252:255]
    buffer_load_dwordx4 v[16:19], v4, s[12:15], s24 offen offset:0
    buffer_load_dwordx4 v[20:23], v4, s[12:15], s24 offen offset:1024
    buffer_load_dwordx4 v[24:27], v5, s[12:15], s24 offen offset:0
    buffer_load_dwordx4 v[28:31], v5, s[12:15], s24 offen offset:1024
    buffer_load_dwordx4 v[32:35], v6, s[12:15], s24 offen offset:0
    buffer_load_dwordx4 v[36:39], v6, s[12:15], s24 offen offset:1024
    buffer_load_dwordx4 v[40:43], v7, s[12:15], s24 offen offset:0
    buffer_load_dwordx4 v[44:47], v7, s[12:15], s24 offen offset:1024
    buffer_load_dwordx4 v[48:51], v4, s[16:19], s25 offen offset:0
    buffer_load_dwordx4 v[52:55], v4, s[16:19], s25 offen offset:1024
    buffer_load_dwordx4 v[56:59], v5, s[16:19], s25 offen offset:0
    buffer_load_dwordx4 v[60:63], v5, s[16:19], s25 offen offset:1024
    buffer_load_dwordx4 v[64:67], v6, s[16:19], s25 offen offset:0
    buffer_load_dwordx4 v[68:71], v6, s[16:19], s25 offen offset:1024
    buffer_load_dwordx4 v[72:75], v7, s[16:19], s25 offen offset:0
    buffer_load_dwordx4 v[76:79], v7, s[16:19], s25 offen offset:1024
    s_add_u32 s24, s24, 0x800
    s_add_u32 s25, s25, 0x800
    s_waitcnt vmcnt(16)
    v_mfma_f32_16x16x32_bf16 a[0:3], v[112:115], v[80:83], a[0:3]
    v_mfma_f32_16x16x32_bf16 a[4:7], v[116:119], v[80:83], a[4:7]
    v_mfma_f32_16x16x32_bf16 a[8:11], v[120:123], v[80:83], a[8:11]
    v_mfma_f32_16x16x32_bf16 a[12:15], v[124:127], v[80:83], a[12:15]
    v_mfma_f32_16x16x32_bf16 a[16:19], v[128:131], v[80:83], a[16:19]
    v_mfma_f32_16x16x32_bf16 a[20:23], v[132:135], v[80:83], a[20:23]
    v_mfma_f32_16x16x32_bf16 a[24:27], v[136:139], v[80:83], a[24:27]
    v_mfma_f32_16x16x32_bf16 a[28:31], v[140:143], v[80:83], a[28:31]
    v_mfma_f32_16x16x32_bf16 a[32:35], v[112:115], v[84:87], a[32:35]
    v_mfma_f32_16x16x32_bf16 a[36:39], v[116:119], v[84:87], a[36:39]
    v_mfma_f32_16x16x32_bf16 a[40:43], v[120:123], v[84:87], a[40:43]
    v_mfma_f32_16x16x32_bf16 a[44:47], v[124:127], v[84:87], a[44:47]
    v_mfma_f32_16x16x32_bf16 a[48:51], v[128:131], v[84:87], a[48:51]
    v_mfma_f32_16x16x32_bf16 a[52:55], v[132:135], v[84:87], a[52:55]
    v_mfma_f32_16x16x32_bf16 a[56:59], v[136:139], v[84:87], a[56:59]
    v_mfma_f32_16x16x32_bf16 a[60:63], v[140:143], v[84:87], a[60:63]
    v_mfma_f32_16x16x32_bf16 a[64:67], v[112:115], v[88:91], a[64:67]
    v_mfma_f32_16x16x32_bf16 a[68:71], v[116:119], v[88:91], a[68:71]
    v_mfma_f32_16x16x32_bf16 a[72:75], v[120:123], v[88:91], a[72:75]
    v_mfma_f32_16x16x32_bf16 a[76:79], v[124:127], v[88:91], a[76:79]
    v_mfma_f32_16x16x32_bf16 a[80:83], v[128:131], v[88:91], a[80:83]
    v_mfma_f32_16x16x32_bf16 a[84:87], v[132:135], v[88:91], a[84:87]
    v_mfma_f32_16x16x32_bf16 a[88:91], v[136:139], v[88:91], a[88:91]
    v_mfma_f32_16x16x32_bf16 a[92:95], v[140:143], v[88:91], a[92:95]
    v_mfma_f32_16x16x32_bf16 a[96:99], v[112:115], v[92:95], a[96:99]
    v_mfma_f32_16x16x32_bf16 a[100:103], v[116:119], v[92:95], a[100:103]
    v_mfma_f32_16x16x32_bf16 a[104:107], v[120:123], v[92:95], a[104:107]
    v_mfma_f32_16x16x32_bf16 a[108:111], v[124:127], v[92:95], a[108:111]
    v_mfma_f32_16x16x32_bf16 a[112:115], v[128:131], v[92:95], a[112:115]
    v_mfma_f32_16x16x32_bf16 a[116:119], v[132:135], v[92:95], a[116:119]
    v_mfma_f32_16x16x32_bf16 a[120:123], v[136:139], v[92:95], a[120:123]
    v_mfma_f32_16x16x32_bf16 a[124:127], v[140:143], v[92:95], a[124:127]
    v_mfma_f32_16x16x32_bf16 a[128:131], v[112:115], v[96:99], a[128:131]
    v_mfma_f32_16x16x32_bf16 a[132:135], v[116:119], v[96:99], a[132:135]
    v_mfma_f32_16x16x32_bf16 a[136:139], v[120:123], v[96:99], a[136:139]
    v_mfma_f32_16x16x32_bf16 a[140:143], v[124:127], v[96:99], a[140:143]
    v_mfma_f32_16x16x32_bf16 a[144:147], v[128:131], v[96:99], a[144:147]
    v_mfma_f32_16x16x32_bf16 a[148:151], v[132:135], v[96:99], a[148:151]
    v_mfma_f32_16x16x32_bf16 a[152:155], v[136:139], v[96:99], a[152:155]
    v_mfma_f32_16x16x32_bf16 a[156:159], v[140:143], v[96:99], a[156:159]
    v_mfma_f32_16x16x32_bf16 a[160:163], v[112:115], v[100:103], a[160:163]
    v_mfma_f32_16x16x32_bf16 a[164:167], v[116:119], v[100:103], a[164:167]
    v_mfma_f32_16x16x32_bf16 a[168:171], v[120:123], v[100:103], a[168:171]
    v_mfma_f32_16x16x32_bf16 a[172:175], v[124:127], v[100:103], a[172:175]
    v_mfma_f32_16x16x32_bf16 a[176:179], v[128:131], v[100:103], a[176:179]
    v_mfma_f32_16x16x32_bf16 a[180:183], v[132:135], v[100:103], a[180:183]
    v_mfma_f32_16x16x32_bf16 a[184:187], v[136:139], v[100:103], a[184:187]
    v_mfma_f32_16x16x32_bf16 a[188:191], v[140:143], v[100:103], a[188:191]
    v_mfma_f32_16x16x32_bf16 a[192:195], v[112:115], v[104:107], a[192:195]
    v_mfma_f32_16x16x32_bf16 a[196:199], v[116:119], v[104:107], a[196:199]
    v_mfma_f32_16x16x32_bf16 a[200:203], v[120:123], v[104:107], a[200:203]
    v_mfma_f32_16x16x32_bf16 a[204:207], v[124:127], v[104:107], a[204:207]
    v_mfma_f32_16x16x32_bf16 a[208:211], v[128:131], v[104:107], a[208:211]
    v_mfma_f32_16x16x32_bf16 a[212:215], v[132:135], v[104:107], a[212:215]
    v_mfma_f32_16x16x32_bf16 a[216:219], v[136:139], v[104:107], a[216:219]
    v_mfma_f32_16x16x32_bf16 a[220:223], v[140:143], v[104:107], a[220:223]
    v_mfma_f32_16x16x32_bf16 a[224:227], v[112:115], v[108:111], a[224:227]
    v_mfma_f32_16x16x32_bf16 a[228:231], v[116:119], v[108:111], a[228:231]
    v_mfma_f32_16x16x32_bf16 a[232:235], v[120:123], v[108:111], a[232:235]
    v_mfma_f32_16x16x32_bf16 a[236:239], v[124:127], v[108:111], a[236:239]
    v_mfma_f32_16x16x32_bf16 a[240:243], v[128:131], v[108:111], a[240:243]
    v_mfma_f32_16x16x32_bf16 a[244:247], v[132:135], v[108:111], a[244:247]
    v_mfma_f32_16x16x32_bf16 a[248:251], v[136:139], v[108:111], a[248:251]
    v_mfma_f32_16x16x32_bf16 a[252:255], v[140:143], v[108:111], a[252:255]
    buffer_load_dwordx4 v[80:83], v4, s[12:15], s24 offen offset:0
    buffer_load_dwordx4 v[84:87], v4, s[12:15], s24 offen offset:1024
    buffer_load_dwordx4 v[88:91], v5, s[12:15], s24 offen offset:0
    buffer_load_dwordx4 v[92:95], v5, s[12:15], s24 offen offset:1024
    buffer_load_dwordx4 v[96:99], v6, s[12:15], s24 offen offset:0
    buffer_load_dwordx4 v[100:103], v6, s[12:15], s24 offen offset:1024
    buffer_load_dwordx4 v[104:107], v7, s[12:15], s24 offen offset:0
    buffer_load_dwordx4 v[108:111], v7, s[12:15], s24 offen offset:1024
    buffer_load_dwordx4 v[112:115], v4, s[16:19], s25 offen offset:0
    buffer_load_dwordx4 v[116:119], v4, s[16:19], s25 offen offset:1024
    buffer_load_dwordx4 v[120:123], v5, s[16:19], s25 offen offset:0
    buffer_load_dwordx4 v[124:127], v5, s[16:19], s25 offen offset:1024
    buffer_load_dwordx4 v[128:131], v6, s[16:19], s25 offen offset:0
    buffer_load_dwordx4 v[132:135], v6, s[16:19], s25 offen offset:1024
    buffer_load_dwordx4 v[136:139], v7, s[16:19], s25 offen offset:0
    buffer_load_dwordx4 v[140:143], v7, s[16:19], s25 offen offset:1024
    s_add_u32 s24, s24, 0x800
    s_add_u32 s25, s25, 0x800
    s_waitcnt vmcnt(16)
    v_mfma_f32_16x16x32_bf16 a[0:3], v[48:51], v[16:19], a[0:3]
    v_mfma_f32_16x16x32_bf16 a[4:7], v[52:55], v[16:19], a[4:7]
    v_mfma_f32_16x16x32_bf16 a[8:11], v[56:59], v[16:19], a[8:11]
    v_mfma_f32_16x16x32_bf16 a[12:15], v[60:63], v[16:19], a[12:15]
    v_mfma_f32_16x16x32_bf16 a[16:19], v[64:67], v[16:19], a[16:19]
    v_mfma_f32_16x16x32_bf16 a[20:23], v[68:71], v[16:19], a[20:23]
    v_mfma_f32_16x16x32_bf16 a[24:27], v[72:75], v[16:19], a[24:27]
    v_mfma_f32_16x16x32_bf16 a[28:31], v[76:79], v[16:19], a[28:31]
    v_mfma_f32_16x16x32_bf16 a[32:35], v[48:51], v[20:23], a[32:35]
    v_mfma_f32_16x16x32_bf16 a[36:39], v[52:55], v[20:23], a[36:39]
    v_mfma_f32_16x16x32_bf16 a[40:43], v[56:59], v[20:23], a[40:43]
    v_mfma_f32_16x16x32_bf16 a[44:47], v[60:63], v[20:23], a[44:47]
    v_mfma_f32_16x16x32_bf16 a[48:51], v[64:67], v[20:23], a[48:51]
    v_mfma_f32_16x16x32_bf16 a[52:55], v[68:71], v[20:23], a[52:55]
    v_mfma_f32_16x16x32_bf16 a[56:59], v[72:75], v[20:23], a[56:59]
    v_mfma_f32_16x16x32_bf16 a[60:63], v[76:79], v[20:23], a[60:63]
    v_mfma_f32_16x16x32_bf16 a[64:67], v[48:51], v[24:27], a[64:67]
    v_mfma_f32_16x16x32_bf16 a[68:71], v[52:55], v[24:27], a[68:71]
    v_mfma_f32_16x16x32_bf16 a[72:75], v[56:59], v[24:27], a[72:75]
    v_mfma_f32_16x16x32_bf16 a[76:79], v[60:63], v[24:27], a[76:79]
    v_mfma_f32_16x16x32_bf16 a[80:83], v[64:67], v[24:27], a[80:83]
    v_mfma_f32_16x16x32_bf16 a[84:87], v[68:71], v[24:27], a[84:87]
    v_mfma_f32_16x16x32_bf16 a[88:91], v[72:75], v[24:27], a[88:91]
    v_mfma_f32_16x16x32_bf16 a[92:95], v[76:79], v[24:27], a[92:95]
    v_mfma_f32_16x16x32_bf16 a[96:99], v[48:51], v[28:31], a[96:99]
    v_mfma_f32_16x16x32_bf16 a[100:103], v[52:55], v[28:31], a[100:103]
    v_mfma_f32_16x16x32_bf16 a[104:107], v[56:59], v[28:31], a[104:107]
    v_mfma_f32_16x16x32_bf16 a[108:111], v[60:63], v[28:31], a[108:111]
    v_mfma_f32_16x16x32_bf16 a[112:115], v[64:67], v[28:31], a[112:115]
    v_mfma_f32_16x16x32_bf16 a[116:119], v[68:71], v[28:31], a[116:119]
    v_mfma_f32_16x16x32_bf16 a[120:123], v[72:75], v[28:31], a[120:123]
    v_mfma_f32_16x16x32_bf16 a[124:127], v[76:79], v[28:31], a[124:127]
    v_mfma_f32_16x16x32_bf16 a[128:131], v[48:51], v[32:35], a[128:131]
    v_mfma_f32_16x16x32_bf16 a[132:135], v[52:55], v[32:35], a[132:135]
    v_mfma_f32_16x16x32_bf16 a[136:139], v[56:59], v[32:35], a[136:139]
    v_mfma_f32_16x16x32_bf16 a[140:143], v[60:63], v[32:35], a[140:143]
    v_mfma_f32_16x16x32_bf16 a[144:147], v[64:67], v[32:35], a[144:147]
    v_mfma_f32_16x16x32_bf16 a[148:151], v[68:71], v[32:35], a[148:151]
    v_mfma_f32_16x16x32_bf16 a[152:155], v[72:75], v[32:35], a[152:155]
    v_mfma_f32_16x16x32_bf16 a[156:159], v[76:79], v[32:35], a[156:159]
    v_mfma_f32_16x16x32_bf16 a[160:163], v[48:51], v[36:39], a[160:163]
    v_mfma_f32_16x16x32_bf16 a[164:167], v[52:55], v[36:39], a[164:167]
    v_mfma_f32_16x16x32_bf16 a[168:171], v[56:59], v[36:39], a[168:171]
    v_mfma_f32_16x16x32_bf16 a[172:175], v[60:63], v[36:39], a[172:175]
    v_mfma_f32_16x16x32_bf16 a[176:179], v[64:67], v[36:39], a[176:179]
    v_mfma_f32_16x16x32_bf16 a[180:183], v[68:71], v[36:39], a[180:183]
    v_mfma_f32_16x16x32_bf16 a[184:187], v[72:75], v[36:39], a[184:187]
    v_mfma_f32_16x16x32_bf16 a[188:191], v[76:79], v[36:39], a[188:191]
    v_mfma_f32_16x16x32_bf16 a[192:195], v[48:51], v[40:43], a[192:195]
    v_mfma_f32_16x16x32_bf16 a[196:199], v[52:55], v[40:43], a[196:199]
    v_mfma_f32_16x16x32_bf16 a[200:203], v[56:59], v[40:43], a[200:203]
    v_mfma_f32_16x16x32_bf16 a[204:207], v[60:63], v[40:43], a[204:207]
    v_mfma_f32_16x16x32_bf16 a[208:211], v[64:67], v[40:43], a[208:211]
    v_mfma_f32_16x16x32_bf16 a[212:215], v[68:71], v[40:43], a[212:215]
    v_mfma_f32_16x16x32_bf16 a[216:219], v[72:75], v[40:43], a[216:219]
    v_mfma_f32_16x16x32_bf16 a[220:223], v[76:79], v[40:43], a[220:223]
    v_mfma_f32_16x16x32_bf16 a[224:227], v[48:51], v[44:47], a[224:227]
    v_mfma_f32_16x16x32_bf16 a[228:231], v[52:55], v[44:47], a[228:231]
    v_mfma_f32_16x16x32_bf16 a[232:235], v[56:59], v[44:47], a[232:235]
    v_mfma_f32_16x16x32_bf16 a[236:239], v[60:63], v[44:47], a[236:239]
    v_mfma_f32_16x16x32_bf16 a[240:243], v[64:67], v[44:47], a[240:243]
    v_mfma_f32_16x16x32_bf16 a[244:247], v[68:71], v[44:47], a[244:247]
    v_mfma_f32_16x16x32_bf16 a[248:251], v[72:75], v[44:47], a[248:251]
    v_mfma_f32_16x16x32_bf16 a[252:255], v[76:79], v[44:47], a[252:255]
    buffer_load_dwordx4 v[16:19], v4, s[12:15], s24 offen offset:0
    buffer_load_dwordx4 v[20:23], v4, s[12:15], s24 offen offset:1024
    buffer_load_dwordx4 v[24:27], v5, s[12:15], s24 offen offset:0
    buffer_load_dwordx4 v[28:31], v5, s[12:15], s24 offen offset:1024
    buffer_load_dwordx4 v[32:35], v6, s[12:15], s24 offen offset:0
    buffer_load_dwordx4 v[36:39], v6, s[12:15], s24 offen offset:1024
    buffer_load_dwordx4 v[40:43], v7, s[12:15], s24 offen offset:0
    buffer_load_dwordx4 v[44:47], v7, s[12:15], s24 offen offset:1024
    buffer_load_dwordx4 v[48:51], v4, s[16:19], s25 offen offset:0
    buffer_load_dwordx4 v[52:55], v4, s[16:19], s25 offen offset:1024
    buffer_load_dwordx4 v[56:59], v5, s[16:19], s25 offen offset:0
    buffer_load_dwordx4 v[60:63], v5, s[16:19], s25 offen offset:1024
    buffer_load_dwordx4 v[64:67], v6, s[16:19], s25 offen offset:0
    buffer_load_dwordx4 v[68:71], v6, s[16:19], s25 offen offset:1024
    buffer_load_dwordx4 v[72:75], v7, s[16:19], s25 offen offset:0
    buffer_load_dwordx4 v[76:79], v7, s[16:19], s25 offen offset:1024
    s_add_u32 s24, s24, 0x800
    s_add_u32 s25, s25, 0x800
    s_waitcnt vmcnt(16)
    v_mfma_f32_16x16x32_bf16 a[0:3], v[112:115], v[80:83], a[0:3]
    v_mfma_f32_16x16x32_bf16 a[4:7], v[116:119], v[80:83], a[4:7]
    v_mfma_f32_16x16x32_bf16 a[8:11], v[120:123], v[80:83], a[8:11]
    v_mfma_f32_16x16x32_bf16 a[12:15], v[124:127], v[80:83], a[12:15]
    v_mfma_f32_16x16x32_bf16 a[16:19], v[128:131], v[80:83], a[16:19]
    v_mfma_f32_16x16x32_bf16 a[20:23], v[132:135], v[80:83], a[20:23]
    v_mfma_f32_16x16x32_bf16 a[24:27], v[136:139], v[80:83], a[24:27]
    v_mfma_f32_16x16x32_bf16 a[28:31], v[140:143], v[80:83], a[28:31]
    v_mfma_f32_16x16x32_bf16 a[32:35], v[112:115], v[84:87], a[32:35]
    v_mfma_f32_16x16x32_bf16 a[36:39], v[116:119], v[84:87], a[36:39]
    v_mfma_f32_16x16x32_bf16 a[40:43], v[120:123], v[84:87], a[40:43]
    v_mfma_f32_16x16x32_bf16 a[44:47], v[124:127], v[84:87], a[44:47]
    v_mfma_f32_16x16x32_bf16 a[48:51], v[128:131], v[84:87], a[48:51]
    v_mfma_f32_16x16x32_bf16 a[52:55], v[132:135], v[84:87], a[52:55]
    v_mfma_f32_16x16x32_bf16 a[56:59], v[136:139], v[84:87], a[56:59]
    v_mfma_f32_16x16x32_bf16 a[60:63], v[140:143], v[84:87], a[60:63]
    v_mfma_f32_16x16x32_bf16 a[64:67], v[112:115], v[88:91], a[64:67]
    v_mfma_f32_16x16x32_bf16 a[68:71], v[116:119], v[88:91], a[68:71]
    v_mfma_f32_16x16x32_bf16 a[72:75], v[120:123], v[88:91], a[72:75]
    v_mfma_f32_16x16x32_bf16 a[76:79], v[124:127], v[88:91], a[76:79]
    v_mfma_f32_16x16x32_bf16 a[80:83], v[128:131], v[88:91], a[80:83]
    v_mfma_f32_16x16x32_bf16 a[84:87], v[132:135], v[88:91], a[84:87]
    v_mfma_f32_16x16x32_bf16 a[88:91], v[136:139], v[88:91], a[88:91]
    v_mfma_f32_16x16x32_bf16 a[92:95], v[140:143], v[88:91], a[92:95]
    v_mfma_f32_16x16x32_bf16 a[96:99], v[112:115], v[92:95], a[96:99]
    v_mfma_f32_16x16x32_bf16 a[100:103], v[116:119], v[92:95], a[100:103]
    v_mfma_f32_16x16x32_bf16 a[104:107], v[120:123], v[92:95], a[104:107]
    v_mfma_f32_16x16x32_bf16 a[108:111], v[124:127], v[92:95], a[108:111]
    v_mfma_f32_16x16x32_bf16 a[112:115], v[128:131], v[92:95], a[112:115]
    v_mfma_f32_16x16x32_bf16 a[116:119], v[132:135], v[92:95], a[116:119]
    v_mfma_f32_16x16x32_bf16 a[120:123], v[136:139], v[92:95], a[120:123]
    v_mfma_f32_16x16x32_bf16 a[124:127], v[140:143], v[92:95], a[124:127]
    v_mfma_f32_16x16x32_bf16 a[128:131], v[112:115], v[96:99], a[128:131]
    v_mfma_f32_16x16x32_bf16 a[132:135], v[116:119], v[96:99], a[132:135]
    v_mfma_f32_16x16x32_bf16 a[136:139], v[120:123], v[96:99], a[136:139]
    v_mfma_f32_16x16x32_bf16 a[140:143], v[124:127], v[96:99], a[140:143]
    v_mfma_f32_16x16x32_bf16 a[144:147], v[128:131], v[96:99], a[144:147]
    v_mfma_f32_16x16x32_bf16 a[148:151], v[132:135], v[96:99], a[148:151]
    v_mfma_f32_16x16x32_bf16 a[152:155], v[136:139], v[96:99], a[152:155]
    v_mfma_f32_16x16x32_bf16 a[156:159], v[140:143], v[96:99], a[156:159]
    v_mfma_f32_16x16x32_bf16 a[160:163], v[112:115], v[100:103], a[160:163]
    v_mfma_f32_16x16x32_bf16 a[164:167], v[116:119], v[100:103], a[164:167]
    v_mfma_f32_16x16x32_bf16 a[168:171], v[120:123], v[100:103], a[168:171]
    v_mfma_f32_16x16x32_bf16 a[172:175], v[124:127], v[100:103], a[172:175]
    v_mfma_f32_16x16x32_bf16 a[176:179], v[128:131], v[100:103], a[176:179]
    v_mfma_f32_16x16x32_bf16 a[180:183], v[132:135], v[100:103], a[180:183]
    v_mfma_f32_16x16x32_bf16 a[184:187], v[136:139], v[100:103], a[184:187]
    v_mfma_f32_16x16x32_bf16 a[188:191], v[140:143], v[100:103], a[188:191]
    v_mfma_f32_16x16x32_bf16 a[192:195], v[112:115], v[104:107], a[192:195]
    v_mfma_f32_16x16x32_bf16 a[196:199], v[116:119], v[104:107], a[196:199]
    v_mfma_f32_16x16x32_bf16 a[200:203], v[120:123], v[104:107], a[200:203]
    v_mfma_f32_16x16x32_bf16 a[204:207], v[124:127], v[104:107], a[204:207]
    v_mfma_f32_16x16x32_bf16 a[208:211], v[128:131], v[104:107], a[208:211]
    v_mfma_f32_16x16x32_bf16 a[212:215], v[132:135], v[104:107], a[212:215]
    v_mfma_f32_16x16x32_bf16 a[216:219], v[136:139], v[104:107], a[216:219]
    v_mfma_f32_16x16x32_bf16 a[220:223], v[140:143], v[104:107], a[220:223]
    v_mfma_f32_16x16x32_bf16 a[224:227], v[112:115], v[108:111], a[224:227]
    v_mfma_f32_16x16x32_bf16 a[228:231], v[116:119], v[108:111], a[228:231]
    v_mfma_f32_16x16x32_bf16 a[232:235], v[120:123], v[108:111], a[232:235]
    v_mfma_f32_16x16x32_bf16 a[236:239], v[124:127], v[108:111], a[236:239]
    v_mfma_f32_16x16x32_bf16 a[240:243], v[128:131], v[108:111], a[240:243]
    v_mfma_f32_16x16x32_bf16 a[244:247], v[132:135], v[108:111], a[244:247]
    v_mfma_f32_16x16x32_bf16 a[248:251], v[136:139], v[108:111], a[248:251]
    v_mfma_f32_16x16x32_bf16 a[252:255], v[140:143], v[108:111], a[252:255]
    buffer_load_dwordx4 v[80:83], v4, s[12:15], s24 offen offset:0
    buffer_load_dwordx4 v[84:87], v4, s[12:15], s24 offen offset:1024
    buffer_load_dwordx4 v[88:91], v5, s[12:15], s24 offen offset:0
    buffer_load_dwordx4 v[92:95], v5, s[12:15], s24 offen offset:1024
    buffer_load_dwordx4 v[96:99], v6, s[12:15], s24 offen offset:0
    buffer_load_dwordx4 v[100:103], v6, s[12:15], s24 offen offset:1024
    buffer_load_dwordx4 v[104:107], v7, s[12:15], s24 offen offset:0
    buffer_load_dwordx4 v[108:111], v7, s[12:15], s24 offen offset:1024
    buffer_load_dwordx4 v[112:115], v4, s[16:19], s25 offen offset:0
    buffer_load_dwordx4 v[116:119], v4, s[16:19], s25 offen offset:1024
    buffer_load_dwordx4 v[120:123], v5, s[16:19], s25 offen offset:0
    buffer_load_dwordx4 v[124:127], v5, s[16:19], s25 offen offset:1024
    buffer_load_dwordx4 v[128:131], v6, s[16:19], s25 offen offset:0
    buffer_load_dwordx4 v[132:135], v6, s[16:19], s25 offen offset:1024
    buffer_load_dwordx4 v[136:139], v7, s[16:19], s25 offen offset:0
    buffer_load_dwordx4 v[140:143], v7, s[16:19], s25 offen offset:1024
    s_add_u32 s24, s24, 0x800
    s_add_u32 s25, s25, 0x800
    s_waitcnt vmcnt(16)
    v_mfma_f32_16x16x32_bf16 a[0:3], v[48:51], v[16:19], a[0:3]
    v_mfma_f32_16x16x32_bf16 a[4:7], v[52:55], v[16:19], a[4:7]
    v_mfma_f32_16x16x32_bf16 a[8:11], v[56:59], v[16:19], a[8:11]
    v_mfma_f32_16x16x32_bf16 a[12:15], v[60:63], v[16:19], a[12:15]
    v_mfma_f32_16x16x32_bf16 a[16:19], v[64:67], v[16:19], a[16:19]
    v_mfma_f32_16x16x32_bf16 a[20:23], v[68:71], v[16:19], a[20:23]
    v_mfma_f32_16x16x32_bf16 a[24:27], v[72:75], v[16:19], a[24:27]
    v_mfma_f32_16x16x32_bf16 a[28:31], v[76:79], v[16:19], a[28:31]
    v_mfma_f32_16x16x32_bf16 a[32:35], v[48:51], v[20:23], a[32:35]
    v_mfma_f32_16x16x32_bf16 a[36:39], v[52:55], v[20:23], a[36:39]
    v_mfma_f32_16x16x32_bf16 a[40:43], v[56:59], v[20:23], a[40:43]
    v_mfma_f32_16x16x32_bf16 a[44:47], v[60:63], v[20:23], a[44:47]
    v_mfma_f32_16x16x32_bf16 a[48:51], v[64:67], v[20:23], a[48:51]
    v_mfma_f32_16x16x32_bf16 a[52:55], v[68:71], v[20:23], a[52:55]
    v_mfma_f32_16x16x32_bf16 a[56:59], v[72:75], v[20:23], a[56:59]
    v_mfma_f32_16x16x32_bf16 a[60:63], v[76:79], v[20:23], a[60:63]
    v_mfma_f32_16x16x32_bf16 a[64:67], v[48:51], v[24:27], a[64:67]
    v_mfma_f32_16x16x32_bf16 a[68:71], v[52:55], v[24:27], a[68:71]
    v_mfma_f32_16x16x32_bf16 a[72:75], v[56:59], v[24:27], a[72:75]
    v_mfma_f32_16x16x32_bf16 a[76:79], v[60:63], v[24:27], a[76:79]
    v_mfma_f32_16x16x32_bf16 a[80:83], v[64:67], v[24:27], a[80:83]
    v_mfma_f32_16x16x32_bf16 a[84:87], v[68:71], v[24:27], a[84:87]
    v_mfma_f32_16x16x32_bf16 a[88:91], v[72:75], v[24:27], a[88:91]
    v_mfma_f32_16x16x32_bf16 a[92:95], v[76:79], v[24:27], a[92:95]
    v_mfma_f32_16x16x32_bf16 a[96:99], v[48:51], v[28:31], a[96:99]
    v_mfma_f32_16x16x32_bf16 a[100:103], v[52:55], v[28:31], a[100:103]
    v_mfma_f32_16x16x32_bf16 a[104:107], v[56:59], v[28:31], a[104:107]
    v_mfma_f32_16x16x32_bf16 a[108:111], v[60:63], v[28:31], a[108:111]
    v_mfma_f32_16x16x32_bf16 a[112:115], v[64:67], v[28:31], a[112:115]
    v_mfma_f32_16x16x32_bf16 a[116:119], v[68:71], v[28:31], a[116:119]
    v_mfma_f32_16x16x32_bf16 a[120:123], v[72:75], v[28:31], a[120:123]
    v_mfma_f32_16x16x32_bf16 a[124:127], v[76:79], v[28:31], a[124:127]
    v_mfma_f32_16x16x32_bf16 a[128:131], v[48:51], v[32:35], a[128:131]
    v_mfma_f32_16x16x32_bf16 a[132:135], v[52:55], v[32:35], a[132:135]
    v_mfma_f32_16x16x32_bf16 a[136:139], v[56:59], v[32:35], a[136:139]
    v_mfma_f32_16x16x32_bf16 a[140:143], v[60:63], v[32:35], a[140:143]
    v_mfma_f32_16x16x32_bf16 a[144:147], v[64:67], v[32:35], a[144:147]
    v_mfma_f32_16x16x32_bf16 a[148:151], v[68:71], v[32:35], a[148:151]
    v_mfma_f32_16x16x32_bf16 a[152:155], v[72:75], v[32:35], a[152:155]
    v_mfma_f32_16x16x32_bf16 a[156:159], v[76:79], v[32:35], a[156:159]
    v_mfma_f32_16x16x32_bf16 a[160:163], v[48:51], v[36:39], a[160:163]
    v_mfma_f32_16x16x32_bf16 a[164:167], v[52:55], v[36:39], a[164:167]
    v_mfma_f32_16x16x32_bf16 a[168:171], v[56:59], v[36:39], a[168:171]
    v_mfma_f32_16x16x32_bf16 a[172:175], v[60:63], v[36:39], a[172:175]
    v_mfma_f32_16x16x32_bf16 a[176:179], v[64:67], v[36:39], a[176:179]
    v_mfma_f32_16x16x32_bf16 a[180:183], v[68:71], v[36:39], a[180:183]
    v_mfma_f32_16x16x32_bf16 a[184:187], v[72:75], v[36:39], a[184:187]
    v_mfma_f32_16x16x32_bf16 a[188:191], v[76:79], v[36:39], a[188:191]
    v_mfma_f32_16x16x32_bf16 a[192:195], v[48:51], v[40:43], a[192:195]
    v_mfma_f32_16x16x32_bf16 a[196:199], v[52:55], v[40:43], a[196:199]
    v_mfma_f32_16x16x32_bf16 a[200:203], v[56:59], v[40:43], a[200:203]
    v_mfma_f32_16x16x32_bf16 a[204:207], v[60:63], v[40:43], a[204:207]
    v_mfma_f32_16x16x32_bf16 a[208:211], v[64:67], v[40:43], a[208:211]
    v_mfma_f32_16x16x32_bf16 a[212:215], v[68:71], v[40:43], a[212:215]
    v_mfma_f32_16x16x32_bf16 a[216:219], v[72:75], v[40:43], a[216:219]
    v_mfma_f32_16x16x32_bf16 a[220:223], v[76:79], v[40:43], a[220:223]
    v_mfma_f32_16x16x32_bf16 a[224:227], v[48:51], v[44:47], a[224:227]
    v_mfma_f32_16x16x32_bf16 a[228:231], v[52:55], v[44:47], a[228:231]
    v_mfma_f32_16x16x32_bf16 a[232:235], v[56:59], v[44:47], a[232:235]
    v_mfma_f32_16x16x32_bf16 a[236:239], v[60:63], v[44:47], a[236:239]
    v_mfma_f32_16x16x32_bf16 a[240:243], v[64:67], v[44:47], a[240:243]
    v_mfma_f32_16x16x32_bf16 a[244:247], v[68:71], v[44:47], a[244:247]
    v_mfma_f32_16x16x32_bf16 a[248:251], v[72:75], v[44:47], a[248:251]
    v_mfma_f32_16x16x32_bf16 a[252:255], v[76:79], v[44:47], a[252:255]
    buffer_load_dwordx4 v[16:19], v4, s[12:15], s24 offen offset:0
    buffer_load_dwordx4 v[20:23], v4, s[12:15], s24 offen offset:1024
    buffer_load_dwordx4 v[24:27], v5, s[12:15], s24 offen offset:0
    buffer_load_dwordx4 v[28:31], v5, s[12:15], s24 offen offset:1024
    buffer_load_dwordx4 v[32:35], v6, s[12:15], s24 offen offset:0
    buffer_load_dwordx4 v[36:39], v6, s[12:15], s24 offen offset:1024
    buffer_load_dwordx4 v[40:43], v7, s[12:15], s24 offen offset:0
    buffer_load_dwordx4 v[44:47], v7, s[12:15], s24 offen offset:1024
    buffer_load_dwordx4 v[48:51], v4, s[16:19], s25 offen offset:0
    buffer_load_dwordx4 v[52:55], v4, s[16:19], s25 offen offset:1024
    buffer_load_dwordx4 v[56:59], v5, s[16:19], s25 offen offset:0
    buffer_load_dwordx4 v[60:63], v5, s[16:19], s25 offen offset:1024
    buffer_load_dwordx4 v[64:67], v6, s[16:19], s25 offen offset:0
    buffer_load_dwordx4 v[68:71], v6, s[16:19], s25 offen offset:1024
    buffer_load_dwordx4 v[72:75], v7, s[16:19], s25 offen offset:0
    buffer_load_dwordx4 v[76:79], v7, s[16:19], s25 offen offset:1024
    s_add_u32 s24, s24, 0x800
    s_add_u32 s25, s25, 0x800
    s_waitcnt vmcnt(16)
    v_mfma_f32_16x16x32_bf16 a[0:3], v[112:115], v[80:83], a[0:3]
    v_mfma_f32_16x16x32_bf16 a[4:7], v[116:119], v[80:83], a[4:7]
    v_mfma_f32_16x16x32_bf16 a[8:11], v[120:123], v[80:83], a[8:11]
    v_mfma_f32_16x16x32_bf16 a[12:15], v[124:127], v[80:83], a[12:15]
    v_mfma_f32_16x16x32_bf16 a[16:19], v[128:131], v[80:83], a[16:19]
    v_mfma_f32_16x16x32_bf16 a[20:23], v[132:135], v[80:83], a[20:23]
    v_mfma_f32_16x16x32_bf16 a[24:27], v[136:139], v[80:83], a[24:27]
    v_mfma_f32_16x16x32_bf16 a[28:31], v[140:143], v[80:83], a[28:31]
    v_mfma_f32_16x16x32_bf16 a[32:35], v[112:115], v[84:87], a[32:35]
    v_mfma_f32_16x16x32_bf16 a[36:39], v[116:119], v[84:87], a[36:39]
    v_mfma_f32_16x16x32_bf16 a[40:43], v[120:123], v[84:87], a[40:43]
    v_mfma_f32_16x16x32_bf16 a[44:47], v[124:127], v[84:87], a[44:47]
    v_mfma_f32_16x16x32_bf16 a[48:51], v[128:131], v[84:87], a[48:51]
    v_mfma_f32_16x16x32_bf16 a[52:55], v[132:135], v[84:87], a[52:55]
    v_mfma_f32_16x16x32_bf16 a[56:59], v[136:139], v[84:87], a[56:59]
    v_mfma_f32_16x16x32_bf16 a[60:63], v[140:143], v[84:87], a[60:63]
    v_mfma_f32_16x16x32_bf16 a[64:67], v[112:115], v[88:91], a[64:67]
    v_mfma_f32_16x16x32_bf16 a[68:71], v[116:119], v[88:91], a[68:71]
    v_mfma_f32_16x16x32_bf16 a[72:75], v[120:123], v[88:91], a[72:75]
    v_mfma_f32_16x16x32_bf16 a[76:79], v[124:127], v[88:91], a[76:79]
    v_mfma_f32_16x16x32_bf16 a[80:83], v[128:131], v[88:91], a[80:83]
    v_mfma_f32_16x16x32_bf16 a[84:87], v[132:135], v[88:91], a[84:87]
    v_mfma_f32_16x16x32_bf16 a[88:91], v[136:139], v[88:91], a[88:91]
    v_mfma_f32_16x16x32_bf16 a[92:95], v[140:143], v[88:91], a[92:95]
    v_mfma_f32_16x16x32_bf16 a[96:99], v[112:115], v[92:95], a[96:99]
    v_mfma_f32_16x16x32_bf16 a[100:103], v[116:119], v[92:95], a[100:103]
    v_mfma_f32_16x16x32_bf16 a[104:107], v[120:123], v[92:95], a[104:107]
    v_mfma_f32_16x16x32_bf16 a[108:111], v[124:127], v[92:95], a[108:111]
    v_mfma_f32_16x16x32_bf16 a[112:115], v[128:131], v[92:95], a[112:115]
    v_mfma_f32_16x16x32_bf16 a[116:119], v[132:135], v[92:95], a[116:119]
    v_mfma_f32_16x16x32_bf16 a[120:123], v[136:139], v[92:95], a[120:123]
    v_mfma_f32_16x16x32_bf16 a[124:127], v[140:143], v[92:95], a[124:127]
    v_mfma_f32_16x16x32_bf16 a[128:131], v[112:115], v[96:99], a[128:131]
    v_mfma_f32_16x16x32_bf16 a[132:135], v[116:119], v[96:99], a[132:135]
    v_mfma_f32_16x16x32_bf16 a[136:139], v[120:123], v[96:99], a[136:139]
    v_mfma_f32_16x16x32_bf16 a[140:143], v[124:127], v[96:99], a[140:143]
    v_mfma_f32_16x16x32_bf16 a[144:147], v[128:131], v[96:99], a[144:147]
    v_mfma_f32_16x16x32_bf16 a[148:151], v[132:135], v[96:99], a[148:151]
    v_mfma_f32_16x16x32_bf16 a[152:155], v[136:139], v[96:99], a[152:155]
    v_mfma_f32_16x16x32_bf16 a[156:159], v[140:143], v[96:99], a[156:159]
    v_mfma_f32_16x16x32_bf16 a[160:163], v[112:115], v[100:103], a[160:163]
    v_mfma_f32_16x16x32_bf16 a[164:167], v[116:119], v[100:103], a[164:167]
    v_mfma_f32_16x16x32_bf16 a[168:171], v[120:123], v[100:103], a[168:171]
    v_mfma_f32_16x16x32_bf16 a[172:175], v[124:127], v[100:103], a[172:175]
    v_mfma_f32_16x16x32_bf16 a[176:179], v[128:131], v[100:103], a[176:179]
    v_mfma_f32_16x16x32_bf16 a[180:183], v[132:135], v[100:103], a[180:183]
    v_mfma_f32_16x16x32_bf16 a[184:187], v[136:139], v[100:103], a[184:187]
    v_mfma_f32_16x16x32_bf16 a[188:191], v[140:143], v[100:103], a[188:191]
    v_mfma_f32_16x16x32_bf16 a[192:195], v[112:115], v[104:107], a[192:195]
    v_mfma_f32_16x16x32_bf16 a[196:199], v[116:119], v[104:107], a[196:199]
    v_mfma_f32_16x16x32_bf16 a[200:203], v[120:123], v[104:107], a[200:203]
    v_mfma_f32_16x16x32_bf16 a[204:207], v[124:127], v[104:107], a[204:207]
    v_mfma_f32_16x16x32_bf16 a[208:211], v[128:131], v[104:107], a[208:211]
    v_mfma_f32_16x16x32_bf16 a[212:215], v[132:135], v[104:107], a[212:215]
    v_mfma_f32_16x16x32_bf16 a[216:219], v[136:139], v[104:107], a[216:219]
    v_mfma_f32_16x16x32_bf16 a[220:223], v[140:143], v[104:107], a[220:223]
    v_mfma_f32_16x16x32_bf16 a[224:227], v[112:115], v[108:111], a[224:227]
    v_mfma_f32_16x16x32_bf16 a[228:231], v[116:119], v[108:111], a[228:231]
    v_mfma_f32_16x16x32_bf16 a[232:235], v[120:123], v[108:111], a[232:235]
    v_mfma_f32_16x16x32_bf16 a[236:239], v[124:127], v[108:111], a[236:239]
    v_mfma_f32_16x16x32_bf16 a[240:243], v[128:131], v[108:111], a[240:243]
    v_mfma_f32_16x16x32_bf16 a[244:247], v[132:135], v[108:111], a[244:247]
    v_mfma_f32_16x16x32_bf16 a[248:251], v[136:139], v[108:111], a[248:251]
    v_mfma_f32_16x16x32_bf16 a[252:255], v[140:143], v[108:111], a[252:255]
    buffer_load_dwordx4 v[80:83], v4, s[12:15], s24 offen offset:0
    buffer_load_dwordx4 v[84:87], v4, s[12:15], s24 offen offset:1024
    buffer_load_dwordx4 v[88:91], v5, s[12:15], s24 offen offset:0
    buffer_load_dwordx4 v[92:95], v5, s[12:15], s24 offen offset:1024
    buffer_load_dwordx4 v[96:99], v6, s[12:15], s24 offen offset:0
    buffer_load_dwordx4 v[100:103], v6, s[12:15], s24 offen offset:1024
    buffer_load_dwordx4 v[104:107], v7, s[12:15], s24 offen offset:0
    buffer_load_dwordx4 v[108:111], v7, s[12:15], s24 offen offset:1024
    buffer_load_dwordx4 v[112:115], v4, s[16:19], s25 offen offset:0
    buffer_load_dwordx4 v[116:119], v4, s[16:19], s25 offen offset:1024
    buffer_load_dwordx4 v[120:123], v5, s[16:19], s25 offen offset:0
    buffer_load_dwordx4 v[124:127], v5, s[16:19], s25 offen offset:1024
    buffer_load_dwordx4 v[128:131], v6, s[16:19], s25 offen offset:0
    buffer_load_dwordx4 v[132:135], v6, s[16:19], s25 offen offset:1024
    buffer_load_dwordx4 v[136:139], v7, s[16:19], s25 offen offset:0
    buffer_load_dwordx4 v[140:143], v7, s[16:19], s25 offen offset:1024
    s_add_u32 s24, s24, 0x800
    s_add_u32 s25, s25, 0x800
    s_waitcnt vmcnt(16)
    v_mfma_f32_16x16x32_bf16 a[0:3], v[48:51], v[16:19], a[0:3]
    v_mfma_f32_16x16x32_bf16 a[4:7], v[52:55], v[16:19], a[4:7]
    v_mfma_f32_16x16x32_bf16 a[8:11], v[56:59], v[16:19], a[8:11]
    v_mfma_f32_16x16x32_bf16 a[12:15], v[60:63], v[16:19], a[12:15]
    v_mfma_f32_16x16x32_bf16 a[16:19], v[64:67], v[16:19], a[16:19]
    v_mfma_f32_16x16x32_bf16 a[20:23], v[68:71], v[16:19], a[20:23]
    v_mfma_f32_16x16x32_bf16 a[24:27], v[72:75], v[16:19], a[24:27]
    v_mfma_f32_16x16x32_bf16 a[28:31], v[76:79], v[16:19], a[28:31]
    v_mfma_f32_16x16x32_bf16 a[32:35], v[48:51], v[20:23], a[32:35]
    v_mfma_f32_16x16x32_bf16 a[36:39], v[52:55], v[20:23], a[36:39]
    v_mfma_f32_16x16x32_bf16 a[40:43], v[56:59], v[20:23], a[40:43]
    v_mfma_f32_16x16x32_bf16 a[44:47], v[60:63], v[20:23], a[44:47]
    v_mfma_f32_16x16x32_bf16 a[48:51], v[64:67], v[20:23], a[48:51]
    v_mfma_f32_16x16x32_bf16 a[52:55], v[68:71], v[20:23], a[52:55]
    v_mfma_f32_16x16x32_bf16 a[56:59], v[72:75], v[20:23], a[56:59]
    v_mfma_f32_16x16x32_bf16 a[60:63], v[76:79], v[20:23], a[60:63]
    v_mfma_f32_16x16x32_bf16 a[64:67], v[48:51], v[24:27], a[64:67]
    v_mfma_f32_16x16x32_bf16 a[68:71], v[52:55], v[24:27], a[68:71]
    v_mfma_f32_16x16x32_bf16 a[72:75], v[56:59], v[24:27], a[72:75]
    v_mfma_f32_16x16x32_bf16 a[76:79], v[60:63], v[24:27], a[76:79]
    v_mfma_f32_16x16x32_bf16 a[80:83], v[64:67], v[24:27], a[80:83]
    v_mfma_f32_16x16x32_bf16 a[84:87], v[68:71], v[24:27], a[84:87]
    v_mfma_f32_16x16x32_bf16 a[88:91], v[72:75], v[24:27], a[88:91]
    v_mfma_f32_16x16x32_bf16 a[92:95], v[76:79], v[24:27], a[92:95]
    v_mfma_f32_16x16x32_bf16 a[96:99], v[48:51], v[28:31], a[96:99]
    v_mfma_f32_16x16x32_bf16 a[100:103], v[52:55], v[28:31], a[100:103]
    v_mfma_f32_16x16x32_bf16 a[104:107], v[56:59], v[28:31], a[104:107]
    v_mfma_f32_16x16x32_bf16 a[108:111], v[60:63], v[28:31], a[108:111]
    v_mfma_f32_16x16x32_bf16 a[112:115], v[64:67], v[28:31], a[112:115]
    v_mfma_f32_16x16x32_bf16 a[116:119], v[68:71], v[28:31], a[116:119]
    v_mfma_f32_16x16x32_bf16 a[120:123], v[72:75], v[28:31], a[120:123]
    v_mfma_f32_16x16x32_bf16 a[124:127], v[76:79], v[28:31], a[124:127]
    v_mfma_f32_16x16x32_bf16 a[128:131], v[48:51], v[32:35], a[128:131]
    v_mfma_f32_16x16x32_bf16 a[132:135], v[52:55], v[32:35], a[132:135]
    v_mfma_f32_16x16x32_bf16 a[136:139], v[56:59], v[32:35], a[136:139]
    v_mfma_f32_16x16x32_bf16 a[140:143], v[60:63], v[32:35], a[140:143]
    v_mfma_f32_16x16x32_bf16 a[144:147], v[64:67], v[32:35], a[144:147]
    v_mfma_f32_16x16x32_bf16 a[148:151], v[68:71], v[32:35], a[148:151]
    v_mfma_f32_16x16x32_bf16 a[152:155], v[72:75], v[32:35], a[152:155]
    v_mfma_f32_16x16x32_bf16 a[156:159], v[76:79], v[32:35], a[156:159]
    v_mfma_f32_16x16x32_bf16 a[160:163], v[48:51], v[36:39], a[160:163]
    v_mfma_f32_16x16x32_bf16 a[164:167], v[52:55], v[36:39], a[164:167]
    v_mfma_f32_16x16x32_bf16 a[168:171], v[56:59], v[36:39], a[168:171]
    v_mfma_f32_16x16x32_bf16 a[172:175], v[60:63], v[36:39], a[172:175]
    v_mfma_f32_16x16x32_bf16 a[176:179], v[64:67], v[36:39], a[176:179]
    v_mfma_f32_16x16x32_bf16 a[180:183], v[68:71], v[36:39], a[180:183]
    v_mfma_f32_16x16x32_bf16 a[184:187], v[72:75], v[36:39], a[184:187]
    v_mfma_f32_16x16x32_bf16 a[188:191], v[76:79], v[36:39], a[188:191]
    v_mfma_f32_16x16x32_bf16 a[192:195], v[48:51], v[40:43], a[192:195]
    v_mfma_f32_16x16x32_bf16 a[196:199], v[52:55], v[40:43], a[196:199]
    v_mfma_f32_16x16x32_bf16 a[200:203], v[56:59], v[40:43], a[200:203]
    v_mfma_f32_16x16x32_bf16 a[204:207], v[60:63], v[40:43], a[204:207]
    v_mfma_f32_16x16x32_bf16 a[208:211], v[64:67], v[40:43], a[208:211]
    v_mfma_f32_16x16x32_bf16 a[212:215], v[68:71], v[40:43], a[212:215]
    v_mfma_f32_16x16x32_bf16 a[216:219], v[72:75], v[40:43], a[216:219]
    v_mfma_f32_16x16x32_bf16 a[220:223], v[76:79], v[40:43], a[220:223]
    v_mfma_f32_16x16x32_bf16 a[224:227], v[48:51], v[44:47], a[224:227]
    v_mfma_f32_16x16x32_bf16 a[228:231], v[52:55], v[44:47], a[228:231]
    v_mfma_f32_16x16x32_bf16 a[232:235], v[56:59], v[44:47], a[232:235]
    v_mfma_f32_16x16x32_bf16 a[236:239], v[60:63], v[44:47], a[236:239]
    v_mfma_f32_16x16x32_bf16 a[240:243], v[64:67], v[44:47], a[240:243]
    v_mfma_f32_16x16x32_bf16 a[244:247], v[68:71], v[44:47], a[244:247]
    v_mfma_f32_16x16x32_bf16 a[248:251], v[72:75], v[44:47], a[248:251]
    v_mfma_f32_16x16x32_bf16 a[252:255], v[76:79], v[44:47], a[252:255]
    s_waitcnt vmcnt(0)
    v_mfma_f32_16x16x32_bf16 a[0:3], v[112:115], v[80:83], a[0:3]
    v_mfma_f32_16x16x32_bf16 a[4:7], v[116:119], v[80:83], a[4:7]
    v_mfma_f32_16x16x32_bf16 a[8:11], v[120:123], v[80:83], a[8:11]
    v_mfma_f32_16x16x32_bf16 a[12:15], v[124:127], v[80:83], a[12:15]
    v_mfma_f32_16x16x32_bf16 a[16:19], v[128:131], v[80:83], a[16:19]
    v_mfma_f32_16x16x32_bf16 a[20:23], v[132:135], v[80:83], a[20:23]
    v_mfma_f32_16x16x32_bf16 a[24:27], v[136:139], v[80:83], a[24:27]
    v_mfma_f32_16x16x32_bf16 a[28:31], v[140:143], v[80:83], a[28:31]
    v_mfma_f32_16x16x32_bf16 a[32:35], v[112:115], v[84:87], a[32:35]
    v_mfma_f32_16x16x32_bf16 a[36:39], v[116:119], v[84:87], a[36:39]
    v_mfma_f32_16x16x32_bf16 a[40:43], v[120:123], v[84:87], a[40:43]
    v_mfma_f32_16x16x32_bf16 a[44:47], v[124:127], v[84:87], a[44:47]
    v_mfma_f32_16x16x32_bf16 a[48:51], v[128:131], v[84:87], a[48:51]
    v_mfma_f32_16x16x32_bf16 a[52:55], v[132:135], v[84:87], a[52:55]
    v_mfma_f32_16x16x32_bf16 a[56:59], v[136:139], v[84:87], a[56:59]
    v_mfma_f32_16x16x32_bf16 a[60:63], v[140:143], v[84:87], a[60:63]
    v_mfma_f32_16x16x32_bf16 a[64:67], v[112:115], v[88:91], a[64:67]
    v_mfma_f32_16x16x32_bf16 a[68:71], v[116:119], v[88:91], a[68:71]
    v_mfma_f32_16x16x32_bf16 a[72:75], v[120:123], v[88:91], a[72:75]
    v_mfma_f32_16x16x32_bf16 a[76:79], v[124:127], v[88:91], a[76:79]
    v_mfma_f32_16x16x32_bf16 a[80:83], v[128:131], v[88:91], a[80:83]
    v_mfma_f32_16x16x32_bf16 a[84:87], v[132:135], v[88:91], a[84:87]
    v_mfma_f32_16x16x32_bf16 a[88:91], v[136:139], v[88:91], a[88:91]
    v_mfma_f32_16x16x32_bf16 a[92:95], v[140:143], v[88:91], a[92:95]
    v_mfma_f32_16x16x32_bf16 a[96:99], v[112:115], v[92:95], a[96:99]
    v_mfma_f32_16x16x32_bf16 a[100:103], v[116:119], v[92:95], a[100:103]
    v_mfma_f32_16x16x32_bf16 a[104:107], v[120:123], v[92:95], a[104:107]
    v_mfma_f32_16x16x32_bf16 a[108:111], v[124:127], v[92:95], a[108:111]
    v_mfma_f32_16x16x32_bf16 a[112:115], v[128:131], v[92:95], a[112:115]
    v_mfma_f32_16x16x32_bf16 a[116:119], v[132:135], v[92:95], a[116:119]
    v_mfma_f32_16x16x32_bf16 a[120:123], v[136:139], v[92:95], a[120:123]
    v_mfma_f32_16x16x32_bf16 a[124:127], v[140:143], v[92:95], a[124:127]
    v_mfma_f32_16x16x32_bf16 a[128:131], v[112:115], v[96:99], a[128:131]
    v_mfma_f32_16x16x32_bf16 a[132:135], v[116:119], v[96:99], a[132:135]
    v_mfma_f32_16x16x32_bf16 a[136:139], v[120:123], v[96:99], a[136:139]
    v_mfma_f32_16x16x32_bf16 a[140:143], v[124:127], v[96:99], a[140:143]
    v_mfma_f32_16x16x32_bf16 a[144:147], v[128:131], v[96:99], a[144:147]
    v_mfma_f32_16x16x32_bf16 a[148:151], v[132:135], v[96:99], a[148:151]
    v_mfma_f32_16x16x32_bf16 a[152:155], v[136:139], v[96:99], a[152:155]
    v_mfma_f32_16x16x32_bf16 a[156:159], v[140:143], v[96:99], a[156:159]
    v_mfma_f32_16x16x32_bf16 a[160:163], v[112:115], v[100:103], a[160:163]
    v_mfma_f32_16x16x32_bf16 a[164:167], v[116:119], v[100:103], a[164:167]
    v_mfma_f32_16x16x32_bf16 a[168:171], v[120:123], v[100:103], a[168:171]
    v_mfma_f32_16x16x32_bf16 a[172:175], v[124:127], v[100:103], a[172:175]
    v_mfma_f32_16x16x32_bf16 a[176:179], v[128:131], v[100:103], a[176:179]
    v_mfma_f32_16x16x32_bf16 a[180:183], v[132:135], v[100:103], a[180:183]
    v_mfma_f32_16x16x32_bf16 a[184:187], v[136:139], v[100:103], a[184:187]
    v_mfma_f32_16x16x32_bf16 a[188:191], v[140:143], v[100:103], a[188:191]
    v_mfma_f32_16x16x32_bf16 a[192:195], v[112:115], v[104:107], a[192:195]
    v_mfma_f32_16x16x32_bf16 a[196:199], v[116:119], v[104:107], a[196:199]
    v_mfma_f32_16x16x32_bf16 a[200:203], v[120:123], v[104:107], a[200:203]
    v_mfma_f32_16x16x32_bf16 a[204:207], v[124:127], v[104:107], a[204:207]
    v_mfma_f32_16x16x32_bf16 a[208:211], v[128:131], v[104:107], a[208:211]
    v_mfma_f32_16x16x32_bf16 a[212:215], v[132:135], v[104:107], a[212:215]
    v_mfma_f32_16x16x32_bf16 a[216:219], v[136:139], v[104:107], a[216:219]
    v_mfma_f32_16x16x32_bf16 a[220:223], v[140:143], v[104:107], a[220:223]
    v_mfma_f32_16x16x32_bf16 a[224:227], v[112:115], v[108:111], a[224:227]
    v_mfma_f32_16x16x32_bf16 a[228:231], v[116:119], v[108:111], a[228:231]
    v_mfma_f32_16x16x32_bf16 a[232:235], v[120:123], v[108:111], a[232:235]
    v_mfma_f32_16x16x32_bf16 a[236:239], v[124:127], v[108:111], a[236:239]
    v_mfma_f32_16x16x32_bf16 a[240:243], v[128:131], v[108:111], a[240:243]
    v_mfma_f32_16x16x32_bf16 a[244:247], v[132:135], v[108:111], a[244:247]
    v_mfma_f32_16x16x32_bf16 a[248:251], v[136:139], v[108:111], a[248:251]
    v_mfma_f32_16x16x32_bf16 a[252:255], v[140:143], v[108:111], a[252:255]
    s_add_u32 s32, s6, 0x3716000
    s_addc_u32 s33, s7, 0
    s_and_b32 s33, s33, 0xffff
    s_mov_b32 s34, 0x1000000
    s_mov_b32 s35, 0x20000
    s_and_b32 s27, s30, 31
    s_lshl_b32 s27, s27, 19
    s_lshl_b32 s28, s31, 8
    s_add_u32 s27, s27, s28
    v_lshrrev_b32 v10, 2, v8
    v_lshlrev_b32 v10, 3, v10
    v_and_b32 v11, 3, v8
    v_add_u32 v10, v10, v11
    v_mul_u32_u24 v10, 0x1000, v10
    v_lshl_add_u32 v10, v9, 4, v10
    s_add_u32 s28, s27, 0
    v_accvgpr_read_b32 v16, a0
    v_accvgpr_read_b32 v17, a1
    v_accvgpr_read_b32 v18, a2
    v_accvgpr_read_b32 v19, a3
    v_accvgpr_read_b32 v20, a4
    v_accvgpr_read_b32 v21, a5
    v_accvgpr_read_b32 v22, a6
    v_accvgpr_read_b32 v23, a7
    v_cvt_pk_bf16_f32 v24, v16, v17
    v_cvt_pk_bf16_f32 v25, v18, v19
    v_cvt_pk_bf16_f32 v26, v20, v21
    v_cvt_pk_bf16_f32 v27, v22, v23
    buffer_store_dwordx4 v[24:27], v10, s[32:35], s28 offen offset:0 sc1
    v_accvgpr_read_b32 v28, a8
    v_accvgpr_read_b32 v29, a9
    v_accvgpr_read_b32 v30, a10
    v_accvgpr_read_b32 v31, a11
    v_accvgpr_read_b32 v32, a12
    v_accvgpr_read_b32 v33, a13
    v_accvgpr_read_b32 v34, a14
    v_accvgpr_read_b32 v35, a15
    v_cvt_pk_bf16_f32 v36, v28, v29
    v_cvt_pk_bf16_f32 v37, v30, v31
    v_cvt_pk_bf16_f32 v38, v32, v33
    v_cvt_pk_bf16_f32 v39, v34, v35
    buffer_store_dwordx4 v[36:39], v10, s[32:35], s28 offen offset:64 sc1
    v_accvgpr_read_b32 v40, a16
    v_accvgpr_read_b32 v41, a17
    v_accvgpr_read_b32 v42, a18
    v_accvgpr_read_b32 v43, a19
    v_accvgpr_read_b32 v44, a20
    v_accvgpr_read_b32 v45, a21
    v_accvgpr_read_b32 v46, a22
    v_accvgpr_read_b32 v47, a23
    v_cvt_pk_bf16_f32 v48, v40, v41
    v_cvt_pk_bf16_f32 v49, v42, v43
    v_cvt_pk_bf16_f32 v50, v44, v45
    v_cvt_pk_bf16_f32 v51, v46, v47
    buffer_store_dwordx4 v[48:51], v10, s[32:35], s28 offen offset:128 sc1
    v_accvgpr_read_b32 v52, a24
    v_accvgpr_read_b32 v53, a25
    v_accvgpr_read_b32 v54, a26
    v_accvgpr_read_b32 v55, a27
    v_accvgpr_read_b32 v56, a28
    v_accvgpr_read_b32 v57, a29
    v_accvgpr_read_b32 v58, a30
    v_accvgpr_read_b32 v59, a31
    v_cvt_pk_bf16_f32 v60, v52, v53
    v_cvt_pk_bf16_f32 v61, v54, v55
    v_cvt_pk_bf16_f32 v62, v56, v57
    v_cvt_pk_bf16_f32 v63, v58, v59
    buffer_store_dwordx4 v[60:63], v10, s[32:35], s28 offen offset:192 sc1
    s_nop 0
    s_add_u32 s28, s27, 0x4000
    v_accvgpr_read_b32 v64, a32
    v_accvgpr_read_b32 v65, a33
    v_accvgpr_read_b32 v66, a34
    v_accvgpr_read_b32 v67, a35
    v_accvgpr_read_b32 v68, a36
    v_accvgpr_read_b32 v69, a37
    v_accvgpr_read_b32 v70, a38
    v_accvgpr_read_b32 v71, a39
    v_cvt_pk_bf16_f32 v72, v64, v65
    v_cvt_pk_bf16_f32 v73, v66, v67
    v_cvt_pk_bf16_f32 v74, v68, v69
    v_cvt_pk_bf16_f32 v75, v70, v71
    buffer_store_dwordx4 v[72:75], v10, s[32:35], s28 offen offset:0 sc1
    v_accvgpr_read_b32 v76, a40
    v_accvgpr_read_b32 v77, a41
    v_accvgpr_read_b32 v78, a42
    v_accvgpr_read_b32 v79, a43
    v_accvgpr_read_b32 v80, a44
    v_accvgpr_read_b32 v81, a45
    v_accvgpr_read_b32 v82, a46
    v_accvgpr_read_b32 v83, a47
    v_cvt_pk_bf16_f32 v84, v76, v77
    v_cvt_pk_bf16_f32 v85, v78, v79
    v_cvt_pk_bf16_f32 v86, v80, v81
    v_cvt_pk_bf16_f32 v87, v82, v83
    buffer_store_dwordx4 v[84:87], v10, s[32:35], s28 offen offset:64 sc1
    v_accvgpr_read_b32 v88, a48
    v_accvgpr_read_b32 v89, a49
    v_accvgpr_read_b32 v90, a50
    v_accvgpr_read_b32 v91, a51
    v_accvgpr_read_b32 v92, a52
    v_accvgpr_read_b32 v93, a53
    v_accvgpr_read_b32 v94, a54
    v_accvgpr_read_b32 v95, a55
    v_cvt_pk_bf16_f32 v96, v88, v89
    v_cvt_pk_bf16_f32 v97, v90, v91
    v_cvt_pk_bf16_f32 v98, v92, v93
    v_cvt_pk_bf16_f32 v99, v94, v95
    buffer_store_dwordx4 v[96:99], v10, s[32:35], s28 offen offset:128 sc1
    v_accvgpr_read_b32 v100, a56
    v_accvgpr_read_b32 v101, a57
    v_accvgpr_read_b32 v102, a58
    v_accvgpr_read_b32 v103, a59
    v_accvgpr_read_b32 v104, a60
    v_accvgpr_read_b32 v105, a61
    v_accvgpr_read_b32 v106, a62
    v_accvgpr_read_b32 v107, a63
    v_cvt_pk_bf16_f32 v108, v100, v101
    v_cvt_pk_bf16_f32 v109, v102, v103
    v_cvt_pk_bf16_f32 v110, v104, v105
    v_cvt_pk_bf16_f32 v111, v106, v107
    buffer_store_dwordx4 v[108:111], v10, s[32:35], s28 offen offset:192 sc1
    s_nop 0
    s_add_u32 s28, s27, 0x20000
    v_accvgpr_read_b32 v16, a64
    v_accvgpr_read_b32 v17, a65
    v_accvgpr_read_b32 v18, a66
    v_accvgpr_read_b32 v19, a67
    v_accvgpr_read_b32 v20, a68
    v_accvgpr_read_b32 v21, a69
    v_accvgpr_read_b32 v22, a70
    v_accvgpr_read_b32 v23, a71
    v_cvt_pk_bf16_f32 v24, v16, v17
    v_cvt_pk_bf16_f32 v25, v18, v19
    v_cvt_pk_bf16_f32 v26, v20, v21
    v_cvt_pk_bf16_f32 v27, v22, v23
    buffer_store_dwordx4 v[24:27], v10, s[32:35], s28 offen offset:0 sc1
    v_accvgpr_read_b32 v28, a72
    v_accvgpr_read_b32 v29, a73
    v_accvgpr_read_b32 v30, a74
    v_accvgpr_read_b32 v31, a75
    v_accvgpr_read_b32 v32, a76
    v_accvgpr_read_b32 v33, a77
    v_accvgpr_read_b32 v34, a78
    v_accvgpr_read_b32 v35, a79
    v_cvt_pk_bf16_f32 v36, v28, v29
    v_cvt_pk_bf16_f32 v37, v30, v31
    v_cvt_pk_bf16_f32 v38, v32, v33
    v_cvt_pk_bf16_f32 v39, v34, v35
    buffer_store_dwordx4 v[36:39], v10, s[32:35], s28 offen offset:64 sc1
    v_accvgpr_read_b32 v40, a80
    v_accvgpr_read_b32 v41, a81
    v_accvgpr_read_b32 v42, a82
    v_accvgpr_read_b32 v43, a83
    v_accvgpr_read_b32 v44, a84
    v_accvgpr_read_b32 v45, a85
    v_accvgpr_read_b32 v46, a86
    v_accvgpr_read_b32 v47, a87
    v_cvt_pk_bf16_f32 v48, v40, v41
    v_cvt_pk_bf16_f32 v49, v42, v43
    v_cvt_pk_bf16_f32 v50, v44, v45
    v_cvt_pk_bf16_f32 v51, v46, v47
    buffer_store_dwordx4 v[48:51], v10, s[32:35], s28 offen offset:128 sc1
    v_accvgpr_read_b32 v52, a88
    v_accvgpr_read_b32 v53, a89
    v_accvgpr_read_b32 v54, a90
    v_accvgpr_read_b32 v55, a91
    v_accvgpr_read_b32 v56, a92
    v_accvgpr_read_b32 v57, a93
    v_accvgpr_read_b32 v58, a94
    v_accvgpr_read_b32 v59, a95
    v_cvt_pk_bf16_f32 v60, v52, v53
    v_cvt_pk_bf16_f32 v61, v54, v55
    v_cvt_pk_bf16_f32 v62, v56, v57
    v_cvt_pk_bf16_f32 v63, v58, v59
    buffer_store_dwordx4 v[60:63], v10, s[32:35], s28 offen offset:192 sc1
    s_nop 0
    s_add_u32 s28, s27, 0x24000
    v_accvgpr_read_b32 v64, a96
    v_accvgpr_read_b32 v65, a97
    v_accvgpr_read_b32 v66, a98
    v_accvgpr_read_b32 v67, a99
    v_accvgpr_read_b32 v68, a100
    v_accvgpr_read_b32 v69, a101
    v_accvgpr_read_b32 v70, a102
    v_accvgpr_read_b32 v71, a103
    v_cvt_pk_bf16_f32 v72, v64, v65
    v_cvt_pk_bf16_f32 v73, v66, v67
    v_cvt_pk_bf16_f32 v74, v68, v69
    v_cvt_pk_bf16_f32 v75, v70, v71
    buffer_store_dwordx4 v[72:75], v10, s[32:35], s28 offen offset:0 sc1
    v_accvgpr_read_b32 v76, a104
    v_accvgpr_read_b32 v77, a105
    v_accvgpr_read_b32 v78, a106
    v_accvgpr_read_b32 v79, a107
    v_accvgpr_read_b32 v80, a108
    v_accvgpr_read_b32 v81, a109
    v_accvgpr_read_b32 v82, a110
    v_accvgpr_read_b32 v83, a111
    v_cvt_pk_bf16_f32 v84, v76, v77
    v_cvt_pk_bf16_f32 v85, v78, v79
    v_cvt_pk_bf16_f32 v86, v80, v81
    v_cvt_pk_bf16_f32 v87, v82, v83
    buffer_store_dwordx4 v[84:87], v10, s[32:35], s28 offen offset:64 sc1
    v_accvgpr_read_b32 v88, a112
    v_accvgpr_read_b32 v89, a113
    v_accvgpr_read_b32 v90, a114
    v_accvgpr_read_b32 v91, a115
    v_accvgpr_read_b32 v92, a116
    v_accvgpr_read_b32 v93, a117
    v_accvgpr_read_b32 v94, a118
    v_accvgpr_read_b32 v95, a119
    v_cvt_pk_bf16_f32 v96, v88, v89
    v_cvt_pk_bf16_f32 v97, v90, v91
    v_cvt_pk_bf16_f32 v98, v92, v93
    v_cvt_pk_bf16_f32 v99, v94, v95
    buffer_store_dwordx4 v[96:99], v10, s[32:35], s28 offen offset:128 sc1
    v_accvgpr_read_b32 v100, a120
    v_accvgpr_read_b32 v101, a121
    v_accvgpr_read_b32 v102, a122
    v_accvgpr_read_b32 v103, a123
    v_accvgpr_read_b32 v104, a124
    v_accvgpr_read_b32 v105, a125
    v_accvgpr_read_b32 v106, a126
    v_accvgpr_read_b32 v107, a127
    v_cvt_pk_bf16_f32 v108, v100, v101
    v_cvt_pk_bf16_f32 v109, v102, v103
    v_cvt_pk_bf16_f32 v110, v104, v105
    v_cvt_pk_bf16_f32 v111, v106, v107
    buffer_store_dwordx4 v[108:111], v10, s[32:35], s28 offen offset:192 sc1
    s_nop 0
    s_add_u32 s28, s27, 0x40000
    v_accvgpr_read_b32 v16, a128
    v_accvgpr_read_b32 v17, a129
    v_accvgpr_read_b32 v18, a130
    v_accvgpr_read_b32 v19, a131
    v_accvgpr_read_b32 v20, a132
    v_accvgpr_read_b32 v21, a133
    v_accvgpr_read_b32 v22, a134
    v_accvgpr_read_b32 v23, a135
    v_cvt_pk_bf16_f32 v24, v16, v17
    v_cvt_pk_bf16_f32 v25, v18, v19
    v_cvt_pk_bf16_f32 v26, v20, v21
    v_cvt_pk_bf16_f32 v27, v22, v23
    buffer_store_dwordx4 v[24:27], v10, s[32:35], s28 offen offset:0 sc1
    v_accvgpr_read_b32 v28, a136
    v_accvgpr_read_b32 v29, a137
    v_accvgpr_read_b32 v30, a138
    v_accvgpr_read_b32 v31, a139
    v_accvgpr_read_b32 v32, a140
    v_accvgpr_read_b32 v33, a141
    v_accvgpr_read_b32 v34, a142
    v_accvgpr_read_b32 v35, a143
    v_cvt_pk_bf16_f32 v36, v28, v29
    v_cvt_pk_bf16_f32 v37, v30, v31
    v_cvt_pk_bf16_f32 v38, v32, v33
    v_cvt_pk_bf16_f32 v39, v34, v35
    buffer_store_dwordx4 v[36:39], v10, s[32:35], s28 offen offset:64 sc1
    v_accvgpr_read_b32 v40, a144
    v_accvgpr_read_b32 v41, a145
    v_accvgpr_read_b32 v42, a146
    v_accvgpr_read_b32 v43, a147
    v_accvgpr_read_b32 v44, a148
    v_accvgpr_read_b32 v45, a149
    v_accvgpr_read_b32 v46, a150
    v_accvgpr_read_b32 v47, a151
    v_cvt_pk_bf16_f32 v48, v40, v41
    v_cvt_pk_bf16_f32 v49, v42, v43
    v_cvt_pk_bf16_f32 v50, v44, v45
    v_cvt_pk_bf16_f32 v51, v46, v47
    buffer_store_dwordx4 v[48:51], v10, s[32:35], s28 offen offset:128 sc1
    v_accvgpr_read_b32 v52, a152
    v_accvgpr_read_b32 v53, a153
    v_accvgpr_read_b32 v54, a154
    v_accvgpr_read_b32 v55, a155
    v_accvgpr_read_b32 v56, a156
    v_accvgpr_read_b32 v57, a157
    v_accvgpr_read_b32 v58, a158
    v_accvgpr_read_b32 v59, a159
    v_cvt_pk_bf16_f32 v60, v52, v53
    v_cvt_pk_bf16_f32 v61, v54, v55
    v_cvt_pk_bf16_f32 v62, v56, v57
    v_cvt_pk_bf16_f32 v63, v58, v59
    buffer_store_dwordx4 v[60:63], v10, s[32:35], s28 offen offset:192 sc1
    s_nop 0
    s_add_u32 s28, s27, 0x44000
    v_accvgpr_read_b32 v64, a160
    v_accvgpr_read_b32 v65, a161
    v_accvgpr_read_b32 v66, a162
    v_accvgpr_read_b32 v67, a163
    v_accvgpr_read_b32 v68, a164
    v_accvgpr_read_b32 v69, a165
    v_accvgpr_read_b32 v70, a166
    v_accvgpr_read_b32 v71, a167
    v_cvt_pk_bf16_f32 v72, v64, v65
    v_cvt_pk_bf16_f32 v73, v66, v67
    v_cvt_pk_bf16_f32 v74, v68, v69
    v_cvt_pk_bf16_f32 v75, v70, v71
    buffer_store_dwordx4 v[72:75], v10, s[32:35], s28 offen offset:0 sc1
    v_accvgpr_read_b32 v76, a168
    v_accvgpr_read_b32 v77, a169
    v_accvgpr_read_b32 v78, a170
    v_accvgpr_read_b32 v79, a171
    v_accvgpr_read_b32 v80, a172
    v_accvgpr_read_b32 v81, a173
    v_accvgpr_read_b32 v82, a174
    v_accvgpr_read_b32 v83, a175
    v_cvt_pk_bf16_f32 v84, v76, v77
    v_cvt_pk_bf16_f32 v85, v78, v79
    v_cvt_pk_bf16_f32 v86, v80, v81
    v_cvt_pk_bf16_f32 v87, v82, v83
    buffer_store_dwordx4 v[84:87], v10, s[32:35], s28 offen offset:64 sc1
    v_accvgpr_read_b32 v88, a176
    v_accvgpr_read_b32 v89, a177
    v_accvgpr_read_b32 v90, a178
    v_accvgpr_read_b32 v91, a179
    v_accvgpr_read_b32 v92, a180
    v_accvgpr_read_b32 v93, a181
    v_accvgpr_read_b32 v94, a182
    v_accvgpr_read_b32 v95, a183
    v_cvt_pk_bf16_f32 v96, v88, v89
    v_cvt_pk_bf16_f32 v97, v90, v91
    v_cvt_pk_bf16_f32 v98, v92, v93
    v_cvt_pk_bf16_f32 v99, v94, v95
    buffer_store_dwordx4 v[96:99], v10, s[32:35], s28 offen offset:128 sc1
    v_accvgpr_read_b32 v100, a184
    v_accvgpr_read_b32 v101, a185
    v_accvgpr_read_b32 v102, a186
    v_accvgpr_read_b32 v103, a187
    v_accvgpr_read_b32 v104, a188
    v_accvgpr_read_b32 v105, a189
    v_accvgpr_read_b32 v106, a190
    v_accvgpr_read_b32 v107, a191
    v_cvt_pk_bf16_f32 v108, v100, v101
    v_cvt_pk_bf16_f32 v109, v102, v103
    v_cvt_pk_bf16_f32 v110, v104, v105
    v_cvt_pk_bf16_f32 v111, v106, v107
    buffer_store_dwordx4 v[108:111], v10, s[32:35], s28 offen offset:192 sc1
    s_nop 0
    s_add_u32 s28, s27, 0x60000
    v_accvgpr_read_b32 v16, a192
    v_accvgpr_read_b32 v17, a193
    v_accvgpr_read_b32 v18, a194
    v_accvgpr_read_b32 v19, a195
    v_accvgpr_read_b32 v20, a196
    v_accvgpr_read_b32 v21, a197
    v_accvgpr_read_b32 v22, a198
    v_accvgpr_read_b32 v23, a199
    v_cvt_pk_bf16_f32 v24, v16, v17
    v_cvt_pk_bf16_f32 v25, v18, v19
    v_cvt_pk_bf16_f32 v26, v20, v21
    v_cvt_pk_bf16_f32 v27, v22, v23
    buffer_store_dwordx4 v[24:27], v10, s[32:35], s28 offen offset:0 sc1
    v_accvgpr_read_b32 v28, a200
    v_accvgpr_read_b32 v29, a201
    v_accvgpr_read_b32 v30, a202
    v_accvgpr_read_b32 v31, a203
    v_accvgpr_read_b32 v32, a204
    v_accvgpr_read_b32 v33, a205
    v_accvgpr_read_b32 v34, a206
    v_accvgpr_read_b32 v35, a207
    v_cvt_pk_bf16_f32 v36, v28, v29
    v_cvt_pk_bf16_f32 v37, v30, v31
    v_cvt_pk_bf16_f32 v38, v32, v33
    v_cvt_pk_bf16_f32 v39, v34, v35
    buffer_store_dwordx4 v[36:39], v10, s[32:35], s28 offen offset:64 sc1
    v_accvgpr_read_b32 v40, a208
    v_accvgpr_read_b32 v41, a209
    v_accvgpr_read_b32 v42, a210
    v_accvgpr_read_b32 v43, a211
    v_accvgpr_read_b32 v44, a212
    v_accvgpr_read_b32 v45, a213
    v_accvgpr_read_b32 v46, a214
    v_accvgpr_read_b32 v47, a215
    v_cvt_pk_bf16_f32 v48, v40, v41
    v_cvt_pk_bf16_f32 v49, v42, v43
    v_cvt_pk_bf16_f32 v50, v44, v45
    v_cvt_pk_bf16_f32 v51, v46, v47
    buffer_store_dwordx4 v[48:51], v10, s[32:35], s28 offen offset:128 sc1
    v_accvgpr_read_b32 v52, a216
    v_accvgpr_read_b32 v53, a217
    v_accvgpr_read_b32 v54, a218
    v_accvgpr_read_b32 v55, a219
    v_accvgpr_read_b32 v56, a220
    v_accvgpr_read_b32 v57, a221
    v_accvgpr_read_b32 v58, a222
    v_accvgpr_read_b32 v59, a223
    v_cvt_pk_bf16_f32 v60, v52, v53
    v_cvt_pk_bf16_f32 v61, v54, v55
    v_cvt_pk_bf16_f32 v62, v56, v57
    v_cvt_pk_bf16_f32 v63, v58, v59
    buffer_store_dwordx4 v[60:63], v10, s[32:35], s28 offen offset:192 sc1
    s_nop 0
    s_add_u32 s28, s27, 0x64000
    v_accvgpr_read_b32 v64, a224
    v_accvgpr_read_b32 v65, a225
    v_accvgpr_read_b32 v66, a226
    v_accvgpr_read_b32 v67, a227
    v_accvgpr_read_b32 v68, a228
    v_accvgpr_read_b32 v69, a229
    v_accvgpr_read_b32 v70, a230
    v_accvgpr_read_b32 v71, a231
    v_cvt_pk_bf16_f32 v72, v64, v65
    v_cvt_pk_bf16_f32 v73, v66, v67
    v_cvt_pk_bf16_f32 v74, v68, v69
    v_cvt_pk_bf16_f32 v75, v70, v71
    buffer_store_dwordx4 v[72:75], v10, s[32:35], s28 offen offset:0 sc1
    v_accvgpr_read_b32 v76, a232
    v_accvgpr_read_b32 v77, a233
    v_accvgpr_read_b32 v78, a234
    v_accvgpr_read_b32 v79, a235
    v_accvgpr_read_b32 v80, a236
    v_accvgpr_read_b32 v81, a237
    v_accvgpr_read_b32 v82, a238
    v_accvgpr_read_b32 v83, a239
    v_cvt_pk_bf16_f32 v84, v76, v77
    v_cvt_pk_bf16_f32 v85, v78, v79
    v_cvt_pk_bf16_f32 v86, v80, v81
    v_cvt_pk_bf16_f32 v87, v82, v83
    buffer_store_dwordx4 v[84:87], v10, s[32:35], s28 offen offset:64 sc1
    v_accvgpr_read_b32 v88, a240
    v_accvgpr_read_b32 v89, a241
    v_accvgpr_read_b32 v90, a242
    v_accvgpr_read_b32 v91, a243
    v_accvgpr_read_b32 v92, a244
    v_accvgpr_read_b32 v93, a245
    v_accvgpr_read_b32 v94, a246
    v_accvgpr_read_b32 v95, a247
    v_cvt_pk_bf16_f32 v96, v88, v89
    v_cvt_pk_bf16_f32 v97, v90, v91
    v_cvt_pk_bf16_f32 v98, v92, v93
    v_cvt_pk_bf16_f32 v99, v94, v95
    buffer_store_dwordx4 v[96:99], v10, s[32:35], s28 offen offset:128 sc1
    v_accvgpr_read_b32 v100, a248
    v_accvgpr_read_b32 v101, a249
    v_accvgpr_read_b32 v102, a250
    v_accvgpr_read_b32 v103, a251
    v_accvgpr_read_b32 v104, a252
    v_accvgpr_read_b32 v105, a253
    v_accvgpr_read_b32 v106, a254
    v_accvgpr_read_b32 v107, a255
    v_cvt_pk_bf16_f32 v108, v100, v101
    v_cvt_pk_bf16_f32 v109, v102, v103
    v_cvt_pk_bf16_f32 v110, v104, v105
    v_cvt_pk_bf16_f32 v111, v106, v107
    buffer_store_dwordx4 v[108:111], v10, s[32:35], s28 offen offset:192 sc1
qkv_sig_66:
    s_waitcnt vmcnt(0)
    s_barrier
    s_cmp_lg_u32 s3, 0
    s_cbranch_scc1 w_loop
    s_lshl_b32 s90, s22, 8
    s_add_u32 s90, s90, 0
    s_mov_b64 exec, 1
    v_mov_b32 v250, 0
    v_mov_b32 v251, 4
    buffer_atomic_add v251, v250, s[8:11], s90 offen
    s_mov_b64 exec, -1
    s_branch w_loop
w_r_22:
    s_sub_u32 s5, s5, 0x4d0
    s_cmp_eq_u32 s93, 2
    s_cbranch_scc1 w_idone_67
    s_cmp_lg_u32 s3, 0
    s_cbranch_scc1 dwd_69
    v_mov_b32 v250, 0xa0
dw_68:
    buffer_load_dword v251, v250, s[96:99], 0 offen sc1
    s_waitcnt vmcnt(0)
    v_readfirstlane_b32 s91, v251
    s_cmp_ge_u32 s91, 24
    s_cbranch_scc1 dwd_69
    s_sleep 4
    s_add_u32 s92, s92, 1
    s_cmp_gt_u32 s92, 0x1e8480
    s_cbranch_scc1 main_kernel_exit_w
    s_branch dw_68
dwd_69:
    s_waitcnt vmcnt(0)
    s_barrier
    s_mov_b32 s93, 2
w_idone_67:
    s_mov_b32 s20, 0x129e413
    s_mul_hi_u32 s23, s5, s20
    s_mul_i32 s20, s23, 0xdc
    s_sub_u32 s21, s5, s20
    s_cmp_ge_u32 s21, 32
    s_cbranch_scc1 w_nx_76
    s_sub_u32 s20, s23, 5
    s_cmp_ge_u32 s20, 16
    s_cbranch_scc1 w_loop
    s_branch w_mlp2_70
w_nx_76:
    s_sub_u32 s21, s21, 32
    s_cmp_ge_u32 s21, 28
    s_cbranch_scc1 w_nx_77
    s_sub_u32 s20, s23, 4
    s_cmp_ge_u32 s20, 16
    s_cbranch_scc1 w_loop
    s_branch w_mlp1_71
w_nx_77:
    s_sub_u32 s21, s21, 28
    s_cmp_ge_u32 s21, 32
    s_cbranch_scc1 w_nx_78
    s_sub_u32 s20, s23, 3
    s_cmp_ge_u32 s20, 16
    s_cbranch_scc1 w_loop
    s_branch w_ln2_72
w_nx_78:
    s_sub_u32 s21, s21, 32
    s_cmp_ge_u32 s21, 64
    s_cbranch_scc1 w_nx_79
    s_sub_u32 s20, s23, 2
    s_cmp_ge_u32 s20, 16
    s_cbranch_scc1 w_loop
    s_branch w_wo_73
w_nx_79:
    s_sub_u32 s21, s21, 64
    s_cmp_ge_u32 s21, 32
    s_cbranch_scc1 w_nx_80
    s_sub_u32 s20, s23, 1
    s_cmp_ge_u32 s20, 16
    s_cbranch_scc1 w_loop
    s_branch w_attn_74
w_nx_80:
    s_sub_u32 s21, s21, 32
    s_cmp_ge_u32 s21, 32
    s_cbranch_scc1 w_nx_81
    s_sub_u32 s20, s23, 0
    s_cmp_ge_u32 s20, 16
    s_cbranch_scc1 w_loop
    s_branch w_memkv_75
w_nx_81:
    s_sub_u32 s21, s21, 32
    s_branch w_loop
w_mlp2_70:
    s_add_u32 s8, s6, 0x3000
    s_addc_u32 s9, s7, 0
    s_and_b32 s9, s9, 0xffff
    s_mov_b32 s10, 0x10000
    s_mov_b32 s11, 0x20000
    s_load_dwordx2 s[4:5], s[0:1], 0x58
    s_load_dwordx2 s[40:41], s[0:1], 0x70
    s_and_b32 s42, s21, 7
    s_lshr_b32 s43, s21, 3
    s_lshl_b32 s22, s20, 2
    s_add_u32 s43, s43, s22
    s_add_u32 s12, s6, 0x1556000
    s_addc_u32 s13, s7, 0
    s_and_b32 s13, s13, 0xffff
    s_mov_b32 s14, 0x1c0000
    s_mov_b32 s15, 0x20000
    s_add_u32 s16, s6, 0x6316000
    s_addc_u32 s17, s7, 0
    s_and_b32 s17, s17, 0xffff
    s_mov_b32 s18, 0x700000
    s_mov_b32 s19, 0x20000
    s_mul_i32 s24, s42, 0x38000
    s_mul_i32 s25, s43, 0x1c000
    s_mul_i32 s26, s3, 0x7000
    s_add_u32 s24, s24, s26
    s_add_u32 s25, s25, s26
    v_lshlrev_b32 v2, 4, v0
    v_and_b32 v8, 15, v0
    v_lshrrev_b32 v9, 4, v0
    v_add_u32 v4, 0, v2
    v_add_u32 v5, 0x1c000, v2
    s_mov_b32 s23, 2
    s_cmp_lg_u32 s3, 0
    s_cbranch_scc1 wcd_83
    s_lshl_b32 s90, s23, 8
    s_add_u32 s90, s90, 0xd000
    v_mov_b32 v250, 0
wc_82:
    buffer_load_dword v251, v250, s[8:11], s90 offen sc1
    s_waitcnt vmcnt(0)
    v_readfirstlane_b32 s91, v251
    s_cmp_ge_u32 s91, 56
    s_cbranch_scc1 wcd_83
    s_sleep 2
    s_add_u32 s92, s92, 1
    s_cmp_gt_u32 s92, 0x1e8480
    s_cbranch_scc1 main_kernel_exit_w
    s_branch wc_82
wcd_83:
    s_waitcnt vmcnt(0)
    s_barrier
    buffer_load_dwordx4 a[0:3], v4, s[12:15], s24 offen offset:0
    buffer_load_dwordx4 a[4:7], v4, s[12:15], s24 offen offset:1024
    buffer_load_dwordx4 a[8:11], v5, s[12:15], s24 offen offset:0
    buffer_load_dwordx4 a[12:15], v5, s[12:15], s24 offen offset:1024
    s_add_u32 s24, s24, 0x800
    buffer_load_dwordx4 a[16:19], v4, s[12:15], s24 offen offset:0
    buffer_load_dwordx4 a[20:23], v4, s[12:15], s24 offen offset:1024
    buffer_load_dwordx4 a[24:27], v5, s[12:15], s24 offen offset:0
    buffer_load_dwordx4 a[28:31], v5, s[12:15], s24 offen offset:1024
    s_add_u32 s24, s24, 0x800
    buffer_load_dwordx4 a[32:35], v4, s[12:15], s24 offen offset:0
    buffer_load_dwordx4 a[36:39], v4, s[12:15], s24 offen offset:1024
    buffer_load_dwordx4 a[40:43], v5, s[12:15], s24 offen offset:0
    buffer_load_dwordx4 a[44:47], v5, s[12:15], s24 offen offset:1024
    s_add_u32 s24, s24, 0x800
    buffer_load_dwordx4 a[48:51], v4, s[12:15], s24 offen offset:0
    buffer_load_dwordx4 a[52:55], v4, s[12:15], s24 offen offset:1024
    buffer_load_dwordx4 a[56:59], v5, s[12:15], s24 offen offset:0
    buffer_load_dwordx4 a[60:63], v5, s[12:15], s24 offen offset:1024
    s_add_u32 s24, s24, 0x800
    buffer_load_dwordx4 a[64:67], v4, s[12:15], s24 offen offset:0
    buffer_load_dwordx4 a[68:71], v4, s[12:15], s24 offen offset:1024
    buffer_load_dwordx4 a[72:75], v5, s[12:15], s24 offen offset:0
    buffer_load_dwordx4 a[76:79], v5, s[12:15], s24 offen offset:1024
    s_add_u32 s24, s24, 0x800
    buffer_load_dwordx4 a[80:83], v4, s[12:15], s24 offen offset:0
    buffer_load_dwordx4 a[84:87], v4, s[12:15], s24 offen offset:1024
    buffer_load_dwordx4 a[88:91], v5, s[12:15], s24 offen offset:0
    buffer_load_dwordx4 a[92:95], v5, s[12:15], s24 offen offset:1024
    s_add_u32 s24, s24, 0x800
    buffer_load_dwordx4 a[96:99], v4, s[12:15], s24 offen offset:0
    buffer_load_dwordx4 a[100:103], v4, s[12:15], s24 offen offset:1024
    buffer_load_dwordx4 a[104:107], v5, s[12:15], s24 offen offset:0
    buffer_load_dwordx4 a[108:111], v5, s[12:15], s24 offen offset:1024
    s_add_u32 s24, s24, 0x800
    buffer_load_dwordx4 a[112:115], v4, s[12:15], s24 offen offset:0
    buffer_load_dwordx4 a[116:119], v4, s[12:15], s24 offen offset:1024
    buffer_load_dwordx4 a[120:123], v5, s[12:15], s24 offen offset:0
    buffer_load_dwordx4 a[124:127], v5, s[12:15], s24 offen offset:1024
    s_add_u32 s24, s24, 0x800
    buffer_load_dwordx4 a[128:131], v4, s[12:15], s24 offen offset:0
    buffer_load_dwordx4 a[132:135], v4, s[12:15], s24 offen offset:1024
    buffer_load_dwordx4 a[136:139], v5, s[12:15], s24 offen offset:0
    buffer_load_dwordx4 a[140:143], v5, s[12:15], s24 offen offset:1024
    s_add_u32 s24, s24, 0x800
    buffer_load_dwordx4 a[144:147], v4, s[12:15], s24 offen offset:0
    buffer_load_dwordx4 a[148:151], v4, s[12:15], s24 offen offset:1024
    buffer_load_dwordx4 a[152:155], v5, s[12:15], s24 offen offset:0
    buffer_load_dwordx4 a[156:159], v5, s[12:15], s24 offen offset:1024
    s_add_u32 s24, s24, 0x800
    buffer_load_dwordx4 a[160:163], v4, s[12:15], s24 offen offset:0
    buffer_load_dwordx4 a[164:167], v4, s[12:15], s24 offen offset:1024
    buffer_load_dwordx4 a[168:171], v5, s[12:15], s24 offen offset:0
    buffer_load_dwordx4 a[172:175], v5, s[12:15], s24 offen offset:1024
    s_add_u32 s24, s24, 0x800
    buffer_load_dwordx4 a[176:179], v4, s[12:15], s24 offen offset:0
    buffer_load_dwordx4 a[180:183], v4, s[12:15], s24 offen offset:1024
    buffer_load_dwordx4 a[184:187], v5, s[12:15], s24 offen offset:0
    buffer_load_dwordx4 a[188:191], v5, s[12:15], s24 offen offset:1024
    s_add_u32 s24, s24, 0x800
    s_waitcnt vmcnt(16)
    buffer_load_dwordx4 a[192:195], v4, s[12:15], s24 offen offset:0
    buffer_load_dwordx4 a[196:199], v4, s[12:15], s24 offen offset:1024
    buffer_load_dwordx4 a[200:203], v5, s[12:15], s24 offen offset:0
    buffer_load_dwordx4 a[204:207], v5, s[12:15], s24 offen offset:1024
    s_add_u32 s24, s24, 0x800
    buffer_load_dwordx4 a[208:211], v4, s[12:15], s24 offen offset:0
    buffer_load_dwordx4 a[212:215], v4, s[12:15], s24 offen offset:1024
    buffer_load_dwordx4 a[216:219], v5, s[12:15], s24 offen offset:0
    buffer_load_dwordx4 a[220:223], v5, s[12:15], s24 offen offset:1024
    s_add_u32 s24, s24, 0x800
    s_waitcnt lgkmcnt(0)
    s_mov_b32 s44, s6
    s_mov_b32 s45, s7
    s_and_b32 s45, s45, 0xffff
    s_mov_b32 s46, 0x3000
    s_mov_b32 s47, 0x20000
    s_add_u32 s28, s6, 0x5f16000
    s_addc_u32 s29, s7, 0
    s_and_b32 s29, s29, 0xffff
    s_mov_b32 s30, 0x200000
    s_mov_b32 s31, 0x20000
    s_mov_b32 s32, s4
    s_mov_b32 s33, s5
    s_and_b32 s33, s33, 0xffff
    s_mov_b32 s34, 0x400
    s_mov_b32 s35, 0x20000
    s_mov_b32 s36, s40
    s_mov_b32 s37, s41
    s_and_b32 s37, s37, 0xffff
    s_mov_b32 s38, 0x200000
    s_mov_b32 s39, 0x20000
    v_lshrrev_b32 v10, 2, v8
    v_lshlrev_b32 v10, 3, v10
    v_and_b32 v11, 3, v8
    v_add_u32 v10, v10, v11
    v_lshlrev_b32 v10, 10, v10
    v_lshl_add_u32 v10, v9, 4, v10
    s_lshl_b32 s27, s43, 5
    s_and_b32 s26, s3, 1
    s_lshl_b32 s26, s26, 2
    s_add_u32 s27, s27, s26
    s_lshl_b32 s27, s27, 10
    s_mul_i32 s26, s42, 0x80
    s_add_u32 s27, s27, s26
    s_lshr_b32 s23, s3, 1
    s_lshl_b32 s26, s23, 6
    s_add_u32 s27, s27, s26
    v_lshlrev_b32 v11, 5, v9
    s_mul_i32 s26, s42, 0x100
    s_add_u32 s26, s26, 0x2800
    s_lshl_b32 s22, s23, 7
    s_add_u32 s26, s26, s22
    buffer_load_dwordx4 v[224:227], v11, s[44:47], s26 offen
    buffer_load_dwordx4 v[228:231], v11, s[44:47], s26 offen offset:16
    v_lshlrev_b32 v12, 4, v9
    s_lshl_b32 s22, s42, 7
    s_lshl_b32 s26, s23, 6
    s_add_u32 s22, s22, s26
    buffer_load_dwordx4 v[240:243], v12, s[32:35], s22 offen
    s_cmp_lg_u32 s3, 0
    s_cbranch_scc1 wcd_85
    s_lshl_b32 s90, s20, 8
    s_add_u32 s90, s90, 0x8000
    v_mov_b32 v250, 0
wc_84:
    buffer_load_dword v251, v250, s[8:11], s90 offen sc1
    s_waitcnt vmcnt(0)
    v_readfirstlane_b32 s91, v251
    s_cmp_ge_u32 s91, 28
    s_cbranch_scc1 wcd_85
    s_sleep 2
    s_add_u32 s92, s92, 1
    s_cmp_gt_u32 s92, 0x1e8480
    s_cbranch_scc1 main_kernel_exit_w
    s_branch wc_84
wcd_85:
    s_waitcnt vmcnt(0)
    s_barrier
    buffer_load_dwordx4 v[216:219], v10, s[28:31], s27 offen
    s_waitcnt vmcnt(0)
    buffer_load_dwordx4 v[16:19], v4, s[16:19], s25 offen offset:0
    buffer_load_dwordx4 v[20:23], v4, s[16:19], s25 offen offset:1024
    s_add_u32 s25, s25, 0x800
    buffer_load_dwordx4 v[24:27], v4, s[16:19], s25 offen offset:0
    buffer_load_dwordx4 v[28:31], v4, s[16:19], s25 offen offset:1024
    s_add_u32 s25, s25, 0x800
    buffer_load_dwordx4 v[32:35], v4, s[16:19], s25 offen offset:0
    buffer_load_dwordx4 v[36:39], v4, s[16:19], s25 offen offset:1024
    s_add_u32 s25, s25, 0x800
    buffer_load_dwordx4 v[40:43], v4, s[16:19], s25 offen offset:0
    buffer_load_dwordx4 v[44:47], v4, s[16:19], s25 offen offset:1024
    s_add_u32 s25, s25, 0x800
    buffer_load_dwordx4 v[48:51], v4, s[16:19], s25 offen offset:0
    buffer_load_dwordx4 v[52:55], v4, s[16:19], s25 offen offset:1024
    s_add_u32 s25, s25, 0x800
    buffer_load_dwordx4 v[56:59], v4, s[16:19], s25 offen offset:0
    buffer_load_dwordx4 v[60:63], v4, s[16:19], s25 offen offset:1024
    s_add_u32 s25, s25, 0x800
    buffer_load_dwordx4 v[64:67], v4, s[16:19], s25 offen offset:0
    buffer_load_dwordx4 v[68:71], v4, s[16:19], s25 offen offset:1024
    s_add_u32 s25, s25, 0x800
    buffer_load_dwordx4 v[72:75], v4, s[16:19], s25 offen offset:0
    buffer_load_dwordx4 v[76:79], v4, s[16:19], s25 offen offset:1024
    s_add_u32 s25, s25, 0x800
    buffer_load_dwordx4 v[80:83], v4, s[16:19], s25 offen offset:0
    buffer_load_dwordx4 v[84:87], v4, s[16:19], s25 offen offset:1024
    s_add_u32 s25, s25, 0x800
    buffer_load_dwordx4 v[88:91], v4, s[16:19], s25 offen offset:0
    buffer_load_dwordx4 v[92:95], v4, s[16:19], s25 offen offset:1024
    s_add_u32 s25, s25, 0x800
    buffer_load_dwordx4 v[96:99], v4, s[16:19], s25 offen offset:0
    buffer_load_dwordx4 v[100:103], v4, s[16:19], s25 offen offset:1024
    s_add_u32 s25, s25, 0x800
    buffer_load_dwordx4 v[104:107], v4, s[16:19], s25 offen offset:0
    buffer_load_dwordx4 v[108:111], v4, s[16:19], s25 offen offset:1024
    s_add_u32 s25, s25, 0x800
    buffer_load_dwordx4 v[112:115], v4, s[16:19], s25 offen offset:0
    buffer_load_dwordx4 v[116:119], v4, s[16:19], s25 offen offset:1024
    s_add_u32 s25, s25, 0x800
    buffer_load_dwordx4 v[120:123], v4, s[16:19], s25 offen offset:0
    buffer_load_dwordx4 v[124:127], v4, s[16:19], s25 offen offset:1024
    s_add_u32 s25, s25, 0x800
    s_waitcnt vmcnt(26)
    v_mfma_f32_16x16x32_bf16 v[144:147], a[0:3], v[16:19], 0
    v_mfma_f32_16x16x32_bf16 v[148:151], a[0:3], v[20:23], 0
    v_mfma_f32_16x16x32_bf16 v[152:155], a[4:7], v[16:19], 0
    v_mfma_f32_16x16x32_bf16 v[156:159], a[4:7], v[20:23], 0
    v_mfma_f32_16x16x32_bf16 v[160:163], a[8:11], v[16:19], 0
    v_mfma_f32_16x16x32_bf16 v[164:167], a[8:11], v[20:23], 0
    v_mfma_f32_16x16x32_bf16 v[168:171], a[12:15], v[16:19], 0
    v_mfma_f32_16x16x32_bf16 v[172:175], a[12:15], v[20:23], 0
    s_waitcnt vmcnt(24)
    v_mfma_f32_16x16x32_bf16 v[144:147], a[16:19], v[24:27], v[144:147]
    v_mfma_f32_16x16x32_bf16 v[148:151], a[16:19], v[28:31], v[148:151]
    v_mfma_f32_16x16x32_bf16 v[152:155], a[20:23], v[24:27], v[152:155]
    v_mfma_f32_16x16x32_bf16 v[156:159], a[20:23], v[28:31], v[156:159]
    v_mfma_f32_16x16x32_bf16 v[160:163], a[24:27], v[24:27], v[160:163]
    v_mfma_f32_16x16x32_bf16 v[164:167], a[24:27], v[28:31], v[164:167]
    v_mfma_f32_16x16x32_bf16 v[168:171], a[28:31], v[24:27], v[168:171]
    v_mfma_f32_16x16x32_bf16 v[172:175], a[28:31], v[28:31], v[172:175]
    s_waitcnt vmcnt(22)
    v_mfma_f32_16x16x32_bf16 v[144:147], a[32:35], v[32:35], v[144:147]
    v_mfma_f32_16x16x32_bf16 v[148:151], a[32:35], v[36:39], v[148:151]
    v_mfma_f32_16x16x32_bf16 v[152:155], a[36:39], v[32:35], v[152:155]
    v_mfma_f32_16x16x32_bf16 v[156:159], a[36:39], v[36:39], v[156:159]
    v_mfma_f32_16x16x32_bf16 v[160:163], a[40:43], v[32:35], v[160:163]
    v_mfma_f32_16x16x32_bf16 v[164:167], a[40:43], v[36:39], v[164:167]
    v_mfma_f32_16x16x32_bf16 v[168:171], a[44:47], v[32:35], v[168:171]
    v_mfma_f32_16x16x32_bf16 v[172:175], a[44:47], v[36:39], v[172:175]
    s_waitcnt vmcnt(20)
    v_mfma_f32_16x16x32_bf16 v[144:147], a[48:51], v[40:43], v[144:147]
    v_mfma_f32_16x16x32_bf16 v[148:151], a[48:51], v[44:47], v[148:151]
    v_mfma_f32_16x16x32_bf16 v[152:155], a[52:55], v[40:43], v[152:155]
    v_mfma_f32_16x16x32_bf16 v[156:159], a[52:55], v[44:47], v[156:159]
    v_mfma_f32_16x16x32_bf16 v[160:163], a[56:59], v[40:43], v[160:163]
    v_mfma_f32_16x16x32_bf16 v[164:167], a[56:59], v[44:47], v[164:167]
    v_mfma_f32_16x16x32_bf16 v[168:171], a[60:63], v[40:43], v[168:171]
    v_mfma_f32_16x16x32_bf16 v[172:175], a[60:63], v[44:47], v[172:175]
    s_waitcnt vmcnt(18)
    v_mfma_f32_16x16x32_bf16 v[144:147], a[64:67], v[48:51], v[144:147]
    v_mfma_f32_16x16x32_bf16 v[148:151], a[64:67], v[52:55], v[148:151]
    v_mfma_f32_16x16x32_bf16 v[152:155], a[68:71], v[48:51], v[152:155]
    v_mfma_f32_16x16x32_bf16 v[156:159], a[68:71], v[52:55], v[156:159]
    v_mfma_f32_16x16x32_bf16 v[160:163], a[72:75], v[48:51], v[160:163]
    v_mfma_f32_16x16x32_bf16 v[164:167], a[72:75], v[52:55], v[164:167]
    v_mfma_f32_16x16x32_bf16 v[168:171], a[76:79], v[48:51], v[168:171]
    v_mfma_f32_16x16x32_bf16 v[172:175], a[76:79], v[52:55], v[172:175]
    s_waitcnt vmcnt(16)
    v_mfma_f32_16x16x32_bf16 v[144:147], a[80:83], v[56:59], v[144:147]
    v_mfma_f32_16x16x32_bf16 v[148:151], a[80:83], v[60:63], v[148:151]
    v_mfma_f32_16x16x32_bf16 v[152:155], a[84:87], v[56:59], v[152:155]
    v_mfma_f32_16x16x32_bf16 v[156:159], a[84:87], v[60:63], v[156:159]
    v_mfma_f32_16x16x32_bf16 v[160:163], a[88:91], v[56:59], v[160:163]
    v_mfma_f32_16x16x32_bf16 v[164:167], a[88:91], v[60:63], v[164:167]
    v_mfma_f32_16x16x32_bf16 v[168:171], a[92:95], v[56:59], v[168:171]
    v_mfma_f32_16x16x32_bf16 v[172:175], a[92:95], v[60:63], v[172:175]
    s_waitcnt vmcnt(14)
    v_mfma_f32_16x16x32_bf16 v[144:147], a[96:99], v[64:67], v[144:147]
    v_mfma_f32_16x16x32_bf16 v[148:151], a[96:99], v[68:71], v[148:151]
    v_mfma_f32_16x16x32_bf16 v[152:155], a[100:103], v[64:67], v[152:155]
    v_mfma_f32_16x16x32_bf16 v[156:159], a[100:103], v[68:71], v[156:159]
    v_mfma_f32_16x16x32_bf16 v[160:163], a[104:107], v[64:67], v[160:163]
    v_mfma_f32_16x16x32_bf16 v[164:167], a[104:107], v[68:71], v[164:167]
    v_mfma_f32_16x16x32_bf16 v[168:171], a[108:111], v[64:67], v[168:171]
    v_mfma_f32_16x16x32_bf16 v[172:175], a[108:111], v[68:71], v[172:175]
    s_waitcnt vmcnt(12)
    v_mfma_f32_16x16x32_bf16 v[144:147], a[112:115], v[72:75], v[144:147]
    v_mfma_f32_16x16x32_bf16 v[148:151], a[112:115], v[76:79], v[148:151]
    v_mfma_f32_16x16x32_bf16 v[152:155], a[116:119], v[72:75], v[152:155]
    v_mfma_f32_16x16x32_bf16 v[156:159], a[116:119], v[76:79], v[156:159]
    v_mfma_f32_16x16x32_bf16 v[160:163], a[120:123], v[72:75], v[160:163]
    v_mfma_f32_16x16x32_bf16 v[164:167], a[120:123], v[76:79], v[164:167]
    v_mfma_f32_16x16x32_bf16 v[168:171], a[124:127], v[72:75], v[168:171]
    v_mfma_f32_16x16x32_bf16 v[172:175], a[124:127], v[76:79], v[172:175]
    s_waitcnt vmcnt(10)
    v_mfma_f32_16x16x32_bf16 v[144:147], a[128:131], v[80:83], v[144:147]
    v_mfma_f32_16x16x32_bf16 v[148:151], a[128:131], v[84:87], v[148:151]
    v_mfma_f32_16x16x32_bf16 v[152:155], a[132:135], v[80:83], v[152:155]
    v_mfma_f32_16x16x32_bf16 v[156:159], a[132:135], v[84:87], v[156:159]
    v_mfma_f32_16x16x32_bf16 v[160:163], a[136:139], v[80:83], v[160:163]
    v_mfma_f32_16x16x32_bf16 v[164:167], a[136:139], v[84:87], v[164:167]
    v_mfma_f32_16x16x32_bf16 v[168:171], a[140:143], v[80:83], v[168:171]
    v_mfma_f32_16x16x32_bf16 v[172:175], a[140:143], v[84:87], v[172:175]
    s_waitcnt vmcnt(8)
    v_mfma_f32_16x16x32_bf16 v[144:147], a[144:147], v[88:91], v[144:147]
    v_mfma_f32_16x16x32_bf16 v[148:151], a[144:147], v[92:95], v[148:151]
    v_mfma_f32_16x16x32_bf16 v[152:155], a[148:151], v[88:91], v[152:155]
    v_mfma_f32_16x16x32_bf16 v[156:159], a[148:151], v[92:95], v[156:159]
    v_mfma_f32_16x16x32_bf16 v[160:163], a[152:155], v[88:91], v[160:163]
    v_mfma_f32_16x16x32_bf16 v[164:167], a[152:155], v[92:95], v[164:167]
    v_mfma_f32_16x16x32_bf16 v[168:171], a[156:159], v[88:91], v[168:171]
    v_mfma_f32_16x16x32_bf16 v[172:175], a[156:159], v[92:95], v[172:175]
    s_waitcnt vmcnt(6)
    v_mfma_f32_16x16x32_bf16 v[144:147], a[160:163], v[96:99], v[144:147]
    v_mfma_f32_16x16x32_bf16 v[148:151], a[160:163], v[100:103], v[148:151]
    v_mfma_f32_16x16x32_bf16 v[152:155], a[164:167], v[96:99], v[152:155]
    v_mfma_f32_16x16x32_bf16 v[156:159], a[164:167], v[100:103], v[156:159]
    v_mfma_f32_16x16x32_bf16 v[160:163], a[168:171], v[96:99], v[160:163]
    v_mfma_f32_16x16x32_bf16 v[164:167], a[168:171], v[100:103], v[164:167]
    v_mfma_f32_16x16x32_bf16 v[168:171], a[172:175], v[96:99], v[168:171]
    v_mfma_f32_16x16x32_bf16 v[172:175], a[172:175], v[100:103], v[172:175]
    s_waitcnt vmcnt(4)
    v_mfma_f32_16x16x32_bf16 v[144:147], a[176:179], v[104:107], v[144:147]
    v_mfma_f32_16x16x32_bf16 v[148:151], a[176:179], v[108:111], v[148:151]
    v_mfma_f32_16x16x32_bf16 v[152:155], a[180:183], v[104:107], v[152:155]
    v_mfma_f32_16x16x32_bf16 v[156:159], a[180:183], v[108:111], v[156:159]
    v_mfma_f32_16x16x32_bf16 v[160:163], a[184:187], v[104:107], v[160:163]
    v_mfma_f32_16x16x32_bf16 v[164:167], a[184:187], v[108:111], v[164:167]
    v_mfma_f32_16x16x32_bf16 v[168:171], a[188:191], v[104:107], v[168:171]
    v_mfma_f32_16x16x32_bf16 v[172:175], a[188:191], v[108:111], v[172:175]
    s_waitcnt vmcnt(2)
    v_mfma_f32_16x16x32_bf16 v[144:147], a[192:195], v[112:115], v[144:147]
    v_mfma_f32_16x16x32_bf16 v[148:151], a[192:195], v[116:119], v[148:151]
    v_mfma_f32_16x16x32_bf16 v[152:155], a[196:199], v[112:115], v[152:155]
    v_mfma_f32_16x16x32_bf16 v[156:159], a[196:199], v[116:119], v[156:159]
    v_mfma_f32_16x16x32_bf16 v[160:163], a[200:203], v[112:115], v[160:163]
    v_mfma_f32_16x16x32_bf16 v[164:167], a[200:203], v[116:119], v[164:167]
    v_mfma_f32_16x16x32_bf16 v[168:171], a[204:207], v[112:115], v[168:171]
    v_mfma_f32_16x16x32_bf16 v[172:175], a[204:207], v[116:119], v[172:175]
    s_waitcnt vmcnt(0)
    v_mfma_f32_16x16x32_bf16 v[144:147], a[208:211], v[120:123], v[144:147]
    v_mfma_f32_16x16x32_bf16 v[148:151], a[208:211], v[124:127], v[148:151]
    v_mfma_f32_16x16x32_bf16 v[152:155], a[212:215], v[120:123], v[152:155]
    v_mfma_f32_16x16x32_bf16 v[156:159], a[212:215], v[124:127], v[156:159]
    v_mfma_f32_16x16x32_bf16 v[160:163], a[216:219], v[120:123], v[160:163]
    v_mfma_f32_16x16x32_bf16 v[164:167], a[216:219], v[124:127], v[164:167]
    v_mfma_f32_16x16x32_bf16 v[168:171], a[220:223], v[120:123], v[168:171]
    v_mfma_f32_16x16x32_bf16 v[172:175], a[220:223], v[124:127], v[172:175]
    s_mul_i32 s24, s3, 0x2000
    v_add_u32 v3, s24, v2
    ds_write_b128 v3, v[144:147] offset:0
    ds_write_b128 v3, v[148:151] offset:4096
    ds_write_b128 v3, v[152:155] offset:1024
    ds_write_b128 v3, v[156:159] offset:5120
    ds_write_b128 v3, v[160:163] offset:2048
    ds_write_b128 v3, v[164:167] offset:6144
    ds_write_b128 v3, v[168:171] offset:3072
    ds_write_b128 v3, v[172:175] offset:7168
    s_waitcnt lgkmcnt(0)
    s_barrier
    s_and_b32 s24, s3, 1
    s_mul_i32 s24, s24, 0x1000
    s_lshl_b32 s26, s23, 11
    s_add_u32 s24, s24, s26
    v_add_u32 v3, s24, v2
    ds_read_b128 v[16:19], v3 offset:0
    ds_read_b128 v[20:23], v3 offset:1024
    ds_read_b128 v[24:27], v3 offset:8192
    ds_read_b128 v[28:31], v3 offset:9216
    ds_read_b128 v[32:35], v3 offset:16384
    ds_read_b128 v[36:39], v3 offset:17408
    ds_read_b128 v[40:43], v3 offset:24576
    ds_read_b128 v[44:47], v3 offset:25600
    s_waitcnt lgkmcnt(0)
    v_add_f32 v16, v16, v24
    v_add_f32 v32, v32, v40
    v_add_f32 v16, v16, v32
    v_add_f32 v17, v17, v25
    v_add_f32 v33, v33, v41
    v_add_f32 v17, v17, v33
    v_add_f32 v18, v18, v26
    v_add_f32 v34, v34, v42
    v_add_f32 v18, v18, v34
    v_add_f32 v19, v19, v27
    v_add_f32 v35, v35, v43
    v_add_f32 v19, v19, v35
    v_add_f32 v20, v20, v28
    v_add_f32 v36, v36, v44
    v_add_f32 v20, v20, v36
    v_add_f32 v21, v21, v29
    v_add_f32 v37, v37, v45
    v_add_f32 v21, v21, v37
    v_add_f32 v22, v22, v30
    v_add_f32 v38, v38, v46
    v_add_f32 v22, v22, v38
    v_add_f32 v23, v23, v31
    v_add_f32 v39, v39, v47
    v_add_f32 v23, v23, v39
    v_lshlrev_b32 v96, 16, v216
    v_and_b32 v97, 0xffff0000, v216
    v_lshlrev_b32 v98, 16, v217
    v_and_b32 v99, 0xffff0000, v217
    v_lshlrev_b32 v100, 16, v218
    v_and_b32 v101, 0xffff0000, v218
    v_lshlrev_b32 v102, 16, v219
    v_and_b32 v103, 0xffff0000, v219
    v_lshlrev_b32 v104, 16, v240
    v_and_b32 v105, 0xffff0000, v240
    v_lshlrev_b32 v106, 16, v241
    v_and_b32 v107, 0xffff0000, v241
    v_lshlrev_b32 v108, 16, v242
    v_and_b32 v109, 0xffff0000, v242
    v_lshlrev_b32 v110, 16, v243
    v_and_b32 v111, 0xffff0000, v243
    v_cvt_pk_bf16_f32 v16, v16, v16
    v_lshlrev_b32 v16, 16, v16
    v_add_f32 v16, v16, v104
    v_cvt_pk_bf16_f32 v16, v16, v16
    v_lshlrev_b32 v16, 16, v16
    v_mul_f32 v16, v16, v224
    v_cvt_pk_bf16_f32 v16, v16, v16
    v_lshlrev_b32 v16, 16, v16
    v_add_f32 v16, v16, v96
    v_cvt_pk_bf16_f32 v17, v17, v17
    v_lshlrev_b32 v17, 16, v17
    v_add_f32 v17, v17, v105
    v_cvt_pk_bf16_f32 v17, v17, v17
    v_lshlrev_b32 v17, 16, v17
    v_mul_f32 v17, v17, v225
    v_cvt_pk_bf16_f32 v17, v17, v17
    v_lshlrev_b32 v17, 16, v17
    v_add_f32 v17, v17, v97
    v_cvt_pk_bf16_f32 v18, v18, v18
    v_lshlrev_b32 v18, 16, v18
    v_add_f32 v18, v18, v106
    v_cvt_pk_bf16_f32 v18, v18, v18
    v_lshlrev_b32 v18, 16, v18
    v_mul_f32 v18, v18, v226
    v_cvt_pk_bf16_f32 v18, v18, v18
    v_lshlrev_b32 v18, 16, v18
    v_add_f32 v18, v18, v98
    v_cvt_pk_bf16_f32 v19, v19, v19
    v_lshlrev_b32 v19, 16, v19
    v_add_f32 v19, v19, v107
    v_cvt_pk_bf16_f32 v19, v19, v19
    v_lshlrev_b32 v19, 16, v19
    v_mul_f32 v19, v19, v227
    v_cvt_pk_bf16_f32 v19, v19, v19
    v_lshlrev_b32 v19, 16, v19
    v_add_f32 v19, v19, v99
    v_cvt_pk_bf16_f32 v20, v20, v20
    v_lshlrev_b32 v20, 16, v20
    v_add_f32 v20, v20, v108
    v_cvt_pk_bf16_f32 v20, v20, v20
    v_lshlrev_b32 v20, 16, v20
    v_mul_f32 v20, v20, v228
    v_cvt_pk_bf16_f32 v20, v20, v20
    v_lshlrev_b32 v20, 16, v20
    v_add_f32 v20, v20, v100
    v_cvt_pk_bf16_f32 v21, v21, v21
    v_lshlrev_b32 v21, 16, v21
    v_add_f32 v21, v21, v109
    v_cvt_pk_bf16_f32 v21, v21, v21
    v_lshlrev_b32 v21, 16, v21
    v_mul_f32 v21, v21, v229
    v_cvt_pk_bf16_f32 v21, v21, v21
    v_lshlrev_b32 v21, 16, v21
    v_add_f32 v21, v21, v101
    v_cvt_pk_bf16_f32 v22, v22, v22
    v_lshlrev_b32 v22, 16, v22
    v_add_f32 v22, v22, v110
    v_cvt_pk_bf16_f32 v22, v22, v22
    v_lshlrev_b32 v22, 16, v22
    v_mul_f32 v22, v22, v230
    v_cvt_pk_bf16_f32 v22, v22, v22
    v_lshlrev_b32 v22, 16, v22
    v_add_f32 v22, v22, v102
    v_cvt_pk_bf16_f32 v23, v23, v23
    v_lshlrev_b32 v23, 16, v23
    v_add_f32 v23, v23, v111
    v_cvt_pk_bf16_f32 v23, v23, v23
    v_lshlrev_b32 v23, 16, v23
    v_mul_f32 v23, v23, v231
    v_cvt_pk_bf16_f32 v23, v23, v23
    v_lshlrev_b32 v23, 16, v23
    v_add_f32 v23, v23, v103
    v_cvt_pk_bf16_f32 v112, v16, v17
    v_cvt_pk_bf16_f32 v113, v18, v19
    v_cvt_pk_bf16_f32 v114, v20, v21
    v_cvt_pk_bf16_f32 v115, v22, v23
    buffer_store_dwordx4 v[112:115], v10, s[36:39], s27 offen
sk_skip_86:
    s_barrier
    s_branch w_loop
w_mlp1_71:
    s_add_u32 s8, s6, 0x3000
    s_addc_u32 s9, s7, 0
    s_and_b32 s9, s9, 0xffff
    s_mov_b32 s10, 0x10000
    s_mov_b32 s11, 0x20000
    s_load_dwordx2 s[4:5], s[0:1], 0x48
    s_lshr_b32 s42, s21, 1
    s_lshl_b32 s42, s42, 2
    s_add_u32 s42, s42, s3
    s_and_b32 s43, s21, 1
    s_lshl_b32 s22, s20, 1
    s_add_u32 s43, s43, s22
    s_add_u32 s12, s6, 0x1396000
    s_addc_u32 s13, s7, 0
    s_and_b32 s13, s13, 0xffff
    s_mov_b32 s14, 0x1c0000
    s_mov_b32 s15, 0x20000
    s_add_u32 s16, s6, 0x6116000
    s_addc_u32 s17, s7, 0
    s_and_b32 s17, s17, 0xffff
    s_mov_b32 s18, 0x200000
    s_mov_b32 s19, 0x20000
    s_lshl_b32 s24, s42, 15
    s_lshl_b32 s25, s43, 16
    v_lshlrev_b32 v2, 4, v0
    v_and_b32 v8, 15, v0
    v_lshrrev_b32 v9, 4, v0
    v_add_u32 v4, 0, v2
    v_add_u32 v5, 0x8000, v2
    s_mov_b32 s23, 1
    s_cmp_lg_u32 s3, 0
    s_cbranch_scc1 wcd_88
    s_lshl_b32 s90, s23, 8
    s_add_u32 s90, s90, 0xd000
    v_mov_b32 v250, 0
wc_87:
    buffer_load_dword v251, v250, s[8:11], s90 offen sc1
    s_waitcnt vmcnt(0)
    v_readfirstlane_b32 s91, v251
    s_cmp_ge_u32 s91, 56
    s_cbranch_scc1 wcd_88
    s_sleep 2
    s_add_u32 s92, s92, 1
    s_cmp_gt_u32 s92, 0x1e8480
    s_cbranch_scc1 main_kernel_exit_w
    s_branch wc_87
wcd_88:
    s_waitcnt vmcnt(0)
    s_barrier
    buffer_load_dwordx4 a[0:3], v4, s[12:15], s24 offen offset:0
    buffer_load_dwordx4 a[4:7], v4, s[12:15], s24 offen offset:1024
    s_add_u32 s24, s24, 0x800
    buffer_load_dwordx4 a[8:11], v4, s[12:15], s24 offen offset:0
    buffer_load_dwordx4 a[12:15], v4, s[12:15], s24 offen offset:1024
    s_add_u32 s24, s24, 0x800
    buffer_load_dwordx4 a[16:19], v4, s[12:15], s24 offen offset:0
    buffer_load_dwordx4 a[20:23], v4, s[12:15], s24 offen offset:1024
    s_add_u32 s24, s24, 0x800
    buffer_load_dwordx4 a[24:27], v4, s[12:15], s24 offen offset:0
    buffer_load_dwordx4 a[28:31], v4, s[12:15], s24 offen offset:1024
    s_add_u32 s24, s24, 0x800
    buffer_load_dwordx4 a[32:35], v4, s[12:15], s24 offen offset:0
    buffer_load_dwordx4 a[36:39], v4, s[12:15], s24 offen offset:1024
    s_add_u32 s24, s24, 0x800
    buffer_load_dwordx4 a[40:43], v4, s[12:15], s24 offen offset:0
    buffer_load_dwordx4 a[44:47], v4, s[12:15], s24 offen offset:1024
    s_add_u32 s24, s24, 0x800
    buffer_load_dwordx4 a[48:51], v4, s[12:15], s24 offen offset:0
    buffer_load_dwordx4 a[52:55], v4, s[12:15], s24 offen offset:1024
    s_add_u32 s24, s24, 0x800
    buffer_load_dwordx4 a[56:59], v4, s[12:15], s24 offen offset:0
    buffer_load_dwordx4 a[60:63], v4, s[12:15], s24 offen offset:1024
    s_add_u32 s24, s24, 0x800
    buffer_load_dwordx4 a[64:67], v4, s[12:15], s24 offen offset:0
    buffer_load_dwordx4 a[68:71], v4, s[12:15], s24 offen offset:1024
    s_add_u32 s24, s24, 0x800
    buffer_load_dwordx4 a[72:75], v4, s[12:15], s24 offen offset:0
    buffer_load_dwordx4 a[76:79], v4, s[12:15], s24 offen offset:1024
    s_add_u32 s24, s24, 0x800
    buffer_load_dwordx4 a[80:83], v4, s[12:15], s24 offen offset:0
    buffer_load_dwordx4 a[84:87], v4, s[12:15], s24 offen offset:1024
    s_add_u32 s24, s24, 0x800
    buffer_load_dwordx4 a[88:91], v4, s[12:15], s24 offen offset:0
    buffer_load_dwordx4 a[92:95], v4, s[12:15], s24 offen offset:1024
    s_add_u32 s24, s24, 0x800
    buffer_load_dwordx4 a[96:99], v4, s[12:15], s24 offen offset:0
    buffer_load_dwordx4 a[100:103], v4, s[12:15], s24 offen offset:1024
    s_add_u32 s24, s24, 0x800
    buffer_load_dwordx4 a[104:107], v4, s[12:15], s24 offen offset:0
    buffer_load_dwordx4 a[108:111], v4, s[12:15], s24 offen offset:1024
    s_add_u32 s24, s24, 0x800
    buffer_load_dwordx4 a[112:115], v4, s[12:15], s24 offen offset:0
    buffer_load_dwordx4 a[116:119], v4, s[12:15], s24 offen offset:1024
    s_add_u32 s24, s24, 0x800
    buffer_load_dwordx4 a[120:123], v4, s[12:15], s24 offen offset:0
    buffer_load_dwordx4 a[124:127], v4, s[12:15], s24 offen offset:1024
    s_add_u32 s24, s24, 0x800
    s_waitcnt lgkmcnt(0)
    s_mov_b32 s32, s4
    s_mov_b32 s33, s5
    s_and_b32 s33, s33, 0xffff
    s_mov_b32 s34, 0xe00
    s_mov_b32 s35, 0x20000
    s_add_u32 s28, s6, 0x6316000
    s_addc_u32 s29, s7, 0
    s_and_b32 s29, s29, 0xffff
    s_mov_b32 s30, 0x700000
    s_mov_b32 s31, 0x20000
    v_lshlrev_b32 v12, 4, v9
    s_lshl_b32 s23, s42, 6
    buffer_load_dwordx4 v[216:219], v12, s[32:35], s23 offen
    s_cmp_lg_u32 s3, 0
    s_cbranch_scc1 wcd_90
    s_lshl_b32 s90, s20, 8
    s_add_u32 s90, s90, 0x7000
    v_mov_b32 v250, 0
wc_89:
    buffer_load_dword v251, v250, s[8:11], s90 offen sc1
    s_waitcnt vmcnt(0)
    v_readfirstlane_b32 s91, v251
    s_cmp_ge_u32 s91, 32
    s_cbranch_scc1 wcd_90
    s_sleep 2
    s_add_u32 s92, s92, 1
    s_cmp_gt_u32 s92, 0x1e8480
    s_cbranch_scc1 main_kernel_exit_w
    s_branch wc_89
wcd_90:
    s_waitcnt vmcnt(0)
    s_barrier
    v_lshlrev_b32 v224, 16, v216
    v_and_b32 v225, 0xffff0000, v216
    v_lshlrev_b32 v226, 16, v217
    v_and_b32 v227, 0xffff0000, v217
    v_lshlrev_b32 v228, 16, v218
    v_and_b32 v229, 0xffff0000, v218
    v_lshlrev_b32 v230, 16, v219
    v_and_b32 v231, 0xffff0000, v219
    buffer_load_dwordx4 v[16:19], v4, s[16:19], s25 offen offset:0
    buffer_load_dwordx4 v[20:23], v4, s[16:19], s25 offen offset:1024
    buffer_load_dwordx4 v[24:27], v5, s[16:19], s25 offen offset:0
    buffer_load_dwordx4 v[28:31], v5, s[16:19], s25 offen offset:1024
    s_add_u32 s25, s25, 0x800
    buffer_load_dwordx4 v[32:35], v4, s[16:19], s25 offen offset:0
    buffer_load_dwordx4 v[36:39], v4, s[16:19], s25 offen offset:1024
    buffer_load_dwordx4 v[40:43], v5, s[16:19], s25 offen offset:0
    buffer_load_dwordx4 v[44:47], v5, s[16:19], s25 offen offset:1024
    s_add_u32 s25, s25, 0x800
    buffer_load_dwordx4 v[48:51], v4, s[16:19], s25 offen offset:0
    buffer_load_dwordx4 v[52:55], v4, s[16:19], s25 offen offset:1024
    buffer_load_dwordx4 v[56:59], v5, s[16:19], s25 offen offset:0
    buffer_load_dwordx4 v[60:63], v5, s[16:19], s25 offen offset:1024
    s_add_u32 s25, s25, 0x800
    buffer_load_dwordx4 v[64:67], v4, s[16:19], s25 offen offset:0
    buffer_load_dwordx4 v[68:71], v4, s[16:19], s25 offen offset:1024
    buffer_load_dwordx4 v[72:75], v5, s[16:19], s25 offen offset:0
    buffer_load_dwordx4 v[76:79], v5, s[16:19], s25 offen offset:1024
    s_add_u32 s25, s25, 0x800
    buffer_load_dwordx4 v[80:83], v4, s[16:19], s25 offen offset:0
    buffer_load_dwordx4 v[84:87], v4, s[16:19], s25 offen offset:1024
    buffer_load_dwordx4 v[88:91], v5, s[16:19], s25 offen offset:0
    buffer_load_dwordx4 v[92:95], v5, s[16:19], s25 offen offset:1024
    s_add_u32 s25, s25, 0x800
    buffer_load_dwordx4 v[96:99], v4, s[16:19], s25 offen offset:0
    buffer_load_dwordx4 v[100:103], v4, s[16:19], s25 offen offset:1024
    buffer_load_dwordx4 v[104:107], v5, s[16:19], s25 offen offset:0
    buffer_load_dwordx4 v[108:111], v5, s[16:19], s25 offen offset:1024
    s_add_u32 s25, s25, 0x800
    buffer_load_dwordx4 v[112:115], v4, s[16:19], s25 offen offset:0
    buffer_load_dwordx4 v[116:119], v4, s[16:19], s25 offen offset:1024
    buffer_load_dwordx4 v[120:123], v5, s[16:19], s25 offen offset:0
    buffer_load_dwordx4 v[124:127], v5, s[16:19], s25 offen offset:1024
    s_add_u32 s25, s25, 0x800
    buffer_load_dwordx4 v[128:131], v4, s[16:19], s25 offen offset:0
    buffer_load_dwordx4 v[132:135], v4, s[16:19], s25 offen offset:1024
    buffer_load_dwordx4 v[136:139], v5, s[16:19], s25 offen offset:0
    buffer_load_dwordx4 v[140:143], v5, s[16:19], s25 offen offset:1024
    s_add_u32 s25, s25, 0x800
    s_waitcnt vmcnt(28)
    v_mfma_f32_16x16x32_bf16 v[144:147], a[0:3], v[16:19], 0
    v_mfma_f32_16x16x32_bf16 v[148:151], a[0:3], v[20:23], 0
    v_mfma_f32_16x16x32_bf16 v[152:155], a[0:3], v[24:27], 0
    v_mfma_f32_16x16x32_bf16 v[156:159], a[0:3], v[28:31], 0
    v_mfma_f32_16x16x32_bf16 v[160:163], a[4:7], v[16:19], 0
    v_mfma_f32_16x16x32_bf16 v[164:167], a[4:7], v[20:23], 0
    v_mfma_f32_16x16x32_bf16 v[168:171], a[4:7], v[24:27], 0
    v_mfma_f32_16x16x32_bf16 v[172:175], a[4:7], v[28:31], 0
    buffer_load_dwordx4 v[16:19], v4, s[16:19], s25 offen offset:0
    buffer_load_dwordx4 v[20:23], v4, s[16:19], s25 offen offset:1024
    buffer_load_dwordx4 v[24:27], v5, s[16:19], s25 offen offset:0
    buffer_load_dwordx4 v[28:31], v5, s[16:19], s25 offen offset:1024
    s_add_u32 s25, s25, 0x800
    s_waitcnt vmcnt(28)
    v_mfma_f32_16x16x32_bf16 v[144:147], a[8:11], v[32:35], v[144:147]
    v_mfma_f32_16x16x32_bf16 v[148:151], a[8:11], v[36:39], v[148:151]
    v_mfma_f32_16x16x32_bf16 v[152:155], a[8:11], v[40:43], v[152:155]
    v_mfma_f32_16x16x32_bf16 v[156:159], a[8:11], v[44:47], v[156:159]
    v_mfma_f32_16x16x32_bf16 v[160:163], a[12:15], v[32:35], v[160:163]
    v_mfma_f32_16x16x32_bf16 v[164:167], a[12:15], v[36:39], v[164:167]
    v_mfma_f32_16x16x32_bf16 v[168:171], a[12:15], v[40:43], v[168:171]
    v_mfma_f32_16x16x32_bf16 v[172:175], a[12:15], v[44:47], v[172:175]
    buffer_load_dwordx4 v[32:35], v4, s[16:19], s25 offen offset:0
    buffer_load_dwordx4 v[36:39], v4, s[16:19], s25 offen offset:1024
    buffer_load_dwordx4 v[40:43], v5, s[16:19], s25 offen offset:0
    buffer_load_dwordx4 v[44:47], v5, s[16:19], s25 offen offset:1024
    s_add_u32 s25, s25, 0x800
    s_waitcnt vmcnt(28)
    v_mfma_f32_16x16x32_bf16 v[144:147], a[16:19], v[48:51], v[144:147]
    v_mfma_f32_16x16x32_bf16 v[148:151], a[16:19], v[52:55], v[148:151]
    v_mfma_f32_16x16x32_bf16 v[152:155], a[16:19], v[56:59], v[152:155]
    v_mfma_f32_16x16x32_bf16 v[156:159], a[16:19], v[60:63], v[156:159]
    v_mfma_f32_16x16x32_bf16 v[160:163], a[20:23], v[48:51], v[160:163]
    v_mfma_f32_16x16x32_bf16 v[164:167], a[20:23], v[52:55], v[164:167]
    v_mfma_f32_16x16x32_bf16 v[168:171], a[20:23], v[56:59], v[168:171]
    v_mfma_f32_16x16x32_bf16 v[172:175], a[20:23], v[60:63], v[172:175]
    buffer_load_dwordx4 v[48:51], v4, s[16:19], s25 offen offset:0
    buffer_load_dwordx4 v[52:55], v4, s[16:19], s25 offen offset:1024
    buffer_load_dwordx4 v[56:59], v5, s[16:19], s25 offen offset:0
    buffer_load_dwordx4 v[60:63], v5, s[16:19], s25 offen offset:1024
    s_add_u32 s25, s25, 0x800
    s_waitcnt vmcnt(28)
    v_mfma_f32_16x16x32_bf16 v[144:147], a[24:27], v[64:67], v[144:147]
    v_mfma_f32_16x16x32_bf16 v[148:151], a[24:27], v[68:71], v[148:151]
    v_mfma_f32_16x16x32_bf16 v[152:155], a[24:27], v[72:75], v[152:155]
    v_mfma_f32_16x16x32_bf16 v[156:159], a[24:27], v[76:79], v[156:159]
    v_mfma_f32_16x16x32_bf16 v[160:163], a[28:31], v[64:67], v[160:163]
    v_mfma_f32_16x16x32_bf16 v[164:167], a[28:31], v[68:71], v[164:167]
    v_mfma_f32_16x16x32_bf16 v[168:171], a[28:31], v[72:75], v[168:171]
    v_mfma_f32_16x16x32_bf16 v[172:175], a[28:31], v[76:79], v[172:175]
    buffer_load_dwordx4 v[64:67], v4, s[16:19], s25 offen offset:0
    buffer_load_dwordx4 v[68:71], v4, s[16:19], s25 offen offset:1024
    buffer_load_dwordx4 v[72:75], v5, s[16:19], s25 offen offset:0
    buffer_load_dwordx4 v[76:79], v5, s[16:19], s25 offen offset:1024
    s_add_u32 s25, s25, 0x800
    s_waitcnt vmcnt(28)
    v_mfma_f32_16x16x32_bf16 v[144:147], a[32:35], v[80:83], v[144:147]
    v_mfma_f32_16x16x32_bf16 v[148:151], a[32:35], v[84:87], v[148:151]
    v_mfma_f32_16x16x32_bf16 v[152:155], a[32:35], v[88:91], v[152:155]
    v_mfma_f32_16x16x32_bf16 v[156:159], a[32:35], v[92:95], v[156:159]
    v_mfma_f32_16x16x32_bf16 v[160:163], a[36:39], v[80:83], v[160:163]
    v_mfma_f32_16x16x32_bf16 v[164:167], a[36:39], v[84:87], v[164:167]
    v_mfma_f32_16x16x32_bf16 v[168:171], a[36:39], v[88:91], v[168:171]
    v_mfma_f32_16x16x32_bf16 v[172:175], a[36:39], v[92:95], v[172:175]
    buffer_load_dwordx4 v[80:83], v4, s[16:19], s25 offen offset:0
    buffer_load_dwordx4 v[84:87], v4, s[16:19], s25 offen offset:1024
    buffer_load_dwordx4 v[88:91], v5, s[16:19], s25 offen offset:0
    buffer_load_dwordx4 v[92:95], v5, s[16:19], s25 offen offset:1024
    s_add_u32 s25, s25, 0x800
    s_waitcnt vmcnt(28)
    v_mfma_f32_16x16x32_bf16 v[144:147], a[40:43], v[96:99], v[144:147]
    v_mfma_f32_16x16x32_bf16 v[148:151], a[40:43], v[100:103], v[148:151]
    v_mfma_f32_16x16x32_bf16 v[152:155], a[40:43], v[104:107], v[152:155]
    v_mfma_f32_16x16x32_bf16 v[156:159], a[40:43], v[108:111], v[156:159]
    v_mfma_f32_16x16x32_bf16 v[160:163], a[44:47], v[96:99], v[160:163]
    v_mfma_f32_16x16x32_bf16 v[164:167], a[44:47], v[100:103], v[164:167]
    v_mfma_f32_16x16x32_bf16 v[168:171], a[44:47], v[104:107], v[168:171]
    v_mfma_f32_16x16x32_bf16 v[172:175], a[44:47], v[108:111], v[172:175]
    buffer_load_dwordx4 v[96:99], v4, s[16:19], s25 offen offset:0
    buffer_load_dwordx4 v[100:103], v4, s[16:19], s25 offen offset:1024
    buffer_load_dwordx4 v[104:107], v5, s[16:19], s25 offen offset:0
    buffer_load_dwordx4 v[108:111], v5, s[16:19], s25 offen offset:1024
    s_add_u32 s25, s25, 0x800
    s_waitcnt vmcnt(28)
    v_mfma_f32_16x16x32_bf16 v[144:147], a[48:51], v[112:115], v[144:147]
    v_mfma_f32_16x16x32_bf16 v[148:151], a[48:51], v[116:119], v[148:151]
    v_mfma_f32_16x16x32_bf16 v[152:155], a[48:51], v[120:123], v[152:155]
    v_mfma_f32_16x16x32_bf16 v[156:159], a[48:51], v[124:127], v[156:159]
    v_mfma_f32_16x16x32_bf16 v[160:163], a[52:55], v[112:115], v[160:163]
    v_mfma_f32_16x16x32_bf16 v[164:167], a[52:55], v[116:119], v[164:167]
    v_mfma_f32_16x16x32_bf16 v[168:171], a[52:55], v[120:123], v[168:171]
    v_mfma_f32_16x16x32_bf16 v[172:175], a[52:55], v[124:127], v[172:175]
    buffer_load_dwordx4 v[112:115], v4, s[16:19], s25 offen offset:0
    buffer_load_dwordx4 v[116:119], v4, s[16:19], s25 offen offset:1024
    buffer_load_dwordx4 v[120:123], v5, s[16:19], s25 offen offset:0
    buffer_load_dwordx4 v[124:127], v5, s[16:19], s25 offen offset:1024
    s_add_u32 s25, s25, 0x800
    s_waitcnt vmcnt(28)
    v_mfma_f32_16x16x32_bf16 v[144:147], a[56:59], v[128:131], v[144:147]
    v_mfma_f32_16x16x32_bf16 v[148:151], a[56:59], v[132:135], v[148:151]
    v_mfma_f32_16x16x32_bf16 v[152:155], a[56:59], v[136:139], v[152:155]
    v_mfma_f32_16x16x32_bf16 v[156:159], a[56:59], v[140:143], v[156:159]
    v_mfma_f32_16x16x32_bf16 v[160:163], a[60:63], v[128:131], v[160:163]
    v_mfma_f32_16x16x32_bf16 v[164:167], a[60:63], v[132:135], v[164:167]
    v_mfma_f32_16x16x32_bf16 v[168:171], a[60:63], v[136:139], v[168:171]
    v_mfma_f32_16x16x32_bf16 v[172:175], a[60:63], v[140:143], v[172:175]
    buffer_load_dwordx4 v[128:131], v4, s[16:19], s25 offen offset:0
    buffer_load_dwordx4 v[132:135], v4, s[16:19], s25 offen offset:1024
    buffer_load_dwordx4 v[136:139], v5, s[16:19], s25 offen offset:0
    buffer_load_dwordx4 v[140:143], v5, s[16:19], s25 offen offset:1024
    s_add_u32 s25, s25, 0x800
    s_waitcnt vmcnt(28)
    v_mfma_f32_16x16x32_bf16 v[144:147], a[64:67], v[16:19], v[144:147]
    v_mfma_f32_16x16x32_bf16 v[148:151], a[64:67], v[20:23], v[148:151]
    v_mfma_f32_16x16x32_bf16 v[152:155], a[64:67], v[24:27], v[152:155]
    v_mfma_f32_16x16x32_bf16 v[156:159], a[64:67], v[28:31], v[156:159]
    v_mfma_f32_16x16x32_bf16 v[160:163], a[68:71], v[16:19], v[160:163]
    v_mfma_f32_16x16x32_bf16 v[164:167], a[68:71], v[20:23], v[164:167]
    v_mfma_f32_16x16x32_bf16 v[168:171], a[68:71], v[24:27], v[168:171]
    v_mfma_f32_16x16x32_bf16 v[172:175], a[68:71], v[28:31], v[172:175]
    s_waitcnt vmcnt(24)
    v_mfma_f32_16x16x32_bf16 v[144:147], a[72:75], v[32:35], v[144:147]
    v_mfma_f32_16x16x32_bf16 v[148:151], a[72:75], v[36:39], v[148:151]
    v_mfma_f32_16x16x32_bf16 v[152:155], a[72:75], v[40:43], v[152:155]
    v_mfma_f32_16x16x32_bf16 v[156:159], a[72:75], v[44:47], v[156:159]
    v_mfma_f32_16x16x32_bf16 v[160:163], a[76:79], v[32:35], v[160:163]
    v_mfma_f32_16x16x32_bf16 v[164:167], a[76:79], v[36:39], v[164:167]
    v_mfma_f32_16x16x32_bf16 v[168:171], a[76:79], v[40:43], v[168:171]
    v_mfma_f32_16x16x32_bf16 v[172:175], a[76:79], v[44:47], v[172:175]
    s_waitcnt vmcnt(20)
    v_mfma_f32_16x16x32_bf16 v[144:147], a[80:83], v[48:51], v[144:147]
    v_mfma_f32_16x16x32_bf16 v[148:151], a[80:83], v[52:55], v[148:151]
    v_mfma_f32_16x16x32_bf16 v[152:155], a[80:83], v[56:59], v[152:155]
    v_mfma_f32_16x16x32_bf16 v[156:159], a[80:83], v[60:63], v[156:159]
    v_mfma_f32_16x16x32_bf16 v[160:163], a[84:87], v[48:51], v[160:163]
    v_mfma_f32_16x16x32_bf16 v[164:167], a[84:87], v[52:55], v[164:167]
    v_mfma_f32_16x16x32_bf16 v[168:171], a[84:87], v[56:59], v[168:171]
    v_mfma_f32_16x16x32_bf16 v[172:175], a[84:87], v[60:63], v[172:175]
    s_waitcnt vmcnt(16)
    v_mfma_f32_16x16x32_bf16 v[144:147], a[88:91], v[64:67], v[144:147]
    v_mfma_f32_16x16x32_bf16 v[148:151], a[88:91], v[68:71], v[148:151]
    v_mfma_f32_16x16x32_bf16 v[152:155], a[88:91], v[72:75], v[152:155]
    v_mfma_f32_16x16x32_bf16 v[156:159], a[88:91], v[76:79], v[156:159]
    v_mfma_f32_16x16x32_bf16 v[160:163], a[92:95], v[64:67], v[160:163]
    v_mfma_f32_16x16x32_bf16 v[164:167], a[92:95], v[68:71], v[164:167]
    v_mfma_f32_16x16x32_bf16 v[168:171], a[92:95], v[72:75], v[168:171]
    v_mfma_f32_16x16x32_bf16 v[172:175], a[92:95], v[76:79], v[172:175]
    s_waitcnt vmcnt(12)
    v_mfma_f32_16x16x32_bf16 v[144:147], a[96:99], v[80:83], v[144:147]
    v_mfma_f32_16x16x32_bf16 v[148:151], a[96:99], v[84:87], v[148:151]
    v_mfma_f32_16x16x32_bf16 v[152:155], a[96:99], v[88:91], v[152:155]
    v_mfma_f32_16x16x32_bf16 v[156:159], a[96:99], v[92:95], v[156:159]
    v_mfma_f32_16x16x32_bf16 v[160:163], a[100:103], v[80:83], v[160:163]
    v_mfma_f32_16x16x32_bf16 v[164:167], a[100:103], v[84:87], v[164:167]
    v_mfma_f32_16x16x32_bf16 v[168:171], a[100:103], v[88:91], v[168:171]
    v_mfma_f32_16x16x32_bf16 v[172:175], a[100:103], v[92:95], v[172:175]
    s_waitcnt vmcnt(8)
    v_mfma_f32_16x16x32_bf16 v[144:147], a[104:107], v[96:99], v[144:147]
    v_mfma_f32_16x16x32_bf16 v[148:151], a[104:107], v[100:103], v[148:151]
    v_mfma_f32_16x16x32_bf16 v[152:155], a[104:107], v[104:107], v[152:155]
    v_mfma_f32_16x16x32_bf16 v[156:159], a[104:107], v[108:111], v[156:159]
    v_mfma_f32_16x16x32_bf16 v[160:163], a[108:111], v[96:99], v[160:163]
    v_mfma_f32_16x16x32_bf16 v[164:167], a[108:111], v[100:103], v[164:167]
    v_mfma_f32_16x16x32_bf16 v[168:171], a[108:111], v[104:107], v[168:171]
    v_mfma_f32_16x16x32_bf16 v[172:175], a[108:111], v[108:111], v[172:175]
    s_waitcnt vmcnt(4)
    v_mfma_f32_16x16x32_bf16 v[144:147], a[112:115], v[112:115], v[144:147]
    v_mfma_f32_16x16x32_bf16 v[148:151], a[112:115], v[116:119], v[148:151]
    v_mfma_f32_16x16x32_bf16 v[152:155], a[112:115], v[120:123], v[152:155]
    v_mfma_f32_16x16x32_bf16 v[156:159], a[112:115], v[124:127], v[156:159]
    v_mfma_f32_16x16x32_bf16 v[160:163], a[116:119], v[112:115], v[160:163]
    v_mfma_f32_16x16x32_bf16 v[164:167], a[116:119], v[116:119], v[164:167]
    v_mfma_f32_16x16x32_bf16 v[168:171], a[116:119], v[120:123], v[168:171]
    v_mfma_f32_16x16x32_bf16 v[172:175], a[116:119], v[124:127], v[172:175]
    s_waitcnt vmcnt(0)
    v_mfma_f32_16x16x32_bf16 v[144:147], a[120:123], v[128:131], v[144:147]
    v_mfma_f32_16x16x32_bf16 v[148:151], a[120:123], v[132:135], v[148:151]
    v_mfma_f32_16x16x32_bf16 v[152:155], a[120:123], v[136:139], v[152:155]
    v_mfma_f32_16x16x32_bf16 v[156:159], a[120:123], v[140:143], v[156:159]
    v_mfma_f32_16x16x32_bf16 v[160:163], a[124:127], v[128:131], v[160:163]
    v_mfma_f32_16x16x32_bf16 v[164:167], a[124:127], v[132:135], v[164:167]
    v_mfma_f32_16x16x32_bf16 v[168:171], a[124:127], v[136:139], v[168:171]
    v_mfma_f32_16x16x32_bf16 v[172:175], a[124:127], v[140:143], v[172:175]
    s_mul_i32 s27, s43, 0x70
    s_add_u32 s27, s27, s42
    s_lshl_b32 s27, s27, 11
    v_cvt_pk_bf16_f32 v144, v144, v144
    v_lshlrev_b32 v144, 16, v144
    v_add_f32 v144, v144, v224
    v_cvt_pk_bf16_f32 v144, v144, v144
    v_lshlrev_b32 v144, 16, v144
    v_mul_f32 v24, v144, v144
    v_mul_f32 v24, 0x3d372713, v24
    v_fma_f32 v24, v24, v144, v144
    v_mul_f32 v24, 0x40135761, v24
    v_exp_f32 v24, v24
    s_nop 0
    v_add_f32 v24, 1.0, v24
    v_rcp_f32 v24, v24
    s_nop 0
    v_fma_f32 v24, v24, -2.0, 2.0
    v_mul_f32 v144, 0.5, v144
    v_mul_f32 v16, v144, v24
    v_cvt_pk_bf16_f32 v145, v145, v145
    v_lshlrev_b32 v145, 16, v145
    v_add_f32 v145, v145, v225
    v_cvt_pk_bf16_f32 v145, v145, v145
    v_lshlrev_b32 v145, 16, v145
    v_mul_f32 v25, v145, v145
    v_mul_f32 v25, 0x3d372713, v25
    v_fma_f32 v25, v25, v145, v145
    v_mul_f32 v25, 0x40135761, v25
    v_exp_f32 v25, v25
    s_nop 0
    v_add_f32 v25, 1.0, v25
    v_rcp_f32 v25, v25
    s_nop 0
    v_fma_f32 v25, v25, -2.0, 2.0
    v_mul_f32 v145, 0.5, v145
    v_mul_f32 v17, v145, v25
    v_cvt_pk_bf16_f32 v146, v146, v146
    v_lshlrev_b32 v146, 16, v146
    v_add_f32 v146, v146, v226
    v_cvt_pk_bf16_f32 v146, v146, v146
    v_lshlrev_b32 v146, 16, v146
    v_mul_f32 v26, v146, v146
    v_mul_f32 v26, 0x3d372713, v26
    v_fma_f32 v26, v26, v146, v146
    v_mul_f32 v26, 0x40135761, v26
    v_exp_f32 v26, v26
    s_nop 0
    v_add_f32 v26, 1.0, v26
    v_rcp_f32 v26, v26
    s_nop 0
    v_fma_f32 v26, v26, -2.0, 2.0
    v_mul_f32 v146, 0.5, v146
    v_mul_f32 v18, v146, v26
    v_cvt_pk_bf16_f32 v147, v147, v147
    v_lshlrev_b32 v147, 16, v147
    v_add_f32 v147, v147, v227
    v_cvt_pk_bf16_f32 v147, v147, v147
    v_lshlrev_b32 v147, 16, v147
    v_mul_f32 v27, v147, v147
    v_mul_f32 v27, 0x3d372713, v27
    v_fma_f32 v27, v27, v147, v147
    v_mul_f32 v27, 0x40135761, v27
    v_exp_f32 v27, v27
    s_nop 0
    v_add_f32 v27, 1.0, v27
    v_rcp_f32 v27, v27
    s_nop 0
    v_fma_f32 v27, v27, -2.0, 2.0
    v_mul_f32 v147, 0.5, v147
    v_mul_f32 v19, v147, v27
    v_cvt_pk_bf16_f32 v160, v160, v160
    v_lshlrev_b32 v160, 16, v160
    v_add_f32 v160, v160, v228
    v_cvt_pk_bf16_f32 v160, v160, v160
    v_lshlrev_b32 v160, 16, v160
    v_mul_f32 v24, v160, v160
    v_mul_f32 v24, 0x3d372713, v24
    v_fma_f32 v24, v24, v160, v160
    v_mul_f32 v24, 0x40135761, v24
    v_exp_f32 v24, v24
    s_nop 0
    v_add_f32 v24, 1.0, v24
    v_rcp_f32 v24, v24
    s_nop 0
    v_fma_f32 v24, v24, -2.0, 2.0
    v_mul_f32 v160, 0.5, v160
    v_mul_f32 v20, v160, v24
    v_cvt_pk_bf16_f32 v161, v161, v161
    v_lshlrev_b32 v161, 16, v161
    v_add_f32 v161, v161, v229
    v_cvt_pk_bf16_f32 v161, v161, v161
    v_lshlrev_b32 v161, 16, v161
    v_mul_f32 v25, v161, v161
    v_mul_f32 v25, 0x3d372713, v25
    v_fma_f32 v25, v25, v161, v161
    v_mul_f32 v25, 0x40135761, v25
    v_exp_f32 v25, v25
    s_nop 0
    v_add_f32 v25, 1.0, v25
    v_rcp_f32 v25, v25
    s_nop 0
    v_fma_f32 v25, v25, -2.0, 2.0
    v_mul_f32 v161, 0.5, v161
    v_mul_f32 v21, v161, v25
    v_cvt_pk_bf16_f32 v162, v162, v162
    v_lshlrev_b32 v162, 16, v162
    v_add_f32 v162, v162, v230
    v_cvt_pk_bf16_f32 v162, v162, v162
    v_lshlrev_b32 v162, 16, v162
    v_mul_f32 v26, v162, v162
    v_mul_f32 v26, 0x3d372713, v26
    v_fma_f32 v26, v26, v162, v162
    v_mul_f32 v26, 0x40135761, v26
    v_exp_f32 v26, v26
    s_nop 0
    v_add_f32 v26, 1.0, v26
    v_rcp_f32 v26, v26
    s_nop 0
    v_fma_f32 v26, v26, -2.0, 2.0
    v_mul_f32 v162, 0.5, v162
    v_mul_f32 v22, v162, v26
    v_cvt_pk_bf16_f32 v163, v163, v163
    v_lshlrev_b32 v163, 16, v163
    v_add_f32 v163, v163, v231
    v_cvt_pk_bf16_f32 v163, v163, v163
    v_lshlrev_b32 v163, 16, v163
    v_mul_f32 v27, v163, v163
    v_mul_f32 v27, 0x3d372713, v27
    v_fma_f32 v27, v27, v163, v163
    v_mul_f32 v27, 0x40135761, v27
    v_exp_f32 v27, v27
    s_nop 0
    v_add_f32 v27, 1.0, v27
    v_rcp_f32 v27, v27
    s_nop 0
    v_fma_f32 v27, v27, -2.0, 2.0
    v_mul_f32 v163, 0.5, v163
    v_mul_f32 v23, v163, v27
    v_cvt_pk_bf16_f32 v28, v16, v17
    v_cvt_pk_bf16_f32 v29, v18, v19
    v_cvt_pk_bf16_f32 v30, v20, v21
    v_cvt_pk_bf16_f32 v31, v22, v23
    s_add_u32 s26, s27, 0
    buffer_store_dwordx4 v[28:31], v2, s[28:31], s26 offen sc1
    v_cvt_pk_bf16_f32 v148, v148, v148
    v_lshlrev_b32 v148, 16, v148
    v_add_f32 v148, v148, v224
    v_cvt_pk_bf16_f32 v148, v148, v148
    v_lshlrev_b32 v148, 16, v148
    v_mul_f32 v40, v148, v148
    v_mul_f32 v40, 0x3d372713, v40
    v_fma_f32 v40, v40, v148, v148
    v_mul_f32 v40, 0x40135761, v40
    v_exp_f32 v40, v40
    s_nop 0
    v_add_f32 v40, 1.0, v40
    v_rcp_f32 v40, v40
    s_nop 0
    v_fma_f32 v40, v40, -2.0, 2.0
    v_mul_f32 v148, 0.5, v148
    v_mul_f32 v32, v148, v40
    v_cvt_pk_bf16_f32 v149, v149, v149
    v_lshlrev_b32 v149, 16, v149
    v_add_f32 v149, v149, v225
    v_cvt_pk_bf16_f32 v149, v149, v149
    v_lshlrev_b32 v149, 16, v149
    v_mul_f32 v41, v149, v149
    v_mul_f32 v41, 0x3d372713, v41
    v_fma_f32 v41, v41, v149, v149
    v_mul_f32 v41, 0x40135761, v41
    v_exp_f32 v41, v41
    s_nop 0
    v_add_f32 v41, 1.0, v41
    v_rcp_f32 v41, v41
    s_nop 0
    v_fma_f32 v41, v41, -2.0, 2.0
    v_mul_f32 v149, 0.5, v149
    v_mul_f32 v33, v149, v41
    v_cvt_pk_bf16_f32 v150, v150, v150
    v_lshlrev_b32 v150, 16, v150
    v_add_f32 v150, v150, v226
    v_cvt_pk_bf16_f32 v150, v150, v150
    v_lshlrev_b32 v150, 16, v150
    v_mul_f32 v42, v150, v150
    v_mul_f32 v42, 0x3d372713, v42
    v_fma_f32 v42, v42, v150, v150
    v_mul_f32 v42, 0x40135761, v42
    v_exp_f32 v42, v42
    s_nop 0
    v_add_f32 v42, 1.0, v42
    v_rcp_f32 v42, v42
    s_nop 0
    v_fma_f32 v42, v42, -2.0, 2.0
    v_mul_f32 v150, 0.5, v150
    v_mul_f32 v34, v150, v42
    v_cvt_pk_bf16_f32 v151, v151, v151
    v_lshlrev_b32 v151, 16, v151
    v_add_f32 v151, v151, v227
    v_cvt_pk_bf16_f32 v151, v151, v151
    v_lshlrev_b32 v151, 16, v151
    v_mul_f32 v43, v151, v151
    v_mul_f32 v43, 0x3d372713, v43
    v_fma_f32 v43, v43, v151, v151
    v_mul_f32 v43, 0x40135761, v43
    v_exp_f32 v43, v43
    s_nop 0
    v_add_f32 v43, 1.0, v43
    v_rcp_f32 v43, v43
    s_nop 0
    v_fma_f32 v43, v43, -2.0, 2.0
    v_mul_f32 v151, 0.5, v151
    v_mul_f32 v35, v151, v43
    v_cvt_pk_bf16_f32 v164, v164, v164
    v_lshlrev_b32 v164, 16, v164
    v_add_f32 v164, v164, v228
    v_cvt_pk_bf16_f32 v164, v164, v164
    v_lshlrev_b32 v164, 16, v164
    v_mul_f32 v40, v164, v164
    v_mul_f32 v40, 0x3d372713, v40
    v_fma_f32 v40, v40, v164, v164
    v_mul_f32 v40, 0x40135761, v40
    v_exp_f32 v40, v40
    s_nop 0
    v_add_f32 v40, 1.0, v40
    v_rcp_f32 v40, v40
    s_nop 0
    v_fma_f32 v40, v40, -2.0, 2.0
    v_mul_f32 v164, 0.5, v164
    v_mul_f32 v36, v164, v40
    v_cvt_pk_bf16_f32 v165, v165, v165
    v_lshlrev_b32 v165, 16, v165
    v_add_f32 v165, v165, v229
    v_cvt_pk_bf16_f32 v165, v165, v165
    v_lshlrev_b32 v165, 16, v165
    v_mul_f32 v41, v165, v165
    v_mul_f32 v41, 0x3d372713, v41
    v_fma_f32 v41, v41, v165, v165
    v_mul_f32 v41, 0x40135761, v41
    v_exp_f32 v41, v41
    s_nop 0
    v_add_f32 v41, 1.0, v41
    v_rcp_f32 v41, v41
    s_nop 0
    v_fma_f32 v41, v41, -2.0, 2.0
    v_mul_f32 v165, 0.5, v165
    v_mul_f32 v37, v165, v41
    v_cvt_pk_bf16_f32 v166, v166, v166
    v_lshlrev_b32 v166, 16, v166
    v_add_f32 v166, v166, v230
    v_cvt_pk_bf16_f32 v166, v166, v166
    v_lshlrev_b32 v166, 16, v166
    v_mul_f32 v42, v166, v166
    v_mul_f32 v42, 0x3d372713, v42
    v_fma_f32 v42, v42, v166, v166
    v_mul_f32 v42, 0x40135761, v42
    v_exp_f32 v42, v42
    s_nop 0
    v_add_f32 v42, 1.0, v42
    v_rcp_f32 v42, v42
    s_nop 0
    v_fma_f32 v42, v42, -2.0, 2.0
    v_mul_f32 v166, 0.5, v166
    v_mul_f32 v38, v166, v42
    v_cvt_pk_bf16_f32 v167, v167, v167
    v_lshlrev_b32 v167, 16, v167
    v_add_f32 v167, v167, v231
    v_cvt_pk_bf16_f32 v167, v167, v167
    v_lshlrev_b32 v167, 16, v167
    v_mul_f32 v43, v167, v167
    v_mul_f32 v43, 0x3d372713, v43
    v_fma_f32 v43, v43, v167, v167
    v_mul_f32 v43, 0x40135761, v43
    v_exp_f32 v43, v43
    s_nop 0
    v_add_f32 v43, 1.0, v43
    v_rcp_f32 v43, v43
    s_nop 0
    v_fma_f32 v43, v43, -2.0, 2.0
    v_mul_f32 v167, 0.5, v167
    v_mul_f32 v39, v167, v43
    v_cvt_pk_bf16_f32 v44, v32, v33
    v_cvt_pk_bf16_f32 v45, v34, v35
    v_cvt_pk_bf16_f32 v46, v36, v37
    v_cvt_pk_bf16_f32 v47, v38, v39
    s_add_u32 s26, s27, 0x400
    buffer_store_dwordx4 v[44:47], v2, s[28:31], s26 offen sc1
    v_cvt_pk_bf16_f32 v152, v152, v152
    v_lshlrev_b32 v152, 16, v152
    v_add_f32 v152, v152, v224
    v_cvt_pk_bf16_f32 v152, v152, v152
    v_lshlrev_b32 v152, 16, v152
    v_mul_f32 v56, v152, v152
    v_mul_f32 v56, 0x3d372713, v56
    v_fma_f32 v56, v56, v152, v152
    v_mul_f32 v56, 0x40135761, v56
    v_exp_f32 v56, v56
    s_nop 0
    v_add_f32 v56, 1.0, v56
    v_rcp_f32 v56, v56
    s_nop 0
    v_fma_f32 v56, v56, -2.0, 2.0
    v_mul_f32 v152, 0.5, v152
    v_mul_f32 v48, v152, v56
    v_cvt_pk_bf16_f32 v153, v153, v153
    v_lshlrev_b32 v153, 16, v153
    v_add_f32 v153, v153, v225
    v_cvt_pk_bf16_f32 v153, v153, v153
    v_lshlrev_b32 v153, 16, v153
    v_mul_f32 v57, v153, v153
    v_mul_f32 v57, 0x3d372713, v57
    v_fma_f32 v57, v57, v153, v153
    v_mul_f32 v57, 0x40135761, v57
    v_exp_f32 v57, v57
    s_nop 0
    v_add_f32 v57, 1.0, v57
    v_rcp_f32 v57, v57
    s_nop 0
    v_fma_f32 v57, v57, -2.0, 2.0
    v_mul_f32 v153, 0.5, v153
    v_mul_f32 v49, v153, v57
    v_cvt_pk_bf16_f32 v154, v154, v154
    v_lshlrev_b32 v154, 16, v154
    v_add_f32 v154, v154, v226
    v_cvt_pk_bf16_f32 v154, v154, v154
    v_lshlrev_b32 v154, 16, v154
    v_mul_f32 v58, v154, v154
    v_mul_f32 v58, 0x3d372713, v58
    v_fma_f32 v58, v58, v154, v154
    v_mul_f32 v58, 0x40135761, v58
    v_exp_f32 v58, v58
    s_nop 0
    v_add_f32 v58, 1.0, v58
    v_rcp_f32 v58, v58
    s_nop 0
    v_fma_f32 v58, v58, -2.0, 2.0
    v_mul_f32 v154, 0.5, v154
    v_mul_f32 v50, v154, v58
    v_cvt_pk_bf16_f32 v155, v155, v155
    v_lshlrev_b32 v155, 16, v155
    v_add_f32 v155, v155, v227
    v_cvt_pk_bf16_f32 v155, v155, v155
    v_lshlrev_b32 v155, 16, v155
    v_mul_f32 v59, v155, v155
    v_mul_f32 v59, 0x3d372713, v59
    v_fma_f32 v59, v59, v155, v155
    v_mul_f32 v59, 0x40135761, v59
    v_exp_f32 v59, v59
    s_nop 0
    v_add_f32 v59, 1.0, v59
    v_rcp_f32 v59, v59
    s_nop 0
    v_fma_f32 v59, v59, -2.0, 2.0
    v_mul_f32 v155, 0.5, v155
    v_mul_f32 v51, v155, v59
    v_cvt_pk_bf16_f32 v168, v168, v168
    v_lshlrev_b32 v168, 16, v168
    v_add_f32 v168, v168, v228
    v_cvt_pk_bf16_f32 v168, v168, v168
    v_lshlrev_b32 v168, 16, v168
    v_mul_f32 v56, v168, v168
    v_mul_f32 v56, 0x3d372713, v56
    v_fma_f32 v56, v56, v168, v168
    v_mul_f32 v56, 0x40135761, v56
    v_exp_f32 v56, v56
    s_nop 0
    v_add_f32 v56, 1.0, v56
    v_rcp_f32 v56, v56
    s_nop 0
    v_fma_f32 v56, v56, -2.0, 2.0
    v_mul_f32 v168, 0.5, v168
    v_mul_f32 v52, v168, v56
    v_cvt_pk_bf16_f32 v169, v169, v169
    v_lshlrev_b32 v169, 16, v169
    v_add_f32 v169, v169, v229
    v_cvt_pk_bf16_f32 v169, v169, v169
    v_lshlrev_b32 v169, 16, v169
    v_mul_f32 v57, v169, v169
    v_mul_f32 v57, 0x3d372713, v57
    v_fma_f32 v57, v57, v169, v169
    v_mul_f32 v57, 0x40135761, v57
    v_exp_f32 v57, v57
    s_nop 0
    v_add_f32 v57, 1.0, v57
    v_rcp_f32 v57, v57
    s_nop 0
    v_fma_f32 v57, v57, -2.0, 2.0
    v_mul_f32 v169, 0.5, v169
    v_mul_f32 v53, v169, v57
    v_cvt_pk_bf16_f32 v170, v170, v170
    v_lshlrev_b32 v170, 16, v170
    v_add_f32 v170, v170, v230
    v_cvt_pk_bf16_f32 v170, v170, v170
    v_lshlrev_b32 v170, 16, v170
    v_mul_f32 v58, v170, v170
    v_mul_f32 v58, 0x3d372713, v58
    v_fma_f32 v58, v58, v170, v170
    v_mul_f32 v58, 0x40135761, v58
    v_exp_f32 v58, v58
    s_nop 0
    v_add_f32 v58, 1.0, v58
    v_rcp_f32 v58, v58
    s_nop 0
    v_fma_f32 v58, v58, -2.0, 2.0
    v_mul_f32 v170, 0.5, v170
    v_mul_f32 v54, v170, v58
    v_cvt_pk_bf16_f32 v171, v171, v171
    v_lshlrev_b32 v171, 16, v171
    v_add_f32 v171, v171, v231
    v_cvt_pk_bf16_f32 v171, v171, v171
    v_lshlrev_b32 v171, 16, v171
    v_mul_f32 v59, v171, v171
    v_mul_f32 v59, 0x3d372713, v59
    v_fma_f32 v59, v59, v171, v171
    v_mul_f32 v59, 0x40135761, v59
    v_exp_f32 v59, v59
    s_nop 0
    v_add_f32 v59, 1.0, v59
    v_rcp_f32 v59, v59
    s_nop 0
    v_fma_f32 v59, v59, -2.0, 2.0
    v_mul_f32 v171, 0.5, v171
    v_mul_f32 v55, v171, v59
    v_cvt_pk_bf16_f32 v60, v48, v49
    v_cvt_pk_bf16_f32 v61, v50, v51
    v_cvt_pk_bf16_f32 v62, v52, v53
    v_cvt_pk_bf16_f32 v63, v54, v55
    s_add_u32 s26, s27, 0x1c000
    buffer_store_dwordx4 v[60:63], v2, s[28:31], s26 offen sc1
    v_cvt_pk_bf16_f32 v156, v156, v156
    v_lshlrev_b32 v156, 16, v156
    v_add_f32 v156, v156, v224
    v_cvt_pk_bf16_f32 v156, v156, v156
    v_lshlrev_b32 v156, 16, v156
    v_mul_f32 v72, v156, v156
    v_mul_f32 v72, 0x3d372713, v72
    v_fma_f32 v72, v72, v156, v156
    v_mul_f32 v72, 0x40135761, v72
    v_exp_f32 v72, v72
    s_nop 0
    v_add_f32 v72, 1.0, v72
    v_rcp_f32 v72, v72
    s_nop 0
    v_fma_f32 v72, v72, -2.0, 2.0
    v_mul_f32 v156, 0.5, v156
    v_mul_f32 v64, v156, v72
    v_cvt_pk_bf16_f32 v157, v157, v157
    v_lshlrev_b32 v157, 16, v157
    v_add_f32 v157, v157, v225
    v_cvt_pk_bf16_f32 v157, v157, v157
    v_lshlrev_b32 v157, 16, v157
    v_mul_f32 v73, v157, v157
    v_mul_f32 v73, 0x3d372713, v73
    v_fma_f32 v73, v73, v157, v157
    v_mul_f32 v73, 0x40135761, v73
    v_exp_f32 v73, v73
    s_nop 0
    v_add_f32 v73, 1.0, v73
    v_rcp_f32 v73, v73
    s_nop 0
    v_fma_f32 v73, v73, -2.0, 2.0
    v_mul_f32 v157, 0.5, v157
    v_mul_f32 v65, v157, v73
    v_cvt_pk_bf16_f32 v158, v158, v158
    v_lshlrev_b32 v158, 16, v158
    v_add_f32 v158, v158, v226
    v_cvt_pk_bf16_f32 v158, v158, v158
    v_lshlrev_b32 v158, 16, v158
    v_mul_f32 v74, v158, v158
    v_mul_f32 v74, 0x3d372713, v74
    v_fma_f32 v74, v74, v158, v158
    v_mul_f32 v74, 0x40135761, v74
    v_exp_f32 v74, v74
    s_nop 0
    v_add_f32 v74, 1.0, v74
    v_rcp_f32 v74, v74
    s_nop 0
    v_fma_f32 v74, v74, -2.0, 2.0
    v_mul_f32 v158, 0.5, v158
    v_mul_f32 v66, v158, v74
    v_cvt_pk_bf16_f32 v159, v159, v159
    v_lshlrev_b32 v159, 16, v159
    v_add_f32 v159, v159, v227
    v_cvt_pk_bf16_f32 v159, v159, v159
    v_lshlrev_b32 v159, 16, v159
    v_mul_f32 v75, v159, v159
    v_mul_f32 v75, 0x3d372713, v75
    v_fma_f32 v75, v75, v159, v159
    v_mul_f32 v75, 0x40135761, v75
    v_exp_f32 v75, v75
    s_nop 0
    v_add_f32 v75, 1.0, v75
    v_rcp_f32 v75, v75
    s_nop 0
    v_fma_f32 v75, v75, -2.0, 2.0
    v_mul_f32 v159, 0.5, v159
    v_mul_f32 v67, v159, v75
    v_cvt_pk_bf16_f32 v172, v172, v172
    v_lshlrev_b32 v172, 16, v172
    v_add_f32 v172, v172, v228
    v_cvt_pk_bf16_f32 v172, v172, v172
    v_lshlrev_b32 v172, 16, v172
    v_mul_f32 v72, v172, v172
    v_mul_f32 v72, 0x3d372713, v72
    v_fma_f32 v72, v72, v172, v172
    v_mul_f32 v72, 0x40135761, v72
    v_exp_f32 v72, v72
    s_nop 0
    v_add_f32 v72, 1.0, v72
    v_rcp_f32 v72, v72
    s_nop 0
    v_fma_f32 v72, v72, -2.0, 2.0
    v_mul_f32 v172, 0.5, v172
    v_mul_f32 v68, v172, v72
    v_cvt_pk_bf16_f32 v173, v173, v173
    v_lshlrev_b32 v173, 16, v173
    v_add_f32 v173, v173, v229
    v_cvt_pk_bf16_f32 v173, v173, v173
    v_lshlrev_b32 v173, 16, v173
    v_mul_f32 v73, v173, v173
    v_mul_f32 v73, 0x3d372713, v73
    v_fma_f32 v73, v73, v173, v173
    v_mul_f32 v73, 0x40135761, v73
    v_exp_f32 v73, v73
    s_nop 0
    v_add_f32 v73, 1.0, v73
    v_rcp_f32 v73, v73
    s_nop 0
    v_fma_f32 v73, v73, -2.0, 2.0
    v_mul_f32 v173, 0.5, v173
    v_mul_f32 v69, v173, v73
    v_cvt_pk_bf16_f32 v174, v174, v174
    v_lshlrev_b32 v174, 16, v174
    v_add_f32 v174, v174, v230
    v_cvt_pk_bf16_f32 v174, v174, v174
    v_lshlrev_b32 v174, 16, v174
    v_mul_f32 v74, v174, v174
    v_mul_f32 v74, 0x3d372713, v74
    v_fma_f32 v74, v74, v174, v174
    v_mul_f32 v74, 0x40135761, v74
    v_exp_f32 v74, v74
    s_nop 0
    v_add_f32 v74, 1.0, v74
    v_rcp_f32 v74, v74
    s_nop 0
    v_fma_f32 v74, v74, -2.0, 2.0
    v_mul_f32 v174, 0.5, v174
    v_mul_f32 v70, v174, v74
    v_cvt_pk_bf16_f32 v175, v175, v175
    v_lshlrev_b32 v175, 16, v175
    v_add_f32 v175, v175, v231
    v_cvt_pk_bf16_f32 v175, v175, v175
    v_lshlrev_b32 v175, 16, v175
    v_mul_f32 v75, v175, v175
    v_mul_f32 v75, 0x3d372713, v75
    v_fma_f32 v75, v75, v175, v175
    v_mul_f32 v75, 0x40135761, v75
    v_exp_f32 v75, v75
    s_nop 0
    v_add_f32 v75, 1.0, v75
    v_rcp_f32 v75, v75
    s_nop 0
    v_fma_f32 v75, v75, -2.0, 2.0
    v_mul_f32 v175, 0.5, v175
    v_mul_f32 v71, v175, v75
    v_cvt_pk_bf16_f32 v76, v64, v65
    v_cvt_pk_bf16_f32 v77, v66, v67
    v_cvt_pk_bf16_f32 v78, v68, v69
    v_cvt_pk_bf16_f32 v79, v70, v71
    s_add_u32 s26, s27, 0x1c400
    buffer_store_dwordx4 v[76:79], v2, s[28:31], s26 offen sc1
    s_waitcnt vmcnt(0)
    s_barrier
    s_cmp_lg_u32 s3, 0
    s_cbranch_scc1 w_loop
    s_lshl_b32 s90, s20, 8
    s_add_u32 s90, s90, 0x8000
    s_mov_b64 exec, 1
    v_mov_b32 v250, 0
    v_mov_b32 v251, 1
    buffer_atomic_add v251, v250, s[8:11], s90 offen
    s_mov_b64 exec, -1
    s_branch w_loop
w_ln2_72:
    s_add_u32 s8, s6, 0x3000
    s_addc_u32 s9, s7, 0
    s_and_b32 s9, s9, 0xffff
    s_mov_b32 s10, 0x10000
    s_mov_b32 s11, 0x20000
    s_lshl_b32 s30, s20, 7
    s_lshl_b32 s22, s21, 2
    s_add_u32 s30, s30, s22
    s_add_u32 s30, s30, s3
    s_add_u32 s12, s6, 0x5f16000
    s_addc_u32 s13, s7, 0
    s_and_b32 s13, s13, 0xffff
    s_mov_b32 s14, 0x200000
    s_mov_b32 s15, 0x20000
    s_mov_b32 s16, s6
    s_mov_b32 s17, s7
    s_and_b32 s17, s17, 0xffff
    s_mov_b32 s18, 0x3000
    s_mov_b32 s19, 0x20000
    s_add_u32 s24, s6, 0x6116000
    s_addc_u32 s25, s7, 0
    s_and_b32 s25, s25, 0xffff
    s_mov_b32 s26, 0x200000
    s_mov_b32 s27, 0x20000
    s_lshl_b32 s31, s30, 10
    v_lshlrev_b32 v3, 5, v0
    s_mov_b32 s32, 0x1800
    s_mov_b32 s33, 0x2000
    buffer_load_dwordx4 v[24:27], v3, s[16:19], s32 offen
    buffer_load_dwordx4 v[28:31], v3, s[16:19], s32 offen offset:16
    buffer_load_dwordx4 v[32:35], v3, s[16:19], s33 offen
    buffer_load_dwordx4 v[36:39], v3, s[16:19], s33 offen offset:16
    s_cmp_lg_u32 s3, 0
    s_cbranch_scc1 wcd_92
    s_lshl_b32 s90, s20, 8
    s_add_u32 s90, s90, 0x6000
    v_mov_b32 v250, 0
wc_91:
    buffer_load_dword v251, v250, s[8:11], s90 offen sc1
    s_waitcnt vmcnt(0)
    v_readfirstlane_b32 s91, v251
    s_cmp_ge_u32 s91, 64
    s_cbranch_scc1 wcd_92
    s_sleep 2
    s_add_u32 s92, s92, 1
    s_cmp_gt_u32 s92, 0x1e8480
    s_cbranch_scc1 main_kernel_exit_w
    s_branch wc_91
wcd_92:
    s_waitcnt vmcnt(0)
    s_barrier
    v_lshlrev_b32 v3, 4, v0
    buffer_load_dwordx4 v[4:7], v3, s[12:15], s31 offen
    s_waitcnt vmcnt(0)
    s_waitcnt vmcnt(4)
    v_lshlrev_b32 v8, 16, v4
    v_and_b32 v9, 0xffff0000, v4
    v_lshlrev_b32 v10, 16, v5
    v_and_b32 v11, 0xffff0000, v5
    v_lshlrev_b32 v12, 16, v6
    v_and_b32 v13, 0xffff0000, v6
    v_lshlrev_b32 v14, 16, v7
    v_and_b32 v15, 0xffff0000, v7
    v_add_f32 v16, v8, v9
    v_add_f32 v16, v16, v10
    v_add_f32 v16, v16, v11
    v_add_f32 v16, v16, v12
    v_add_f32 v16, v16, v13
    v_add_f32 v16, v16, v14
    v_add_f32 v16, v16, v15
    s_nop 1
    v_add_f32_dpp v16, v16, v16 quad_perm:[1,0,3,2] row_mask:0xf bank_mask:0xf
    s_nop 1
    v_add_f32_dpp v16, v16, v16 quad_perm:[2,3,0,1] row_mask:0xf bank_mask:0xf
    s_nop 1
    v_add_f32_dpp v16, v16, v16 row_half_mirror row_mask:0xf bank_mask:0xf
    s_nop 1
    v_add_f32_dpp v16, v16, v16 row_mirror row_mask:0xf bank_mask:0xf
    v_mov_b32 v17, v16
    s_nop 1
    v_permlane16_swap_b32 v16, v17
    v_add_f32 v16, v16, v17
    v_mov_b32 v17, v16
    s_nop 1
    v_permlane32_swap_b32 v16, v17
    v_add_f32 v16, v16, v17
    v_mul_f32 v16, 0x3b000000, v16
    v_sub_f32 v18, v8, v16
    v_mul_f32 v17, v18, v18
    v_sub_f32 v18, v9, v16
    v_fmac_f32 v17, v18, v18
    v_sub_f32 v18, v10, v16
    v_fmac_f32 v17, v18, v18
    v_sub_f32 v18, v11, v16
    v_fmac_f32 v17, v18, v18
    v_sub_f32 v18, v12, v16
    v_fmac_f32 v17, v18, v18
    v_sub_f32 v18, v13, v16
    v_fmac_f32 v17, v18, v18
    v_sub_f32 v18, v14, v16
    v_fmac_f32 v17, v18, v18
    v_sub_f32 v18, v15, v16
    v_fmac_f32 v17, v18, v18
    s_nop 1
    v_add_f32_dpp v17, v17, v17 quad_perm:[1,0,3,2] row_mask:0xf bank_mask:0xf
    s_nop 1
    v_add_f32_dpp v17, v17, v17 quad_perm:[2,3,0,1] row_mask:0xf bank_mask:0xf
    s_nop 1
    v_add_f32_dpp v17, v17, v17 row_half_mirror row_mask:0xf bank_mask:0xf
    s_nop 1
    v_add_f32_dpp v17, v17, v17 row_mirror row_mask:0xf bank_mask:0xf
    v_mov_b32 v18, v17
    s_nop 1
    v_permlane16_swap_b32 v17, v18
    v_add_f32 v17, v17, v18
    v_mov_b32 v18, v17
    s_nop 1
    v_permlane32_swap_b32 v17, v18
    v_add_f32 v17, v17, v18
    v_mul_f32 v17, 0x3b000000, v17
    v_cvt_pk_bf16_f32 v16, v16, v16
    v_lshlrev_b32 v16, 16, v16
    v_cvt_pk_bf16_f32 v17, v17, v17
    v_lshlrev_b32 v17, 16, v17
    v_add_f32 v17, 0x3727c5ac, v17
    v_cvt_pk_bf16_f32 v17, v17, v17
    v_lshlrev_b32 v17, 16, v17
    v_sqrt_f32 v17, v17
    s_nop 0
    v_cvt_pk_bf16_f32 v17, v17, v17
    v_lshlrev_b32 v17, 16, v17
    v_rcp_f32 v17, v17
    v_sub_f32 v8, v8, v16
    v_cvt_pk_bf16_f32 v8, v8, v8
    v_lshlrev_b32 v8, 16, v8
    v_mul_f32 v8, v8, v17
    v_cvt_pk_bf16_f32 v8, v8, v8
    v_lshlrev_b32 v8, 16, v8
    v_sub_f32 v9, v9, v16
    v_cvt_pk_bf16_f32 v9, v9, v9
    v_lshlrev_b32 v9, 16, v9
    v_mul_f32 v9, v9, v17
    v_cvt_pk_bf16_f32 v9, v9, v9
    v_lshlrev_b32 v9, 16, v9
    v_sub_f32 v10, v10, v16
    v_cvt_pk_bf16_f32 v10, v10, v10
    v_lshlrev_b32 v10, 16, v10
    v_mul_f32 v10, v10, v17
    v_cvt_pk_bf16_f32 v10, v10, v10
    v_lshlrev_b32 v10, 16, v10
    v_sub_f32 v11, v11, v16
    v_cvt_pk_bf16_f32 v11, v11, v11
    v_lshlrev_b32 v11, 16, v11
    v_mul_f32 v11, v11, v17
    v_cvt_pk_bf16_f32 v11, v11, v11
    v_lshlrev_b32 v11, 16, v11
    v_sub_f32 v12, v12, v16
    v_cvt_pk_bf16_f32 v12, v12, v12
    v_lshlrev_b32 v12, 16, v12
    v_mul_f32 v12, v12, v17
    v_cvt_pk_bf16_f32 v12, v12, v12
    v_lshlrev_b32 v12, 16, v12
    v_sub_f32 v13, v13, v16
    v_cvt_pk_bf16_f32 v13, v13, v13
    v_lshlrev_b32 v13, 16, v13
    v_mul_f32 v13, v13, v17
    v_cvt_pk_bf16_f32 v13, v13, v13
    v_lshlrev_b32 v13, 16, v13
    v_sub_f32 v14, v14, v16
    v_cvt_pk_bf16_f32 v14, v14, v14
    v_lshlrev_b32 v14, 16, v14
    v_mul_f32 v14, v14, v17
    v_cvt_pk_bf16_f32 v14, v14, v14
    v_lshlrev_b32 v14, 16, v14
    v_sub_f32 v15, v15, v16
    v_cvt_pk_bf16_f32 v15, v15, v15
    v_lshlrev_b32 v15, 16, v15
    v_mul_f32 v15, v15, v17
    v_cvt_pk_bf16_f32 v15, v15, v15
    v_lshlrev_b32 v15, 16, v15
    s_waitcnt vmcnt(0)
    v_add_f32 v32, 1.0, v32
    v_cvt_pk_bf16_f32 v32, v32, v32
    v_lshlrev_b32 v32, 16, v32
    v_mul_f32 v8, v8, v32
    v_cvt_pk_bf16_f32 v8, v8, v8
    v_lshlrev_b32 v8, 16, v8
    v_add_f32 v8, v8, v24
    v_cvt_pk_bf16_f32 v8, v8, v8
    v_lshlrev_b32 v8, 16, v8
    v_add_f32 v33, 1.0, v33
    v_cvt_pk_bf16_f32 v33, v33, v33
    v_lshlrev_b32 v33, 16, v33
    v_mul_f32 v9, v9, v33
    v_cvt_pk_bf16_f32 v9, v9, v9
    v_lshlrev_b32 v9, 16, v9
    v_add_f32 v9, v9, v25
    v_cvt_pk_bf16_f32 v9, v9, v9
    v_lshlrev_b32 v9, 16, v9
    v_add_f32 v34, 1.0, v34
    v_cvt_pk_bf16_f32 v34, v34, v34
    v_lshlrev_b32 v34, 16, v34
    v_mul_f32 v10, v10, v34
    v_cvt_pk_bf16_f32 v10, v10, v10
    v_lshlrev_b32 v10, 16, v10
    v_add_f32 v10, v10, v26
    v_cvt_pk_bf16_f32 v10, v10, v10
    v_lshlrev_b32 v10, 16, v10
    v_add_f32 v35, 1.0, v35
    v_cvt_pk_bf16_f32 v35, v35, v35
    v_lshlrev_b32 v35, 16, v35
    v_mul_f32 v11, v11, v35
    v_cvt_pk_bf16_f32 v11, v11, v11
    v_lshlrev_b32 v11, 16, v11
    v_add_f32 v11, v11, v27
    v_cvt_pk_bf16_f32 v11, v11, v11
    v_lshlrev_b32 v11, 16, v11
    v_add_f32 v36, 1.0, v36
    v_cvt_pk_bf16_f32 v36, v36, v36
    v_lshlrev_b32 v36, 16, v36
    v_mul_f32 v12, v12, v36
    v_cvt_pk_bf16_f32 v12, v12, v12
    v_lshlrev_b32 v12, 16, v12
    v_add_f32 v12, v12, v28
    v_cvt_pk_bf16_f32 v12, v12, v12
    v_lshlrev_b32 v12, 16, v12
    v_add_f32 v37, 1.0, v37
    v_cvt_pk_bf16_f32 v37, v37, v37
    v_lshlrev_b32 v37, 16, v37
    v_mul_f32 v13, v13, v37
    v_cvt_pk_bf16_f32 v13, v13, v13
    v_lshlrev_b32 v13, 16, v13
    v_add_f32 v13, v13, v29
    v_cvt_pk_bf16_f32 v13, v13, v13
    v_lshlrev_b32 v13, 16, v13
    v_add_f32 v38, 1.0, v38
    v_cvt_pk_bf16_f32 v38, v38, v38
    v_lshlrev_b32 v38, 16, v38
    v_mul_f32 v14, v14, v38
    v_cvt_pk_bf16_f32 v14, v14, v14
    v_lshlrev_b32 v14, 16, v14
    v_add_f32 v14, v14, v30
    v_cvt_pk_bf16_f32 v14, v14, v14
    v_lshlrev_b32 v14, 16, v14
    v_add_f32 v39, 1.0, v39
    v_cvt_pk_bf16_f32 v39, v39, v39
    v_lshlrev_b32 v39, 16, v39
    v_mul_f32 v15, v15, v39
    v_cvt_pk_bf16_f32 v15, v15, v15
    v_lshlrev_b32 v15, 16, v15
    v_add_f32 v15, v15, v31
    v_cvt_pk_bf16_f32 v15, v15, v15
    v_lshlrev_b32 v15, 16, v15
    v_add_f32 v16, v8, v9
    v_add_f32 v16, v16, v10
    v_add_f32 v16, v16, v11
    v_add_f32 v16, v16, v12
    v_add_f32 v16, v16, v13
    v_add_f32 v16, v16, v14
    v_add_f32 v16, v16, v15
    s_nop 1
    v_add_f32_dpp v16, v16, v16 quad_perm:[1,0,3,2] row_mask:0xf bank_mask:0xf
    s_nop 1
    v_add_f32_dpp v16, v16, v16 quad_perm:[2,3,0,1] row_mask:0xf bank_mask:0xf
    s_nop 1
    v_add_f32_dpp v16, v16, v16 row_half_mirror row_mask:0xf bank_mask:0xf
    s_nop 1
    v_add_f32_dpp v16, v16, v16 row_mirror row_mask:0xf bank_mask:0xf
    v_mov_b32 v17, v16
    s_nop 1
    v_permlane16_swap_b32 v16, v17
    v_add_f32 v16, v16, v17
    v_mov_b32 v17, v16
    s_nop 1
    v_permlane32_swap_b32 v16, v17
    v_add_f32 v16, v16, v17
    v_mul_f32 v16, 0x3b000000, v16
    v_sub_f32 v18, v8, v16
    v_mul_f32 v17, v18, v18
    v_sub_f32 v18, v9, v16
    v_fmac_f32 v17, v18, v18
    v_sub_f32 v18, v10, v16
    v_fmac_f32 v17, v18, v18
    v_sub_f32 v18, v11, v16
    v_fmac_f32 v17, v18, v18
    v_sub_f32 v18, v12, v16
    v_fmac_f32 v17, v18, v18
    v_sub_f32 v18, v13, v16
    v_fmac_f32 v17, v18, v18
    v_sub_f32 v18, v14, v16
    v_fmac_f32 v17, v18, v18
    v_sub_f32 v18, v15, v16
    v_fmac_f32 v17, v18, v18
    s_nop 1
    v_add_f32_dpp v17, v17, v17 quad_perm:[1,0,3,2] row_mask:0xf bank_mask:0xf
    s_nop 1
    v_add_f32_dpp v17, v17, v17 quad_perm:[2,3,0,1] row_mask:0xf bank_mask:0xf
    s_nop 1
    v_add_f32_dpp v17, v17, v17 row_half_mirror row_mask:0xf bank_mask:0xf
    s_nop 1
    v_add_f32_dpp v17, v17, v17 row_mirror row_mask:0xf bank_mask:0xf
    v_mov_b32 v18, v17
    s_nop 1
    v_permlane16_swap_b32 v17, v18
    v_add_f32 v17, v17, v18
    v_mov_b32 v18, v17
    s_nop 1
    v_permlane32_swap_b32 v17, v18
    v_add_f32 v17, v17, v18
    v_mul_f32 v17, 0x3b000000, v17
    v_cvt_pk_bf16_f32 v16, v16, v16
    v_lshlrev_b32 v16, 16, v16
    v_cvt_pk_bf16_f32 v17, v17, v17
    v_lshlrev_b32 v17, 16, v17
    v_add_f32 v17, 0x3727c5ac, v17
    v_cvt_pk_bf16_f32 v17, v17, v17
    v_lshlrev_b32 v17, 16, v17
    v_sqrt_f32 v17, v17
    s_nop 0
    v_cvt_pk_bf16_f32 v17, v17, v17
    v_lshlrev_b32 v17, 16, v17
    v_rcp_f32 v17, v17
    v_sub_f32 v8, v8, v16
    v_cvt_pk_bf16_f32 v8, v8, v8
    v_lshlrev_b32 v8, 16, v8
    v_mul_f32 v8, v8, v17
    v_cvt_pk_bf16_f32 v8, v8, v8
    v_lshlrev_b32 v8, 16, v8
    v_sub_f32 v9, v9, v16
    v_cvt_pk_bf16_f32 v9, v9, v9
    v_lshlrev_b32 v9, 16, v9
    v_mul_f32 v9, v9, v17
    v_cvt_pk_bf16_f32 v9, v9, v9
    v_lshlrev_b32 v9, 16, v9
    v_sub_f32 v10, v10, v16
    v_cvt_pk_bf16_f32 v10, v10, v10
    v_lshlrev_b32 v10, 16, v10
    v_mul_f32 v10, v10, v17
    v_cvt_pk_bf16_f32 v10, v10, v10
    v_lshlrev_b32 v10, 16, v10
    v_sub_f32 v11, v11, v16
    v_cvt_pk_bf16_f32 v11, v11, v11
    v_lshlrev_b32 v11, 16, v11
    v_mul_f32 v11, v11, v17
    v_cvt_pk_bf16_f32 v11, v11, v11
    v_lshlrev_b32 v11, 16, v11
    v_sub_f32 v12, v12, v16
    v_cvt_pk_bf16_f32 v12, v12, v12
    v_lshlrev_b32 v12, 16, v12
    v_mul_f32 v12, v12, v17
    v_cvt_pk_bf16_f32 v12, v12, v12
    v_lshlrev_b32 v12, 16, v12
    v_sub_f32 v13, v13, v16
    v_cvt_pk_bf16_f32 v13, v13, v13
    v_lshlrev_b32 v13, 16, v13
    v_mul_f32 v13, v13, v17
    v_cvt_pk_bf16_f32 v13, v13, v13
    v_lshlrev_b32 v13, 16, v13
    v_sub_f32 v14, v14, v16
    v_cvt_pk_bf16_f32 v14, v14, v14
    v_lshlrev_b32 v14, 16, v14
    v_mul_f32 v14, v14, v17
    v_cvt_pk_bf16_f32 v14, v14, v14
    v_lshlrev_b32 v14, 16, v14
    v_sub_f32 v15, v15, v16
    v_cvt_pk_bf16_f32 v15, v15, v15
    v_lshlrev_b32 v15, 16, v15
    v_mul_f32 v15, v15, v17
    v_cvt_pk_bf16_f32 v15, v15, v15
    v_lshlrev_b32 v15, 16, v15
    v_cvt_pk_bf16_f32 v4, v8, v9
    v_cvt_pk_bf16_f32 v5, v10, v11
    v_cvt_pk_bf16_f32 v6, v12, v13
    v_cvt_pk_bf16_f32 v7, v14, v15
    s_lshr_b32 s31, s30, 5
    s_lshl_b32 s31, s31, 15
    s_bfe_u32 s32, s30, 0x10002
    s_lshl_b32 s32, s32, 10
    s_add_u32 s31, s31, s32
    s_bfe_u32 s32, s30, 0x20003
    s_lshl_b32 s32, s32, 6
    s_add_u32 s31, s31, s32
    s_and_b32 s32, s30, 3
    s_lshl_b32 s32, s32, 4
    s_add_u32 s31, s31, s32
    v_lshrrev_b32 v3, 2, v0
    v_lshlrev_b32 v3, 11, v3
    v_and_b32 v1, 3, v0
    v_lshl_add_u32 v3, v1, 8, v3
    buffer_store_dwordx4 v[4:7], v3, s[24:27], s31 offen sc1
    s_waitcnt vmcnt(0)
    s_barrier
    s_cmp_lg_u32 s3, 0
    s_cbranch_scc1 w_loop
    s_lshl_b32 s90, s20, 8
    s_add_u32 s90, s90, 0x7000
    s_mov_b64 exec, 1
    v_mov_b32 v250, 0
    v_mov_b32 v251, 1
    buffer_atomic_add v251, v250, s[8:11], s90 offen
    s_mov_b64 exec, -1
    s_branch w_loop
w_wo_73:
    s_add_u32 s8, s6, 0x3000
    s_addc_u32 s9, s7, 0
    s_and_b32 s9, s9, 0xffff
    s_mov_b32 s10, 0x10000
    s_mov_b32 s11, 0x20000
    s_load_dwordx2 s[4:5], s[0:1], 0
    s_load_dwordx2 s[40:41], s[0:1], 0x70
    s_and_b32 s42, s21, 15
    s_lshr_b32 s43, s21, 4
    s_lshl_b32 s22, s20, 2
    s_add_u32 s43, s43, s22
    s_add_u32 s12, s6, 0xf96000
    s_addc_u32 s13, s7, 0
    s_and_b32 s13, s13, 0xffff
    s_mov_b32 s14, 0x400000
    s_mov_b32 s15, 0x20000
    s_add_u32 s16, s6, 0x4f16000
    s_addc_u32 s17, s7, 0
    s_and_b32 s17, s17, 0xffff
    s_mov_b32 s18, 0x1000000
    s_mov_b32 s19, 0x20000
    s_mul_i32 s24, s42, 0x40000
    s_mul_i32 s25, s43, 0x40000
    s_mul_i32 s26, s3, 0x10000
    s_add_u32 s24, s24, s26
    s_add_u32 s25, s25, s26
    v_lshlrev_b32 v2, 4, v0
    v_and_b32 v8, 15, v0
    v_lshrrev_b32 v9, 4, v0
    v_add_u32 v4, 0, v2
    v_add_u32 v5, 0x40000, v2
    s_mov_b32 s23, 0
    s_cmp_lg_u32 s3, 0
    s_cbranch_scc1 wcd_94
    s_lshl_b32 s90, s23, 8
    s_add_u32 s90, s90, 0xd000
    v_mov_b32 v250, 0
wc_93:
    buffer_load_dword v251, v250, s[8:11], s90 offen sc1
    s_waitcnt vmcnt(0)
    v_readfirstlane_b32 s91, v251
    s_cmp_ge_u32 s91, 0x80
    s_cbranch_scc1 wcd_94
    s_sleep 2
    s_add_u32 s92, s92, 1
    s_cmp_gt_u32 s92, 0x1e8480
    s_cbranch_scc1 main_kernel_exit_w
    s_branch wc_93
wcd_94:
    s_waitcnt vmcnt(0)
    s_barrier
    buffer_load_dwordx4 a[0:3], v4, s[12:15], s24 offen offset:0
    buffer_load_dwordx4 a[4:7], v4, s[12:15], s24 offen offset:1024
    s_add_u32 s24, s24, 0x800
    buffer_load_dwordx4 a[8:11], v4, s[12:15], s24 offen offset:0
    buffer_load_dwordx4 a[12:15], v4, s[12:15], s24 offen offset:1024
    s_add_u32 s24, s24, 0x800
    buffer_load_dwordx4 a[16:19], v4, s[12:15], s24 offen offset:0
    buffer_load_dwordx4 a[20:23], v4, s[12:15], s24 offen offset:1024
    s_add_u32 s24, s24, 0x800
    buffer_load_dwordx4 a[24:27], v4, s[12:15], s24 offen offset:0
    buffer_load_dwordx4 a[28:31], v4, s[12:15], s24 offen offset:1024
    s_add_u32 s24, s24, 0x800
    buffer_load_dwordx4 a[32:35], v4, s[12:15], s24 offen offset:0
    buffer_load_dwordx4 a[36:39], v4, s[12:15], s24 offen offset:1024
    s_add_u32 s24, s24, 0x800
    buffer_load_dwordx4 a[40:43], v4, s[12:15], s24 offen offset:0
    buffer_load_dwordx4 a[44:47], v4, s[12:15], s24 offen offset:1024
    s_add_u32 s24, s24, 0x800
    buffer_load_dwordx4 a[48:51], v4, s[12:15], s24 offen offset:0
    buffer_load_dwordx4 a[52:55], v4, s[12:15], s24 offen offset:1024
    s_add_u32 s24, s24, 0x800
    buffer_load_dwordx4 a[56:59], v4, s[12:15], s24 offen offset:0
    buffer_load_dwordx4 a[60:63], v4, s[12:15], s24 offen offset:1024
    s_add_u32 s24, s24, 0x800
    buffer_load_dwordx4 a[64:67], v4, s[12:15], s24 offen offset:0
    buffer_load_dwordx4 a[68:71], v4, s[12:15], s24 offen offset:1024
    s_add_u32 s24, s24, 0x800
    buffer_load_dwordx4 a[72:75], v4, s[12:15], s24 offen offset:0
    buffer_load_dwordx4 a[76:79], v4, s[12:15], s24 offen offset:1024
    s_add_u32 s24, s24, 0x800
    buffer_load_dwordx4 a[80:83], v4, s[12:15], s24 offen offset:0
    buffer_load_dwordx4 a[84:87], v4, s[12:15], s24 offen offset:1024
    s_add_u32 s24, s24, 0x800
    buffer_load_dwordx4 a[88:91], v4, s[12:15], s24 offen offset:0
    buffer_load_dwordx4 a[92:95], v4, s[12:15], s24 offen offset:1024
    s_add_u32 s24, s24, 0x800
    buffer_load_dwordx4 a[96:99], v4, s[12:15], s24 offen offset:0
    buffer_load_dwordx4 a[100:103], v4, s[12:15], s24 offen offset:1024
    s_add_u32 s24, s24, 0x800
    buffer_load_dwordx4 a[104:107], v4, s[12:15], s24 offen offset:0
    buffer_load_dwordx4 a[108:111], v4, s[12:15], s24 offen offset:1024
    s_add_u32 s24, s24, 0x800
    buffer_load_dwordx4 a[112:115], v4, s[12:15], s24 offen offset:0
    buffer_load_dwordx4 a[116:119], v4, s[12:15], s24 offen offset:1024
    s_add_u32 s24, s24, 0x800
    buffer_load_dwordx4 a[120:123], v4, s[12:15], s24 offen offset:0
    buffer_load_dwordx4 a[124:127], v4, s[12:15], s24 offen offset:1024
    s_add_u32 s24, s24, 0x800
    buffer_load_dwordx4 a[128:131], v4, s[12:15], s24 offen offset:0
    buffer_load_dwordx4 a[132:135], v4, s[12:15], s24 offen offset:1024
    s_add_u32 s24, s24, 0x800
    buffer_load_dwordx4 a[136:139], v4, s[12:15], s24 offen offset:0
    buffer_load_dwordx4 a[140:143], v4, s[12:15], s24 offen offset:1024
    s_add_u32 s24, s24, 0x800
    buffer_load_dwordx4 a[144:147], v4, s[12:15], s24 offen offset:0
    buffer_load_dwordx4 a[148:151], v4, s[12:15], s24 offen offset:1024
    s_add_u32 s24, s24, 0x800
    buffer_load_dwordx4 a[152:155], v4, s[12:15], s24 offen offset:0
    buffer_load_dwordx4 a[156:159], v4, s[12:15], s24 offen offset:1024
    s_add_u32 s24, s24, 0x800
    buffer_load_dwordx4 a[160:163], v4, s[12:15], s24 offen offset:0
    buffer_load_dwordx4 a[164:167], v4, s[12:15], s24 offen offset:1024
    s_add_u32 s24, s24, 0x800
    buffer_load_dwordx4 a[168:171], v4, s[12:15], s24 offen offset:0
    buffer_load_dwordx4 a[172:175], v4, s[12:15], s24 offen offset:1024
    s_add_u32 s24, s24, 0x800
    buffer_load_dwordx4 a[176:179], v4, s[12:15], s24 offen offset:0
    buffer_load_dwordx4 a[180:183], v4, s[12:15], s24 offen offset:1024
    s_add_u32 s24, s24, 0x800
    buffer_load_dwordx4 a[184:187], v4, s[12:15], s24 offen offset:0
    buffer_load_dwordx4 a[188:191], v4, s[12:15], s24 offen offset:1024
    s_add_u32 s24, s24, 0x800
    s_waitcnt vmcnt(16)
    buffer_load_dwordx4 a[192:195], v4, s[12:15], s24 offen offset:0
    buffer_load_dwordx4 a[196:199], v4, s[12:15], s24 offen offset:1024
    s_add_u32 s24, s24, 0x800
    buffer_load_dwordx4 a[200:203], v4, s[12:15], s24 offen offset:0
    buffer_load_dwordx4 a[204:207], v4, s[12:15], s24 offen offset:1024
    s_add_u32 s24, s24, 0x800
    buffer_load_dwordx4 a[208:211], v4, s[12:15], s24 offen offset:0
    buffer_load_dwordx4 a[212:215], v4, s[12:15], s24 offen offset:1024
    s_add_u32 s24, s24, 0x800
    buffer_load_dwordx4 a[216:219], v4, s[12:15], s24 offen offset:0
    buffer_load_dwordx4 a[220:223], v4, s[12:15], s24 offen offset:1024
    s_add_u32 s24, s24, 0x800
    buffer_load_dwordx4 a[224:227], v4, s[12:15], s24 offen offset:0
    buffer_load_dwordx4 a[228:231], v4, s[12:15], s24 offen offset:1024
    s_add_u32 s24, s24, 0x800
    buffer_load_dwordx4 a[232:235], v4, s[12:15], s24 offen offset:0
    buffer_load_dwordx4 a[236:239], v4, s[12:15], s24 offen offset:1024
    s_add_u32 s24, s24, 0x800
    buffer_load_dwordx4 a[240:243], v4, s[12:15], s24 offen offset:0
    buffer_load_dwordx4 a[244:247], v4, s[12:15], s24 offen offset:1024
    s_add_u32 s24, s24, 0x800
    buffer_load_dwordx4 a[248:251], v4, s[12:15], s24 offen offset:0
    buffer_load_dwordx4 a[252:255], v4, s[12:15], s24 offen offset:1024
    s_add_u32 s24, s24, 0x800
    s_waitcnt lgkmcnt(0)
    s_mov_b32 s44, s6
    s_mov_b32 s45, s7
    s_and_b32 s45, s45, 0xffff
    s_mov_b32 s46, 0x3000
    s_mov_b32 s47, 0x20000
    s_add_u32 s28, s6, 0x5f16000
    s_addc_u32 s29, s7, 0
    s_and_b32 s29, s29, 0xffff
    s_mov_b32 s30, 0x200000
    s_mov_b32 s31, 0x20000
    s_mov_b32 s32, s4
    s_mov_b32 s33, s5
    s_and_b32 s33, s33, 0xffff
    s_mov_b32 s34, 0x200000
    s_mov_b32 s35, 0x20000
    v_lshrrev_b32 v10, 2, v8
    v_lshlrev_b32 v10, 3, v10
    v_and_b32 v11, 3, v8
    v_add_u32 v10, v10, v11
    v_lshlrev_b32 v10, 10, v10
    v_lshl_add_u32 v10, v9, 4, v10
    s_lshl_b32 s27, s43, 5
    s_and_b32 s26, s3, 1
    s_lshl_b32 s26, s26, 2
    s_add_u32 s27, s27, s26
    s_lshl_b32 s27, s27, 10
    s_mul_i32 s26, s42, 64
    s_add_u32 s27, s27, s26
    s_lshr_b32 s23, s3, 1
    s_mov_b32 s23, 0
    s_lshl_b32 s26, s23, 6
    s_add_u32 s27, s27, s26
    v_lshlrev_b32 v11, 5, v9
    s_mul_i32 s26, s42, 0x80
    s_add_u32 s26, s26, 0x1000
    s_lshl_b32 s22, s23, 7
    s_add_u32 s26, s26, s22
    buffer_load_dwordx4 v[216:219], v10, s[32:35], s27 offen
    buffer_load_dwordx4 v[224:227], v11, s[44:47], s26 offen
    buffer_load_dwordx4 v[228:231], v11, s[44:47], s26 offen offset:16
    s_cmp_lg_u32 s3, 0
    s_cbranch_scc1 wcd_96
    s_lshl_b32 s90, s20, 8
    s_add_u32 s90, s90, 0x5000
    v_mov_b32 v250, 0
wc_95:
    buffer_load_dword v251, v250, s[8:11], s90 offen sc1
    s_waitcnt vmcnt(0)
    v_readfirstlane_b32 s91, v251
    s_cmp_ge_u32 s91, 32
    s_cbranch_scc1 wcd_96
    s_sleep 2
    s_add_u32 s92, s92, 1
    s_cmp_gt_u32 s92, 0x1e8480
    s_cbranch_scc1 main_kernel_exit_w
    s_branch wc_95
wcd_96:
    s_waitcnt vmcnt(0)
    s_barrier
    buffer_load_dwordx4 v[16:19], v4, s[16:19], s25 offen offset:0
    buffer_load_dwordx4 v[20:23], v4, s[16:19], s25 offen offset:1024
    s_add_u32 s25, s25, 0x800
    buffer_load_dwordx4 v[24:27], v4, s[16:19], s25 offen offset:0
    buffer_load_dwordx4 v[28:31], v4, s[16:19], s25 offen offset:1024
    s_add_u32 s25, s25, 0x800
    buffer_load_dwordx4 v[32:35], v4, s[16:19], s25 offen offset:0
    buffer_load_dwordx4 v[36:39], v4, s[16:19], s25 offen offset:1024
    s_add_u32 s25, s25, 0x800
    buffer_load_dwordx4 v[40:43], v4, s[16:19], s25 offen offset:0
    buffer_load_dwordx4 v[44:47], v4, s[16:19], s25 offen offset:1024
    s_add_u32 s25, s25, 0x800
    buffer_load_dwordx4 v[48:51], v4, s[16:19], s25 offen offset:0
    buffer_load_dwordx4 v[52:55], v4, s[16:19], s25 offen offset:1024
    s_add_u32 s25, s25, 0x800
    buffer_load_dwordx4 v[56:59], v4, s[16:19], s25 offen offset:0
    buffer_load_dwordx4 v[60:63], v4, s[16:19], s25 offen offset:1024
    s_add_u32 s25, s25, 0x800
    buffer_load_dwordx4 v[64:67], v4, s[16:19], s25 offen offset:0
    buffer_load_dwordx4 v[68:71], v4, s[16:19], s25 offen offset:1024
    s_add_u32 s25, s25, 0x800
    buffer_load_dwordx4 v[72:75], v4, s[16:19], s25 offen offset:0
    buffer_load_dwordx4 v[76:79], v4, s[16:19], s25 offen offset:1024
    s_add_u32 s25, s25, 0x800
    buffer_load_dwordx4 v[80:83], v4, s[16:19], s25 offen offset:0
    buffer_load_dwordx4 v[84:87], v4, s[16:19], s25 offen offset:1024
    s_add_u32 s25, s25, 0x800
    buffer_load_dwordx4 v[88:91], v4, s[16:19], s25 offen offset:0
    buffer_load_dwordx4 v[92:95], v4, s[16:19], s25 offen offset:1024
    s_add_u32 s25, s25, 0x800
    buffer_load_dwordx4 v[96:99], v4, s[16:19], s25 offen offset:0
    buffer_load_dwordx4 v[100:103], v4, s[16:19], s25 offen offset:1024
    s_add_u32 s25, s25, 0x800
    buffer_load_dwordx4 v[104:107], v4, s[16:19], s25 offen offset:0
    buffer_load_dwordx4 v[108:111], v4, s[16:19], s25 offen offset:1024
    s_add_u32 s25, s25, 0x800
    buffer_load_dwordx4 v[112:115], v4, s[16:19], s25 offen offset:0
    buffer_load_dwordx4 v[116:119], v4, s[16:19], s25 offen offset:1024
    s_add_u32 s25, s25, 0x800
    buffer_load_dwordx4 v[120:123], v4, s[16:19], s25 offen offset:0
    buffer_load_dwordx4 v[124:127], v4, s[16:19], s25 offen offset:1024
    s_add_u32 s25, s25, 0x800
    s_waitcnt vmcnt(26)
    v_mfma_f32_16x16x32_bf16 v[144:147], a[0:3], v[16:19], 0
    v_mfma_f32_16x16x32_bf16 v[148:151], a[0:3], v[20:23], 0
    v_mfma_f32_16x16x32_bf16 v[152:155], a[4:7], v[16:19], 0
    v_mfma_f32_16x16x32_bf16 v[156:159], a[4:7], v[20:23], 0
    buffer_load_dwordx4 v[16:19], v4, s[16:19], s25 offen offset:0
    buffer_load_dwordx4 v[20:23], v4, s[16:19], s25 offen offset:1024
    s_add_u32 s25, s25, 0x800
    s_waitcnt vmcnt(26)
    v_mfma_f32_16x16x32_bf16 v[144:147], a[8:11], v[24:27], v[144:147]
    v_mfma_f32_16x16x32_bf16 v[148:151], a[8:11], v[28:31], v[148:151]
    v_mfma_f32_16x16x32_bf16 v[152:155], a[12:15], v[24:27], v[152:155]
    v_mfma_f32_16x16x32_bf16 v[156:159], a[12:15], v[28:31], v[156:159]
    buffer_load_dwordx4 v[24:27], v4, s[16:19], s25 offen offset:0
    buffer_load_dwordx4 v[28:31], v4, s[16:19], s25 offen offset:1024
    s_add_u32 s25, s25, 0x800
    s_waitcnt vmcnt(26)
    v_mfma_f32_16x16x32_bf16 v[144:147], a[16:19], v[32:35], v[144:147]
    v_mfma_f32_16x16x32_bf16 v[148:151], a[16:19], v[36:39], v[148:151]
    v_mfma_f32_16x16x32_bf16 v[152:155], a[20:23], v[32:35], v[152:155]
    v_mfma_f32_16x16x32_bf16 v[156:159], a[20:23], v[36:39], v[156:159]
    buffer_load_dwordx4 v[32:35], v4, s[16:19], s25 offen offset:0
    buffer_load_dwordx4 v[36:39], v4, s[16:19], s25 offen offset:1024
    s_add_u32 s25, s25, 0x800
    s_waitcnt vmcnt(26)
    v_mfma_f32_16x16x32_bf16 v[144:147], a[24:27], v[40:43], v[144:147]
    v_mfma_f32_16x16x32_bf16 v[148:151], a[24:27], v[44:47], v[148:151]
    v_mfma_f32_16x16x32_bf16 v[152:155], a[28:31], v[40:43], v[152:155]
    v_mfma_f32_16x16x32_bf16 v[156:159], a[28:31], v[44:47], v[156:159]
    buffer_load_dwordx4 v[40:43], v4, s[16:19], s25 offen offset:0
    buffer_load_dwordx4 v[44:47], v4, s[16:19], s25 offen offset:1024
    s_add_u32 s25, s25, 0x800
    s_waitcnt vmcnt(26)
    v_mfma_f32_16x16x32_bf16 v[144:147], a[32:35], v[48:51], v[144:147]
    v_mfma_f32_16x16x32_bf16 v[148:151], a[32:35], v[52:55], v[148:151]
    v_mfma_f32_16x16x32_bf16 v[152:155], a[36:39], v[48:51], v[152:155]
    v_mfma_f32_16x16x32_bf16 v[156:159], a[36:39], v[52:55], v[156:159]
    buffer_load_dwordx4 v[48:51], v4, s[16:19], s25 offen offset:0
    buffer_load_dwordx4 v[52:55], v4, s[16:19], s25 offen offset:1024
    s_add_u32 s25, s25, 0x800
    s_waitcnt vmcnt(26)
    v_mfma_f32_16x16x32_bf16 v[144:147], a[40:43], v[56:59], v[144:147]
    v_mfma_f32_16x16x32_bf16 v[148:151], a[40:43], v[60:63], v[148:151]
    v_mfma_f32_16x16x32_bf16 v[152:155], a[44:47], v[56:59], v[152:155]
    v_mfma_f32_16x16x32_bf16 v[156:159], a[44:47], v[60:63], v[156:159]
    buffer_load_dwordx4 v[56:59], v4, s[16:19], s25 offen offset:0
    buffer_load_dwordx4 v[60:63], v4, s[16:19], s25 offen offset:1024
    s_add_u32 s25, s25, 0x800
    s_waitcnt vmcnt(26)
    v_mfma_f32_16x16x32_bf16 v[144:147], a[48:51], v[64:67], v[144:147]
    v_mfma_f32_16x16x32_bf16 v[148:151], a[48:51], v[68:71], v[148:151]
    v_mfma_f32_16x16x32_bf16 v[152:155], a[52:55], v[64:67], v[152:155]
    v_mfma_f32_16x16x32_bf16 v[156:159], a[52:55], v[68:71], v[156:159]
    buffer_load_dwordx4 v[64:67], v4, s[16:19], s25 offen offset:0
    buffer_load_dwordx4 v[68:71], v4, s[16:19], s25 offen offset:1024
    s_add_u32 s25, s25, 0x800
    s_waitcnt vmcnt(26)
    v_mfma_f32_16x16x32_bf16 v[144:147], a[56:59], v[72:75], v[144:147]
    v_mfma_f32_16x16x32_bf16 v[148:151], a[56:59], v[76:79], v[148:151]
    v_mfma_f32_16x16x32_bf16 v[152:155], a[60:63], v[72:75], v[152:155]
    v_mfma_f32_16x16x32_bf16 v[156:159], a[60:63], v[76:79], v[156:159]
    buffer_load_dwordx4 v[72:75], v4, s[16:19], s25 offen offset:0
    buffer_load_dwordx4 v[76:79], v4, s[16:19], s25 offen offset:1024
    s_add_u32 s25, s25, 0x800
    s_waitcnt vmcnt(26)
    v_mfma_f32_16x16x32_bf16 v[144:147], a[64:67], v[80:83], v[144:147]
    v_mfma_f32_16x16x32_bf16 v[148:151], a[64:67], v[84:87], v[148:151]
    v_mfma_f32_16x16x32_bf16 v[152:155], a[68:71], v[80:83], v[152:155]
    v_mfma_f32_16x16x32_bf16 v[156:159], a[68:71], v[84:87], v[156:159]
    buffer_load_dwordx4 v[80:83], v4, s[16:19], s25 offen offset:0
    buffer_load_dwordx4 v[84:87], v4, s[16:19], s25 offen offset:1024
    s_add_u32 s25, s25, 0x800
    s_waitcnt vmcnt(26)
    v_mfma_f32_16x16x32_bf16 v[144:147], a[72:75], v[88:91], v[144:147]
    v_mfma_f32_16x16x32_bf16 v[148:151], a[72:75], v[92:95], v[148:151]
    v_mfma_f32_16x16x32_bf16 v[152:155], a[76:79], v[88:91], v[152:155]
    v_mfma_f32_16x16x32_bf16 v[156:159], a[76:79], v[92:95], v[156:159]
    buffer_load_dwordx4 v[88:91], v4, s[16:19], s25 offen offset:0
    buffer_load_dwordx4 v[92:95], v4, s[16:19], s25 offen offset:1024
    s_add_u32 s25, s25, 0x800
    s_waitcnt vmcnt(26)
    v_mfma_f32_16x16x32_bf16 v[144:147], a[80:83], v[96:99], v[144:147]
    v_mfma_f32_16x16x32_bf16 v[148:151], a[80:83], v[100:103], v[148:151]
    v_mfma_f32_16x16x32_bf16 v[152:155], a[84:87], v[96:99], v[152:155]
    v_mfma_f32_16x16x32_bf16 v[156:159], a[84:87], v[100:103], v[156:159]
    buffer_load_dwordx4 v[96:99], v4, s[16:19], s25 offen offset:0
    buffer_load_dwordx4 v[100:103], v4, s[16:19], s25 offen offset:1024
    s_add_u32 s25, s25, 0x800
    s_waitcnt vmcnt(26)
    v_mfma_f32_16x16x32_bf16 v[144:147], a[88:91], v[104:107], v[144:147]
    v_mfma_f32_16x16x32_bf16 v[148:151], a[88:91], v[108:111], v[148:151]
    v_mfma_f32_16x16x32_bf16 v[152:155], a[92:95], v[104:107], v[152:155]
    v_mfma_f32_16x16x32_bf16 v[156:159], a[92:95], v[108:111], v[156:159]
    buffer_load_dwordx4 v[104:107], v4, s[16:19], s25 offen offset:0
    buffer_load_dwordx4 v[108:111], v4, s[16:19], s25 offen offset:1024
    s_add_u32 s25, s25, 0x800
    s_waitcnt vmcnt(26)
    v_mfma_f32_16x16x32_bf16 v[144:147], a[96:99], v[112:115], v[144:147]
    v_mfma_f32_16x16x32_bf16 v[148:151], a[96:99], v[116:119], v[148:151]
    v_mfma_f32_16x16x32_bf16 v[152:155], a[100:103], v[112:115], v[152:155]
    v_mfma_f32_16x16x32_bf16 v[156:159], a[100:103], v[116:119], v[156:159]
    buffer_load_dwordx4 v[112:115], v4, s[16:19], s25 offen offset:0
    buffer_load_dwordx4 v[116:119], v4, s[16:19], s25 offen offset:1024
    s_add_u32 s25, s25, 0x800
    s_waitcnt vmcnt(26)
    v_mfma_f32_16x16x32_bf16 v[144:147], a[104:107], v[120:123], v[144:147]
    v_mfma_f32_16x16x32_bf16 v[148:151], a[104:107], v[124:127], v[148:151]
    v_mfma_f32_16x16x32_bf16 v[152:155], a[108:111], v[120:123], v[152:155]
    v_mfma_f32_16x16x32_bf16 v[156:159], a[108:111], v[124:127], v[156:159]
    buffer_load_dwordx4 v[120:123], v4, s[16:19], s25 offen offset:0
    buffer_load_dwordx4 v[124:127], v4, s[16:19], s25 offen offset:1024
    s_add_u32 s25, s25, 0x800
    s_waitcnt vmcnt(26)
    v_mfma_f32_16x16x32_bf16 v[144:147], a[112:115], v[16:19], v[144:147]
    v_mfma_f32_16x16x32_bf16 v[148:151], a[112:115], v[20:23], v[148:151]
    v_mfma_f32_16x16x32_bf16 v[152:155], a[116:119], v[16:19], v[152:155]
    v_mfma_f32_16x16x32_bf16 v[156:159], a[116:119], v[20:23], v[156:159]
    buffer_load_dwordx4 v[16:19], v4, s[16:19], s25 offen offset:0
    buffer_load_dwordx4 v[20:23], v4, s[16:19], s25 offen offset:1024
    s_add_u32 s25, s25, 0x800
    s_waitcnt vmcnt(26)
    v_mfma_f32_16x16x32_bf16 v[144:147], a[120:123], v[24:27], v[144:147]
    v_mfma_f32_16x16x32_bf16 v[148:151], a[120:123], v[28:31], v[148:151]
    v_mfma_f32_16x16x32_bf16 v[152:155], a[124:127], v[24:27], v[152:155]
    v_mfma_f32_16x16x32_bf16 v[156:159], a[124:127], v[28:31], v[156:159]
    buffer_load_dwordx4 v[24:27], v4, s[16:19], s25 offen offset:0
    buffer_load_dwordx4 v[28:31], v4, s[16:19], s25 offen offset:1024
    s_add_u32 s25, s25, 0x800
    s_waitcnt vmcnt(26)
    v_mfma_f32_16x16x32_bf16 v[144:147], a[128:131], v[32:35], v[144:147]
    v_mfma_f32_16x16x32_bf16 v[148:151], a[128:131], v[36:39], v[148:151]
    v_mfma_f32_16x16x32_bf16 v[152:155], a[132:135], v[32:35], v[152:155]
    v_mfma_f32_16x16x32_bf16 v[156:159], a[132:135], v[36:39], v[156:159]
    buffer_load_dwordx4 v[32:35], v4, s[16:19], s25 offen offset:0
    buffer_load_dwordx4 v[36:39], v4, s[16:19], s25 offen offset:1024
    s_add_u32 s25, s25, 0x800
    s_waitcnt vmcnt(26)
    v_mfma_f32_16x16x32_bf16 v[144:147], a[136:139], v[40:43], v[144:147]
    v_mfma_f32_16x16x32_bf16 v[148:151], a[136:139], v[44:47], v[148:151]
    v_mfma_f32_16x16x32_bf16 v[152:155], a[140:143], v[40:43], v[152:155]
    v_mfma_f32_16x16x32_bf16 v[156:159], a[140:143], v[44:47], v[156:159]
    buffer_load_dwordx4 v[40:43], v4, s[16:19], s25 offen offset:0
    buffer_load_dwordx4 v[44:47], v4, s[16:19], s25 offen offset:1024
    s_add_u32 s25, s25, 0x800
    s_waitcnt vmcnt(26)
    v_mfma_f32_16x16x32_bf16 v[144:147], a[144:147], v[48:51], v[144:147]
    v_mfma_f32_16x16x32_bf16 v[148:151], a[144:147], v[52:55], v[148:151]
    v_mfma_f32_16x16x32_bf16 v[152:155], a[148:151], v[48:51], v[152:155]
    v_mfma_f32_16x16x32_bf16 v[156:159], a[148:151], v[52:55], v[156:159]
    s_waitcnt vmcnt(24)
    v_mfma_f32_16x16x32_bf16 v[144:147], a[152:155], v[56:59], v[144:147]
    v_mfma_f32_16x16x32_bf16 v[148:151], a[152:155], v[60:63], v[148:151]
    v_mfma_f32_16x16x32_bf16 v[152:155], a[156:159], v[56:59], v[152:155]
    v_mfma_f32_16x16x32_bf16 v[156:159], a[156:159], v[60:63], v[156:159]
    s_waitcnt vmcnt(22)
    v_mfma_f32_16x16x32_bf16 v[144:147], a[160:163], v[64:67], v[144:147]
    v_mfma_f32_16x16x32_bf16 v[148:151], a[160:163], v[68:71], v[148:151]
    v_mfma_f32_16x16x32_bf16 v[152:155], a[164:167], v[64:67], v[152:155]
    v_mfma_f32_16x16x32_bf16 v[156:159], a[164:167], v[68:71], v[156:159]
    s_waitcnt vmcnt(20)
    v_mfma_f32_16x16x32_bf16 v[144:147], a[168:171], v[72:75], v[144:147]
    v_mfma_f32_16x16x32_bf16 v[148:151], a[168:171], v[76:79], v[148:151]
    v_mfma_f32_16x16x32_bf16 v[152:155], a[172:175], v[72:75], v[152:155]
    v_mfma_f32_16x16x32_bf16 v[156:159], a[172:175], v[76:79], v[156:159]
    s_waitcnt vmcnt(18)
    v_mfma_f32_16x16x32_bf16 v[144:147], a[176:179], v[80:83], v[144:147]
    v_mfma_f32_16x16x32_bf16 v[148:151], a[176:179], v[84:87], v[148:151]
    v_mfma_f32_16x16x32_bf16 v[152:155], a[180:183], v[80:83], v[152:155]
    v_mfma_f32_16x16x32_bf16 v[156:159], a[180:183], v[84:87], v[156:159]
    s_waitcnt vmcnt(16)
    v_mfma_f32_16x16x32_bf16 v[144:147], a[184:187], v[88:91], v[144:147]
    v_mfma_f32_16x16x32_bf16 v[148:151], a[184:187], v[92:95], v[148:151]
    v_mfma_f32_16x16x32_bf16 v[152:155], a[188:191], v[88:91], v[152:155]
    v_mfma_f32_16x16x32_bf16 v[156:159], a[188:191], v[92:95], v[156:159]
    s_waitcnt vmcnt(14)
    v_mfma_f32_16x16x32_bf16 v[144:147], a[192:195], v[96:99], v[144:147]
    v_mfma_f32_16x16x32_bf16 v[148:151], a[192:195], v[100:103], v[148:151]
    v_mfma_f32_16x16x32_bf16 v[152:155], a[196:199], v[96:99], v[152:155]
    v_mfma_f32_16x16x32_bf16 v[156:159], a[196:199], v[100:103], v[156:159]
    s_waitcnt vmcnt(12)
    v_mfma_f32_16x16x32_bf16 v[144:147], a[200:203], v[104:107], v[144:147]
    v_mfma_f32_16x16x32_bf16 v[148:151], a[200:203], v[108:111], v[148:151]
    v_mfma_f32_16x16x32_bf16 v[152:155], a[204:207], v[104:107], v[152:155]
    v_mfma_f32_16x16x32_bf16 v[156:159], a[204:207], v[108:111], v[156:159]
    s_waitcnt vmcnt(10)
    v_mfma_f32_16x16x32_bf16 v[144:147], a[208:211], v[112:115], v[144:147]
    v_mfma_f32_16x16x32_bf16 v[148:151], a[208:211], v[116:119], v[148:151]
    v_mfma_f32_16x16x32_bf16 v[152:155], a[212:215], v[112:115], v[152:155]
    v_mfma_f32_16x16x32_bf16 v[156:159], a[212:215], v[116:119], v[156:159]
    s_waitcnt vmcnt(8)
    v_mfma_f32_16x16x32_bf16 v[144:147], a[216:219], v[120:123], v[144:147]
    v_mfma_f32_16x16x32_bf16 v[148:151], a[216:219], v[124:127], v[148:151]
    v_mfma_f32_16x16x32_bf16 v[152:155], a[220:223], v[120:123], v[152:155]
    v_mfma_f32_16x16x32_bf16 v[156:159], a[220:223], v[124:127], v[156:159]
    s_waitcnt vmcnt(6)
    v_mfma_f32_16x16x32_bf16 v[144:147], a[224:227], v[16:19], v[144:147]
    v_mfma_f32_16x16x32_bf16 v[148:151], a[224:227], v[20:23], v[148:151]
    v_mfma_f32_16x16x32_bf16 v[152:155], a[228:231], v[16:19], v[152:155]
    v_mfma_f32_16x16x32_bf16 v[156:159], a[228:231], v[20:23], v[156:159]
    s_waitcnt vmcnt(4)
    v_mfma_f32_16x16x32_bf16 v[144:147], a[232:235], v[24:27], v[144:147]
    v_mfma_f32_16x16x32_bf16 v[148:151], a[232:235], v[28:31], v[148:151]
    v_mfma_f32_16x16x32_bf16 v[152:155], a[236:239], v[24:27], v[152:155]
    v_mfma_f32_16x16x32_bf16 v[156:159], a[236:239], v[28:31], v[156:159]
    s_waitcnt vmcnt(2)
    v_mfma_f32_16x16x32_bf16 v[144:147], a[240:243], v[32:35], v[144:147]
    v_mfma_f32_16x16x32_bf16 v[148:151], a[240:243], v[36:39], v[148:151]
    v_mfma_f32_16x16x32_bf16 v[152:155], a[244:247], v[32:35], v[152:155]
    v_mfma_f32_16x16x32_bf16 v[156:159], a[244:247], v[36:39], v[156:159]
    s_waitcnt vmcnt(0)
    v_mfma_f32_16x16x32_bf16 v[144:147], a[248:251], v[40:43], v[144:147]
    v_mfma_f32_16x16x32_bf16 v[148:151], a[248:251], v[44:47], v[148:151]
    v_mfma_f32_16x16x32_bf16 v[152:155], a[252:255], v[40:43], v[152:155]
    v_mfma_f32_16x16x32_bf16 v[156:159], a[252:255], v[44:47], v[156:159]
    s_mul_i32 s24, s3, 0x1000
    v_add_u32 v3, s24, v2
    s_nop 2
    ds_write_b128 v3, v[144:147] offset:0
    ds_write_b128 v3, v[148:151] offset:2048
    ds_write_b128 v3, v[152:155] offset:1024
    ds_write_b128 v3, v[156:159] offset:3072
    s_waitcnt lgkmcnt(0)
    s_barrier
    s_cmp_ge_u32 s3, 2
    s_cbranch_scc1 sk_skip_97
    s_and_b32 s24, s3, 1
    s_mul_i32 s24, s24, 0x800
    s_lshl_b32 s26, s23, 11
    s_add_u32 s24, s24, s26
    v_add_u32 v3, s24, v2
    ds_read_b128 v[16:19], v3 offset:0
    ds_read_b128 v[20:23], v3 offset:1024
    ds_read_b128 v[24:27], v3 offset:4096
    ds_read_b128 v[28:31], v3 offset:5120
    ds_read_b128 v[32:35], v3 offset:8192
    ds_read_b128 v[36:39], v3 offset:9216
    ds_read_b128 v[40:43], v3 offset:12288
    ds_read_b128 v[44:47], v3 offset:13312
    s_waitcnt lgkmcnt(0)
    v_add_f32 v16, v16, v24
    v_add_f32 v32, v32, v40
    v_add_f32 v16, v16, v32
    v_add_f32 v17, v17, v25
    v_add_f32 v33, v33, v41
    v_add_f32 v17, v17, v33
    v_add_f32 v18, v18, v26
    v_add_f32 v34, v34, v42
    v_add_f32 v18, v18, v34
    v_add_f32 v19, v19, v27
    v_add_f32 v35, v35, v43
    v_add_f32 v19, v19, v35
    v_add_f32 v20, v20, v28
    v_add_f32 v36, v36, v44
    v_add_f32 v20, v20, v36
    v_add_f32 v21, v21, v29
    v_add_f32 v37, v37, v45
    v_add_f32 v21, v21, v37
    v_add_f32 v22, v22, v30
    v_add_f32 v38, v38, v46
    v_add_f32 v22, v22, v38
    v_add_f32 v23, v23, v31
    v_add_f32 v39, v39, v47
    v_add_f32 v23, v23, v39
    v_lshlrev_b32 v96, 16, v216
    v_and_b32 v97, 0xffff0000, v216
    v_lshlrev_b32 v98, 16, v217
    v_and_b32 v99, 0xffff0000, v217
    v_lshlrev_b32 v100, 16, v218
    v_and_b32 v101, 0xffff0000, v218
    v_lshlrev_b32 v102, 16, v219
    v_and_b32 v103, 0xffff0000, v219
    v_cvt_pk_bf16_f32 v16, v16, v16
    v_lshlrev_b32 v16, 16, v16
    v_mul_f32 v16, v16, v224
    v_cvt_pk_bf16_f32 v16, v16, v16
    v_lshlrev_b32 v16, 16, v16
    v_add_f32 v16, v16, v96
    v_cvt_pk_bf16_f32 v17, v17, v17
    v_lshlrev_b32 v17, 16, v17
    v_mul_f32 v17, v17, v225
    v_cvt_pk_bf16_f32 v17, v17, v17
    v_lshlrev_b32 v17, 16, v17
    v_add_f32 v17, v17, v97
    v_cvt_pk_bf16_f32 v18, v18, v18
    v_lshlrev_b32 v18, 16, v18
    v_mul_f32 v18, v18, v226
    v_cvt_pk_bf16_f32 v18, v18, v18
    v_lshlrev_b32 v18, 16, v18
    v_add_f32 v18, v18, v98
    v_cvt_pk_bf16_f32 v19, v19, v19
    v_lshlrev_b32 v19, 16, v19
    v_mul_f32 v19, v19, v227
    v_cvt_pk_bf16_f32 v19, v19, v19
    v_lshlrev_b32 v19, 16, v19
    v_add_f32 v19, v19, v99
    v_cvt_pk_bf16_f32 v20, v20, v20
    v_lshlrev_b32 v20, 16, v20
    v_mul_f32 v20, v20, v228
    v_cvt_pk_bf16_f32 v20, v20, v20
    v_lshlrev_b32 v20, 16, v20
    v_add_f32 v20, v20, v100
    v_cvt_pk_bf16_f32 v21, v21, v21
    v_lshlrev_b32 v21, 16, v21
    v_mul_f32 v21, v21, v229
    v_cvt_pk_bf16_f32 v21, v21, v21
    v_lshlrev_b32 v21, 16, v21
    v_add_f32 v21, v21, v101
    v_cvt_pk_bf16_f32 v22, v22, v22
    v_lshlrev_b32 v22, 16, v22
    v_mul_f32 v22, v22, v230
    v_cvt_pk_bf16_f32 v22, v22, v22
    v_lshlrev_b32 v22, 16, v22
    v_add_f32 v22, v22, v102
    v_cvt_pk_bf16_f32 v23, v23, v23
    v_lshlrev_b32 v23, 16, v23
    v_mul_f32 v23, v23, v231
    v_cvt_pk_bf16_f32 v23, v23, v23
    v_lshlrev_b32 v23, 16, v23
    v_add_f32 v23, v23, v103
    v_cvt_pk_bf16_f32 v112, v16, v17
    v_cvt_pk_bf16_f32 v113, v18, v19
    v_cvt_pk_bf16_f32 v114, v20, v21
    v_cvt_pk_bf16_f32 v115, v22, v23
    buffer_store_dwordx4 v[112:115], v10, s[28:31], s27 offen sc1
sk_skip_97:
    s_waitcnt vmcnt(0)
    s_barrier
    s_cmp_lg_u32 s3, 0
    s_cbranch_scc1 w_loop
    s_lshl_b32 s90, s20, 8
    s_add_u32 s90, s90, 0x6000
    s_mov_b64 exec, 1
    v_mov_b32 v250, 0
    v_mov_b32 v251, 1
    buffer_atomic_add v251, v250, s[8:11], s90 offen
    s_mov_b64 exec, -1
    s_branch w_loop
w_attn_74:
    s_add_u32 s8, s6, 0x3000
    s_addc_u32 s9, s7, 0
    s_and_b32 s9, s9, 0xffff
    s_mov_b32 s10, 0x10000
    s_mov_b32 s11, 0x20000
    s_lshr_b32 s22, s20, 1
    s_cmp_lg_u32 s3, 0
    s_cbranch_scc1 wcd_99
    s_lshl_b32 s90, s22, 8
    s_add_u32 s90, s90, 0x2000
    v_mov_b32 v250, 0
wc_98:
    buffer_load_dword v251, v250, s[8:11], s90 offen sc1
    s_waitcnt vmcnt(0)
    v_readfirstlane_b32 s91, v251
    s_cmp_ge_u32 s91, 0x80
    s_cbranch_scc1 wcd_99
    s_sleep 2
    s_add_u32 s92, s92, 1
    s_cmp_gt_u32 s92, 0x1e8480
    s_cbranch_scc1 main_kernel_exit_w
    s_branch wc_98
wcd_99:
    s_waitcnt vmcnt(0)
    s_barrier
    s_cmp_lg_u32 s3, 0
    s_cbranch_scc1 wcd_101
    s_lshl_b32 s90, s22, 8
    s_add_u32 s90, s90, 0x3000
    v_mov_b32 v250, 0
wc_100:
    buffer_load_dword v251, v250, s[8:11], s90 offen sc1
    s_waitcnt vmcnt(0)
    v_readfirstlane_b32 s91, v251
    s_cmp_ge_u32 s91, 64
    s_cbranch_scc1 wcd_101
    s_sleep 2
    s_add_u32 s92, s92, 1
    s_cmp_gt_u32 s92, 0x1e8480
    s_cbranch_scc1 main_kernel_exit_w
    s_branch wc_100
wcd_101:
    s_waitcnt vmcnt(0)
    s_barrier
    s_lshl_b32 s4, s21, 2
    s_add_u32 s4, s4, s3
    s_lshr_b32 s23, s4, 5
    s_lshl_b32 s22, s20, 2
    s_add_u32 s23, s23, s22
    s_and_b32 s4, s4, 31
    s_add_u32 s40, s6, 0x1716000
    s_addc_u32 s41, s7, 0
    s_and_b32 s41, s41, 0xffff
    s_mov_b32 s42, 0x1000000
    s_mov_b32 s43, 0x20000
    s_add_u32 s12, s6, 0x2716000
    s_addc_u32 s13, s7, 0
    s_and_b32 s13, s13, 0xffff
    s_mov_b32 s14, 0x1000000
    s_mov_b32 s15, 0x20000
    s_add_u32 s16, s6, 0x3716000
    s_addc_u32 s17, s7, 0
    s_and_b32 s17, s17, 0xffff
    s_mov_b32 s18, 0x1000000
    s_mov_b32 s19, 0x20000
    s_add_u32 s44, s6, 0x4716000
    s_addc_u32 s45, s7, 0
    s_and_b32 s45, s45, 0xffff
    s_mov_b32 s46, 0x400000
    s_mov_b32 s47, 0x20000
    s_add_u32 s24, s6, 0x4b16000
    s_addc_u32 s25, s7, 0
    s_and_b32 s25, s25, 0xffff
    s_mov_b32 s26, 0x400000
    s_mov_b32 s27, 0x20000
    s_add_u32 s28, s6, 0x4f16000
    s_addc_u32 s29, s7, 0
    s_and_b32 s29, s29, 0xffff
    s_mov_b32 s30, 0x1000000
    s_mov_b32 s31, 0x20000
    v_lshlrev_b32 v1, 4, v0
    v_and_b32 v2, 15, v0
    v_lshrrev_b32 v3, 4, v0
    v_lshrrev_b32 v4, 2, v2
    v_lshlrev_b32 v4, 3, v4
    v_and_b32 v5, 3, v2
    v_add_u32 v4, v4, v5
    v_lshlrev_b32 v6, 13, v4
    v_lshl_add_u32 v6, v3, 4, v6
    v_add_u32 v7, 0x8000, v6
    v_lshlrev_b32 v8, 12, v4
    v_lshl_add_u32 v8, v3, 4, v8
    v_add_u32 v9, 0x4000, v8
    v_and_b32 v5, 7, v2
    v_lshlrev_b32 v10, 8, v5
    v_lshl_add_u32 v10, v3, 4, v10
    v_and_b32 v5, 1, v3
    v_lshlrev_b32 v11, 4, v4
    v_lshl_add_u32 v11, v5, 3, v11
    v_lshlrev_b32 v12, 3, v3
    v_sub_u32 v12, v12, v4
    s_lshl_b32 s32, s23, 18
    s_lshl_b32 s33, s4, 8
    s_add_u32 s32, s32, s33
    s_lshl_b32 s33, s4, 19
    s_lshl_b32 s34, s23, 6
    s_add_u32 s33, s33, s34
    s_lshl_b32 s34, s23, 16
    s_lshl_b32 s35, s4, 11
    s_add_u32 s34, s34, s35
    s_lshl_b32 s35, s23, 7
    s_lshl_b32 s36, s4, 2
    s_add_u32 s35, s35, s36
    s_lshl_b32 s35, s35, 11
    s_mov_b32 s38, 0
    s_mov_b32 s39, -1
    buffer_load_dwordx4 v[16:19], v6, s[40:43], s32 offen offset:0
    buffer_load_dwordx4 v[20:23], v6, s[40:43], s32 offen offset:64
    buffer_load_dwordx4 v[24:27], v6, s[40:43], s32 offen offset:128
    buffer_load_dwordx4 v[28:31], v6, s[40:43], s32 offen offset:192
    buffer_load_dwordx4 v[32:35], v7, s[40:43], s32 offen offset:0
    buffer_load_dwordx4 v[36:39], v7, s[40:43], s32 offen offset:64
    buffer_load_dwordx4 v[40:43], v7, s[40:43], s32 offen offset:128
    buffer_load_dwordx4 v[44:47], v7, s[40:43], s32 offen offset:192
    buffer_load_dwordx4 v[48:51], v6, s[12:15], s32 offen offset:0
    buffer_load_dwordx4 v[52:55], v6, s[12:15], s32 offen offset:64
    buffer_load_dwordx4 v[56:59], v6, s[12:15], s32 offen offset:128
    buffer_load_dwordx4 v[60:63], v6, s[12:15], s32 offen offset:192
    buffer_load_dwordx4 v[64:67], v7, s[12:15], s32 offen offset:0
    buffer_load_dwordx4 v[68:71], v7, s[12:15], s32 offen offset:64
    buffer_load_dwordx4 v[72:75], v7, s[12:15], s32 offen offset:128
    buffer_load_dwordx4 v[76:79], v7, s[12:15], s32 offen offset:192
    s_add_u32 s36, s33, 0
    buffer_load_dwordx4 v[96:99], v8, s[16:19], s36 offen
    buffer_load_dwordx4 v[100:103], v9, s[16:19], s36 offen
    s_add_u32 s36, s33, 0x20000
    buffer_load_dwordx4 v[104:107], v8, s[16:19], s36 offen
    buffer_load_dwordx4 v[108:111], v9, s[16:19], s36 offen
    s_add_u32 s36, s33, 0x40000
    buffer_load_dwordx4 v[112:115], v8, s[16:19], s36 offen
    buffer_load_dwordx4 v[116:119], v9, s[16:19], s36 offen
    s_add_u32 s36, s33, 0x60000
    buffer_load_dwordx4 v[120:123], v8, s[16:19], s36 offen
    buffer_load_dwordx4 v[124:127], v9, s[16:19], s36 offen
    s_cmp_lg_u32 s3, 0
    s_cbranch_scc1 wcd_103
    s_lshl_b32 s90, s20, 8
    s_add_u32 s90, s90, 0x4000
    v_mov_b32 v250, 0
wc_102:
    buffer_load_dword v251, v250, s[8:11], s90 offen sc1
    s_waitcnt vmcnt(0)
    v_readfirstlane_b32 s91, v251
    s_cmp_ge_u32 s91, 32
    s_cbranch_scc1 wcd_103
    s_sleep 2
    s_add_u32 s92, s92, 1
    s_cmp_gt_u32 s92, 0x1e8480
    s_cbranch_scc1 main_kernel_exit_w
    s_branch wc_102
wcd_103:
    s_waitcnt vmcnt(0)
    s_barrier
    buffer_load_dwordx4 v[80:83], v10, s[44:47], s34 offen offset:0
    buffer_load_dwordx4 v[84:87], v10, s[44:47], s34 offen offset:64
    buffer_load_dwordx4 v[88:91], v10, s[44:47], s34 offen offset:128
    buffer_load_dwordx4 v[92:95], v10, s[44:47], s34 offen offset:192
    buffer_load_dwordx2 v[128:129], v11, s[24:27], s34 offen offset:0
    v_mov_b32 v130, 0
    v_mov_b32 v131, 0
    buffer_load_dwordx2 v[132:133], v11, s[24:27], s34 offen offset:64
    v_mov_b32 v134, 0
    v_mov_b32 v135, 0
    buffer_load_dwordx2 v[136:137], v11, s[24:27], s34 offen offset:512
    v_mov_b32 v138, 0
    v_mov_b32 v139, 0
    buffer_load_dwordx2 v[140:141], v11, s[24:27], s34 offen offset:576
    v_mov_b32 v142, 0
    v_mov_b32 v143, 0
    buffer_load_dwordx2 v[144:145], v11, s[24:27], s34 offen offset:1024
    v_mov_b32 v146, 0
    v_mov_b32 v147, 0
    buffer_load_dwordx2 v[148:149], v11, s[24:27], s34 offen offset:1088
    v_mov_b32 v150, 0
    v_mov_b32 v151, 0
    buffer_load_dwordx2 v[152:153], v11, s[24:27], s34 offen offset:1536
    v_mov_b32 v154, 0
    v_mov_b32 v155, 0
    buffer_load_dwordx2 v[156:157], v11, s[24:27], s34 offen offset:1600
    v_mov_b32 v158, 0
    v_mov_b32 v159, 0
    s_waitcnt vmcnt(8)
    v_mfma_f32_16x16x32_bf16 v[160:163], v[80:83], v[16:19], 0
    v_mfma_f32_16x16x32_bf16 v[160:163], v[84:87], v[20:23], v[160:163]
    v_mfma_f32_16x16x32_bf16 v[160:163], v[88:91], v[24:27], v[160:163]
    v_mfma_f32_16x16x32_bf16 v[160:163], v[92:95], v[28:31], v[160:163]
    v_mfma_f32_16x16x32_bf16 v[164:167], v[48:51], v[16:19], 0
    v_mfma_f32_16x16x32_bf16 v[164:167], v[52:55], v[20:23], v[164:167]
    v_mfma_f32_16x16x32_bf16 v[164:167], v[56:59], v[24:27], v[164:167]
    v_mfma_f32_16x16x32_bf16 v[164:167], v[60:63], v[28:31], v[164:167]
    v_mfma_f32_16x16x32_bf16 v[168:171], v[64:67], v[16:19], 0
    v_mfma_f32_16x16x32_bf16 v[168:171], v[68:71], v[20:23], v[168:171]
    v_mfma_f32_16x16x32_bf16 v[168:171], v[72:75], v[24:27], v[168:171]
    v_mfma_f32_16x16x32_bf16 v[168:171], v[76:79], v[28:31], v[168:171]
    v_mfma_f32_16x16x32_bf16 v[172:175], v[80:83], v[32:35], 0
    v_mfma_f32_16x16x32_bf16 v[172:175], v[84:87], v[36:39], v[172:175]
    v_mfma_f32_16x16x32_bf16 v[172:175], v[88:91], v[40:43], v[172:175]
    v_mfma_f32_16x16x32_bf16 v[172:175], v[92:95], v[44:47], v[172:175]
    v_mfma_f32_16x16x32_bf16 v[176:179], v[48:51], v[32:35], 0
    v_mfma_f32_16x16x32_bf16 v[176:179], v[52:55], v[36:39], v[176:179]
    v_mfma_f32_16x16x32_bf16 v[176:179], v[56:59], v[40:43], v[176:179]
    v_mfma_f32_16x16x32_bf16 v[176:179], v[60:63], v[44:47], v[176:179]
    v_mfma_f32_16x16x32_bf16 v[180:183], v[64:67], v[32:35], 0
    v_mfma_f32_16x16x32_bf16 v[180:183], v[68:71], v[36:39], v[180:183]
    v_mfma_f32_16x16x32_bf16 v[180:183], v[72:75], v[40:43], v[180:183]
    v_mfma_f32_16x16x32_bf16 v[180:183], v[76:79], v[44:47], v[180:183]
    v_mov_b32 v13, 0xff800000
    v_cvt_pk_bf16_f32 v160, v160, v160
    v_lshlrev_b32 v160, 16, v160
    v_mul_f32 v160, 0x3db504f3, v160
    v_cvt_pk_bf16_f32 v160, v160, v160
    v_lshlrev_b32 v160, 16, v160
    v_cvt_pk_bf16_f32 v161, v161, v161
    v_lshlrev_b32 v161, 16, v161
    v_mul_f32 v161, 0x3db504f3, v161
    v_cvt_pk_bf16_f32 v161, v161, v161
    v_lshlrev_b32 v161, 16, v161
    v_cvt_pk_bf16_f32 v162, v162, v162
    v_lshlrev_b32 v162, 16, v162
    v_mul_f32 v162, 0x3db504f3, v162
    v_cvt_pk_bf16_f32 v162, v162, v162
    v_lshlrev_b32 v162, 16, v162
    v_cvt_pk_bf16_f32 v163, v163, v163
    v_lshlrev_b32 v163, 16, v163
    v_mul_f32 v163, 0x3db504f3, v163
    v_cvt_pk_bf16_f32 v163, v163, v163
    v_lshlrev_b32 v163, 16, v163
    v_cvt_pk_bf16_f32 v164, v164, v164
    v_lshlrev_b32 v164, 16, v164
    v_mul_f32 v164, 0x3db504f3, v164
    v_cvt_pk_bf16_f32 v164, v164, v164
    v_lshlrev_b32 v164, 16, v164
    v_cvt_pk_bf16_f32 v165, v165, v165
    v_lshlrev_b32 v165, 16, v165
    v_mul_f32 v165, 0x3db504f3, v165
    v_cvt_pk_bf16_f32 v165, v165, v165
    v_lshlrev_b32 v165, 16, v165
    v_cvt_pk_bf16_f32 v166, v166, v166
    v_lshlrev_b32 v166, 16, v166
    v_mul_f32 v166, 0x3db504f3, v166
    v_cvt_pk_bf16_f32 v166, v166, v166
    v_lshlrev_b32 v166, 16, v166
    v_cvt_pk_bf16_f32 v167, v167, v167
    v_lshlrev_b32 v167, 16, v167
    v_mul_f32 v167, 0x3db504f3, v167
    v_cvt_pk_bf16_f32 v167, v167, v167
    v_lshlrev_b32 v167, 16, v167
    v_cvt_pk_bf16_f32 v168, v168, v168
    v_lshlrev_b32 v168, 16, v168
    v_mul_f32 v168, 0x3db504f3, v168
    v_cvt_pk_bf16_f32 v168, v168, v168
    v_lshlrev_b32 v168, 16, v168
    v_cvt_pk_bf16_f32 v169, v169, v169
    v_lshlrev_b32 v169, 16, v169
    v_mul_f32 v169, 0x3db504f3, v169
    v_cvt_pk_bf16_f32 v169, v169, v169
    v_lshlrev_b32 v169, 16, v169
    v_cvt_pk_bf16_f32 v170, v170, v170
    v_lshlrev_b32 v170, 16, v170
    v_mul_f32 v170, 0x3db504f3, v170
    v_cvt_pk_bf16_f32 v170, v170, v170
    v_lshlrev_b32 v170, 16, v170
    v_cvt_pk_bf16_f32 v171, v171, v171
    v_lshlrev_b32 v171, 16, v171
    v_mul_f32 v171, 0x3db504f3, v171
    v_cvt_pk_bf16_f32 v171, v171, v171
    v_lshlrev_b32 v171, 16, v171
    v_cndmask_b32 v160, v160, v13, s[38:39]
    v_cndmask_b32 v161, v161, v13, s[38:39]
    v_cndmask_b32 v162, v162, v13, s[38:39]
    v_cndmask_b32 v163, v163, v13, s[38:39]
    v_cmp_lt_i32 vcc, 0, v12
    s_nop 1
    v_cndmask_b32 v164, v164, v13, vcc
    v_cmp_lt_i32 vcc, -1, v12
    s_nop 1
    v_cndmask_b32 v165, v165, v13, vcc
    v_cmp_lt_i32 vcc, -2, v12
    s_nop 1
    v_cndmask_b32 v166, v166, v13, vcc
    v_cmp_lt_i32 vcc, -3, v12
    s_nop 1
    v_cndmask_b32 v167, v167, v13, vcc
    v_cmp_lt_i32 vcc, -4, v12
    s_nop 1
    v_cndmask_b32 v168, v168, v13, vcc
    v_cmp_lt_i32 vcc, -5, v12
    s_nop 1
    v_cndmask_b32 v169, v169, v13, vcc
    v_cmp_lt_i32 vcc, -6, v12
    s_nop 1
    v_cndmask_b32 v170, v170, v13, vcc
    v_cmp_lt_i32 vcc, -7, v12
    s_nop 1
    v_cndmask_b32 v171, v171, v13, vcc
    v_max3_f32 v14, v160, v161, v162
    v_max3_f32 v14, v14, v163, v164
    v_max3_f32 v14, v14, v165, v166
    v_max3_f32 v14, v14, v167, v168
    v_max3_f32 v14, v14, v169, v170
    v_max_f32 v14, v14, v171
    v_mov_b32 v15, v14
    s_nop 1
    v_permlane16_swap_b32 v14, v15
    v_max_f32 v14, v14, v15
    v_mov_b32 v15, v14
    s_nop 1
    v_permlane32_swap_b32 v14, v15
    v_max_f32 v14, v14, v15
    v_sub_f32 v160, v160, v14
    v_mul_f32 v160, 0x3fb8aa3b, v160
    v_exp_f32 v160, v160
    v_sub_f32 v161, v161, v14
    v_mul_f32 v161, 0x3fb8aa3b, v161
    v_exp_f32 v161, v161
    v_sub_f32 v162, v162, v14
    v_mul_f32 v162, 0x3fb8aa3b, v162
    v_exp_f32 v162, v162
    v_sub_f32 v163, v163, v14
    v_mul_f32 v163, 0x3fb8aa3b, v163
    v_exp_f32 v163, v163
    v_sub_f32 v164, v164, v14
    v_mul_f32 v164, 0x3fb8aa3b, v164
    v_exp_f32 v164, v164
    v_sub_f32 v165, v165, v14
    v_mul_f32 v165, 0x3fb8aa3b, v165
    v_exp_f32 v165, v165
    v_sub_f32 v166, v166, v14
    v_mul_f32 v166, 0x3fb8aa3b, v166
    v_exp_f32 v166, v166
    v_sub_f32 v167, v167, v14
    v_mul_f32 v167, 0x3fb8aa3b, v167
    v_exp_f32 v167, v167
    v_sub_f32 v168, v168, v14
    v_mul_f32 v168, 0x3fb8aa3b, v168
    v_exp_f32 v168, v168
    v_sub_f32 v169, v169, v14
    v_mul_f32 v169, 0x3fb8aa3b, v169
    v_exp_f32 v169, v169
    v_sub_f32 v170, v170, v14
    v_mul_f32 v170, 0x3fb8aa3b, v170
    v_exp_f32 v170, v170
    v_sub_f32 v171, v171, v14
    v_mul_f32 v171, 0x3fb8aa3b, v171
    v_exp_f32 v171, v171
    v_add_f32 v14, v160, v161
    v_add_f32 v14, v14, v162
    v_add_f32 v14, v14, v163
    v_add_f32 v14, v14, v164
    v_add_f32 v14, v14, v165
    v_add_f32 v14, v14, v166
    v_add_f32 v14, v14, v167
    v_add_f32 v14, v14, v168
    v_add_f32 v14, v14, v169
    v_add_f32 v14, v14, v170
    v_add_f32 v14, v14, v171
    v_mov_b32 v15, v14
    s_nop 1
    v_permlane16_swap_b32 v14, v15
    v_add_f32 v14, v14, v15
    v_mov_b32 v15, v14
    s_nop 1
    v_permlane32_swap_b32 v14, v15
    v_add_f32 v14, v14, v15
    v_rcp_f32 v14, v14
    s_nop 0
    v_mul_f32 v160, v160, v14
    v_mul_f32 v161, v161, v14
    v_mul_f32 v162, v162, v14
    v_mul_f32 v163, v163, v14
    v_mul_f32 v164, v164, v14
    v_mul_f32 v165, v165, v14
    v_mul_f32 v166, v166, v14
    v_mul_f32 v167, v167, v14
    v_mul_f32 v168, v168, v14
    v_mul_f32 v169, v169, v14
    v_mul_f32 v170, v170, v14
    v_mul_f32 v171, v171, v14
    v_cvt_pk_bf16_f32 v16, v164, v165
    v_cvt_pk_bf16_f32 v17, v166, v167
    v_cvt_pk_bf16_f32 v18, v168, v169
    v_cvt_pk_bf16_f32 v19, v170, v171
    v_cvt_pk_bf16_f32 v20, v160, v161
    v_cvt_pk_bf16_f32 v21, v162, v163
    v_mov_b32 v22, 0
    v_mov_b32 v23, 0
    v_cvt_pk_bf16_f32 v172, v172, v172
    v_lshlrev_b32 v172, 16, v172
    v_mul_f32 v172, 0x3db504f3, v172
    v_cvt_pk_bf16_f32 v172, v172, v172
    v_lshlrev_b32 v172, 16, v172
    v_cvt_pk_bf16_f32 v173, v173, v173
    v_lshlrev_b32 v173, 16, v173
    v_mul_f32 v173, 0x3db504f3, v173
    v_cvt_pk_bf16_f32 v173, v173, v173
    v_lshlrev_b32 v173, 16, v173
    v_cvt_pk_bf16_f32 v174, v174, v174
    v_lshlrev_b32 v174, 16, v174
    v_mul_f32 v174, 0x3db504f3, v174
    v_cvt_pk_bf16_f32 v174, v174, v174
    v_lshlrev_b32 v174, 16, v174
    v_cvt_pk_bf16_f32 v175, v175, v175
    v_lshlrev_b32 v175, 16, v175
    v_mul_f32 v175, 0x3db504f3, v175
    v_cvt_pk_bf16_f32 v175, v175, v175
    v_lshlrev_b32 v175, 16, v175
    v_cvt_pk_bf16_f32 v176, v176, v176
    v_lshlrev_b32 v176, 16, v176
    v_mul_f32 v176, 0x3db504f3, v176
    v_cvt_pk_bf16_f32 v176, v176, v176
    v_lshlrev_b32 v176, 16, v176
    v_cvt_pk_bf16_f32 v177, v177, v177
    v_lshlrev_b32 v177, 16, v177
    v_mul_f32 v177, 0x3db504f3, v177
    v_cvt_pk_bf16_f32 v177, v177, v177
    v_lshlrev_b32 v177, 16, v177
    v_cvt_pk_bf16_f32 v178, v178, v178
    v_lshlrev_b32 v178, 16, v178
    v_mul_f32 v178, 0x3db504f3, v178
    v_cvt_pk_bf16_f32 v178, v178, v178
    v_lshlrev_b32 v178, 16, v178
    v_cvt_pk_bf16_f32 v179, v179, v179
    v_lshlrev_b32 v179, 16, v179
    v_mul_f32 v179, 0x3db504f3, v179
    v_cvt_pk_bf16_f32 v179, v179, v179
    v_lshlrev_b32 v179, 16, v179
    v_cvt_pk_bf16_f32 v180, v180, v180
    v_lshlrev_b32 v180, 16, v180
    v_mul_f32 v180, 0x3db504f3, v180
    v_cvt_pk_bf16_f32 v180, v180, v180
    v_lshlrev_b32 v180, 16, v180
    v_cvt_pk_bf16_f32 v181, v181, v181
    v_lshlrev_b32 v181, 16, v181
    v_mul_f32 v181, 0x3db504f3, v181
    v_cvt_pk_bf16_f32 v181, v181, v181
    v_lshlrev_b32 v181, 16, v181
    v_cvt_pk_bf16_f32 v182, v182, v182
    v_lshlrev_b32 v182, 16, v182
    v_mul_f32 v182, 0x3db504f3, v182
    v_cvt_pk_bf16_f32 v182, v182, v182
    v_lshlrev_b32 v182, 16, v182
    v_cvt_pk_bf16_f32 v183, v183, v183
    v_lshlrev_b32 v183, 16, v183
    v_mul_f32 v183, 0x3db504f3, v183
    v_cvt_pk_bf16_f32 v183, v183, v183
    v_lshlrev_b32 v183, 16, v183
    v_cndmask_b32 v172, v172, v13, s[38:39]
    v_cndmask_b32 v173, v173, v13, s[38:39]
    v_cndmask_b32 v174, v174, v13, s[38:39]
    v_cndmask_b32 v175, v175, v13, s[38:39]
    v_cmp_lt_i32 vcc, 4, v12
    s_nop 1
    v_cndmask_b32 v176, v176, v13, vcc
    v_cmp_lt_i32 vcc, 3, v12
    s_nop 1
    v_cndmask_b32 v177, v177, v13, vcc
    v_cmp_lt_i32 vcc, 2, v12
    s_nop 1
    v_cndmask_b32 v178, v178, v13, vcc
    v_cmp_lt_i32 vcc, 1, v12
    s_nop 1
    v_cndmask_b32 v179, v179, v13, vcc
    v_cmp_lt_i32 vcc, 0, v12
    s_nop 1
    v_cndmask_b32 v180, v180, v13, vcc
    v_cmp_lt_i32 vcc, -1, v12
    s_nop 1
    v_cndmask_b32 v181, v181, v13, vcc
    v_cmp_lt_i32 vcc, -2, v12
    s_nop 1
    v_cndmask_b32 v182, v182, v13, vcc
    v_cmp_lt_i32 vcc, -3, v12
    s_nop 1
    v_cndmask_b32 v183, v183, v13, vcc
    v_max3_f32 v14, v172, v173, v174
    v_max3_f32 v14, v14, v175, v176
    v_max3_f32 v14, v14, v177, v178
    v_max3_f32 v14, v14, v179, v180
    v_max3_f32 v14, v14, v181, v182
    v_max_f32 v14, v14, v183
    v_mov_b32 v15, v14
    s_nop 1
    v_permlane16_swap_b32 v14, v15
    v_max_f32 v14, v14, v15
    v_mov_b32 v15, v14
    s_nop 1
    v_permlane32_swap_b32 v14, v15
    v_max_f32 v14, v14, v15
    v_sub_f32 v172, v172, v14
    v_mul_f32 v172, 0x3fb8aa3b, v172
    v_exp_f32 v172, v172
    v_sub_f32 v173, v173, v14
    v_mul_f32 v173, 0x3fb8aa3b, v173
    v_exp_f32 v173, v173
    v_sub_f32 v174, v174, v14
    v_mul_f32 v174, 0x3fb8aa3b, v174
    v_exp_f32 v174, v174
    v_sub_f32 v175, v175, v14
    v_mul_f32 v175, 0x3fb8aa3b, v175
    v_exp_f32 v175, v175
    v_sub_f32 v176, v176, v14
    v_mul_f32 v176, 0x3fb8aa3b, v176
    v_exp_f32 v176, v176
    v_sub_f32 v177, v177, v14
    v_mul_f32 v177, 0x3fb8aa3b, v177
    v_exp_f32 v177, v177
    v_sub_f32 v178, v178, v14
    v_mul_f32 v178, 0x3fb8aa3b, v178
    v_exp_f32 v178, v178
    v_sub_f32 v179, v179, v14
    v_mul_f32 v179, 0x3fb8aa3b, v179
    v_exp_f32 v179, v179
    v_sub_f32 v180, v180, v14
    v_mul_f32 v180, 0x3fb8aa3b, v180
    v_exp_f32 v180, v180
    v_sub_f32 v181, v181, v14
    v_mul_f32 v181, 0x3fb8aa3b, v181
    v_exp_f32 v181, v181
    v_sub_f32 v182, v182, v14
    v_mul_f32 v182, 0x3fb8aa3b, v182
    v_exp_f32 v182, v182
    v_sub_f32 v183, v183, v14
    v_mul_f32 v183, 0x3fb8aa3b, v183
    v_exp_f32 v183, v183
    v_add_f32 v14, v172, v173
    v_add_f32 v14, v14, v174
    v_add_f32 v14, v14, v175
    v_add_f32 v14, v14, v176
    v_add_f32 v14, v14, v177
    v_add_f32 v14, v14, v178
    v_add_f32 v14, v14, v179
    v_add_f32 v14, v14, v180
    v_add_f32 v14, v14, v181
    v_add_f32 v14, v14, v182
    v_add_f32 v14, v14, v183
    v_mov_b32 v15, v14
    s_nop 1
    v_permlane16_swap_b32 v14, v15
    v_add_f32 v14, v14, v15
    v_mov_b32 v15, v14
    s_nop 1
    v_permlane32_swap_b32 v14, v15
    v_add_f32 v14, v14, v15
    v_rcp_f32 v14, v14
    s_nop 0
    v_mul_f32 v172, v172, v14
    v_mul_f32 v173, v173, v14
    v_mul_f32 v174, v174, v14
    v_mul_f32 v175, v175, v14
    v_mul_f32 v176, v176, v14
    v_mul_f32 v177, v177, v14
    v_mul_f32 v178, v178, v14
    v_mul_f32 v179, v179, v14
    v_mul_f32 v180, v180, v14
    v_mul_f32 v181, v181, v14
    v_mul_f32 v182, v182, v14
    v_mul_f32 v183, v183, v14
    v_cvt_pk_bf16_f32 v24, v176, v177
    v_cvt_pk_bf16_f32 v25, v178, v179
    v_cvt_pk_bf16_f32 v26, v180, v181
    v_cvt_pk_bf16_f32 v27, v182, v183
    v_cvt_pk_bf16_f32 v28, v172, v173
    v_cvt_pk_bf16_f32 v29, v174, v175
    v_mov_b32 v30, 0
    v_mov_b32 v31, 0
    s_waitcnt vmcnt(0)
    v_mfma_f32_16x16x32_bf16 v[184:187], v[96:99], v[16:19], 0
    v_mfma_f32_16x16x32_bf16 v[188:191], v[100:103], v[16:19], 0
    v_mfma_f32_16x16x32_bf16 v[192:195], v[104:107], v[16:19], 0
    v_mfma_f32_16x16x32_bf16 v[196:199], v[108:111], v[16:19], 0
    v_mfma_f32_16x16x32_bf16 v[200:203], v[112:115], v[16:19], 0
    v_mfma_f32_16x16x32_bf16 v[204:207], v[116:119], v[16:19], 0
    v_mfma_f32_16x16x32_bf16 v[208:211], v[120:123], v[16:19], 0
    v_mfma_f32_16x16x32_bf16 v[212:215], v[124:127], v[16:19], 0
    v_mfma_f32_16x16x32_bf16 v[184:187], v[128:131], v[20:23], v[184:187]
    v_mfma_f32_16x16x32_bf16 v[188:191], v[132:135], v[20:23], v[188:191]
    v_mfma_f32_16x16x32_bf16 v[192:195], v[136:139], v[20:23], v[192:195]
    v_mfma_f32_16x16x32_bf16 v[196:199], v[140:143], v[20:23], v[196:199]
    v_mfma_f32_16x16x32_bf16 v[200:203], v[144:147], v[20:23], v[200:203]
    v_mfma_f32_16x16x32_bf16 v[204:207], v[148:151], v[20:23], v[204:207]
    v_mfma_f32_16x16x32_bf16 v[208:211], v[152:155], v[20:23], v[208:211]
    v_mfma_f32_16x16x32_bf16 v[212:215], v[156:159], v[20:23], v[212:215]
    v_mfma_f32_16x16x32_bf16 v[216:219], v[96:99], v[24:27], 0
    v_mfma_f32_16x16x32_bf16 v[220:223], v[100:103], v[24:27], 0
    v_mfma_f32_16x16x32_bf16 v[224:227], v[104:107], v[24:27], 0
    v_mfma_f32_16x16x32_bf16 v[228:231], v[108:111], v[24:27], 0
    v_mfma_f32_16x16x32_bf16 v[232:235], v[112:115], v[24:27], 0
    v_mfma_f32_16x16x32_bf16 v[236:239], v[116:119], v[24:27], 0
    v_mfma_f32_16x16x32_bf16 v[240:243], v[120:123], v[24:27], 0
    v_mfma_f32_16x16x32_bf16 v[244:247], v[124:127], v[24:27], 0
    v_mfma_f32_16x16x32_bf16 v[216:219], v[128:131], v[28:31], v[216:219]
    v_mfma_f32_16x16x32_bf16 v[220:223], v[132:135], v[28:31], v[220:223]
    v_mfma_f32_16x16x32_bf16 v[224:227], v[136:139], v[28:31], v[224:227]
    v_mfma_f32_16x16x32_bf16 v[228:231], v[140:143], v[28:31], v[228:231]
    v_mfma_f32_16x16x32_bf16 v[232:235], v[144:147], v[28:31], v[232:235]
    v_mfma_f32_16x16x32_bf16 v[236:239], v[148:151], v[28:31], v[236:239]
    v_mfma_f32_16x16x32_bf16 v[240:243], v[152:155], v[28:31], v[240:243]
    v_mfma_f32_16x16x32_bf16 v[244:247], v[156:159], v[28:31], v[244:247]
    v_cvt_pk_bf16_f32 v48, v184, v185
    v_cvt_pk_bf16_f32 v49, v186, v187
    v_cvt_pk_bf16_f32 v50, v188, v189
    v_cvt_pk_bf16_f32 v51, v190, v191
    s_add_u32 s36, s35, 0
    buffer_store_dwordx4 v[48:51], v1, s[28:31], s36 offen offset:0 sc1
    v_cvt_pk_bf16_f32 v52, v192, v193
    v_cvt_pk_bf16_f32 v53, v194, v195
    v_cvt_pk_bf16_f32 v54, v196, v197
    v_cvt_pk_bf16_f32 v55, v198, v199
    buffer_store_dwordx4 v[52:55], v1, s[28:31], s36 offen offset:2048 sc1
    v_cvt_pk_bf16_f32 v56, v200, v201
    v_cvt_pk_bf16_f32 v57, v202, v203
    v_cvt_pk_bf16_f32 v58, v204, v205
    v_cvt_pk_bf16_f32 v59, v206, v207
    s_add_u32 s36, s35, 0x1000
    buffer_store_dwordx4 v[56:59], v1, s[28:31], s36 offen offset:0 sc1
    v_cvt_pk_bf16_f32 v60, v208, v209
    v_cvt_pk_bf16_f32 v61, v210, v211
    v_cvt_pk_bf16_f32 v62, v212, v213
    v_cvt_pk_bf16_f32 v63, v214, v215
    buffer_store_dwordx4 v[60:63], v1, s[28:31], s36 offen offset:2048 sc1
    v_cvt_pk_bf16_f32 v64, v216, v217
    v_cvt_pk_bf16_f32 v65, v218, v219
    v_cvt_pk_bf16_f32 v66, v220, v221
    v_cvt_pk_bf16_f32 v67, v222, v223
    s_add_u32 s36, s35, 0
    buffer_store_dwordx4 v[64:67], v1, s[28:31], s36 offen offset:1024 sc1
    v_cvt_pk_bf16_f32 v68, v224, v225
    v_cvt_pk_bf16_f32 v69, v226, v227
    v_cvt_pk_bf16_f32 v70, v228, v229
    v_cvt_pk_bf16_f32 v71, v230, v231
    buffer_store_dwordx4 v[68:71], v1, s[28:31], s36 offen offset:3072 sc1
    v_cvt_pk_bf16_f32 v72, v232, v233
    v_cvt_pk_bf16_f32 v73, v234, v235
    v_cvt_pk_bf16_f32 v74, v236, v237
    v_cvt_pk_bf16_f32 v75, v238, v239
    s_add_u32 s36, s35, 0x1000
    buffer_store_dwordx4 v[72:75], v1, s[28:31], s36 offen offset:1024 sc1
    v_cvt_pk_bf16_f32 v76, v240, v241
    v_cvt_pk_bf16_f32 v77, v242, v243
    v_cvt_pk_bf16_f32 v78, v244, v245
    v_cvt_pk_bf16_f32 v79, v246, v247
    buffer_store_dwordx4 v[76:79], v1, s[28:31], s36 offen offset:3072 sc1
    s_waitcnt vmcnt(0)
    s_barrier
    s_cmp_lg_u32 s3, 0
    s_cbranch_scc1 w_loop
    s_lshl_b32 s90, s20, 8
    s_add_u32 s90, s90, 0x5000
    s_mov_b64 exec, 1
    v_mov_b32 v250, 0
    v_mov_b32 v251, 1
    buffer_atomic_add v251, v250, s[8:11], s90 offen
    s_mov_b64 exec, -1
    s_branch w_loop
w_memkv_75:
    s_add_u32 s8, s6, 0x3000
    s_addc_u32 s9, s7, 0
    s_and_b32 s9, s9, 0xffff
    s_mov_b32 s10, 0x10000
    s_mov_b32 s11, 0x20000
    s_add_u32 s12, s6, 0x396000
    s_addc_u32 s13, s7, 0
    s_and_b32 s13, s13, 0xffff
    s_mov_b32 s14, 0xc00000
    s_mov_b32 s15, 0x20000
    s_add_u32 s16, s6, 0x116000
    s_addc_u32 s17, s7, 0
    s_and_b32 s17, s17, 0xffff
    s_mov_b32 s18, 0x80000
    s_mov_b32 s19, 0x20000
    s_lshl_b32 s30, s21, 2
    s_add_u32 s30, s30, s3
    s_lshl_b32 s30, s30, 1
    s_add_u32 s30, s30, 0x80
    s_sub_u32 s31, s30, 0x80
    s_lshr_b32 s31, s31, 2
    s_and_b32 s29, s3, 1
    s_lshl_b32 s24, s30, 15
    s_lshl_b32 s25, s20, 15
    v_lshlrev_b32 v2, 4, v0
    v_and_b32 v8, 15, v0
    v_lshrrev_b32 v9, 4, v0
    v_mov_b32 v4, v2
    v_add_u32 v5, 0x8000, v2
    s_lshr_b32 s23, s30, 3
    s_cmp_lg_u32 s3, 0
    s_cbranch_scc1 wcd_105
    s_lshl_b32 s90, s23, 8
    s_add_u32 s90, s90, 0x9000
    v_mov_b32 v250, 0
wc_104:
    buffer_load_dword v251, v250, s[8:11], s90 offen sc1
    s_waitcnt vmcnt(0)
    v_readfirstlane_b32 s91, v251
    s_cmp_ge_u32 s91, 8
    s_cbranch_scc1 wcd_105
    s_sleep 2
    s_add_u32 s92, s92, 1
    s_cmp_gt_u32 s92, 0x1e8480
    s_cbranch_scc1 main_kernel_exit_w
    s_branch wc_104
wcd_105:
    s_waitcnt vmcnt(0)
    s_barrier
    buffer_load_dwordx4 a[0:3], v4, s[12:15], s24 offen offset:0
    buffer_load_dwordx4 a[4:7], v4, s[12:15], s24 offen offset:1024
    buffer_load_dwordx4 a[8:11], v5, s[12:15], s24 offen offset:0
    buffer_load_dwordx4 a[12:15], v5, s[12:15], s24 offen offset:1024
    s_add_u32 s24, s24, 0x800
    buffer_load_dwordx4 a[16:19], v4, s[12:15], s24 offen offset:0
    buffer_load_dwordx4 a[20:23], v4, s[12:15], s24 offen offset:1024
    buffer_load_dwordx4 a[24:27], v5, s[12:15], s24 offen offset:0
    buffer_load_dwordx4 a[28:31], v5, s[12:15], s24 offen offset:1024
    s_add_u32 s24, s24, 0x800
    buffer_load_dwordx4 a[32:35], v4, s[12:15], s24 offen offset:0
    buffer_load_dwordx4 a[36:39], v4, s[12:15], s24 offen offset:1024
    buffer_load_dwordx4 a[40:43], v5, s[12:15], s24 offen offset:0
    buffer_load_dwordx4 a[44:47], v5, s[12:15], s24 offen offset:1024
    s_add_u32 s24, s24, 0x800
    buffer_load_dwordx4 a[48:51], v4, s[12:15], s24 offen offset:0
    buffer_load_dwordx4 a[52:55], v4, s[12:15], s24 offen offset:1024
    buffer_load_dwordx4 a[56:59], v5, s[12:15], s24 offen offset:0
    buffer_load_dwordx4 a[60:63], v5, s[12:15], s24 offen offset:1024
    s_add_u32 s24, s24, 0x800
    buffer_load_dwordx4 a[64:67], v4, s[12:15], s24 offen offset:0
    buffer_load_dwordx4 a[68:71], v4, s[12:15], s24 offen offset:1024
    buffer_load_dwordx4 a[72:75], v5, s[12:15], s24 offen offset:0
    buffer_load_dwordx4 a[76:79], v5, s[12:15], s24 offen offset:1024
    s_add_u32 s24, s24, 0x800
    buffer_load_dwordx4 a[80:83], v4, s[12:15], s24 offen offset:0
    buffer_load_dwordx4 a[84:87], v4, s[12:15], s24 offen offset:1024
    buffer_load_dwordx4 a[88:91], v5, s[12:15], s24 offen offset:0
    buffer_load_dwordx4 a[92:95], v5, s[12:15], s24 offen offset:1024
    s_add_u32 s24, s24, 0x800
    buffer_load_dwordx4 a[96:99], v4, s[12:15], s24 offen offset:0
    buffer_load_dwordx4 a[100:103], v4, s[12:15], s24 offen offset:1024
    buffer_load_dwordx4 a[104:107], v5, s[12:15], s24 offen offset:0
    buffer_load_dwordx4 a[108:111], v5, s[12:15], s24 offen offset:1024
    s_add_u32 s24, s24, 0x800
    buffer_load_dwordx4 a[112:115], v4, s[12:15], s24 offen offset:0
    buffer_load_dwordx4 a[116:119], v4, s[12:15], s24 offen offset:1024
    buffer_load_dwordx4 a[120:123], v5, s[12:15], s24 offen offset:0
    buffer_load_dwordx4 a[124:127], v5, s[12:15], s24 offen offset:1024
    s_add_u32 s24, s24, 0x800
    buffer_load_dwordx4 a[128:131], v4, s[12:15], s24 offen offset:0
    buffer_load_dwordx4 a[132:135], v4, s[12:15], s24 offen offset:1024
    buffer_load_dwordx4 a[136:139], v5, s[12:15], s24 offen offset:0
    buffer_load_dwordx4 a[140:143], v5, s[12:15], s24 offen offset:1024
    s_add_u32 s24, s24, 0x800
    buffer_load_dwordx4 a[144:147], v4, s[12:15], s24 offen offset:0
    buffer_load_dwordx4 a[148:151], v4, s[12:15], s24 offen offset:1024
    buffer_load_dwordx4 a[152:155], v5, s[12:15], s24 offen offset:0
    buffer_load_dwordx4 a[156:159], v5, s[12:15], s24 offen offset:1024
    s_add_u32 s24, s24, 0x800
    buffer_load_dwordx4 a[160:163], v4, s[12:15], s24 offen offset:0
    buffer_load_dwordx4 a[164:167], v4, s[12:15], s24 offen offset:1024
    buffer_load_dwordx4 a[168:171], v5, s[12:15], s24 offen offset:0
    buffer_load_dwordx4 a[172:175], v5, s[12:15], s24 offen offset:1024
    s_add_u32 s24, s24, 0x800
    buffer_load_dwordx4 a[176:179], v4, s[12:15], s24 offen offset:0
    buffer_load_dwordx4 a[180:183], v4, s[12:15], s24 offen offset:1024
    buffer_load_dwordx4 a[184:187], v5, s[12:15], s24 offen offset:0
    buffer_load_dwordx4 a[188:191], v5, s[12:15], s24 offen offset:1024
    s_add_u32 s24, s24, 0x800
    s_waitcnt vmcnt(16)
    buffer_load_dwordx4 a[192:195], v4, s[12:15], s24 offen offset:0
    buffer_load_dwordx4 a[196:199], v4, s[12:15], s24 offen offset:1024
    buffer_load_dwordx4 a[200:203], v5, s[12:15], s24 offen offset:0
    buffer_load_dwordx4 a[204:207], v5, s[12:15], s24 offen offset:1024
    s_add_u32 s24, s24, 0x800
    buffer_load_dwordx4 a[208:211], v4, s[12:15], s24 offen offset:0
    buffer_load_dwordx4 a[212:215], v4, s[12:15], s24 offen offset:1024
    buffer_load_dwordx4 a[216:219], v5, s[12:15], s24 offen offset:0
    buffer_load_dwordx4 a[220:223], v5, s[12:15], s24 offen offset:1024
    s_add_u32 s24, s24, 0x800
    buffer_load_dwordx4 a[224:227], v4, s[12:15], s24 offen offset:0
    buffer_load_dwordx4 a[228:231], v4, s[12:15], s24 offen offset:1024
    buffer_load_dwordx4 a[232:235], v5, s[12:15], s24 offen offset:0
    buffer_load_dwordx4 a[236:239], v5, s[12:15], s24 offen offset:1024
    s_add_u32 s24, s24, 0x800
    buffer_load_dwordx4 a[240:243], v4, s[12:15], s24 offen offset:0
    buffer_load_dwordx4 a[244:247], v4, s[12:15], s24 offen offset:1024
    buffer_load_dwordx4 a[248:251], v5, s[12:15], s24 offen offset:0
    buffer_load_dwordx4 a[252:255], v5, s[12:15], s24 offen offset:1024
    s_add_u32 s24, s24, 0x800
    s_cmp_lg_u32 s3, 0
    s_cbranch_scc1 mkv_pred_107
    s_add_u32 s26, s25, 0x7c00
mkv_pre_106:
    buffer_load_dwordx4 v[16:19], v2, s[16:19], s26 offen sc1
    s_waitcnt vmcnt(0)
    v_max3_u32 v10, v16, v17, v18
    v_max_u32 v10, v10, v19
    v_cmp_eq_u32 vcc, -1, v10
    s_cbranch_vccz mkv_pred_107
    s_sleep 2
    s_add_u32 s92, s92, 1
    s_cmp_gt_u32 s92, 0x1e8480
    s_cbranch_scc1 main_kernel_exit_w
    s_branch mkv_pre_106
mkv_pred_107:
    s_barrier
mkv_poll_108:
    s_mov_b32 s26, s25
    buffer_load_dwordx4 v[16:19], v2, s[16:19], s26 offen offset:0 sc1
    buffer_load_dwordx4 v[20:23], v2, s[16:19], s26 offen offset:1024 sc1
    buffer_load_dwordx4 v[24:27], v2, s[16:19], s26 offen offset:2048 sc1
    buffer_load_dwordx4 v[28:31], v2, s[16:19], s26 offen offset:3072 sc1
    s_add_u32 s26, s26, 0x1000
    buffer_load_dwordx4 v[32:35], v2, s[16:19], s26 offen offset:0 sc1
    buffer_load_dwordx4 v[36:39], v2, s[16:19], s26 offen offset:1024 sc1
    buffer_load_dwordx4 v[40:43], v2, s[16:19], s26 offen offset:2048 sc1
    buffer_load_dwordx4 v[44:47], v2, s[16:19], s26 offen offset:3072 sc1
    s_add_u32 s26, s26, 0x1000
    buffer_load_dwordx4 v[48:51], v2, s[16:19], s26 offen offset:0 sc1
    buffer_load_dwordx4 v[52:55], v2, s[16:19], s26 offen offset:1024 sc1
    buffer_load_dwordx4 v[56:59], v2, s[16:19], s26 offen offset:2048 sc1
    buffer_load_dwordx4 v[60:63], v2, s[16:19], s26 offen offset:3072 sc1
    s_add_u32 s26, s26, 0x1000
    buffer_load_dwordx4 v[64:67], v2, s[16:19], s26 offen offset:0 sc1
    buffer_load_dwordx4 v[68:71], v2, s[16:19], s26 offen offset:1024 sc1
    buffer_load_dwordx4 v[72:75], v2, s[16:19], s26 offen offset:2048 sc1
    buffer_load_dwordx4 v[76:79], v2, s[16:19], s26 offen offset:3072 sc1
    s_add_u32 s26, s26, 0x1000
    buffer_load_dwordx4 v[80:83], v2, s[16:19], s26 offen offset:0 sc1
    buffer_load_dwordx4 v[84:87], v2, s[16:19], s26 offen offset:1024 sc1
    buffer_load_dwordx4 v[88:91], v2, s[16:19], s26 offen offset:2048 sc1
    buffer_load_dwordx4 v[92:95], v2, s[16:19], s26 offen offset:3072 sc1
    s_add_u32 s26, s26, 0x1000
    buffer_load_dwordx4 v[96:99], v2, s[16:19], s26 offen offset:0 sc1
    buffer_load_dwordx4 v[100:103], v2, s[16:19], s26 offen offset:1024 sc1
    buffer_load_dwordx4 v[104:107], v2, s[16:19], s26 offen offset:2048 sc1
    buffer_load_dwordx4 v[108:111], v2, s[16:19], s26 offen offset:3072 sc1
    s_add_u32 s26, s26, 0x1000
    buffer_load_dwordx4 v[112:115], v2, s[16:19], s26 offen offset:0 sc1
    buffer_load_dwordx4 v[116:119], v2, s[16:19], s26 offen offset:1024 sc1
    buffer_load_dwordx4 v[120:123], v2, s[16:19], s26 offen offset:2048 sc1
    buffer_load_dwordx4 v[124:127], v2, s[16:19], s26 offen offset:3072 sc1
    s_add_u32 s26, s26, 0x1000
    buffer_load_dwordx4 v[128:131], v2, s[16:19], s26 offen offset:0 sc1
    buffer_load_dwordx4 v[132:135], v2, s[16:19], s26 offen offset:1024 sc1
    buffer_load_dwordx4 v[136:139], v2, s[16:19], s26 offen offset:2048 sc1
    buffer_load_dwordx4 v[140:143], v2, s[16:19], s26 offen offset:3072 sc1
    s_waitcnt vmcnt(0)
    v_max3_u32 v10, v16, v17, v18
    v_max_u32 v10, v10, v19
    v_max3_u32 v10, v10, v20, v21
    v_max3_u32 v10, v10, v22, v23
    v_max3_u32 v10, v10, v24, v25
    v_max3_u32 v10, v10, v26, v27
    v_max3_u32 v10, v10, v28, v29
    v_max3_u32 v10, v10, v30, v31
    v_max3_u32 v10, v10, v32, v33
    v_max3_u32 v10, v10, v34, v35
    v_max3_u32 v10, v10, v36, v37
    v_max3_u32 v10, v10, v38, v39
    v_max3_u32 v10, v10, v40, v41
    v_max3_u32 v10, v10, v42, v43
    v_max3_u32 v10, v10, v44, v45
    v_max3_u32 v10, v10, v46, v47
    v_max3_u32 v10, v10, v48, v49
    v_max3_u32 v10, v10, v50, v51
    v_max3_u32 v10, v10, v52, v53
    v_max3_u32 v10, v10, v54, v55
    v_max3_u32 v10, v10, v56, v57
    v_max3_u32 v10, v10, v58, v59
    v_max3_u32 v10, v10, v60, v61
    v_max3_u32 v10, v10, v62, v63
    v_max3_u32 v10, v10, v64, v65
    v_max3_u32 v10, v10, v66, v67
    v_max3_u32 v10, v10, v68, v69
    v_max3_u32 v10, v10, v70, v71
    v_max3_u32 v10, v10, v72, v73
    v_max3_u32 v10, v10, v74, v75
    v_max3_u32 v10, v10, v76, v77
    v_max3_u32 v10, v10, v78, v79
    v_max3_u32 v10, v10, v80, v81
    v_max3_u32 v10, v10, v82, v83
    v_max3_u32 v10, v10, v84, v85
    v_max3_u32 v10, v10, v86, v87
    v_max3_u32 v10, v10, v88, v89
    v_max3_u32 v10, v10, v90, v91
    v_max3_u32 v10, v10, v92, v93
    v_max3_u32 v10, v10, v94, v95
    v_max3_u32 v10, v10, v96, v97
    v_max3_u32 v10, v10, v98, v99
    v_max3_u32 v10, v10, v100, v101
    v_max3_u32 v10, v10, v102, v103
    v_max3_u32 v10, v10, v104, v105
    v_max3_u32 v10, v10, v106, v107
    v_max3_u32 v10, v10, v108, v109
    v_max3_u32 v10, v10, v110, v111
    v_max3_u32 v10, v10, v112, v113
    v_max3_u32 v10, v10, v114, v115
    v_max3_u32 v10, v10, v116, v117
    v_max3_u32 v10, v10, v118, v119
    v_max3_u32 v10, v10, v120, v121
    v_max3_u32 v10, v10, v122, v123
    v_max3_u32 v10, v10, v124, v125
    v_max3_u32 v10, v10, v126, v127
    v_max3_u32 v10, v10, v128, v129
    v_max3_u32 v10, v10, v130, v131
    v_max3_u32 v10, v10, v132, v133
    v_max3_u32 v10, v10, v134, v135
    v_max3_u32 v10, v10, v136, v137
    v_max3_u32 v10, v10, v138, v139
    v_max3_u32 v10, v10, v140, v141
    v_max3_u32 v10, v10, v142, v143
    v_cmp_eq_u32 vcc, -1, v10
    s_cbranch_vccz mkv_ok_109
    s_sleep 2
    s_add_u32 s92, s92, 1
    s_cmp_gt_u32 s92, 0x1e8480
    s_cbranch_scc1 main_kernel_exit_w
    s_branch mkv_poll_108
mkv_ok_109:
    s_cmp_ge_u32 s21, 16
    s_cbranch_scc1 mkv_v_110
    v_mfma_f32_16x16x32_bf16 v[144:147], a[0:3], v[16:19], 0
    v_mfma_f32_16x16x32_bf16 v[148:151], a[0:3], v[20:23], 0
    v_mfma_f32_16x16x32_bf16 v[152:155], a[4:7], v[16:19], 0
    v_mfma_f32_16x16x32_bf16 v[156:159], a[4:7], v[20:23], 0
    v_mfma_f32_16x16x32_bf16 v[160:163], a[8:11], v[16:19], 0
    v_mfma_f32_16x16x32_bf16 v[164:167], a[8:11], v[20:23], 0
    v_mfma_f32_16x16x32_bf16 v[168:171], a[12:15], v[16:19], 0
    v_mfma_f32_16x16x32_bf16 v[172:175], a[12:15], v[20:23], 0
    v_mfma_f32_16x16x32_bf16 v[144:147], a[16:19], v[24:27], v[144:147]
    v_mfma_f32_16x16x32_bf16 v[148:151], a[16:19], v[28:31], v[148:151]
    v_mfma_f32_16x16x32_bf16 v[152:155], a[20:23], v[24:27], v[152:155]
    v_mfma_f32_16x16x32_bf16 v[156:159], a[20:23], v[28:31], v[156:159]
    v_mfma_f32_16x16x32_bf16 v[160:163], a[24:27], v[24:27], v[160:163]
    v_mfma_f32_16x16x32_bf16 v[164:167], a[24:27], v[28:31], v[164:167]
    v_mfma_f32_16x16x32_bf16 v[168:171], a[28:31], v[24:27], v[168:171]
    v_mfma_f32_16x16x32_bf16 v[172:175], a[28:31], v[28:31], v[172:175]
    v_mfma_f32_16x16x32_bf16 v[144:147], a[32:35], v[32:35], v[144:147]
    v_mfma_f32_16x16x32_bf16 v[148:151], a[32:35], v[36:39], v[148:151]
    v_mfma_f32_16x16x32_bf16 v[152:155], a[36:39], v[32:35], v[152:155]
    v_mfma_f32_16x16x32_bf16 v[156:159], a[36:39], v[36:39], v[156:159]
    v_mfma_f32_16x16x32_bf16 v[160:163], a[40:43], v[32:35], v[160:163]
    v_mfma_f32_16x16x32_bf16 v[164:167], a[40:43], v[36:39], v[164:167]
    v_mfma_f32_16x16x32_bf16 v[168:171], a[44:47], v[32:35], v[168:171]
    v_mfma_f32_16x16x32_bf16 v[172:175], a[44:47], v[36:39], v[172:175]
    v_mfma_f32_16x16x32_bf16 v[144:147], a[48:51], v[40:43], v[144:147]
    v_mfma_f32_16x16x32_bf16 v[148:151], a[48:51], v[44:47], v[148:151]
    v_mfma_f32_16x16x32_bf16 v[152:155], a[52:55], v[40:43], v[152:155]
    v_mfma_f32_16x16x32_bf16 v[156:159], a[52:55], v[44:47], v[156:159]
    v_mfma_f32_16x16x32_bf16 v[160:163], a[56:59], v[40:43], v[160:163]
    v_mfma_f32_16x16x32_bf16 v[164:167], a[56:59], v[44:47], v[164:167]
    v_mfma_f32_16x16x32_bf16 v[168:171], a[60:63], v[40:43], v[168:171]
    v_mfma_f32_16x16x32_bf16 v[172:175], a[60:63], v[44:47], v[172:175]
    v_mfma_f32_16x16x32_bf16 v[144:147], a[64:67], v[48:51], v[144:147]
    v_mfma_f32_16x16x32_bf16 v[148:151], a[64:67], v[52:55], v[148:151]
    v_mfma_f32_16x16x32_bf16 v[152:155], a[68:71], v[48:51], v[152:155]
    v_mfma_f32_16x16x32_bf16 v[156:159], a[68:71], v[52:55], v[156:159]
    v_mfma_f32_16x16x32_bf16 v[160:163], a[72:75], v[48:51], v[160:163]
    v_mfma_f32_16x16x32_bf16 v[164:167], a[72:75], v[52:55], v[164:167]
    v_mfma_f32_16x16x32_bf16 v[168:171], a[76:79], v[48:51], v[168:171]
    v_mfma_f32_16x16x32_bf16 v[172:175], a[76:79], v[52:55], v[172:175]
    v_mfma_f32_16x16x32_bf16 v[144:147], a[80:83], v[56:59], v[144:147]
    v_mfma_f32_16x16x32_bf16 v[148:151], a[80:83], v[60:63], v[148:151]
    v_mfma_f32_16x16x32_bf16 v[152:155], a[84:87], v[56:59], v[152:155]
    v_mfma_f32_16x16x32_bf16 v[156:159], a[84:87], v[60:63], v[156:159]
    v_mfma_f32_16x16x32_bf16 v[160:163], a[88:91], v[56:59], v[160:163]
    v_mfma_f32_16x16x32_bf16 v[164:167], a[88:91], v[60:63], v[164:167]
    v_mfma_f32_16x16x32_bf16 v[168:171], a[92:95], v[56:59], v[168:171]
    v_mfma_f32_16x16x32_bf16 v[172:175], a[92:95], v[60:63], v[172:175]
    v_mfma_f32_16x16x32_bf16 v[144:147], a[96:99], v[64:67], v[144:147]
    v_mfma_f32_16x16x32_bf16 v[148:151], a[96:99], v[68:71], v[148:151]
    v_mfma_f32_16x16x32_bf16 v[152:155], a[100:103], v[64:67], v[152:155]
    v_mfma_f32_16x16x32_bf16 v[156:159], a[100:103], v[68:71], v[156:159]
    v_mfma_f32_16x16x32_bf16 v[160:163], a[104:107], v[64:67], v[160:163]
    v_mfma_f32_16x16x32_bf16 v[164:167], a[104:107], v[68:71], v[164:167]
    v_mfma_f32_16x16x32_bf16 v[168:171], a[108:111], v[64:67], v[168:171]
    v_mfma_f32_16x16x32_bf16 v[172:175], a[108:111], v[68:71], v[172:175]
    v_mfma_f32_16x16x32_bf16 v[144:147], a[112:115], v[72:75], v[144:147]
    v_mfma_f32_16x16x32_bf16 v[148:151], a[112:115], v[76:79], v[148:151]
    v_mfma_f32_16x16x32_bf16 v[152:155], a[116:119], v[72:75], v[152:155]
    v_mfma_f32_16x16x32_bf16 v[156:159], a[116:119], v[76:79], v[156:159]
    v_mfma_f32_16x16x32_bf16 v[160:163], a[120:123], v[72:75], v[160:163]
    v_mfma_f32_16x16x32_bf16 v[164:167], a[120:123], v[76:79], v[164:167]
    v_mfma_f32_16x16x32_bf16 v[168:171], a[124:127], v[72:75], v[168:171]
    v_mfma_f32_16x16x32_bf16 v[172:175], a[124:127], v[76:79], v[172:175]
    v_mfma_f32_16x16x32_bf16 v[144:147], a[128:131], v[80:83], v[144:147]
    v_mfma_f32_16x16x32_bf16 v[148:151], a[128:131], v[84:87], v[148:151]
    v_mfma_f32_16x16x32_bf16 v[152:155], a[132:135], v[80:83], v[152:155]
    v_mfma_f32_16x16x32_bf16 v[156:159], a[132:135], v[84:87], v[156:159]
    v_mfma_f32_16x16x32_bf16 v[160:163], a[136:139], v[80:83], v[160:163]
    v_mfma_f32_16x16x32_bf16 v[164:167], a[136:139], v[84:87], v[164:167]
    v_mfma_f32_16x16x32_bf16 v[168:171], a[140:143], v[80:83], v[168:171]
    v_mfma_f32_16x16x32_bf16 v[172:175], a[140:143], v[84:87], v[172:175]
    v_mfma_f32_16x16x32_bf16 v[144:147], a[144:147], v[88:91], v[144:147]
    v_mfma_f32_16x16x32_bf16 v[148:151], a[144:147], v[92:95], v[148:151]
    v_mfma_f32_16x16x32_bf16 v[152:155], a[148:151], v[88:91], v[152:155]
    v_mfma_f32_16x16x32_bf16 v[156:159], a[148:151], v[92:95], v[156:159]
    v_mfma_f32_16x16x32_bf16 v[160:163], a[152:155], v[88:91], v[160:163]
    v_mfma_f32_16x16x32_bf16 v[164:167], a[152:155], v[92:95], v[164:167]
    v_mfma_f32_16x16x32_bf16 v[168:171], a[156:159], v[88:91], v[168:171]
    v_mfma_f32_16x16x32_bf16 v[172:175], a[156:159], v[92:95], v[172:175]
    v_mfma_f32_16x16x32_bf16 v[144:147], a[160:163], v[96:99], v[144:147]
    v_mfma_f32_16x16x32_bf16 v[148:151], a[160:163], v[100:103], v[148:151]
    v_mfma_f32_16x16x32_bf16 v[152:155], a[164:167], v[96:99], v[152:155]
    v_mfma_f32_16x16x32_bf16 v[156:159], a[164:167], v[100:103], v[156:159]
    v_mfma_f32_16x16x32_bf16 v[160:163], a[168:171], v[96:99], v[160:163]
    v_mfma_f32_16x16x32_bf16 v[164:167], a[168:171], v[100:103], v[164:167]
    v_mfma_f32_16x16x32_bf16 v[168:171], a[172:175], v[96:99], v[168:171]
    v_mfma_f32_16x16x32_bf16 v[172:175], a[172:175], v[100:103], v[172:175]
    v_mfma_f32_16x16x32_bf16 v[144:147], a[176:179], v[104:107], v[144:147]
    v_mfma_f32_16x16x32_bf16 v[148:151], a[176:179], v[108:111], v[148:151]
    v_mfma_f32_16x16x32_bf16 v[152:155], a[180:183], v[104:107], v[152:155]
    v_mfma_f32_16x16x32_bf16 v[156:159], a[180:183], v[108:111], v[156:159]
    v_mfma_f32_16x16x32_bf16 v[160:163], a[184:187], v[104:107], v[160:163]
    v_mfma_f32_16x16x32_bf16 v[164:167], a[184:187], v[108:111], v[164:167]
    v_mfma_f32_16x16x32_bf16 v[168:171], a[188:191], v[104:107], v[168:171]
    v_mfma_f32_16x16x32_bf16 v[172:175], a[188:191], v[108:111], v[172:175]
    v_mfma_f32_16x16x32_bf16 v[144:147], a[192:195], v[112:115], v[144:147]
    v_mfma_f32_16x16x32_bf16 v[148:151], a[192:195], v[116:119], v[148:151]
    v_mfma_f32_16x16x32_bf16 v[152:155], a[196:199], v[112:115], v[152:155]
    v_mfma_f32_16x16x32_bf16 v[156:159], a[196:199], v[116:119], v[156:159]
    v_mfma_f32_16x16x32_bf16 v[160:163], a[200:203], v[112:115], v[160:163]
    v_mfma_f32_16x16x32_bf16 v[164:167], a[200:203], v[116:119], v[164:167]
    v_mfma_f32_16x16x32_bf16 v[168:171], a[204:207], v[112:115], v[168:171]
    v_mfma_f32_16x16x32_bf16 v[172:175], a[204:207], v[116:119], v[172:175]
    v_mfma_f32_16x16x32_bf16 v[144:147], a[208:211], v[120:123], v[144:147]
    v_mfma_f32_16x16x32_bf16 v[148:151], a[208:211], v[124:127], v[148:151]
    v_mfma_f32_16x16x32_bf16 v[152:155], a[212:215], v[120:123], v[152:155]
    v_mfma_f32_16x16x32_bf16 v[156:159], a[212:215], v[124:127], v[156:159]
    v_mfma_f32_16x16x32_bf16 v[160:163], a[216:219], v[120:123], v[160:163]
    v_mfma_f32_16x16x32_bf16 v[164:167], a[216:219], v[124:127], v[164:167]
    v_mfma_f32_16x16x32_bf16 v[168:171], a[220:223], v[120:123], v[168:171]
    v_mfma_f32_16x16x32_bf16 v[172:175], a[220:223], v[124:127], v[172:175]
    v_mfma_f32_16x16x32_bf16 v[144:147], a[224:227], v[128:131], v[144:147]
    v_mfma_f32_16x16x32_bf16 v[148:151], a[224:227], v[132:135], v[148:151]
    v_mfma_f32_16x16x32_bf16 v[152:155], a[228:231], v[128:131], v[152:155]
    v_mfma_f32_16x16x32_bf16 v[156:159], a[228:231], v[132:135], v[156:159]
    v_mfma_f32_16x16x32_bf16 v[160:163], a[232:235], v[128:131], v[160:163]
    v_mfma_f32_16x16x32_bf16 v[164:167], a[232:235], v[132:135], v[164:167]
    v_mfma_f32_16x16x32_bf16 v[168:171], a[236:239], v[128:131], v[168:171]
    v_mfma_f32_16x16x32_bf16 v[172:175], a[236:239], v[132:135], v[172:175]
    v_mfma_f32_16x16x32_bf16 v[144:147], a[240:243], v[136:139], v[144:147]
    v_mfma_f32_16x16x32_bf16 v[148:151], a[240:243], v[140:143], v[148:151]
    v_mfma_f32_16x16x32_bf16 v[152:155], a[244:247], v[136:139], v[152:155]
    v_mfma_f32_16x16x32_bf16 v[156:159], a[244:247], v[140:143], v[156:159]
    v_mfma_f32_16x16x32_bf16 v[160:163], a[248:251], v[136:139], v[160:163]
    v_mfma_f32_16x16x32_bf16 v[164:167], a[248:251], v[140:143], v[164:167]
    v_mfma_f32_16x16x32_bf16 v[168:171], a[252:255], v[136:139], v[168:171]
    v_mfma_f32_16x16x32_bf16 v[172:175], a[252:255], v[140:143], v[172:175]
    s_add_u32 s32, s6, 0x4716000
    s_addc_u32 s33, s7, 0
    s_and_b32 s33, s33, 0xffff
    s_mov_b32 s34, 0x400000
    s_mov_b32 s35, 0x20000
    s_lshl_b32 s27, s31, 11
    s_lshl_b32 s28, s20, 18
    s_add_u32 s27, s27, s28
    s_lshl_b32 s28, s29, 7
    s_add_u32 s27, s27, s28
    v_lshrrev_b32 v10, 2, v8
    v_lshlrev_b32 v10, 16, v10
    v_and_b32 v11, 3, v8
    v_lshl_add_u32 v10, v11, 8, v10
    v_lshl_add_u32 v10, v9, 4, v10
    v_cvt_pk_bf16_f32 v16, v144, v145
    v_cvt_pk_bf16_f32 v17, v146, v147
    v_cvt_pk_bf16_f32 v18, v152, v153
    v_cvt_pk_bf16_f32 v19, v154, v155
    buffer_store_dwordx4 v[16:19], v10, s[32:35], s27 offen offset:0 sc1
    v_cvt_pk_bf16_f32 v20, v148, v149
    v_cvt_pk_bf16_f32 v21, v150, v151
    v_cvt_pk_bf16_f32 v22, v156, v157
    v_cvt_pk_bf16_f32 v23, v158, v159
    buffer_store_dwordx4 v[20:23], v10, s[32:35], s27 offen offset:1024 sc1
    v_cvt_pk_bf16_f32 v24, v160, v161
    v_cvt_pk_bf16_f32 v25, v162, v163
    v_cvt_pk_bf16_f32 v26, v168, v169
    v_cvt_pk_bf16_f32 v27, v170, v171
    buffer_store_dwordx4 v[24:27], v10, s[32:35], s27 offen offset:64 sc1
    v_cvt_pk_bf16_f32 v28, v164, v165
    v_cvt_pk_bf16_f32 v29, v166, v167
    v_cvt_pk_bf16_f32 v30, v172, v173
    v_cvt_pk_bf16_f32 v31, v174, v175
    buffer_store_dwordx4 v[28:31], v10, s[32:35], s27 offen offset:1088 sc1
    s_branch mkv_sig_111
mkv_v_110:
    v_mfma_f32_16x16x32_bf16 v[144:147], v[16:19], a[0:3], 0
    v_mfma_f32_16x16x32_bf16 v[148:151], v[20:23], a[0:3], 0
    v_mfma_f32_16x16x32_bf16 v[152:155], v[16:19], a[4:7], 0
    v_mfma_f32_16x16x32_bf16 v[156:159], v[20:23], a[4:7], 0
    v_mfma_f32_16x16x32_bf16 v[160:163], v[16:19], a[8:11], 0
    v_mfma_f32_16x16x32_bf16 v[164:167], v[20:23], a[8:11], 0
    v_mfma_f32_16x16x32_bf16 v[168:171], v[16:19], a[12:15], 0
    v_mfma_f32_16x16x32_bf16 v[172:175], v[20:23], a[12:15], 0
    v_mfma_f32_16x16x32_bf16 v[144:147], v[24:27], a[16:19], v[144:147]
    v_mfma_f32_16x16x32_bf16 v[148:151], v[28:31], a[16:19], v[148:151]
    v_mfma_f32_16x16x32_bf16 v[152:155], v[24:27], a[20:23], v[152:155]
    v_mfma_f32_16x16x32_bf16 v[156:159], v[28:31], a[20:23], v[156:159]
    v_mfma_f32_16x16x32_bf16 v[160:163], v[24:27], a[24:27], v[160:163]
    v_mfma_f32_16x16x32_bf16 v[164:167], v[28:31], a[24:27], v[164:167]
    v_mfma_f32_16x16x32_bf16 v[168:171], v[24:27], a[28:31], v[168:171]
    v_mfma_f32_16x16x32_bf16 v[172:175], v[28:31], a[28:31], v[172:175]
    v_mfma_f32_16x16x32_bf16 v[144:147], v[32:35], a[32:35], v[144:147]
    v_mfma_f32_16x16x32_bf16 v[148:151], v[36:39], a[32:35], v[148:151]
    v_mfma_f32_16x16x32_bf16 v[152:155], v[32:35], a[36:39], v[152:155]
    v_mfma_f32_16x16x32_bf16 v[156:159], v[36:39], a[36:39], v[156:159]
    v_mfma_f32_16x16x32_bf16 v[160:163], v[32:35], a[40:43], v[160:163]
    v_mfma_f32_16x16x32_bf16 v[164:167], v[36:39], a[40:43], v[164:167]
    v_mfma_f32_16x16x32_bf16 v[168:171], v[32:35], a[44:47], v[168:171]
    v_mfma_f32_16x16x32_bf16 v[172:175], v[36:39], a[44:47], v[172:175]
    v_mfma_f32_16x16x32_bf16 v[144:147], v[40:43], a[48:51], v[144:147]
    v_mfma_f32_16x16x32_bf16 v[148:151], v[44:47], a[48:51], v[148:151]
    v_mfma_f32_16x16x32_bf16 v[152:155], v[40:43], a[52:55], v[152:155]
    v_mfma_f32_16x16x32_bf16 v[156:159], v[44:47], a[52:55], v[156:159]
    v_mfma_f32_16x16x32_bf16 v[160:163], v[40:43], a[56:59], v[160:163]
    v_mfma_f32_16x16x32_bf16 v[164:167], v[44:47], a[56:59], v[164:167]
    v_mfma_f32_16x16x32_bf16 v[168:171], v[40:43], a[60:63], v[168:171]
    v_mfma_f32_16x16x32_bf16 v[172:175], v[44:47], a[60:63], v[172:175]
    v_mfma_f32_16x16x32_bf16 v[144:147], v[48:51], a[64:67], v[144:147]
    v_mfma_f32_16x16x32_bf16 v[148:151], v[52:55], a[64:67], v[148:151]
    v_mfma_f32_16x16x32_bf16 v[152:155], v[48:51], a[68:71], v[152:155]
    v_mfma_f32_16x16x32_bf16 v[156:159], v[52:55], a[68:71], v[156:159]
    v_mfma_f32_16x16x32_bf16 v[160:163], v[48:51], a[72:75], v[160:163]
    v_mfma_f32_16x16x32_bf16 v[164:167], v[52:55], a[72:75], v[164:167]
    v_mfma_f32_16x16x32_bf16 v[168:171], v[48:51], a[76:79], v[168:171]
    v_mfma_f32_16x16x32_bf16 v[172:175], v[52:55], a[76:79], v[172:175]
    v_mfma_f32_16x16x32_bf16 v[144:147], v[56:59], a[80:83], v[144:147]
    v_mfma_f32_16x16x32_bf16 v[148:151], v[60:63], a[80:83], v[148:151]
    v_mfma_f32_16x16x32_bf16 v[152:155], v[56:59], a[84:87], v[152:155]
    v_mfma_f32_16x16x32_bf16 v[156:159], v[60:63], a[84:87], v[156:159]
    v_mfma_f32_16x16x32_bf16 v[160:163], v[56:59], a[88:91], v[160:163]
    v_mfma_f32_16x16x32_bf16 v[164:167], v[60:63], a[88:91], v[164:167]
    v_mfma_f32_16x16x32_bf16 v[168:171], v[56:59], a[92:95], v[168:171]
    v_mfma_f32_16x16x32_bf16 v[172:175], v[60:63], a[92:95], v[172:175]
    v_mfma_f32_16x16x32_bf16 v[144:147], v[64:67], a[96:99], v[144:147]
    v_mfma_f32_16x16x32_bf16 v[148:151], v[68:71], a[96:99], v[148:151]
    v_mfma_f32_16x16x32_bf16 v[152:155], v[64:67], a[100:103], v[152:155]
    v_mfma_f32_16x16x32_bf16 v[156:159], v[68:71], a[100:103], v[156:159]
    v_mfma_f32_16x16x32_bf16 v[160:163], v[64:67], a[104:107], v[160:163]
    v_mfma_f32_16x16x32_bf16 v[164:167], v[68:71], a[104:107], v[164:167]
    v_mfma_f32_16x16x32_bf16 v[168:171], v[64:67], a[108:111], v[168:171]
    v_mfma_f32_16x16x32_bf16 v[172:175], v[68:71], a[108:111], v[172:175]
    v_mfma_f32_16x16x32_bf16 v[144:147], v[72:75], a[112:115], v[144:147]
    v_mfma_f32_16x16x32_bf16 v[148:151], v[76:79], a[112:115], v[148:151]
    v_mfma_f32_16x16x32_bf16 v[152:155], v[72:75], a[116:119], v[152:155]
    v_mfma_f32_16x16x32_bf16 v[156:159], v[76:79], a[116:119], v[156:159]
    v_mfma_f32_16x16x32_bf16 v[160:163], v[72:75], a[120:123], v[160:163]
    v_mfma_f32_16x16x32_bf16 v[164:167], v[76:79], a[120:123], v[164:167]
    v_mfma_f32_16x16x32_bf16 v[168:171], v[72:75], a[124:127], v[168:171]
    v_mfma_f32_16x16x32_bf16 v[172:175], v[76:79], a[124:127], v[172:175]
    v_mfma_f32_16x16x32_bf16 v[144:147], v[80:83], a[128:131], v[144:147]
    v_mfma_f32_16x16x32_bf16 v[148:151], v[84:87], a[128:131], v[148:151]
    v_mfma_f32_16x16x32_bf16 v[152:155], v[80:83], a[132:135], v[152:155]
    v_mfma_f32_16x16x32_bf16 v[156:159], v[84:87], a[132:135], v[156:159]
    v_mfma_f32_16x16x32_bf16 v[160:163], v[80:83], a[136:139], v[160:163]
    v_mfma_f32_16x16x32_bf16 v[164:167], v[84:87], a[136:139], v[164:167]
    v_mfma_f32_16x16x32_bf16 v[168:171], v[80:83], a[140:143], v[168:171]
    v_mfma_f32_16x16x32_bf16 v[172:175], v[84:87], a[140:143], v[172:175]
    v_mfma_f32_16x16x32_bf16 v[144:147], v[88:91], a[144:147], v[144:147]
    v_mfma_f32_16x16x32_bf16 v[148:151], v[92:95], a[144:147], v[148:151]
    v_mfma_f32_16x16x32_bf16 v[152:155], v[88:91], a[148:151], v[152:155]
    v_mfma_f32_16x16x32_bf16 v[156:159], v[92:95], a[148:151], v[156:159]
    v_mfma_f32_16x16x32_bf16 v[160:163], v[88:91], a[152:155], v[160:163]
    v_mfma_f32_16x16x32_bf16 v[164:167], v[92:95], a[152:155], v[164:167]
    v_mfma_f32_16x16x32_bf16 v[168:171], v[88:91], a[156:159], v[168:171]
    v_mfma_f32_16x16x32_bf16 v[172:175], v[92:95], a[156:159], v[172:175]
    v_mfma_f32_16x16x32_bf16 v[144:147], v[96:99], a[160:163], v[144:147]
    v_mfma_f32_16x16x32_bf16 v[148:151], v[100:103], a[160:163], v[148:151]
    v_mfma_f32_16x16x32_bf16 v[152:155], v[96:99], a[164:167], v[152:155]
    v_mfma_f32_16x16x32_bf16 v[156:159], v[100:103], a[164:167], v[156:159]
    v_mfma_f32_16x16x32_bf16 v[160:163], v[96:99], a[168:171], v[160:163]
    v_mfma_f32_16x16x32_bf16 v[164:167], v[100:103], a[168:171], v[164:167]
    v_mfma_f32_16x16x32_bf16 v[168:171], v[96:99], a[172:175], v[168:171]
    v_mfma_f32_16x16x32_bf16 v[172:175], v[100:103], a[172:175], v[172:175]
    v_mfma_f32_16x16x32_bf16 v[144:147], v[104:107], a[176:179], v[144:147]
    v_mfma_f32_16x16x32_bf16 v[148:151], v[108:111], a[176:179], v[148:151]
    v_mfma_f32_16x16x32_bf16 v[152:155], v[104:107], a[180:183], v[152:155]
    v_mfma_f32_16x16x32_bf16 v[156:159], v[108:111], a[180:183], v[156:159]
    v_mfma_f32_16x16x32_bf16 v[160:163], v[104:107], a[184:187], v[160:163]
    v_mfma_f32_16x16x32_bf16 v[164:167], v[108:111], a[184:187], v[164:167]
    v_mfma_f32_16x16x32_bf16 v[168:171], v[104:107], a[188:191], v[168:171]
    v_mfma_f32_16x16x32_bf16 v[172:175], v[108:111], a[188:191], v[172:175]
    v_mfma_f32_16x16x32_bf16 v[144:147], v[112:115], a[192:195], v[144:147]
    v_mfma_f32_16x16x32_bf16 v[148:151], v[116:119], a[192:195], v[148:151]
    v_mfma_f32_16x16x32_bf16 v[152:155], v[112:115], a[196:199], v[152:155]
    v_mfma_f32_16x16x32_bf16 v[156:159], v[116:119], a[196:199], v[156:159]
    v_mfma_f32_16x16x32_bf16 v[160:163], v[112:115], a[200:203], v[160:163]
    v_mfma_f32_16x16x32_bf16 v[164:167], v[116:119], a[200:203], v[164:167]
    v_mfma_f32_16x16x32_bf16 v[168:171], v[112:115], a[204:207], v[168:171]
    v_mfma_f32_16x16x32_bf16 v[172:175], v[116:119], a[204:207], v[172:175]
    v_mfma_f32_16x16x32_bf16 v[144:147], v[120:123], a[208:211], v[144:147]
    v_mfma_f32_16x16x32_bf16 v[148:151], v[124:127], a[208:211], v[148:151]
    v_mfma_f32_16x16x32_bf16 v[152:155], v[120:123], a[212:215], v[152:155]
    v_mfma_f32_16x16x32_bf16 v[156:159], v[124:127], a[212:215], v[156:159]
    v_mfma_f32_16x16x32_bf16 v[160:163], v[120:123], a[216:219], v[160:163]
    v_mfma_f32_16x16x32_bf16 v[164:167], v[124:127], a[216:219], v[164:167]
    v_mfma_f32_16x16x32_bf16 v[168:171], v[120:123], a[220:223], v[168:171]
    v_mfma_f32_16x16x32_bf16 v[172:175], v[124:127], a[220:223], v[172:175]
    v_mfma_f32_16x16x32_bf16 v[144:147], v[128:131], a[224:227], v[144:147]
    v_mfma_f32_16x16x32_bf16 v[148:151], v[132:135], a[224:227], v[148:151]
    v_mfma_f32_16x16x32_bf16 v[152:155], v[128:131], a[228:231], v[152:155]
    v_mfma_f32_16x16x32_bf16 v[156:159], v[132:135], a[228:231], v[156:159]
    v_mfma_f32_16x16x32_bf16 v[160:163], v[128:131], a[232:235], v[160:163]
    v_mfma_f32_16x16x32_bf16 v[164:167], v[132:135], a[232:235], v[164:167]
    v_mfma_f32_16x16x32_bf16 v[168:171], v[128:131], a[236:239], v[168:171]
    v_mfma_f32_16x16x32_bf16 v[172:175], v[132:135], a[236:239], v[172:175]
    v_mfma_f32_16x16x32_bf16 v[144:147], v[136:139], a[240:243], v[144:147]
    v_mfma_f32_16x16x32_bf16 v[148:151], v[140:143], a[240:243], v[148:151]
    v_mfma_f32_16x16x32_bf16 v[152:155], v[136:139], a[244:247], v[152:155]
    v_mfma_f32_16x16x32_bf16 v[156:159], v[140:143], a[244:247], v[156:159]
    v_mfma_f32_16x16x32_bf16 v[160:163], v[136:139], a[248:251], v[160:163]
    v_mfma_f32_16x16x32_bf16 v[164:167], v[140:143], a[248:251], v[164:167]
    v_mfma_f32_16x16x32_bf16 v[168:171], v[136:139], a[252:255], v[168:171]
    v_mfma_f32_16x16x32_bf16 v[172:175], v[140:143], a[252:255], v[172:175]
    s_add_u32 s32, s6, 0x4b16000
    s_addc_u32 s33, s7, 0
    s_and_b32 s33, s33, 0xffff
    s_mov_b32 s34, 0x400000
    s_mov_b32 s35, 0x20000
    s_sub_u32 s27, s31, 32
    s_lshl_b32 s27, s27, 11
    s_lshl_b32 s28, s20, 18
    s_add_u32 s27, s27, s28
    s_lshl_b32 s28, s29, 10
    s_add_u32 s27, s27, s28
    v_lshrrev_b32 v10, 2, v8
    v_lshlrev_b32 v10, 3, v10
    v_and_b32 v11, 3, v8
    v_add_u32 v10, v10, v11
    v_lshlrev_b32 v10, 4, v10
    v_lshl_add_u32 v10, v9, 16, v10
    v_cvt_pk_bf16_f32 v16, v144, v145
    v_cvt_pk_bf16_f32 v17, v146, v147
    v_cvt_pk_bf16_f32 v18, v148, v149
    v_cvt_pk_bf16_f32 v19, v150, v151
    buffer_store_dwordx4 v[16:19], v10, s[32:35], s27 offen offset:0 sc1
    v_cvt_pk_bf16_f32 v20, v152, v153
    v_cvt_pk_bf16_f32 v21, v154, v155
    v_cvt_pk_bf16_f32 v22, v156, v157
    v_cvt_pk_bf16_f32 v23, v158, v159
    buffer_store_dwordx4 v[20:23], v10, s[32:35], s27 offen offset:64 sc1
    v_cvt_pk_bf16_f32 v24, v160, v161
    v_cvt_pk_bf16_f32 v25, v162, v163
    v_cvt_pk_bf16_f32 v26, v164, v165
    v_cvt_pk_bf16_f32 v27, v166, v167
    buffer_store_dwordx4 v[24:27], v10, s[32:35], s27 offen offset:512 sc1
    v_cvt_pk_bf16_f32 v28, v168, v169
    v_cvt_pk_bf16_f32 v29, v170, v171
    v_cvt_pk_bf16_f32 v30, v172, v173
    v_cvt_pk_bf16_f32 v31, v174, v175
    buffer_store_dwordx4 v[28:31], v10, s[32:35], s27 offen offset:576 sc1
mkv_sig_111:
    s_waitcnt vmcnt(0)
    s_barrier
    s_cmp_lg_u32 s3, 0
    s_cbranch_scc1 w_loop
    s_lshl_b32 s90, s20, 8
    s_add_u32 s90, s90, 0x4000
    s_mov_b64 exec, 1
    v_mov_b32 v250, 0
    v_mov_b32 v251, 1
    buffer_atomic_add v251, v250, s[8:11], s90 offen
    s_mov_b64 exec, -1
    s_branch w_loop
main_kernel_exit_w:
    s_endpgm
.section .rodata,"a"
.p2align 6
.amdhsa_kernel main_kernel
  .amdhsa_next_free_vgpr 512
  .amdhsa_next_free_sgpr 102
  .amdhsa_accum_offset 256
  .amdhsa_group_segment_fixed_size 0
  .amdhsa_kernarg_size 136
  .amdhsa_user_sgpr_count 2
  .amdhsa_user_sgpr_kernarg_segment_ptr 1
  .amdhsa_system_sgpr_workgroup_id_x 1
.end_amdhsa_kernel
```
